```python
import torch

def _softmax(x, axis=-1):
    return torch.softmax(x, dim=axis)
def _gelu(x):
    return torch.nn.functional.gelu(x, approximate="tanh")
def _silu(x):
    return torch.nn.functional.silu(x)
def _sigmoid(x):
    return torch.sigmoid(x)
def _layernorm(x, axis=-1, eps=1e-5):
    m = x.mean(dim=axis, keepdim=True)
    v = x.var(dim=axis, keepdim=True, unbiased=False)
    return (x - m) / torch.sqrt(v + eps)
def _scatter_add(tgt, idx, src, axis=0):
    return tgt.clone().index_add_(axis, idx, src)
def _segment_sum(src, seg, n):
    out = torch.zeros((n,) + src.shape[1:], dtype=src.dtype)
    return out.index_add_(0, seg, src)
def _pad(x, pw):
    flat = tuple(v for pair in reversed(pw) for v in pair)
    return torch.nn.functional.pad(x, flat)

kernel_name = 'recurrent_scan__mha_block_cached__glu_gated_reglu__prompt'

def setup_inputs():

    _w = (lambda a: (lambda t: t.to(torch.bfloat16) if t.is_floating_point() else t)(torch.as_tensor(a)))
    def _A_setup():
        B, Sq, D = 1, 2048, 512
        H, Sk, Dh = 32, 2048, 128
        return {
            "x": _w((lambda *s: torch.randn(*s, dtype=torch.bfloat16) * 0.05)(B, Sq, D)),
            "k_cache": _w((lambda *s: torch.randn(*s, dtype=torch.bfloat16) * 1.6)(B, H, Sk, Dh)),
            "v_cache": _w((lambda *s: torch.randn(*s, dtype=torch.bfloat16) * 1.6)(B, H, Sk, Dh)),
            "wq": _w((lambda *s: torch.randn(*s, dtype=torch.bfloat16) * 1.6)(D, H * Dh) * (D ** -0.5)),
            "wo": _w((lambda *s: torch.randn(*s, dtype=torch.bfloat16) * 1.6)(H * Dh, D) * ((H * Dh) ** -0.5)),
        }
    _A_in = _A_setup()

    def _B_setup():
        B, S, D, F = 1, 2048, 512, 1792
        return {
            "x": _w((lambda *s: torch.randn(*s, dtype=torch.bfloat16) * 0.05)(B, S, D)),
            "W_gate": _w((lambda *s: torch.randn(*s, dtype=torch.bfloat16) * 0.2)(D, F) * (2.0 / D) ** 0.5),
            "W_up": _w((lambda *s: torch.randn(*s, dtype=torch.bfloat16) * 0.2)(D, F) * (2.0 / D) ** 0.5),
            "W_down": _w((lambda *s: torch.randn(*s, dtype=torch.bfloat16) * 0.2)(F, D) * (1.0 / F) ** 0.5),
        }
    _B_in = _B_setup()

    return {
        "A_x": _A_in["x"],
        "A_k_cache": _A_in["k_cache"],
        "A_v_cache": _A_in["v_cache"],
        "A_wq": _A_in["wq"],
        "A_wo": _A_in["wo"],
        "B_x": _B_in["x"],
        "B_W_gate": _B_in["W_gate"],
        "B_W_up": _B_in["W_up"],
        "B_W_down": _B_in["W_down"],
    }

def reference(A_x, A_k_cache, A_v_cache, A_wq, A_wo, B_x, B_W_gate, B_W_up, B_W_down):
    def _A_ref(x, k_cache, v_cache, wq, wo):
        B, Sq, D = x.shape
        H, Dh = 32, 128
        q = (lambda x, *d: x.permute(*d))((x @ wq).reshape(B, Sq, H, Dh), 0, 2, 1, 3)
        scores = torch.einsum("bhqd,bhkd->bhqk", q, k_cache) * (Dh ** -0.5)
        p = _softmax(scores, axis=-1)
        o = torch.einsum("bhqk,bhkd->bhqd", p, v_cache)
        return (lambda x, *d: x.permute(*d))(o, 0, 2, 1, 3).reshape(B, Sq, H * Dh) @ wo

    def _B_ref(x, W_gate, W_up, W_down):
        gate = torch.einsum("bsd,df->bsf", x, W_gate)
        up = torch.einsum("bsd,df->bsf", x, W_up)
        gate = gate * (lambda x, dt: x.to(dt))(gate > 0, gate.dtype)
        h = gate * up
        return torch.einsum("bsf,fd->bsd", h, W_down)

    x = A_x
    xn = _layernorm(x, axis=-1)
    s = _A_ref(xn, A_k_cache, A_v_cache, A_wq, A_wo)
    g = _silu(_B_ref(xn, B_W_gate, B_W_up, B_W_down))
    return x + s * g
```

```asm
; @launch grid=(256,1,1) block=(256,1,1) lds=149504
.amdgcn_target "amdgcn-amd-amdhsa--gfx950"
.text
.globl recurrent_scan__mha_block_cached__glu_gated_reglu__prompt_kernel
.p2align 8
.type recurrent_scan__mha_block_cached__glu_gated_reglu__prompt_kernel,@function
recurrent_scan__mha_block_cached__glu_gated_reglu__prompt_kernel:
KF_start:
    s_cmp_ge_u32 s2, 256
    s_cbranch_scc1 KF_end
    s_load_dwordx2 s[60:61], s[0:1], 0
    s_load_dwordx2 s[6:7], s[0:1], 24
    s_load_dwordx4 s[64:67], s[0:1], 48
    s_load_dwordx4 s[24:27], s[0:1], 8
    s_load_dwordx2 s[4:5], s[0:1], 88
    s_load_dwordx2 s[62:63], s[0:1], 80
    s_load_dwordx2 s[68:69], s[0:1], 72
    s_getpc_b64 s[96:97]
KF_pc_a:
    s_add_u32 s96, s96, KF_start-KF_pc_a
    s_addc_u32 s97, s97, -1
    s_lshr_b32 s98, s2, 3
    s_lshl_b32 s98, s98, 12
    v_lshlrev_b32 v2, 4, v0
    v_add_u32 v2, s98, v2
    v_min_u32 v2, KF_codeend-KF_start-16, v2
    global_load_dwordx4 a[240:243], v2, s[96:97]
    v_and_b32 v1, 63, v0
    v_lshrrev_b32 v2, 6, v0
    s_and_b32 s40, s2, 7
    s_lshl_b32 s40, s40, 2
    s_bfe_u32 s52, s2, 0x20003
    s_add_u32 s40, s40, s52
    v_readfirstlane_b32 s3, v2
    s_lshr_b32 s41, s2, 5
    s_min_u32 s43, s40, 27
    v_lshlrev_b32 v10, 4, v1
    s_lshl_b32 s42, s41, 2
    s_add_u32 s42, s42, s3
    v_lshrrev_b32 v2, 4, v1
    v_and_b32 v3, 15, v1
    v_lshrrev_b32 v4, 2, v3
    v_and_b32 v5, 3, v1
    v_and_b32 v6, 1, v2
    v_lshrrev_b32 v60, 3, v1
    v_lshlrev_b32 v60, 10, v60
    v_and_b32 v61, 7, v1
    v_xor_b32 v62, v61, v2
    v_lshl_add_u32 v11, v62, 4, v60
    v_xor_b32 v62, 4, v62
    v_lshl_add_u32 v12, v62, 4, v60
    v_add_u32 v12, 7168, v12
    v_add_u32 v13, 14336, v11
    v_add_u32 v14, 14336, v12
    s_lshl_b32 s95, s3, 13
    s_add_u32 s95, s95, 98304
    s_lshl_b32 s52, s3, 3
    s_and_b32 s53, s3, 1
    s_lshl_b32 s53, s53, 2
    v_or_b32 v60, s53, v2
    v_lshlrev_b32 v60, 1, v60
    v_xor_b32 v60, v3, v60
    v_lshlrev_b32 v60, 4, v60
    v_add_u32 v61, s52, v2
    v_lshl_add_u32 v15, v61, 13, v60
    v_add_u32 v16, 31744, v15
    v_lshrrev_b32 v60, 3, v1
    v_add_u32 v60, s52, v60
    s_movk_i32 s54, 3584
    v_mul_lo_u32 v60, v60, s54
    s_lshr_b32 s53, s53, 1
    v_or_b32 v61, s53, v6
    v_lshlrev_b32 v61, 1, v61
    v_and_b32 v62, 7, v1
    v_xor_b32 v61, v61, v62
    v_lshl_add_u32 v17, v61, 4, v60
    s_lshl_b32 s56, s3, 12
    s_lshl_b32 s45, s2, 13
    s_lshl_b32 s53, s3, 11
    s_add_u32 s45, s45, s53
    s_waitcnt lgkmcnt(0)
    s_lshl_b32 s52, s40, 8
    s_sub_u32 s53, 0x400000, s52
    s_add_u32 s12, s6, s52
    s_addc_u32 s13, s7, 0
    s_and_b32 s13, s13, 0xffff
    s_mov_b32 s14, s53
    s_mov_b32 s15, 0x20000
    s_lshl_b32 s52, s43, 7
    s_sub_u32 s53, 0x1c0000, s52
    s_add_u32 s16, s64, s52
    s_addc_u32 s17, s65, 0
    s_and_b32 s17, s17, 0xffff
    s_mov_b32 s18, s53
    s_mov_b32 s19, 0x20000
    s_add_u32 s20, s66, s52
    s_addc_u32 s21, s67, 0
    s_and_b32 s21, s21, 0xffff
    s_mov_b32 s22, s53
    s_mov_b32 s23, 0x20000
    s_lshl_b32 s52, s42, 16
    s_add_u32 s8, s60, s52
    s_addc_u32 s9, s61, 0
    s_and_b32 s9, s9, 0xffff
    s_mov_b32 s10, 0x10000
    s_mov_b32 s11, 0x20000
    s_mov_b32 s80, s60
    s_and_b32 s81, s61, 0xffff
    s_mov_b32 s82, 0x200000
    s_mov_b32 s83, 0x20000
    s_mov_b32 s46, s45
    s_mov_b32 s58, 0
    s_mov_b32 s59, 0
    s_add_u32 m0, s56, 0
    s_nop 0
    buffer_load_dwordx4 v15, s[12:15], s58 offen lds
    buffer_load_dwordx4 v16, s[12:15], s58 offen offset:1024 lds
    s_add_u32 m0, s56, 2048
    s_nop 0
    buffer_load_dwordx4 v17, s[16:19], s59 offen lds
    s_add_u32 m0, s56, 3072
    s_nop 0
    buffer_load_dwordx4 v17, s[20:23], s59 offen lds
    s_add_u32 m0, s56, 16384
    s_add_u32 s58, s58, 262144
    buffer_load_dwordx4 v15, s[12:15], s58 offen lds
    buffer_load_dwordx4 v16, s[12:15], s58 offen offset:1024 lds
    s_add_u32 m0, s56, 18432
    s_add_u32 s59, s59, 114688
    buffer_load_dwordx4 v17, s[16:19], s59 offen lds
    s_add_u32 m0, s56, 19456
    s_nop 0
    buffer_load_dwordx4 v17, s[20:23], s59 offen lds
    s_mov_b32 s57, 0
    s_mov_b32 m0, s95
    s_nop 0
    buffer_load_dwordx4 v11, s[8:11], s57 offen offset:0 lds
    buffer_load_dwordx4 v12, s[8:11], s57 offen offset:1024 lds
    buffer_load_dwordx4 v13, s[8:11], s57 offen offset:2048 lds
    buffer_load_dwordx4 v14, s[8:11], s57 offen offset:3072 lds
    s_add_u32 m0, s95, 4096
    s_add_u32 s57, s57, 32768
    buffer_load_dwordx4 v11, s[8:11], s57 offen offset:0 lds
    buffer_load_dwordx4 v12, s[8:11], s57 offen offset:1024 lds
    buffer_load_dwordx4 v13, s[8:11], s57 offen offset:2048 lds
    buffer_load_dwordx4 v14, s[8:11], s57 offen offset:3072 lds
    buffer_load_dwordx4 v[76:79], v10, s[80:83], s46 offen
    buffer_load_dwordx4 v[80:83], v10, s[80:83], s46 offen offset:1024
    s_mov_b32 s58, 524288
    s_mov_b32 s59, 229376
    s_add_u32 m0, s56, 32768
    s_nop 0
    buffer_load_dwordx4 v15, s[12:15], s58 offen lds
    buffer_load_dwordx4 v16, s[12:15], s58 offen offset:1024 lds
    s_add_u32 m0, s56, 34816
    s_nop 0
    buffer_load_dwordx4 v17, s[16:19], s59 offen lds
    s_add_u32 m0, s56, 35840
    s_nop 0
    buffer_load_dwordx4 v17, s[20:23], s59 offen lds
    s_add_u32 m0, s56, 49152
    s_add_u32 s58, s58, 262144
    buffer_load_dwordx4 v15, s[12:15], s58 offen lds
    buffer_load_dwordx4 v16, s[12:15], s58 offen offset:1024 lds
    s_add_u32 m0, s56, 51200
    s_add_u32 s59, s59, 114688
    buffer_load_dwordx4 v17, s[16:19], s59 offen lds
    s_add_u32 m0, s56, 52224
    s_nop 0
    buffer_load_dwordx4 v17, s[20:23], s59 offen lds
    s_mov_b32 s30, s26
    s_mov_b32 s31, s27
    s_mov_b32 s28, s24
    s_mov_b32 s29, s25
    s_lshl_b32 s52, s40, 19
    s_add_u32 s24, s28, s52
    s_addc_u32 s25, s29, 0
    s_and_b32 s25, s25, 0xffff
    s_mov_b32 s26, 0x80000
    s_mov_b32 s27, 0x20000
    s_add_u32 s28, s30, s52
    s_addc_u32 s29, s31, 0
    s_and_b32 s29, s29, 0xffff
    s_mov_b32 s30, 524288
    s_mov_b32 s31, 0x20000
    v_lshlrev_b32 v60, 1, v2
    v_xor_b32 v61, v3, v60
    v_lshlrev_b32 v61, 4, v61
    v_lshl_add_u32 v46, v2, 8, v61
    v_xor_b32 v61, 8, v60
    v_xor_b32 v61, v3, v61
    v_lshlrev_b32 v61, 4, v61
    v_lshl_add_u32 v47, v2, 8, v61
    s_mov_b32 s44, 0
    s_mov_b32 s70, 0x3e800000
    s_max_u32 s47, s3, 2
    s_sub_u32 s47, s47, 2
    s_lshl_b32 s47, s47, 13
    s_add_u32 s48, s3, 2
    s_lshl_b32 s48, s48, 13
    s_mul_i32 s52, s42, 229376
    s_lshl_b32 s53, s43, 13
    s_add_u32 s52, s52, s53
    s_add_u32 s52, s52, 0x400000
    s_add_u32 s32, s4, s52
    s_addc_u32 s33, s5, 0
    s_and_b32 s33, s33, 0xffff
    s_mov_b32 s34, 0x2000
    s_mov_b32 s35, 0x20000
    s_lshl_b32 s52, s42, 19
    s_lshl_b32 s53, s40, 14
    s_add_u32 s52, s52, s53
    s_add_u32 s52, s52, 0x1000000
    s_add_u32 s36, s4, s52
    s_addc_u32 s37, s5, 0
    s_and_b32 s37, s37, 0xffff
    s_mov_b32 s38, 0x4000
    s_mov_b32 s39, 0x20000
    s_mov_b32 s72, s62
    s_and_b32 s73, s63, 0xffff
    s_mov_b32 s74, 0x100
    s_mov_b32 s75, 0x20000
    s_add_u32 s76, s4, 0x0
    s_addc_u32 s77, s5, 0
    s_and_b32 s77, s77, 0xffff
    s_mov_b32 s78, 0x80000
    s_mov_b32 s79, 0x20000
    s_mov_b32 s84, s68
    s_and_b32 s85, s69, 0xffff
    s_mov_b32 s86, 0x200000
    s_mov_b32 s87, 0x20000
    v_lshl_add_u32 v60, v6, 2, v4
    v_lshlrev_b32 v61, 12, v2
    v_lshl_add_u32 v62, v4, 8, v61
    v_lshlrev_b32 v63, 1, v60
    v_add_u32 v64, 0, v5
    v_xor_b32 v64, v64, v63
    v_lshl_add_u32 v18, v64, 4, v62
    v_add_u32 v64, 4, v5
    v_xor_b32 v64, v64, v63
    v_lshl_add_u32 v19, v64, 4, v62
    v_add_u32 v64, 8, v5
    v_xor_b32 v64, v64, v63
    v_lshl_add_u32 v20, v64, 4, v62
    v_add_u32 v64, 12, v5
    v_xor_b32 v64, v64, v63
    v_lshl_add_u32 v21, v64, 4, v62
    v_lshl_add_u32 v62, v4, 7, v61
    v_add_u32 v62, 2048, v62
    v_and_b32 v64, 1, v5
    v_lshl_add_u32 v62, v64, 3, v62
    v_lshrrev_b32 v63, 1, v4
    v_lshl_add_u32 v63, v6, 1, v63
    v_lshlrev_b32 v63, 1, v63
    v_lshrrev_b32 v8, 1, v5
    v_add_u32 v64, 0, v8
    v_xor_b32 v64, v64, v63
    v_lshl_add_u32 v22, v64, 4, v62
    v_add_u32 v64, 2, v8
    v_xor_b32 v64, v64, v63
    v_lshl_add_u32 v23, v64, 4, v62
    v_add_u32 v64, 4, v8
    v_xor_b32 v64, v64, v63
    v_lshl_add_u32 v24, v64, 4, v62
    v_add_u32 v64, 6, v8
    v_xor_b32 v64, v64, v63
    v_lshl_add_u32 v25, v64, 4, v62
    s_cmp_lt_u32 s3, 2
    s_cbranch_scc0 KF_cs_g
    s_cmp_eq_u32 s3, 0
    s_cbranch_scc0 KF_cs_1
    v_add_u32 v26, 0, v18
    v_add_u32 v27, 1024, v18
    v_add_u32 v28, 8, v18
    v_add_u32 v29, 1032, v18
    v_add_u32 v30, 0, v19
    v_add_u32 v31, 1024, v19
    v_add_u32 v32, 8, v19
    v_add_u32 v33, 1032, v19
    s_branch KF_cs_done
KF_cs_1:
    v_add_u32 v26, 0, v20
    v_add_u32 v27, 1024, v20
    v_add_u32 v28, 8, v20
    v_add_u32 v29, 1032, v20
    v_add_u32 v30, 0, v21
    v_add_u32 v31, 1024, v21
    v_add_u32 v32, 8, v21
    v_add_u32 v33, 1032, v21
    s_branch KF_cs_done
KF_cs_g:
    s_sub_u32 s52, s3, 2
    s_lshl_b32 s52, s52, 10
    v_add_u32 v26, 0, v22
    v_add_u32 v26, s52, v26
    v_add_u32 v27, 512, v22
    v_add_u32 v27, s52, v27
    v_add_u32 v28, 0, v23
    v_add_u32 v28, s52, v28
    v_add_u32 v29, 512, v23
    v_add_u32 v29, s52, v29
    v_add_u32 v30, 0, v24
    v_add_u32 v30, s52, v30
    v_add_u32 v31, 512, v24
    v_add_u32 v31, s52, v31
    v_add_u32 v32, 0, v25
    v_add_u32 v32, s52, v32
    v_add_u32 v33, 512, v25
    v_add_u32 v33, s52, v33
KF_cs_done:
    v_and_b32 v63, 7, v1
    v_lshlrev_b32 v63, 1, v63
    v_lshlrev_b32 v62, 8, v3
    v_add_u32 v64, 0, v2
    v_xor_b32 v64, v64, v63
    v_lshl_add_u32 v34, v64, 4, v62
    v_add_u32 v64, 4, v2
    v_xor_b32 v64, v64, v63
    v_lshl_add_u32 v35, v64, 4, v62
    v_add_u32 v64, 8, v2
    v_xor_b32 v64, v64, v63
    v_lshl_add_u32 v36, v64, 4, v62
    v_add_u32 v64, 12, v2
    v_xor_b32 v64, v64, v63
    v_lshl_add_u32 v37, v64, 4, v62
    v_lshl_add_u32 v62, v2, 2, v4
    v_lshlrev_b32 v62, 8, v62
    v_and_b32 v64, 1, v5
    v_lshl_add_u32 v62, v64, 3, v62
    v_add_u32 v62, 0x10000, v62
    v_lshlrev_b32 v63, 1, v60
    v_add_u32 v64, 0, v8
    v_xor_b32 v64, v64, v63
    v_lshl_add_u32 v38, v64, 4, v62
    v_add_u32 v64, 2, v8
    v_xor_b32 v64, v64, v63
    v_lshl_add_u32 v39, v64, 4, v62
    v_add_u32 v64, 4, v8
    v_xor_b32 v64, v64, v63
    v_lshl_add_u32 v40, v64, 4, v62
    v_add_u32 v64, 6, v8
    v_xor_b32 v64, v64, v63
    v_lshl_add_u32 v41, v64, 4, v62
    v_add_u32 v64, 8, v8
    v_xor_b32 v64, v64, v63
    v_lshl_add_u32 v42, v64, 4, v62
    v_add_u32 v64, 10, v8
    v_xor_b32 v64, v64, v63
    v_lshl_add_u32 v43, v64, 4, v62
    v_add_u32 v64, 12, v8
    v_xor_b32 v64, v64, v63
    v_lshl_add_u32 v44, v64, 4, v62
    v_add_u32 v64, 14, v8
    v_xor_b32 v64, v64, v63
    v_lshl_add_u32 v45, v64, 4, v62
    v_mov_b32 v104, 0x3f803f80
    v_mov_b32 v105, 0x3f803f80
    v_mov_b32 v106, 0x3f803f80
    v_mov_b32 v107, 0x3f803f80
    s_load_dwordx2 s[60:61], s[0:1], 32
    s_load_dwordx2 s[64:65], s[0:1], 64
    s_lshl_b32 s52, s41, 2
    v_mov_b32 v75, s52
    v_lshrrev_b32 v60, 1, v3
    v_xor_b32 v60, v60, v2
    v_lshlrev_b32 v61, 7, v3
    v_add_u32 v61, s95, v61
    v_lshl_add_u32 v6, v60, 4, v61
    v_xor_b32 v60, 4, v60
    v_lshl_add_u32 v7, v60, 4, v61
    s_waitcnt vmcnt(8) lgkmcnt(0)
    v_lshlrev_b32 v84, 16, v76
    v_and_b32 v85, 0xffff0000, v76
    v_lshlrev_b32 v86, 16, v77
    v_and_b32 v87, 0xffff0000, v77
    v_lshlrev_b32 v88, 16, v78
    v_and_b32 v89, 0xffff0000, v78
    v_lshlrev_b32 v90, 16, v79
    v_and_b32 v91, 0xffff0000, v79
    v_lshlrev_b32 v92, 16, v80
    v_and_b32 v93, 0xffff0000, v80
    v_lshlrev_b32 v94, 16, v81
    v_and_b32 v95, 0xffff0000, v81
    v_lshlrev_b32 v96, 16, v82
    v_and_b32 v97, 0xffff0000, v82
    v_lshlrev_b32 v98, 16, v83
    v_and_b32 v99, 0xffff0000, v83
    v_add_f32 v108, v84, v85
    v_add_f32 v109, v92, v93
    v_add_f32 v108, v108, v86
    v_add_f32 v109, v109, v94
    v_add_f32 v108, v108, v87
    v_add_f32 v109, v109, v95
    v_add_f32 v108, v108, v88
    v_add_f32 v109, v109, v96
    v_add_f32 v108, v108, v89
    v_add_f32 v109, v109, v97
    v_add_f32 v108, v108, v90
    v_add_f32 v109, v109, v98
    v_add_f32 v108, v108, v91
    v_add_f32 v109, v109, v99
    s_nop 1
    v_add_f32_dpp v108, v108, v108 quad_perm:[1,0,3,2] row_mask:0xf bank_mask:0xf
    v_add_f32_dpp v109, v109, v109 quad_perm:[1,0,3,2] row_mask:0xf bank_mask:0xf
    s_nop 1
    v_add_f32_dpp v108, v108, v108 quad_perm:[2,3,0,1] row_mask:0xf bank_mask:0xf
    v_add_f32_dpp v109, v109, v109 quad_perm:[2,3,0,1] row_mask:0xf bank_mask:0xf
    s_nop 1
    v_add_f32_dpp v108, v108, v108 row_half_mirror row_mask:0xf bank_mask:0xf
    v_add_f32_dpp v109, v109, v109 row_half_mirror row_mask:0xf bank_mask:0xf
    s_nop 1
    v_add_f32_dpp v108, v108, v108 row_mirror row_mask:0xf bank_mask:0xf
    v_add_f32_dpp v109, v109, v109 row_mirror row_mask:0xf bank_mask:0xf
    v_mov_b32 v76, v108
    v_mov_b32 v77, v109
    s_nop 1
    v_permlane16_swap_b32 v108, v76
    v_permlane16_swap_b32 v109, v77
    s_nop 1
    v_add_f32 v108, v108, v76
    v_add_f32 v109, v109, v77
    v_mov_b32 v76, v108
    v_mov_b32 v77, v109
    s_nop 1
    v_permlane32_swap_b32 v108, v76
    v_permlane32_swap_b32 v109, v77
    s_nop 1
    v_add_f32 v108, v108, v76
    v_add_f32 v109, v109, v77
    s_mov_b32 s52, 0x3b000000
    v_mul_f32 v108, s52, v108
    v_mul_f32 v109, s52, v109
    v_sub_f32 v84, v84, v108
    v_sub_f32 v92, v92, v109
    v_sub_f32 v85, v85, v108
    v_sub_f32 v93, v93, v109
    v_sub_f32 v86, v86, v108
    v_sub_f32 v94, v94, v109
    v_sub_f32 v87, v87, v108
    v_sub_f32 v95, v95, v109
    v_sub_f32 v88, v88, v108
    v_sub_f32 v96, v96, v109
    v_sub_f32 v89, v89, v108
    v_sub_f32 v97, v97, v109
    v_sub_f32 v90, v90, v108
    v_sub_f32 v98, v98, v109
    v_sub_f32 v91, v91, v108
    v_sub_f32 v99, v99, v109
    v_mul_f32 v110, v84, v84
    v_mul_f32 v111, v92, v92
    v_fmac_f32 v110, v85, v85
    v_fmac_f32 v111, v93, v93
    v_fmac_f32 v110, v86, v86
    v_fmac_f32 v111, v94, v94
    v_fmac_f32 v110, v87, v87
    v_fmac_f32 v111, v95, v95
    v_fmac_f32 v110, v88, v88
    v_fmac_f32 v111, v96, v96
    v_fmac_f32 v110, v89, v89
    v_fmac_f32 v111, v97, v97
    v_fmac_f32 v110, v90, v90
    v_fmac_f32 v111, v98, v98
    v_fmac_f32 v110, v91, v91
    v_fmac_f32 v111, v99, v99
    s_nop 1
    v_add_f32_dpp v110, v110, v110 quad_perm:[1,0,3,2] row_mask:0xf bank_mask:0xf
    v_add_f32_dpp v111, v111, v111 quad_perm:[1,0,3,2] row_mask:0xf bank_mask:0xf
    s_nop 1
    v_add_f32_dpp v110, v110, v110 quad_perm:[2,3,0,1] row_mask:0xf bank_mask:0xf
    v_add_f32_dpp v111, v111, v111 quad_perm:[2,3,0,1] row_mask:0xf bank_mask:0xf
    s_nop 1
    v_add_f32_dpp v110, v110, v110 row_half_mirror row_mask:0xf bank_mask:0xf
    v_add_f32_dpp v111, v111, v111 row_half_mirror row_mask:0xf bank_mask:0xf
    s_nop 1
    v_add_f32_dpp v110, v110, v110 row_mirror row_mask:0xf bank_mask:0xf
    v_add_f32_dpp v111, v111, v111 row_mirror row_mask:0xf bank_mask:0xf
    v_mov_b32 v76, v110
    v_mov_b32 v77, v111
    s_nop 1
    v_permlane16_swap_b32 v110, v76
    v_permlane16_swap_b32 v111, v77
    s_nop 1
    v_add_f32 v110, v110, v76
    v_add_f32 v111, v111, v77
    v_mov_b32 v76, v110
    v_mov_b32 v77, v111
    s_nop 1
    v_permlane32_swap_b32 v110, v76
    v_permlane32_swap_b32 v111, v77
    s_nop 1
    v_add_f32 v110, v110, v76
    v_add_f32 v111, v111, v77
    v_mul_f32 v110, s52, v110
    v_mul_f32 v111, s52, v111
    v_cvt_pk_bf16_f32 v78, v108, v109
    v_cvt_pk_bf16_f32 v79, v110, v111
    v_lshlrev_b32 v80, 16, v78
    v_and_b32 v82, 0xffff0000, v78
    v_lshlrev_b32 v110, 16, v79
    v_and_b32 v111, 0xffff0000, v79
    v_add_f32 v110, 0x3727c5ac, v110
    v_add_f32 v111, 0x3727c5ac, v111
    v_cvt_pk_bf16_f32 v79, v110, v111
    v_lshlrev_b32 v110, 16, v79
    v_and_b32 v111, 0xffff0000, v79
    v_sqrt_f32 v110, v110
    v_sqrt_f32 v111, v111
    s_nop 0
    v_cvt_pk_bf16_f32 v79, v110, v111
    v_lshlrev_b32 v110, 16, v79
    v_and_b32 v111, 0xffff0000, v79
    v_rcp_f32 v81, v110
    v_rcp_f32 v83, v111
    s_lshl_b32 s52, s2, 6
    s_lshl_b32 s53, s3, 4
    s_add_u32 s52, s52, s53
    v_mov_b32 v84, 0
    s_mov_b64 s[96:97], exec
    s_mov_b64 exec, 1
    buffer_store_dwordx4 v[80:83], v84, s[76:79], s52 offen sc1
    s_lshl_b32 s63, s41, 2
    s_lshr_b32 s53, s40, 3
    s_add_u32 s63, s63, s53
    s_lshl_b32 s63, s63, 7
    s_and_b32 s53, s40, 7
    s_lshl_b32 s53, s53, 2
    s_add_u32 s63, s63, s53
    s_add_u32 s63, s63, 0x10000
    s_bfe_u32 s62, s2, 0x10002
    s_lshl_b32 s62, s62, 3
    s_lshr_b32 s53, s2, 5
    s_add_u32 s62, s62, s53
    s_lshl_b32 s62, s62, 2
    s_bfe_u32 s53, s2, 0x20003
    s_add_u32 s62, s62, s53
    s_lshl_b32 s62, s62, 7
    s_and_b32 s53, s2, 3
    s_lshl_b32 s53, s53, 2
    s_add_u32 s62, s62, s53
    s_add_u32 s62, s62, 0x11000
    buffer_store_dword v84, v84, s[76:79], s63 offen sc1
    buffer_store_dword v84, v84, s[76:79], s62 offen sc1
    buffer_store_dword v84, v84, s[76:79], s62 offen offset:16 sc1
    buffer_store_dword v84, v84, s[76:79], s62 offen offset:32 sc1
    s_mov_b64 exec, s[96:97]
    s_waitcnt vmcnt(15)
    ds_read_b128 a[128:131], v6 offset:0
    ds_read_b128 a[132:135], v6 offset:2048
    ds_read_b128 a[136:139], v6 offset:4096
    ds_read_b128 a[140:143], v6 offset:6144
    ds_read_b128 a[144:147], v7 offset:0
    ds_read_b128 a[148:151], v7 offset:2048
    ds_read_b128 a[152:155], v7 offset:4096
    ds_read_b128 a[156:159], v7 offset:6144
    s_barrier
    ds_read_b64_tr_b16 a[192:193], v18 offset:0
    ds_read_b64_tr_b16 a[194:195], v18 offset:1024
    ds_read_b64_tr_b16 a[196:197], v18 offset:16384
    ds_read_b64_tr_b16 a[198:199], v18 offset:17408
    ds_read_b64_tr_b16 a[200:201], v18 offset:8
    ds_read_b64_tr_b16 a[202:203], v18 offset:1032
    ds_read_b64_tr_b16 a[204:205], v18 offset:16392
    ds_read_b64_tr_b16 a[206:207], v18 offset:17416
    ds_read_b64_tr_b16 a[208:209], v19 offset:0
    ds_read_b64_tr_b16 a[210:211], v19 offset:1024
    ds_read_b64_tr_b16 a[212:213], v19 offset:16384
    ds_read_b64_tr_b16 a[214:215], v19 offset:17408
    s_waitcnt lgkmcnt(8)
    v_mfma_f32_16x16x32_bf16 v[128:131], a[192:195], a[128:131], 0
    s_mov_b32 s57, 128
    ds_read_b64_tr_b16 a[216:217], v19 offset:8
    ds_read_b64_tr_b16 a[218:219], v19 offset:1032
    v_mfma_f32_16x16x32_bf16 v[128:131], a[196:199], a[144:147], v[128:131]
    s_mov_b32 m0, s95
    ds_read_b64_tr_b16 a[220:221], v19 offset:16392
    ds_read_b64_tr_b16 a[222:223], v19 offset:17416
    v_mfma_f32_16x16x32_bf16 v[132:135], a[192:195], a[132:135], 0
    buffer_load_dwordx4 v11, s[8:11], s57 offen offset:0 lds
    v_mfma_f32_16x16x32_bf16 v[132:135], a[196:199], a[148:151], v[132:135]
    v_mfma_f32_16x16x32_bf16 v[136:139], a[192:195], a[136:139], 0
    v_mfma_f32_16x16x32_bf16 v[136:139], a[196:199], a[152:155], v[136:139]
    v_mfma_f32_16x16x32_bf16 v[140:143], a[192:195], a[140:143], 0
    buffer_load_dwordx4 v12, s[8:11], s57 offen offset:1024 lds
    v_mfma_f32_16x16x32_bf16 v[140:143], a[196:199], a[156:159], v[140:143]
    s_waitcnt lgkmcnt(8)
    v_mfma_f32_16x16x32_bf16 v[144:147], a[200:203], a[128:131], 0
    ds_read_b64_tr_b16 a[192:193], v20 offset:0
    ds_read_b64_tr_b16 a[194:195], v20 offset:1024
    v_mfma_f32_16x16x32_bf16 v[144:147], a[204:207], a[144:147], v[144:147]
    ds_read_b64_tr_b16 a[196:197], v20 offset:16384
    ds_read_b64_tr_b16 a[198:199], v20 offset:17408
    v_mfma_f32_16x16x32_bf16 v[148:151], a[200:203], a[132:135], 0
    buffer_load_dwordx4 v13, s[8:11], s57 offen offset:2048 lds
    v_mfma_f32_16x16x32_bf16 v[148:151], a[204:207], a[148:151], v[148:151]
    v_mfma_f32_16x16x32_bf16 v[152:155], a[200:203], a[136:139], 0
    v_mfma_f32_16x16x32_bf16 v[152:155], a[204:207], a[152:155], v[152:155]
    v_mfma_f32_16x16x32_bf16 v[156:159], a[200:203], a[140:143], 0
    buffer_load_dwordx4 v14, s[8:11], s57 offen offset:3072 lds
    v_mfma_f32_16x16x32_bf16 v[156:159], a[204:207], a[156:159], v[156:159]
    s_waitcnt lgkmcnt(8)
    v_mfma_f32_16x16x32_bf16 v[160:163], a[208:211], a[128:131], 0
    s_add_u32 m0, s95, 4096
    ds_read_b64_tr_b16 a[200:201], v20 offset:8
    ds_read_b64_tr_b16 a[202:203], v20 offset:1032
    v_mfma_f32_16x16x32_bf16 v[160:163], a[212:215], a[144:147], v[160:163]
    s_add_u32 s57, s57, 32768
    ds_read_b64_tr_b16 a[204:205], v20 offset:16392
    ds_read_b64_tr_b16 a[206:207], v20 offset:17416
    v_mfma_f32_16x16x32_bf16 v[164:167], a[208:211], a[132:135], 0
    buffer_load_dwordx4 v11, s[8:11], s57 offen offset:0 lds
    v_mfma_f32_16x16x32_bf16 v[164:167], a[212:215], a[148:151], v[164:167]
    v_mfma_f32_16x16x32_bf16 v[168:171], a[208:211], a[136:139], 0
    v_mfma_f32_16x16x32_bf16 v[168:171], a[212:215], a[152:155], v[168:171]
    v_mfma_f32_16x16x32_bf16 v[172:175], a[208:211], a[140:143], 0
    buffer_load_dwordx4 v12, s[8:11], s57 offen offset:1024 lds
    v_mfma_f32_16x16x32_bf16 v[172:175], a[212:215], a[156:159], v[172:175]
    s_waitcnt lgkmcnt(8)
    v_mfma_f32_16x16x32_bf16 v[176:179], a[216:219], a[128:131], 0
    ds_read_b64_tr_b16 a[208:209], v21 offset:0
    ds_read_b64_tr_b16 a[210:211], v21 offset:1024
    v_mfma_f32_16x16x32_bf16 v[176:179], a[220:223], a[144:147], v[176:179]
    ds_read_b64_tr_b16 a[212:213], v21 offset:16384
    ds_read_b64_tr_b16 a[214:215], v21 offset:17408
    v_mfma_f32_16x16x32_bf16 v[180:183], a[216:219], a[132:135], 0
    buffer_load_dwordx4 v13, s[8:11], s57 offen offset:2048 lds
    v_mfma_f32_16x16x32_bf16 v[180:183], a[220:223], a[148:151], v[180:183]
    v_mfma_f32_16x16x32_bf16 v[184:187], a[216:219], a[136:139], 0
    v_mfma_f32_16x16x32_bf16 v[184:187], a[220:223], a[152:155], v[184:187]
    v_mfma_f32_16x16x32_bf16 v[188:191], a[216:219], a[140:143], 0
    buffer_load_dwordx4 v14, s[8:11], s57 offen offset:3072 lds
    v_mfma_f32_16x16x32_bf16 v[188:191], a[220:223], a[156:159], v[188:191]
    s_waitcnt lgkmcnt(8)
    s_mov_b32 s58, 1048576
    v_mfma_f32_16x16x32_bf16 v[192:195], a[192:195], a[128:131], 0
    s_mov_b32 s59, 458752
    ds_read_b64_tr_b16 a[216:217], v21 offset:8
    ds_read_b64_tr_b16 a[218:219], v21 offset:1032
    v_mfma_f32_16x16x32_bf16 v[192:195], a[196:199], a[144:147], v[192:195]
    s_add_u32 m0, s56, 65536
    ds_read_b64_tr_b16 a[220:221], v21 offset:16392
    ds_read_b64_tr_b16 a[222:223], v21 offset:17416
    v_mfma_f32_16x16x32_bf16 v[196:199], a[192:195], a[132:135], 0
    buffer_load_dwordx4 v15, s[12:15], s58 offen lds
    v_mfma_f32_16x16x32_bf16 v[196:199], a[196:199], a[148:151], v[196:199]
    v_mfma_f32_16x16x32_bf16 v[200:203], a[192:195], a[136:139], 0
    v_mfma_f32_16x16x32_bf16 v[200:203], a[196:199], a[152:155], v[200:203]
    v_mfma_f32_16x16x32_bf16 v[204:207], a[192:195], a[140:143], 0
    buffer_load_dwordx4 v16, s[12:15], s58 offen offset:1024 lds
    v_mfma_f32_16x16x32_bf16 v[204:207], a[196:199], a[156:159], v[204:207]
    s_waitcnt lgkmcnt(8)
    v_mfma_f32_16x16x32_bf16 v[208:211], a[200:203], a[128:131], 0
    ds_read_b64_tr_b16 a[192:193], v22 offset:0
    ds_read_b64_tr_b16 a[194:195], v22 offset:512
    v_mfma_f32_16x16x32_bf16 v[208:211], a[204:207], a[144:147], v[208:211]
    s_add_u32 m0, s56, 67584
    ds_read_b64_tr_b16 a[196:197], v22 offset:16384
    ds_read_b64_tr_b16 a[198:199], v22 offset:16896
    v_mfma_f32_16x16x32_bf16 v[212:215], a[200:203], a[132:135], 0
    buffer_load_dwordx4 v17, s[16:19], s59 offen lds
    v_mfma_f32_16x16x32_bf16 v[212:215], a[204:207], a[148:151], v[212:215]
    v_mfma_f32_16x16x32_bf16 v[216:219], a[200:203], a[136:139], 0
    v_mfma_f32_16x16x32_bf16 v[216:219], a[204:207], a[152:155], v[216:219]
    s_add_u32 m0, s56, 68608
    v_mfma_f32_16x16x32_bf16 v[220:223], a[200:203], a[140:143], 0
    buffer_load_dwordx4 v17, s[20:23], s59 offen lds
    v_mfma_f32_16x16x32_bf16 v[220:223], a[204:207], a[156:159], v[220:223]
    s_waitcnt lgkmcnt(8)
    v_mfma_f32_16x16x32_bf16 v[224:227], a[208:211], a[128:131], 0
    s_add_u32 m0, s56, 81920
    ds_read_b64_tr_b16 a[200:201], v23 offset:0
    ds_read_b64_tr_b16 a[202:203], v23 offset:512
    v_mfma_f32_16x16x32_bf16 v[224:227], a[212:215], a[144:147], v[224:227]
    s_add_u32 s58, s58, 262144
    ds_read_b64_tr_b16 a[204:205], v23 offset:16384
    ds_read_b64_tr_b16 a[206:207], v23 offset:16896
    v_mfma_f32_16x16x32_bf16 v[228:231], a[208:211], a[132:135], 0
    buffer_load_dwordx4 v15, s[12:15], s58 offen lds
    v_mfma_f32_16x16x32_bf16 v[228:231], a[212:215], a[148:151], v[228:231]
    ds_read_b64_tr_b16 a[224:225], v26 offset:0
    ds_read_b64_tr_b16 a[226:227], v27 offset:0
    v_mfma_f32_16x16x32_bf16 v[232:235], a[208:211], a[136:139], 0
    v_mfma_f32_16x16x32_bf16 v[232:235], a[212:215], a[152:155], v[232:235]
    ds_read_b64_tr_b16 a[228:229], v26 offset:16384
    ds_read_b64_tr_b16 a[230:231], v27 offset:16384
    v_mfma_f32_16x16x32_bf16 v[236:239], a[208:211], a[140:143], 0
    buffer_load_dwordx4 v16, s[12:15], s58 offen offset:1024 lds
    v_mfma_f32_16x16x32_bf16 v[236:239], a[212:215], a[156:159], v[236:239]
    s_waitcnt lgkmcnt(12)
    v_mfma_f32_16x16x32_bf16 v[240:243], a[216:219], a[128:131], 0
    s_add_u32 m0, s56, 83968
    ds_read_b64_tr_b16 a[208:209], v24 offset:0
    ds_read_b64_tr_b16 a[210:211], v24 offset:512
    v_mfma_f32_16x16x32_bf16 v[240:243], a[220:223], a[144:147], v[240:243]
    s_add_u32 s59, s59, 114688
    ds_read_b64_tr_b16 a[212:213], v24 offset:16384
    ds_read_b64_tr_b16 a[214:215], v24 offset:16896
    v_mfma_f32_16x16x32_bf16 v[244:247], a[216:219], a[132:135], 0
    buffer_load_dwordx4 v17, s[16:19], s59 offen lds
    v_mfma_f32_16x16x32_bf16 v[244:247], a[220:223], a[148:151], v[244:247]
    ds_read_b64_tr_b16 a[232:233], v28 offset:0
    ds_read_b64_tr_b16 a[234:235], v29 offset:0
    v_mfma_f32_16x16x32_bf16 v[248:251], a[216:219], a[136:139], 0
    v_mfma_f32_16x16x32_bf16 v[248:251], a[220:223], a[152:155], v[248:251]
    s_add_u32 m0, s56, 84992
    ds_read_b64_tr_b16 a[236:237], v28 offset:16384
    ds_read_b64_tr_b16 a[238:239], v29 offset:16384
    v_mfma_f32_16x16x32_bf16 v[252:255], a[216:219], a[140:143], 0
    buffer_load_dwordx4 v17, s[20:23], s59 offen lds
    v_mfma_f32_16x16x32_bf16 v[252:255], a[220:223], a[156:159], v[252:255]
    s_waitcnt lgkmcnt(15)
    v_mfma_f32_16x16x32_bf16 a[0:3], a[192:195], a[128:131], 0
    ds_read_b64_tr_b16 a[216:217], v25 offset:0
    ds_read_b64_tr_b16 a[218:219], v25 offset:512
    v_mfma_f32_16x16x32_bf16 a[0:3], a[196:199], a[144:147], a[0:3]
    ds_read_b64_tr_b16 a[220:221], v25 offset:16384
    ds_read_b64_tr_b16 a[222:223], v25 offset:16896
    v_mfma_f32_16x16x32_bf16 a[4:7], a[192:195], a[132:135], 0
    v_mfma_f32_16x16x32_bf16 a[4:7], a[196:199], a[148:151], a[4:7]
    ds_read_b64_tr_b16 a[240:241], v30 offset:0
    ds_read_b64_tr_b16 a[242:243], v31 offset:0
    v_mfma_f32_16x16x32_bf16 a[8:11], a[192:195], a[136:139], 0
    v_mfma_f32_16x16x32_bf16 a[8:11], a[196:199], a[152:155], a[8:11]
    ds_read_b64_tr_b16 a[244:245], v30 offset:16384
    ds_read_b64_tr_b16 a[246:247], v31 offset:16384
    v_mfma_f32_16x16x32_bf16 a[12:15], a[192:195], a[140:143], 0
    v_mfma_f32_16x16x32_bf16 a[12:15], a[196:199], a[156:159], a[12:15]
    s_waitcnt lgkmcnt(15)
    v_mfma_f32_16x16x32_bf16 a[16:19], a[200:203], a[128:131], 0
    ds_read_b64_tr_b16 a[192:193], v22 offset:1024
    ds_read_b64_tr_b16 a[194:195], v22 offset:1536
    v_mfma_f32_16x16x32_bf16 a[16:19], a[204:207], a[144:147], a[16:19]
    ds_read_b64_tr_b16 a[196:197], v22 offset:17408
    ds_read_b64_tr_b16 a[198:199], v22 offset:17920
    v_mfma_f32_16x16x32_bf16 a[20:23], a[200:203], a[132:135], 0
    s_waitcnt vmcnt(8)
    v_mfma_f32_16x16x32_bf16 a[20:23], a[204:207], a[148:151], a[20:23]
    ds_read_b64_tr_b16 a[248:249], v32 offset:0
    ds_read_b64_tr_b16 a[250:251], v33 offset:0
    ds_read_b128 a[160:163], v6 offset:0
    ds_read_b128 a[164:167], v6 offset:2048
    v_mfma_f32_16x16x32_bf16 a[24:27], a[200:203], a[136:139], 0
    v_mfma_f32_16x16x32_bf16 a[24:27], a[204:207], a[152:155], a[24:27]
    ds_read_b64_tr_b16 a[252:253], v32 offset:16384
    ds_read_b64_tr_b16 a[254:255], v33 offset:16384
    ds_read_b128 a[168:171], v6 offset:4096
    ds_read_b128 a[172:175], v6 offset:6144
    v_mfma_f32_16x16x32_bf16 a[28:31], a[200:203], a[140:143], 0
    v_mfma_f32_16x16x32_bf16 a[28:31], a[204:207], a[156:159], a[28:31]
    s_waitcnt lgkmcnt(15)
    v_mfma_f32_16x16x32_bf16 a[32:35], a[208:211], a[128:131], 0
    ds_read_b64_tr_b16 a[200:201], v23 offset:1024
    ds_read_b64_tr_b16 a[202:203], v23 offset:1536
    v_mfma_f32_16x16x32_bf16 a[32:35], a[212:215], a[144:147], a[32:35]
    ds_read_b64_tr_b16 a[204:205], v23 offset:17408
    ds_read_b64_tr_b16 a[206:207], v23 offset:17920
    v_mfma_f32_16x16x32_bf16 a[36:39], a[208:211], a[132:135], 0
    v_mfma_f32_16x16x32_bf16 a[36:39], a[212:215], a[148:151], a[36:39]
    ds_read_b128 a[176:179], v7 offset:0
    ds_read_b128 a[180:183], v7 offset:2048
    v_mfma_f32_16x16x32_bf16 a[40:43], a[208:211], a[136:139], 0
    v_mfma_f32_16x16x32_bf16 a[40:43], a[212:215], a[152:155], a[40:43]
    ds_read_b128 a[184:187], v7 offset:4096
    ds_read_b128 a[188:191], v7 offset:6144
    v_mfma_f32_16x16x32_bf16 a[44:47], a[208:211], a[140:143], 0
    v_mfma_f32_16x16x32_bf16 a[44:47], a[212:215], a[156:159], a[44:47]
    s_waitcnt lgkmcnt(15)
    v_mfma_f32_16x16x32_bf16 a[48:51], a[216:219], a[128:131], 0
    ds_read_b64_tr_b16 a[208:209], v24 offset:1024
    ds_read_b64_tr_b16 a[210:211], v24 offset:1536
    v_mfma_f32_16x16x32_bf16 a[48:51], a[220:223], a[144:147], a[48:51]
    ds_read_b64_tr_b16 a[212:213], v24 offset:17408
    ds_read_b64_tr_b16 a[214:215], v24 offset:17920
    v_mfma_f32_16x16x32_bf16 a[52:55], a[216:219], a[132:135], 0
    v_mfma_f32_16x16x32_bf16 a[52:55], a[220:223], a[148:151], a[52:55]
    v_mfma_f32_16x16x32_bf16 a[56:59], a[216:219], a[136:139], 0
    v_mfma_f32_16x16x32_bf16 a[56:59], a[220:223], a[152:155], a[56:59]
    v_mfma_f32_16x16x32_bf16 a[60:63], a[216:219], a[140:143], 0
    v_mfma_f32_16x16x32_bf16 a[60:63], a[220:223], a[156:159], a[60:63]
    s_waitcnt lgkmcnt(15)
    v_mfma_f32_16x16x32_bf16 a[64:67], a[192:195], a[128:131], 0
    ds_read_b64_tr_b16 a[216:217], v25 offset:1024
    ds_read_b64_tr_b16 a[218:219], v25 offset:1536
    v_mfma_f32_16x16x32_bf16 a[64:67], a[196:199], a[144:147], a[64:67]
    s_mov_b32 s57, 256
    ds_read_b64_tr_b16 a[220:221], v25 offset:17408
    ds_read_b64_tr_b16 a[222:223], v25 offset:17920
    v_mfma_f32_16x16x32_bf16 a[68:71], a[192:195], a[132:135], 0
    s_waitcnt lgkmcnt(8)
    s_mov_b32 m0, s95
    v_mfma_f32_16x16x32_bf16 a[68:71], a[196:199], a[148:151], a[68:71]
    buffer_load_dwordx4 v11, s[8:11], s57 offen offset:0 lds
    v_mfma_f32_16x16x32_bf16 a[72:75], a[192:195], a[136:139], 0
    v_mfma_f32_16x16x32_bf16 a[72:75], a[196:199], a[152:155], a[72:75]
    v_mfma_f32_16x16x32_bf16 a[76:79], a[192:195], a[140:143], 0
    v_mfma_f32_16x16x32_bf16 a[76:79], a[196:199], a[156:159], a[76:79]
    s_waitcnt lgkmcnt(12)
    s_waitcnt lgkmcnt(0)
    s_waitcnt vmcnt(22)
    s_barrier
    v_mfma_f32_16x16x32_bf16 a[80:83], a[200:203], a[128:131], 0
    ds_read_b64_tr_b16 a[192:193], v18 offset:32768
    ds_read_b64_tr_b16 a[194:195], v18 offset:33792
    v_mfma_f32_16x16x32_bf16 a[80:83], a[204:207], a[144:147], a[80:83]
    ds_read_b64_tr_b16 a[196:197], v18 offset:49152
    ds_read_b64_tr_b16 a[198:199], v18 offset:50176
    v_mfma_f32_16x16x32_bf16 a[84:87], a[200:203], a[132:135], 0
    buffer_load_dwordx4 v12, s[8:11], s57 offen offset:1024 lds
    v_mfma_f32_16x16x32_bf16 a[84:87], a[204:207], a[148:151], a[84:87]
    v_mfma_f32_16x16x32_bf16 a[88:91], a[200:203], a[136:139], 0
    v_mfma_f32_16x16x32_bf16 a[88:91], a[204:207], a[152:155], a[88:91]
    v_mfma_f32_16x16x32_bf16 a[92:95], a[200:203], a[140:143], 0
    buffer_load_dwordx4 v13, s[8:11], s57 offen offset:2048 lds
    v_mfma_f32_16x16x32_bf16 a[92:95], a[204:207], a[156:159], a[92:95]
    s_waitcnt lgkmcnt(8)
    v_mfma_f32_16x16x32_bf16 a[96:99], a[208:211], a[128:131], 0
    ds_read_b64_tr_b16 a[200:201], v18 offset:32776
    ds_read_b64_tr_b16 a[202:203], v18 offset:33800
    v_mfma_f32_16x16x32_bf16 a[96:99], a[212:215], a[144:147], a[96:99]
    ds_read_b64_tr_b16 a[204:205], v18 offset:49160
    ds_read_b64_tr_b16 a[206:207], v18 offset:50184
    v_mfma_f32_16x16x32_bf16 a[100:103], a[208:211], a[132:135], 0
    buffer_load_dwordx4 v14, s[8:11], s57 offen offset:3072 lds
    v_mfma_f32_16x16x32_bf16 a[100:103], a[212:215], a[148:151], a[100:103]
    v_mfma_f32_16x16x32_bf16 a[104:107], a[208:211], a[136:139], 0
    s_add_u32 m0, s95, 4096
    v_mfma_f32_16x16x32_bf16 a[104:107], a[212:215], a[152:155], a[104:107]
    s_add_u32 s57, s57, 32768
    v_mfma_f32_16x16x32_bf16 a[108:111], a[208:211], a[140:143], 0
    buffer_load_dwordx4 v11, s[8:11], s57 offen offset:0 lds
    v_mfma_f32_16x16x32_bf16 a[108:111], a[212:215], a[156:159], a[108:111]
    s_waitcnt lgkmcnt(8)
    v_mfma_f32_16x16x32_bf16 a[112:115], a[216:219], a[128:131], 0
    ds_read_b64_tr_b16 a[208:209], v19 offset:32768
    ds_read_b64_tr_b16 a[210:211], v19 offset:33792
    v_mfma_f32_16x16x32_bf16 a[112:115], a[220:223], a[144:147], a[112:115]
    ds_read_b64_tr_b16 a[212:213], v19 offset:49152
    ds_read_b64_tr_b16 a[214:215], v19 offset:50176
    v_mfma_f32_16x16x32_bf16 a[116:119], a[216:219], a[132:135], 0
    buffer_load_dwordx4 v12, s[8:11], s57 offen offset:1024 lds
    v_mfma_f32_16x16x32_bf16 a[116:119], a[220:223], a[148:151], a[116:119]
    v_mfma_f32_16x16x32_bf16 a[120:123], a[216:219], a[136:139], 0
    v_mfma_f32_16x16x32_bf16 a[120:123], a[220:223], a[152:155], a[120:123]
    v_mfma_f32_16x16x32_bf16 a[124:127], a[216:219], a[140:143], 0
    buffer_load_dwordx4 v13, s[8:11], s57 offen offset:2048 lds
    v_mfma_f32_16x16x32_bf16 a[124:127], a[220:223], a[156:159], a[124:127]
    s_waitcnt lgkmcnt(15)
    v_mfma_f32_16x16x32_bf16 v[112:115], a[224:227], v[104:107], 0
    v_mfma_f32_16x16x32_bf16 v[112:115], a[228:231], v[104:107], v[112:115]
    v_mfma_f32_16x16x32_bf16 v[116:119], a[232:235], v[104:107], 0
    buffer_load_dwordx4 v14, s[8:11], s57 offen offset:3072 lds
    v_mfma_f32_16x16x32_bf16 v[116:119], a[236:239], v[104:107], v[116:119]
    s_mov_b32 s58, 1572864
    v_mfma_f32_16x16x32_bf16 v[120:123], a[240:243], v[104:107], 0
    s_mov_b32 s59, 688128
    v_mfma_f32_16x16x32_bf16 v[120:123], a[244:247], v[104:107], v[120:123]
    s_add_u32 m0, s56, 0
    v_mfma_f32_16x16x32_bf16 v[124:127], a[248:251], v[104:107], 0
    buffer_load_dwordx4 v15, s[12:15], s58 offen lds
    v_mfma_f32_16x16x32_bf16 v[124:127], a[252:255], v[104:107], v[124:127]
    s_waitcnt lgkmcnt(8)
    v_mfma_f32_16x16x32_bf16 v[128:131], a[192:195], a[160:163], v[128:131]
    ds_read_b64_tr_b16 a[216:217], v19 offset:32776
    ds_read_b64_tr_b16 a[218:219], v19 offset:33800
    v_mfma_f32_16x16x32_bf16 v[128:131], a[196:199], a[176:179], v[128:131]
    ds_read_b64_tr_b16 a[220:221], v19 offset:49160
    ds_read_b64_tr_b16 a[222:223], v19 offset:50184
    v_mfma_f32_16x16x32_bf16 v[132:135], a[192:195], a[164:167], v[132:135]
    buffer_load_dwordx4 v16, s[12:15], s58 offen offset:1024 lds
    v_mfma_f32_16x16x32_bf16 v[132:135], a[196:199], a[180:183], v[132:135]
    v_mfma_f32_16x16x32_bf16 v[136:139], a[192:195], a[168:171], v[136:139]
    v_mfma_f32_16x16x32_bf16 v[136:139], a[196:199], a[184:187], v[136:139]
    s_add_u32 m0, s56, 2048
    v_mfma_f32_16x16x32_bf16 v[140:143], a[192:195], a[172:175], v[140:143]
    buffer_load_dwordx4 v17, s[16:19], s59 offen lds
    v_mfma_f32_16x16x32_bf16 v[140:143], a[196:199], a[188:191], v[140:143]
    s_waitcnt lgkmcnt(8)
    v_mfma_f32_16x16x32_bf16 v[144:147], a[200:203], a[160:163], v[144:147]
    ds_read_b64_tr_b16 a[192:193], v20 offset:32768
    ds_read_b64_tr_b16 a[194:195], v20 offset:33792
    v_mfma_f32_16x16x32_bf16 v[144:147], a[204:207], a[176:179], v[144:147]
    s_add_u32 m0, s56, 3072
    ds_read_b64_tr_b16 a[196:197], v20 offset:49152
    ds_read_b64_tr_b16 a[198:199], v20 offset:50176
    v_mfma_f32_16x16x32_bf16 v[148:151], a[200:203], a[164:167], v[148:151]
    s_waitcnt vmcnt(3)
    buffer_load_dwordx4 v17, s[20:23], s59 offen lds
    v_mfma_f32_16x16x32_bf16 v[148:151], a[204:207], a[180:183], v[148:151]
    ds_read_b128 a[128:131], v6 offset:0
    ds_read_b128 a[132:135], v6 offset:2048
    v_mfma_f32_16x16x32_bf16 v[152:155], a[200:203], a[168:171], v[152:155]
    s_add_u32 m0, s56, 16384
    v_mfma_f32_16x16x32_bf16 v[152:155], a[204:207], a[184:187], v[152:155]
    s_add_u32 s58, s58, 262144
    ds_read_b128 a[136:139], v6 offset:4096
    ds_read_b128 a[140:143], v6 offset:6144
    v_mfma_f32_16x16x32_bf16 v[156:159], a[200:203], a[172:175], v[156:159]
    buffer_load_dwordx4 v15, s[12:15], s58 offen lds
    v_mfma_f32_16x16x32_bf16 v[156:159], a[204:207], a[188:191], v[156:159]
    s_waitcnt lgkmcnt(12)
    v_mfma_f32_16x16x32_bf16 v[160:163], a[208:211], a[160:163], v[160:163]
    ds_read_b64_tr_b16 a[200:201], v20 offset:32776
    ds_read_b64_tr_b16 a[202:203], v20 offset:33800
    v_mfma_f32_16x16x32_bf16 v[160:163], a[212:215], a[176:179], v[160:163]
    ds_read_b64_tr_b16 a[204:205], v20 offset:49160
    ds_read_b64_tr_b16 a[206:207], v20 offset:50184
    v_mfma_f32_16x16x32_bf16 v[164:167], a[208:211], a[164:167], v[164:167]
    buffer_load_dwordx4 v16, s[12:15], s58 offen offset:1024 lds
    v_mfma_f32_16x16x32_bf16 v[164:167], a[212:215], a[180:183], v[164:167]
    ds_read_b128 a[144:147], v7 offset:0
    ds_read_b128 a[148:151], v7 offset:2048
    v_mfma_f32_16x16x32_bf16 v[168:171], a[208:211], a[168:171], v[168:171]
    s_add_u32 m0, s56, 18432
    v_mfma_f32_16x16x32_bf16 v[168:171], a[212:215], a[184:187], v[168:171]
    s_add_u32 s59, s59, 114688
    ds_read_b128 a[152:155], v7 offset:4096
    ds_read_b128 a[156:159], v7 offset:6144
    v_mfma_f32_16x16x32_bf16 v[172:175], a[208:211], a[172:175], v[172:175]
    buffer_load_dwordx4 v17, s[16:19], s59 offen lds
    v_mfma_f32_16x16x32_bf16 v[172:175], a[212:215], a[188:191], v[172:175]
    s_waitcnt lgkmcnt(15)
    v_mfma_f32_16x16x32_bf16 v[176:179], a[216:219], a[160:163], v[176:179]
    ds_read_b64_tr_b16 a[208:209], v21 offset:32768
    ds_read_b64_tr_b16 a[210:211], v21 offset:33792
    v_mfma_f32_16x16x32_bf16 v[176:179], a[220:223], a[176:179], v[176:179]
    s_add_u32 m0, s56, 19456
    ds_read_b64_tr_b16 a[212:213], v21 offset:49152
    ds_read_b64_tr_b16 a[214:215], v21 offset:50176
    v_mfma_f32_16x16x32_bf16 v[180:183], a[216:219], a[164:167], v[180:183]
    buffer_load_dwordx4 v17, s[20:23], s59 offen lds
    v_mfma_f32_16x16x32_bf16 v[180:183], a[220:223], a[180:183], v[180:183]
    v_mfma_f32_16x16x32_bf16 v[184:187], a[216:219], a[168:171], v[184:187]
    v_mfma_f32_16x16x32_bf16 v[184:187], a[220:223], a[184:187], v[184:187]
    v_mfma_f32_16x16x32_bf16 v[188:191], a[216:219], a[172:175], v[188:191]
    v_mfma_f32_16x16x32_bf16 v[188:191], a[220:223], a[188:191], v[188:191]
    s_waitcnt lgkmcnt(15)
    v_mfma_f32_16x16x32_bf16 v[192:195], a[192:195], a[160:163], v[192:195]
    ds_read_b64_tr_b16 a[216:217], v21 offset:32776
    ds_read_b64_tr_b16 a[218:219], v21 offset:33800
    v_mfma_f32_16x16x32_bf16 v[192:195], a[196:199], a[176:179], v[192:195]
    s_mov_b32 s57, 384
    ds_read_b64_tr_b16 a[220:221], v21 offset:49160
    ds_read_b64_tr_b16 a[222:223], v21 offset:50184
    v_mfma_f32_16x16x32_bf16 v[196:199], a[192:195], a[164:167], v[196:199]
    s_waitcnt lgkmcnt(8)
    s_mov_b32 m0, s95
    v_mfma_f32_16x16x32_bf16 v[196:199], a[196:199], a[180:183], v[196:199]
    buffer_load_dwordx4 v11, s[8:11], s57 offen offset:0 lds
    v_mfma_f32_16x16x32_bf16 v[200:203], a[192:195], a[168:171], v[200:203]
    v_mfma_f32_16x16x32_bf16 v[200:203], a[196:199], a[184:187], v[200:203]
    v_mfma_f32_16x16x32_bf16 v[204:207], a[192:195], a[172:175], v[204:207]
    v_mfma_f32_16x16x32_bf16 v[204:207], a[196:199], a[188:191], v[204:207]
    s_waitcnt lgkmcnt(12)
    buffer_load_dwordx4 v12, s[8:11], s57 offen offset:1024 lds
    v_mfma_f32_16x16x32_bf16 v[208:211], a[200:203], a[160:163], v[208:211]
    ds_read_b64_tr_b16 a[192:193], v22 offset:32768
    ds_read_b64_tr_b16 a[194:195], v22 offset:33280
    v_mfma_f32_16x16x32_bf16 v[208:211], a[204:207], a[176:179], v[208:211]
    ds_read_b64_tr_b16 a[196:197], v22 offset:49152
    ds_read_b64_tr_b16 a[198:199], v22 offset:49664
    v_mfma_f32_16x16x32_bf16 v[212:215], a[200:203], a[164:167], v[212:215]
    v_mfma_f32_16x16x32_bf16 v[212:215], a[204:207], a[180:183], v[212:215]
    buffer_load_dwordx4 v13, s[8:11], s57 offen offset:2048 lds
    v_mfma_f32_16x16x32_bf16 v[216:219], a[200:203], a[168:171], v[216:219]
    v_mfma_f32_16x16x32_bf16 v[216:219], a[204:207], a[184:187], v[216:219]
    v_mfma_f32_16x16x32_bf16 v[220:223], a[200:203], a[172:175], v[220:223]
    v_mfma_f32_16x16x32_bf16 v[220:223], a[204:207], a[188:191], v[220:223]
    s_waitcnt lgkmcnt(8)
    buffer_load_dwordx4 v14, s[8:11], s57 offen offset:3072 lds
    v_mfma_f32_16x16x32_bf16 v[224:227], a[208:211], a[160:163], v[224:227]
    ds_read_b64_tr_b16 a[200:201], v23 offset:32768
    ds_read_b64_tr_b16 a[202:203], v23 offset:33280
    v_mfma_f32_16x16x32_bf16 v[224:227], a[212:215], a[176:179], v[224:227]
    ds_read_b64_tr_b16 a[204:205], v23 offset:49152
    ds_read_b64_tr_b16 a[206:207], v23 offset:49664
    v_mfma_f32_16x16x32_bf16 v[228:231], a[208:211], a[164:167], v[228:231]
    s_add_u32 m0, s95, 4096
    v_mfma_f32_16x16x32_bf16 v[228:231], a[212:215], a[180:183], v[228:231]
    s_add_u32 s57, s57, 32768
    ds_read_b64_tr_b16 a[224:225], v26 offset:32768
    ds_read_b64_tr_b16 a[226:227], v27 offset:32768
    v_mfma_f32_16x16x32_bf16 v[232:235], a[208:211], a[168:171], v[232:235]
    buffer_load_dwordx4 v11, s[8:11], s57 offen offset:0 lds
    v_mfma_f32_16x16x32_bf16 v[232:235], a[212:215], a[184:187], v[232:235]
    ds_read_b64_tr_b16 a[228:229], v26 offset:49152
    ds_read_b64_tr_b16 a[230:231], v27 offset:49152
    v_mfma_f32_16x16x32_bf16 v[236:239], a[208:211], a[172:175], v[236:239]
    v_mfma_f32_16x16x32_bf16 v[236:239], a[212:215], a[188:191], v[236:239]
    s_waitcnt lgkmcnt(12)
    v_mfma_f32_16x16x32_bf16 v[240:243], a[216:219], a[160:163], v[240:243]
    ds_read_b64_tr_b16 a[208:209], v24 offset:32768
    ds_read_b64_tr_b16 a[210:211], v24 offset:33280
    v_mfma_f32_16x16x32_bf16 v[240:243], a[220:223], a[176:179], v[240:243]
    ds_read_b64_tr_b16 a[212:213], v24 offset:49152
    ds_read_b64_tr_b16 a[214:215], v24 offset:49664
    v_mfma_f32_16x16x32_bf16 v[244:247], a[216:219], a[164:167], v[244:247]
    buffer_load_dwordx4 v12, s[8:11], s57 offen offset:1024 lds
    v_mfma_f32_16x16x32_bf16 v[244:247], a[220:223], a[180:183], v[244:247]
    ds_read_b64_tr_b16 a[232:233], v28 offset:32768
    ds_read_b64_tr_b16 a[234:235], v29 offset:32768
    v_mfma_f32_16x16x32_bf16 v[248:251], a[216:219], a[168:171], v[248:251]
    v_mfma_f32_16x16x32_bf16 v[248:251], a[220:223], a[184:187], v[248:251]
    ds_read_b64_tr_b16 a[236:237], v28 offset:49152
    ds_read_b64_tr_b16 a[238:239], v29 offset:49152
    v_mfma_f32_16x16x32_bf16 v[252:255], a[216:219], a[172:175], v[252:255]
    buffer_load_dwordx4 v13, s[8:11], s57 offen offset:2048 lds
    v_mfma_f32_16x16x32_bf16 v[252:255], a[220:223], a[188:191], v[252:255]
    s_waitcnt lgkmcnt(15)
    v_mfma_f32_16x16x32_bf16 a[0:3], a[192:195], a[160:163], a[0:3]
    ds_read_b64_tr_b16 a[216:217], v25 offset:32768
    ds_read_b64_tr_b16 a[218:219], v25 offset:33280
    v_mfma_f32_16x16x32_bf16 a[0:3], a[196:199], a[176:179], a[0:3]
    ds_read_b64_tr_b16 a[220:221], v25 offset:49152
    ds_read_b64_tr_b16 a[222:223], v25 offset:49664
    v_mfma_f32_16x16x32_bf16 a[4:7], a[192:195], a[164:167], a[4:7]
    buffer_load_dwordx4 v14, s[8:11], s57 offen offset:3072 lds
    v_mfma_f32_16x16x32_bf16 a[4:7], a[196:199], a[180:183], a[4:7]
    ds_read_b64_tr_b16 a[240:241], v30 offset:32768
    ds_read_b64_tr_b16 a[242:243], v31 offset:32768
    v_mfma_f32_16x16x32_bf16 a[8:11], a[192:195], a[168:171], a[8:11]
    v_mfma_f32_16x16x32_bf16 a[8:11], a[196:199], a[184:187], a[8:11]
    ds_read_b64_tr_b16 a[244:245], v30 offset:49152
    ds_read_b64_tr_b16 a[246:247], v31 offset:49152
    v_mfma_f32_16x16x32_bf16 a[12:15], a[192:195], a[172:175], a[12:15]
    v_mfma_f32_16x16x32_bf16 a[12:15], a[196:199], a[188:191], a[12:15]
    s_waitcnt lgkmcnt(15)
    v_mfma_f32_16x16x32_bf16 a[16:19], a[200:203], a[160:163], a[16:19]
    ds_read_b64_tr_b16 a[192:193], v22 offset:33792
    ds_read_b64_tr_b16 a[194:195], v22 offset:34304
    v_mfma_f32_16x16x32_bf16 a[16:19], a[204:207], a[176:179], a[16:19]
    ds_read_b64_tr_b16 a[196:197], v22 offset:50176
    ds_read_b64_tr_b16 a[198:199], v22 offset:50688
    v_mfma_f32_16x16x32_bf16 a[20:23], a[200:203], a[164:167], a[20:23]
    v_mfma_f32_16x16x32_bf16 a[20:23], a[204:207], a[180:183], a[20:23]
    ds_read_b64_tr_b16 a[248:249], v32 offset:32768
    ds_read_b64_tr_b16 a[250:251], v33 offset:32768
    v_mfma_f32_16x16x32_bf16 a[24:27], a[200:203], a[168:171], a[24:27]
    v_mfma_f32_16x16x32_bf16 a[24:27], a[204:207], a[184:187], a[24:27]
    ds_read_b64_tr_b16 a[252:253], v32 offset:49152
    ds_read_b64_tr_b16 a[254:255], v33 offset:49152
    v_mfma_f32_16x16x32_bf16 a[28:31], a[200:203], a[172:175], a[28:31]
    v_mfma_f32_16x16x32_bf16 a[28:31], a[204:207], a[188:191], a[28:31]
    s_waitcnt lgkmcnt(15)
    v_mfma_f32_16x16x32_bf16 a[32:35], a[208:211], a[160:163], a[32:35]
    ds_read_b64_tr_b16 a[200:201], v23 offset:33792
    ds_read_b64_tr_b16 a[202:203], v23 offset:34304
    v_mfma_f32_16x16x32_bf16 a[32:35], a[212:215], a[176:179], a[32:35]
    ds_read_b64_tr_b16 a[204:205], v23 offset:50176
    ds_read_b64_tr_b16 a[206:207], v23 offset:50688
    v_mfma_f32_16x16x32_bf16 a[36:39], a[208:211], a[164:167], a[36:39]
    v_mfma_f32_16x16x32_bf16 a[36:39], a[212:215], a[180:183], a[36:39]
    v_xor_b32 v26, 0x10000, v26
    v_xor_b32 v27, 0x10000, v27
    v_mfma_f32_16x16x32_bf16 a[40:43], a[208:211], a[168:171], a[40:43]
    v_mfma_f32_16x16x32_bf16 a[40:43], a[212:215], a[184:187], a[40:43]
    v_xor_b32 v28, 0x10000, v28
    v_xor_b32 v29, 0x10000, v29
    v_mfma_f32_16x16x32_bf16 a[44:47], a[208:211], a[172:175], a[44:47]
    v_mfma_f32_16x16x32_bf16 a[44:47], a[212:215], a[188:191], a[44:47]
    s_waitcnt lgkmcnt(15)
    v_mfma_f32_16x16x32_bf16 a[48:51], a[216:219], a[160:163], a[48:51]
    ds_read_b64_tr_b16 a[208:209], v24 offset:33792
    ds_read_b64_tr_b16 a[210:211], v24 offset:34304
    v_mfma_f32_16x16x32_bf16 a[48:51], a[220:223], a[176:179], a[48:51]
    ds_read_b64_tr_b16 a[212:213], v24 offset:50176
    ds_read_b64_tr_b16 a[214:215], v24 offset:50688
    v_mfma_f32_16x16x32_bf16 a[52:55], a[216:219], a[164:167], a[52:55]
    v_mfma_f32_16x16x32_bf16 a[52:55], a[220:223], a[180:183], a[52:55]
    v_xor_b32 v30, 0x10000, v30
    v_xor_b32 v31, 0x10000, v31
    v_mfma_f32_16x16x32_bf16 a[56:59], a[216:219], a[168:171], a[56:59]
    v_mfma_f32_16x16x32_bf16 a[56:59], a[220:223], a[184:187], a[56:59]
    v_xor_b32 v32, 0x10000, v32
    v_xor_b32 v33, 0x10000, v33
    v_mfma_f32_16x16x32_bf16 a[60:63], a[216:219], a[172:175], a[60:63]
    v_mfma_f32_16x16x32_bf16 a[60:63], a[220:223], a[188:191], a[60:63]
    s_waitcnt lgkmcnt(12)
    v_mfma_f32_16x16x32_bf16 a[64:67], a[192:195], a[160:163], a[64:67]
    ds_read_b64_tr_b16 a[216:217], v25 offset:33792
    ds_read_b64_tr_b16 a[218:219], v25 offset:34304
    v_mfma_f32_16x16x32_bf16 a[64:67], a[196:199], a[176:179], a[64:67]
    ds_read_b64_tr_b16 a[220:221], v25 offset:50176
    ds_read_b64_tr_b16 a[222:223], v25 offset:50688
    v_mfma_f32_16x16x32_bf16 a[68:71], a[192:195], a[164:167], a[68:71]
    v_xor_b32 v18, 0x10000, v18
    v_xor_b32 v19, 0x10000, v19
    v_mfma_f32_16x16x32_bf16 a[68:71], a[196:199], a[180:183], a[68:71]
    v_xor_b32 v20, 0x10000, v20
    v_xor_b32 v21, 0x10000, v21
    v_mfma_f32_16x16x32_bf16 a[72:75], a[192:195], a[168:171], a[72:75]
    v_xor_b32 v22, 0x10000, v22
    v_xor_b32 v23, 0x10000, v23
    v_mfma_f32_16x16x32_bf16 a[72:75], a[196:199], a[184:187], a[72:75]
    v_xor_b32 v24, 0x10000, v24
    v_xor_b32 v25, 0x10000, v25
    v_mfma_f32_16x16x32_bf16 a[76:79], a[192:195], a[172:175], a[76:79]
    v_mfma_f32_16x16x32_bf16 a[76:79], a[196:199], a[188:191], a[76:79]
    s_waitcnt lgkmcnt(8)
    s_waitcnt lgkmcnt(0)
    s_waitcnt vmcnt(24)
    s_barrier
    s_cmp_eq_u32 s3, 0
    s_cbranch_scc0 KF_sigx
    s_mov_b64 s[96:97], exec
    s_mov_b64 exec, 1
    v_mov_b32 v3, 1
    buffer_atomic_add v3, v75, s[72:75], 0 offen sc1
    s_mov_b64 exec, s[96:97]
KF_sigx:
    v_mfma_f32_16x16x32_bf16 a[80:83], a[200:203], a[160:163], a[80:83]
    s_mov_b32 s58, 2097152
    ds_read_b64_tr_b16 a[192:193], v18 offset:0
    ds_read_b64_tr_b16 a[194:195], v18 offset:1024
    v_mfma_f32_16x16x32_bf16 a[80:83], a[204:207], a[176:179], a[80:83]
    s_mov_b32 s59, 917504
    ds_read_b64_tr_b16 a[196:197], v18 offset:16384
    ds_read_b64_tr_b16 a[198:199], v18 offset:17408
    v_mfma_f32_16x16x32_bf16 a[84:87], a[200:203], a[164:167], a[84:87]
    s_add_u32 m0, s56, 32768
    v_mfma_f32_16x16x32_bf16 a[84:87], a[204:207], a[180:183], a[84:87]
    buffer_load_dwordx4 v15, s[12:15], s58 offen lds
    v_mfma_f32_16x16x32_bf16 a[88:91], a[200:203], a[168:171], a[88:91]
    v_mfma_f32_16x16x32_bf16 a[88:91], a[204:207], a[184:187], a[88:91]
    v_mfma_f32_16x16x32_bf16 a[92:95], a[200:203], a[172:175], a[92:95]
    v_mfma_f32_16x16x32_bf16 a[92:95], a[204:207], a[188:191], a[92:95]
    s_waitcnt lgkmcnt(8)
    buffer_load_dwordx4 v16, s[12:15], s58 offen offset:1024 lds
    v_mfma_f32_16x16x32_bf16 a[96:99], a[208:211], a[160:163], a[96:99]
    ds_read_b64_tr_b16 a[200:201], v18 offset:8
    ds_read_b64_tr_b16 a[202:203], v18 offset:1032
    v_mfma_f32_16x16x32_bf16 a[96:99], a[212:215], a[176:179], a[96:99]
    ds_read_b64_tr_b16 a[204:205], v18 offset:16392
    ds_read_b64_tr_b16 a[206:207], v18 offset:17416
    v_mfma_f32_16x16x32_bf16 a[100:103], a[208:211], a[164:167], a[100:103]
    s_add_u32 m0, s56, 34816
    v_mfma_f32_16x16x32_bf16 a[100:103], a[212:215], a[180:183], a[100:103]
    buffer_load_dwordx4 v17, s[16:19], s59 offen lds
    v_mfma_f32_16x16x32_bf16 a[104:107], a[208:211], a[168:171], a[104:107]
    v_mfma_f32_16x16x32_bf16 a[104:107], a[212:215], a[184:187], a[104:107]
    v_mfma_f32_16x16x32_bf16 a[108:111], a[208:211], a[172:175], a[108:111]
    s_add_u32 m0, s56, 35840
    v_mfma_f32_16x16x32_bf16 a[108:111], a[212:215], a[188:191], a[108:111]
    s_waitcnt lgkmcnt(8)
    buffer_load_dwordx4 v17, s[20:23], s59 offen lds
    v_mfma_f32_16x16x32_bf16 a[112:115], a[216:219], a[160:163], a[112:115]
    ds_read_b64_tr_b16 a[208:209], v19 offset:0
    ds_read_b64_tr_b16 a[210:211], v19 offset:1024
    v_mfma_f32_16x16x32_bf16 a[112:115], a[220:223], a[176:179], a[112:115]
    s_add_u32 m0, s56, 49152
    ds_read_b64_tr_b16 a[212:213], v19 offset:16384
    ds_read_b64_tr_b16 a[214:215], v19 offset:17408
    v_mfma_f32_16x16x32_bf16 a[116:119], a[216:219], a[164:167], a[116:119]
    s_add_u32 s58, s58, 262144
    v_mfma_f32_16x16x32_bf16 a[116:119], a[220:223], a[180:183], a[116:119]
    buffer_load_dwordx4 v15, s[12:15], s58 offen lds
    v_mfma_f32_16x16x32_bf16 a[120:123], a[216:219], a[168:171], a[120:123]
    v_mfma_f32_16x16x32_bf16 a[120:123], a[220:223], a[184:187], a[120:123]
    v_mfma_f32_16x16x32_bf16 a[124:127], a[216:219], a[172:175], a[124:127]
    v_mfma_f32_16x16x32_bf16 a[124:127], a[220:223], a[188:191], a[124:127]
    s_waitcnt lgkmcnt(15)
    buffer_load_dwordx4 v16, s[12:15], s58 offen offset:1024 lds
    v_mfma_f32_16x16x32_bf16 v[112:115], a[224:227], v[104:107], v[112:115]
    v_mfma_f32_16x16x32_bf16 v[112:115], a[228:231], v[104:107], v[112:115]
    s_add_u32 m0, s56, 51200
    v_mfma_f32_16x16x32_bf16 v[116:119], a[232:235], v[104:107], v[116:119]
    s_add_u32 s59, s59, 114688
    v_mfma_f32_16x16x32_bf16 v[116:119], a[236:239], v[104:107], v[116:119]
    buffer_load_dwordx4 v17, s[16:19], s59 offen lds
    v_mfma_f32_16x16x32_bf16 v[120:123], a[240:243], v[104:107], v[120:123]
    v_mfma_f32_16x16x32_bf16 v[120:123], a[244:247], v[104:107], v[120:123]
    v_mfma_f32_16x16x32_bf16 v[124:127], a[248:251], v[104:107], v[124:127]
    s_add_u32 m0, s56, 52224
    v_mfma_f32_16x16x32_bf16 v[124:127], a[252:255], v[104:107], v[124:127]
    s_waitcnt lgkmcnt(8)
    buffer_load_dwordx4 v17, s[20:23], s59 offen lds
    v_mfma_f32_16x16x32_bf16 v[128:131], a[192:195], a[128:131], v[128:131]
    ds_read_b64_tr_b16 a[216:217], v19 offset:8
    ds_read_b64_tr_b16 a[218:219], v19 offset:1032
    v_mfma_f32_16x16x32_bf16 v[128:131], a[196:199], a[144:147], v[128:131]
    ds_read_b64_tr_b16 a[220:221], v19 offset:16392
    ds_read_b64_tr_b16 a[222:223], v19 offset:17416
    v_mfma_f32_16x16x32_bf16 v[132:135], a[192:195], a[132:135], v[132:135]
    v_mfma_f32_16x16x32_bf16 v[132:135], a[196:199], a[148:151], v[132:135]
    v_mfma_f32_16x16x32_bf16 v[136:139], a[192:195], a[136:139], v[136:139]
    v_mfma_f32_16x16x32_bf16 v[136:139], a[196:199], a[152:155], v[136:139]
    v_mfma_f32_16x16x32_bf16 v[140:143], a[192:195], a[140:143], v[140:143]
    v_mfma_f32_16x16x32_bf16 v[140:143], a[196:199], a[156:159], v[140:143]
    s_waitcnt lgkmcnt(8)
    v_mfma_f32_16x16x32_bf16 v[144:147], a[200:203], a[128:131], v[144:147]
    ds_read_b64_tr_b16 a[192:193], v20 offset:0
    ds_read_b64_tr_b16 a[194:195], v20 offset:1024
    v_mfma_f32_16x16x32_bf16 v[144:147], a[204:207], a[144:147], v[144:147]
    ds_read_b64_tr_b16 a[196:197], v20 offset:16384
    ds_read_b64_tr_b16 a[198:199], v20 offset:17408
    v_mfma_f32_16x16x32_bf16 v[148:151], a[200:203], a[132:135], v[148:151]
    s_waitcnt vmcnt(8)
    v_mfma_f32_16x16x32_bf16 v[148:151], a[204:207], a[148:151], v[148:151]
    ds_read_b128 a[160:163], v6 offset:0
    ds_read_b128 a[164:167], v6 offset:2048
    v_mfma_f32_16x16x32_bf16 v[152:155], a[200:203], a[136:139], v[152:155]
    v_mfma_f32_16x16x32_bf16 v[152:155], a[204:207], a[152:155], v[152:155]
    ds_read_b128 a[168:171], v6 offset:4096
    ds_read_b128 a[172:175], v6 offset:6144
    v_mfma_f32_16x16x32_bf16 v[156:159], a[200:203], a[140:143], v[156:159]
    v_mfma_f32_16x16x32_bf16 v[156:159], a[204:207], a[156:159], v[156:159]
    s_waitcnt lgkmcnt(12)
    v_mfma_f32_16x16x32_bf16 v[160:163], a[208:211], a[128:131], v[160:163]
    ds_read_b64_tr_b16 a[200:201], v20 offset:8
    ds_read_b64_tr_b16 a[202:203], v20 offset:1032
    v_mfma_f32_16x16x32_bf16 v[160:163], a[212:215], a[144:147], v[160:163]
    ds_read_b64_tr_b16 a[204:205], v20 offset:16392
    ds_read_b64_tr_b16 a[206:207], v20 offset:17416
    v_mfma_f32_16x16x32_bf16 v[164:167], a[208:211], a[132:135], v[164:167]
    v_mfma_f32_16x16x32_bf16 v[164:167], a[212:215], a[148:151], v[164:167]
    ds_read_b128 a[176:179], v7 offset:0
    ds_read_b128 a[180:183], v7 offset:2048
    v_mfma_f32_16x16x32_bf16 v[168:171], a[208:211], a[136:139], v[168:171]
    v_mfma_f32_16x16x32_bf16 v[168:171], a[212:215], a[152:155], v[168:171]
    ds_read_b128 a[184:187], v7 offset:4096
    ds_read_b128 a[188:191], v7 offset:6144
    v_mfma_f32_16x16x32_bf16 v[172:175], a[208:211], a[140:143], v[172:175]
    v_mfma_f32_16x16x32_bf16 v[172:175], a[212:215], a[156:159], v[172:175]
    s_waitcnt lgkmcnt(15)
    v_mfma_f32_16x16x32_bf16 v[176:179], a[216:219], a[128:131], v[176:179]
    ds_read_b64_tr_b16 a[208:209], v21 offset:0
    ds_read_b64_tr_b16 a[210:211], v21 offset:1024
    v_mfma_f32_16x16x32_bf16 v[176:179], a[220:223], a[144:147], v[176:179]
    ds_read_b64_tr_b16 a[212:213], v21 offset:16384
    ds_read_b64_tr_b16 a[214:215], v21 offset:17408
    v_mfma_f32_16x16x32_bf16 v[180:183], a[216:219], a[132:135], v[180:183]
    v_mfma_f32_16x16x32_bf16 v[180:183], a[220:223], a[148:151], v[180:183]
    v_mfma_f32_16x16x32_bf16 v[184:187], a[216:219], a[136:139], v[184:187]
    v_mfma_f32_16x16x32_bf16 v[184:187], a[220:223], a[152:155], v[184:187]
    v_mfma_f32_16x16x32_bf16 v[188:191], a[216:219], a[140:143], v[188:191]
    v_mfma_f32_16x16x32_bf16 v[188:191], a[220:223], a[156:159], v[188:191]
    s_waitcnt lgkmcnt(15)
    v_mfma_f32_16x16x32_bf16 v[192:195], a[192:195], a[128:131], v[192:195]
    ds_read_b64_tr_b16 a[216:217], v21 offset:8
    ds_read_b64_tr_b16 a[218:219], v21 offset:1032
    v_mfma_f32_16x16x32_bf16 v[192:195], a[196:199], a[144:147], v[192:195]
    s_mov_b32 s57, 512
    ds_read_b64_tr_b16 a[220:221], v21 offset:16392
    ds_read_b64_tr_b16 a[222:223], v21 offset:17416
    v_mfma_f32_16x16x32_bf16 v[196:199], a[192:195], a[132:135], v[196:199]
    s_waitcnt lgkmcnt(8)
    s_mov_b32 m0, s95
    v_mfma_f32_16x16x32_bf16 v[196:199], a[196:199], a[148:151], v[196:199]
    buffer_load_dwordx4 v11, s[8:11], s57 offen offset:0 lds
    v_mfma_f32_16x16x32_bf16 v[200:203], a[192:195], a[136:139], v[200:203]
    v_mfma_f32_16x16x32_bf16 v[200:203], a[196:199], a[152:155], v[200:203]
    v_mfma_f32_16x16x32_bf16 v[204:207], a[192:195], a[140:143], v[204:207]
    v_mfma_f32_16x16x32_bf16 v[204:207], a[196:199], a[156:159], v[204:207]
    s_waitcnt lgkmcnt(12)
    buffer_load_dwordx4 v12, s[8:11], s57 offen offset:1024 lds
    v_mfma_f32_16x16x32_bf16 v[208:211], a[200:203], a[128:131], v[208:211]
    ds_read_b64_tr_b16 a[192:193], v22 offset:0
    ds_read_b64_tr_b16 a[194:195], v22 offset:512
    v_mfma_f32_16x16x32_bf16 v[208:211], a[204:207], a[144:147], v[208:211]
    ds_read_b64_tr_b16 a[196:197], v22 offset:16384
    ds_read_b64_tr_b16 a[198:199], v22 offset:16896
    v_mfma_f32_16x16x32_bf16 v[212:215], a[200:203], a[132:135], v[212:215]
    v_mfma_f32_16x16x32_bf16 v[212:215], a[204:207], a[148:151], v[212:215]
    buffer_load_dwordx4 v13, s[8:11], s57 offen offset:2048 lds
    v_mfma_f32_16x16x32_bf16 v[216:219], a[200:203], a[136:139], v[216:219]
    v_mfma_f32_16x16x32_bf16 v[216:219], a[204:207], a[152:155], v[216:219]
    v_mfma_f32_16x16x32_bf16 v[220:223], a[200:203], a[140:143], v[220:223]
    v_mfma_f32_16x16x32_bf16 v[220:223], a[204:207], a[156:159], v[220:223]
    s_waitcnt lgkmcnt(8)
    buffer_load_dwordx4 v14, s[8:11], s57 offen offset:3072 lds
    v_mfma_f32_16x16x32_bf16 v[224:227], a[208:211], a[128:131], v[224:227]
    ds_read_b64_tr_b16 a[200:201], v23 offset:0
    ds_read_b64_tr_b16 a[202:203], v23 offset:512
    v_mfma_f32_16x16x32_bf16 v[224:227], a[212:215], a[144:147], v[224:227]
    ds_read_b64_tr_b16 a[204:205], v23 offset:16384
    ds_read_b64_tr_b16 a[206:207], v23 offset:16896
    v_mfma_f32_16x16x32_bf16 v[228:231], a[208:211], a[132:135], v[228:231]
    s_add_u32 m0, s95, 4096
    v_mfma_f32_16x16x32_bf16 v[228:231], a[212:215], a[148:151], v[228:231]
    s_add_u32 s57, s57, 32768
    ds_read_b64_tr_b16 a[224:225], v26 offset:0
    ds_read_b64_tr_b16 a[226:227], v27 offset:0
    v_mfma_f32_16x16x32_bf16 v[232:235], a[208:211], a[136:139], v[232:235]
    buffer_load_dwordx4 v11, s[8:11], s57 offen offset:0 lds
    v_mfma_f32_16x16x32_bf16 v[232:235], a[212:215], a[152:155], v[232:235]
    ds_read_b64_tr_b16 a[228:229], v26 offset:16384
    ds_read_b64_tr_b16 a[230:231], v27 offset:16384
    v_mfma_f32_16x16x32_bf16 v[236:239], a[208:211], a[140:143], v[236:239]
    v_mfma_f32_16x16x32_bf16 v[236:239], a[212:215], a[156:159], v[236:239]
    s_waitcnt lgkmcnt(12)
    v_mfma_f32_16x16x32_bf16 v[240:243], a[216:219], a[128:131], v[240:243]
    ds_read_b64_tr_b16 a[208:209], v24 offset:0
    ds_read_b64_tr_b16 a[210:211], v24 offset:512
    v_mfma_f32_16x16x32_bf16 v[240:243], a[220:223], a[144:147], v[240:243]
    ds_read_b64_tr_b16 a[212:213], v24 offset:16384
    ds_read_b64_tr_b16 a[214:215], v24 offset:16896
    v_mfma_f32_16x16x32_bf16 v[244:247], a[216:219], a[132:135], v[244:247]
    buffer_load_dwordx4 v12, s[8:11], s57 offen offset:1024 lds
    v_mfma_f32_16x16x32_bf16 v[244:247], a[220:223], a[148:151], v[244:247]
    ds_read_b64_tr_b16 a[232:233], v28 offset:0
    ds_read_b64_tr_b16 a[234:235], v29 offset:0
    v_mfma_f32_16x16x32_bf16 v[248:251], a[216:219], a[136:139], v[248:251]
    v_mfma_f32_16x16x32_bf16 v[248:251], a[220:223], a[152:155], v[248:251]
    ds_read_b64_tr_b16 a[236:237], v28 offset:16384
    ds_read_b64_tr_b16 a[238:239], v29 offset:16384
    v_mfma_f32_16x16x32_bf16 v[252:255], a[216:219], a[140:143], v[252:255]
    buffer_load_dwordx4 v13, s[8:11], s57 offen offset:2048 lds
    v_mfma_f32_16x16x32_bf16 v[252:255], a[220:223], a[156:159], v[252:255]
    s_waitcnt lgkmcnt(15)
    v_mfma_f32_16x16x32_bf16 a[0:3], a[192:195], a[128:131], a[0:3]
    ds_read_b64_tr_b16 a[216:217], v25 offset:0
    ds_read_b64_tr_b16 a[218:219], v25 offset:512
    v_mfma_f32_16x16x32_bf16 a[0:3], a[196:199], a[144:147], a[0:3]
    ds_read_b64_tr_b16 a[220:221], v25 offset:16384
    ds_read_b64_tr_b16 a[222:223], v25 offset:16896
    v_mfma_f32_16x16x32_bf16 a[4:7], a[192:195], a[132:135], a[4:7]
    buffer_load_dwordx4 v14, s[8:11], s57 offen offset:3072 lds
    v_mfma_f32_16x16x32_bf16 a[4:7], a[196:199], a[148:151], a[4:7]
    ds_read_b64_tr_b16 a[240:241], v30 offset:0
    ds_read_b64_tr_b16 a[242:243], v31 offset:0
    v_mfma_f32_16x16x32_bf16 a[8:11], a[192:195], a[136:139], a[8:11]
    v_mfma_f32_16x16x32_bf16 a[8:11], a[196:199], a[152:155], a[8:11]
    ds_read_b64_tr_b16 a[244:245], v30 offset:16384
    ds_read_b64_tr_b16 a[246:247], v31 offset:16384
    v_mfma_f32_16x16x32_bf16 a[12:15], a[192:195], a[140:143], a[12:15]
    v_mfma_f32_16x16x32_bf16 a[12:15], a[196:199], a[156:159], a[12:15]
    s_waitcnt lgkmcnt(15)
    v_mfma_f32_16x16x32_bf16 a[16:19], a[200:203], a[128:131], a[16:19]
    ds_read_b64_tr_b16 a[192:193], v22 offset:1024
    ds_read_b64_tr_b16 a[194:195], v22 offset:1536
    v_mfma_f32_16x16x32_bf16 a[16:19], a[204:207], a[144:147], a[16:19]
    ds_read_b64_tr_b16 a[196:197], v22 offset:17408
    ds_read_b64_tr_b16 a[198:199], v22 offset:17920
    v_mfma_f32_16x16x32_bf16 a[20:23], a[200:203], a[132:135], a[20:23]
    v_mfma_f32_16x16x32_bf16 a[20:23], a[204:207], a[148:151], a[20:23]
    ds_read_b64_tr_b16 a[248:249], v32 offset:0
    ds_read_b64_tr_b16 a[250:251], v33 offset:0
    v_mfma_f32_16x16x32_bf16 a[24:27], a[200:203], a[136:139], a[24:27]
    v_mfma_f32_16x16x32_bf16 a[24:27], a[204:207], a[152:155], a[24:27]
    ds_read_b64_tr_b16 a[252:253], v32 offset:16384
    ds_read_b64_tr_b16 a[254:255], v33 offset:16384
    v_mfma_f32_16x16x32_bf16 a[28:31], a[200:203], a[140:143], a[28:31]
    v_mfma_f32_16x16x32_bf16 a[28:31], a[204:207], a[156:159], a[28:31]
    s_waitcnt lgkmcnt(15)
    v_mfma_f32_16x16x32_bf16 a[32:35], a[208:211], a[128:131], a[32:35]
    ds_read_b64_tr_b16 a[200:201], v23 offset:1024
    ds_read_b64_tr_b16 a[202:203], v23 offset:1536
    v_mfma_f32_16x16x32_bf16 a[32:35], a[212:215], a[144:147], a[32:35]
    ds_read_b64_tr_b16 a[204:205], v23 offset:17408
    ds_read_b64_tr_b16 a[206:207], v23 offset:17920
    v_mfma_f32_16x16x32_bf16 a[36:39], a[208:211], a[132:135], a[36:39]
    v_mfma_f32_16x16x32_bf16 a[36:39], a[212:215], a[148:151], a[36:39]
    v_xor_b32 v26, 0x10000, v26
    v_xor_b32 v27, 0x10000, v27
    v_mfma_f32_16x16x32_bf16 a[40:43], a[208:211], a[136:139], a[40:43]
    v_mfma_f32_16x16x32_bf16 a[40:43], a[212:215], a[152:155], a[40:43]
    v_xor_b32 v28, 0x10000, v28
    v_xor_b32 v29, 0x10000, v29
    v_mfma_f32_16x16x32_bf16 a[44:47], a[208:211], a[140:143], a[44:47]
    v_mfma_f32_16x16x32_bf16 a[44:47], a[212:215], a[156:159], a[44:47]
    s_waitcnt lgkmcnt(15)
    v_mfma_f32_16x16x32_bf16 a[48:51], a[216:219], a[128:131], a[48:51]
    ds_read_b64_tr_b16 a[208:209], v24 offset:1024
    ds_read_b64_tr_b16 a[210:211], v24 offset:1536
    v_mfma_f32_16x16x32_bf16 a[48:51], a[220:223], a[144:147], a[48:51]
    ds_read_b64_tr_b16 a[212:213], v24 offset:17408
    ds_read_b64_tr_b16 a[214:215], v24 offset:17920
    v_mfma_f32_16x16x32_bf16 a[52:55], a[216:219], a[132:135], a[52:55]
    v_mfma_f32_16x16x32_bf16 a[52:55], a[220:223], a[148:151], a[52:55]
    v_xor_b32 v30, 0x10000, v30
    v_xor_b32 v31, 0x10000, v31
    v_mfma_f32_16x16x32_bf16 a[56:59], a[216:219], a[136:139], a[56:59]
    v_mfma_f32_16x16x32_bf16 a[56:59], a[220:223], a[152:155], a[56:59]
    v_xor_b32 v32, 0x10000, v32
    v_xor_b32 v33, 0x10000, v33
    v_mfma_f32_16x16x32_bf16 a[60:63], a[216:219], a[140:143], a[60:63]
    v_mfma_f32_16x16x32_bf16 a[60:63], a[220:223], a[156:159], a[60:63]
    s_waitcnt lgkmcnt(12)
    v_mfma_f32_16x16x32_bf16 a[64:67], a[192:195], a[128:131], a[64:67]
    ds_read_b64_tr_b16 a[216:217], v25 offset:1024
    ds_read_b64_tr_b16 a[218:219], v25 offset:1536
    v_mfma_f32_16x16x32_bf16 a[64:67], a[196:199], a[144:147], a[64:67]
    ds_read_b64_tr_b16 a[220:221], v25 offset:17408
    ds_read_b64_tr_b16 a[222:223], v25 offset:17920
    v_mfma_f32_16x16x32_bf16 a[68:71], a[192:195], a[132:135], a[68:71]
    v_xor_b32 v18, 0x10000, v18
    v_xor_b32 v19, 0x10000, v19
    v_mfma_f32_16x16x32_bf16 a[68:71], a[196:199], a[148:151], a[68:71]
    v_xor_b32 v20, 0x10000, v20
    v_xor_b32 v21, 0x10000, v21
    v_mfma_f32_16x16x32_bf16 a[72:75], a[192:195], a[136:139], a[72:75]
    v_xor_b32 v22, 0x10000, v22
    v_xor_b32 v23, 0x10000, v23
    v_mfma_f32_16x16x32_bf16 a[72:75], a[196:199], a[152:155], a[72:75]
    v_xor_b32 v24, 0x10000, v24
    v_xor_b32 v25, 0x10000, v25
    v_mfma_f32_16x16x32_bf16 a[76:79], a[192:195], a[140:143], a[76:79]
    v_mfma_f32_16x16x32_bf16 a[76:79], a[196:199], a[156:159], a[76:79]
    s_waitcnt lgkmcnt(8)
    s_waitcnt lgkmcnt(0)
    s_waitcnt vmcnt(24)
    s_barrier
    v_mfma_f32_16x16x32_bf16 a[80:83], a[200:203], a[128:131], a[80:83]
    s_mov_b32 s58, 2621440
    ds_read_b64_tr_b16 a[192:193], v18 offset:0
    ds_read_b64_tr_b16 a[194:195], v18 offset:1024
    v_mfma_f32_16x16x32_bf16 a[80:83], a[204:207], a[144:147], a[80:83]
    s_mov_b32 s59, 1146880
    ds_read_b64_tr_b16 a[196:197], v18 offset:16384
    ds_read_b64_tr_b16 a[198:199], v18 offset:17408
    v_mfma_f32_16x16x32_bf16 a[84:87], a[200:203], a[132:135], a[84:87]
    s_add_u32 m0, s56, 65536
    v_mfma_f32_16x16x32_bf16 a[84:87], a[204:207], a[148:151], a[84:87]
    buffer_load_dwordx4 v15, s[12:15], s58 offen lds
    v_mfma_f32_16x16x32_bf16 a[88:91], a[200:203], a[136:139], a[88:91]
    v_mfma_f32_16x16x32_bf16 a[88:91], a[204:207], a[152:155], a[88:91]
    v_mfma_f32_16x16x32_bf16 a[92:95], a[200:203], a[140:143], a[92:95]
    v_mfma_f32_16x16x32_bf16 a[92:95], a[204:207], a[156:159], a[92:95]
    s_waitcnt lgkmcnt(8)
    buffer_load_dwordx4 v16, s[12:15], s58 offen offset:1024 lds
    v_mfma_f32_16x16x32_bf16 a[96:99], a[208:211], a[128:131], a[96:99]
    ds_read_b64_tr_b16 a[200:201], v18 offset:8
    ds_read_b64_tr_b16 a[202:203], v18 offset:1032
    v_mfma_f32_16x16x32_bf16 a[96:99], a[212:215], a[144:147], a[96:99]
    ds_read_b64_tr_b16 a[204:205], v18 offset:16392
    ds_read_b64_tr_b16 a[206:207], v18 offset:17416
    v_mfma_f32_16x16x32_bf16 a[100:103], a[208:211], a[132:135], a[100:103]
    s_add_u32 m0, s56, 67584
    v_mfma_f32_16x16x32_bf16 a[100:103], a[212:215], a[148:151], a[100:103]
    buffer_load_dwordx4 v17, s[16:19], s59 offen lds
    v_mfma_f32_16x16x32_bf16 a[104:107], a[208:211], a[136:139], a[104:107]
    v_mfma_f32_16x16x32_bf16 a[104:107], a[212:215], a[152:155], a[104:107]
    v_mfma_f32_16x16x32_bf16 a[108:111], a[208:211], a[140:143], a[108:111]
    s_add_u32 m0, s56, 68608
    v_mfma_f32_16x16x32_bf16 a[108:111], a[212:215], a[156:159], a[108:111]
    s_waitcnt lgkmcnt(8)
    buffer_load_dwordx4 v17, s[20:23], s59 offen lds
    v_mfma_f32_16x16x32_bf16 a[112:115], a[216:219], a[128:131], a[112:115]
    ds_read_b64_tr_b16 a[208:209], v19 offset:0
    ds_read_b64_tr_b16 a[210:211], v19 offset:1024
    v_mfma_f32_16x16x32_bf16 a[112:115], a[220:223], a[144:147], a[112:115]
    s_add_u32 m0, s56, 81920
    ds_read_b64_tr_b16 a[212:213], v19 offset:16384
    ds_read_b64_tr_b16 a[214:215], v19 offset:17408
    v_mfma_f32_16x16x32_bf16 a[116:119], a[216:219], a[132:135], a[116:119]
    s_add_u32 s58, s58, 262144
    v_mfma_f32_16x16x32_bf16 a[116:119], a[220:223], a[148:151], a[116:119]
    buffer_load_dwordx4 v15, s[12:15], s58 offen lds
    v_mfma_f32_16x16x32_bf16 a[120:123], a[216:219], a[136:139], a[120:123]
    v_mfma_f32_16x16x32_bf16 a[120:123], a[220:223], a[152:155], a[120:123]
    v_mfma_f32_16x16x32_bf16 a[124:127], a[216:219], a[140:143], a[124:127]
    v_mfma_f32_16x16x32_bf16 a[124:127], a[220:223], a[156:159], a[124:127]
    s_waitcnt lgkmcnt(15)
    buffer_load_dwordx4 v16, s[12:15], s58 offen offset:1024 lds
    v_mfma_f32_16x16x32_bf16 v[112:115], a[224:227], v[104:107], v[112:115]
    v_mfma_f32_16x16x32_bf16 v[112:115], a[228:231], v[104:107], v[112:115]
    s_add_u32 m0, s56, 83968
    v_mfma_f32_16x16x32_bf16 v[116:119], a[232:235], v[104:107], v[116:119]
    s_add_u32 s59, s59, 114688
    v_mfma_f32_16x16x32_bf16 v[116:119], a[236:239], v[104:107], v[116:119]
    buffer_load_dwordx4 v17, s[16:19], s59 offen lds
    v_mfma_f32_16x16x32_bf16 v[120:123], a[240:243], v[104:107], v[120:123]
    v_mfma_f32_16x16x32_bf16 v[120:123], a[244:247], v[104:107], v[120:123]
    v_mfma_f32_16x16x32_bf16 v[124:127], a[248:251], v[104:107], v[124:127]
    s_add_u32 m0, s56, 84992
    v_mfma_f32_16x16x32_bf16 v[124:127], a[252:255], v[104:107], v[124:127]
    s_waitcnt lgkmcnt(8)
    buffer_load_dwordx4 v17, s[20:23], s59 offen lds
    v_mfma_f32_16x16x32_bf16 v[128:131], a[192:195], a[160:163], v[128:131]
    ds_read_b64_tr_b16 a[216:217], v19 offset:8
    ds_read_b64_tr_b16 a[218:219], v19 offset:1032
    v_mfma_f32_16x16x32_bf16 v[128:131], a[196:199], a[176:179], v[128:131]
    ds_read_b64_tr_b16 a[220:221], v19 offset:16392
    ds_read_b64_tr_b16 a[222:223], v19 offset:17416
    v_mfma_f32_16x16x32_bf16 v[132:135], a[192:195], a[164:167], v[132:135]
    v_mfma_f32_16x16x32_bf16 v[132:135], a[196:199], a[180:183], v[132:135]
    v_mfma_f32_16x16x32_bf16 v[136:139], a[192:195], a[168:171], v[136:139]
    v_mfma_f32_16x16x32_bf16 v[136:139], a[196:199], a[184:187], v[136:139]
    v_mfma_f32_16x16x32_bf16 v[140:143], a[192:195], a[172:175], v[140:143]
    v_mfma_f32_16x16x32_bf16 v[140:143], a[196:199], a[188:191], v[140:143]
    s_waitcnt lgkmcnt(8)
    v_mfma_f32_16x16x32_bf16 v[144:147], a[200:203], a[160:163], v[144:147]
    ds_read_b64_tr_b16 a[192:193], v20 offset:0
    ds_read_b64_tr_b16 a[194:195], v20 offset:1024
    v_mfma_f32_16x16x32_bf16 v[144:147], a[204:207], a[176:179], v[144:147]
    ds_read_b64_tr_b16 a[196:197], v20 offset:16384
    ds_read_b64_tr_b16 a[198:199], v20 offset:17408
    v_mfma_f32_16x16x32_bf16 v[148:151], a[200:203], a[164:167], v[148:151]
    s_waitcnt vmcnt(8)
    v_mfma_f32_16x16x32_bf16 v[148:151], a[204:207], a[180:183], v[148:151]
    ds_read_b128 a[128:131], v6 offset:0
    ds_read_b128 a[132:135], v6 offset:2048
    v_mfma_f32_16x16x32_bf16 v[152:155], a[200:203], a[168:171], v[152:155]
    v_mfma_f32_16x16x32_bf16 v[152:155], a[204:207], a[184:187], v[152:155]
    ds_read_b128 a[136:139], v6 offset:4096
    ds_read_b128 a[140:143], v6 offset:6144
    v_mfma_f32_16x16x32_bf16 v[156:159], a[200:203], a[172:175], v[156:159]
    v_mfma_f32_16x16x32_bf16 v[156:159], a[204:207], a[188:191], v[156:159]
    s_waitcnt lgkmcnt(12)
    v_mfma_f32_16x16x32_bf16 v[160:163], a[208:211], a[160:163], v[160:163]
    ds_read_b64_tr_b16 a[200:201], v20 offset:8
    ds_read_b64_tr_b16 a[202:203], v20 offset:1032
    v_mfma_f32_16x16x32_bf16 v[160:163], a[212:215], a[176:179], v[160:163]
    ds_read_b64_tr_b16 a[204:205], v20 offset:16392
    ds_read_b64_tr_b16 a[206:207], v20 offset:17416
    v_mfma_f32_16x16x32_bf16 v[164:167], a[208:211], a[164:167], v[164:167]
    v_mfma_f32_16x16x32_bf16 v[164:167], a[212:215], a[180:183], v[164:167]
    ds_read_b128 a[144:147], v7 offset:0
    ds_read_b128 a[148:151], v7 offset:2048
    v_mfma_f32_16x16x32_bf16 v[168:171], a[208:211], a[168:171], v[168:171]
    v_mfma_f32_16x16x32_bf16 v[168:171], a[212:215], a[184:187], v[168:171]
    ds_read_b128 a[152:155], v7 offset:4096
    ds_read_b128 a[156:159], v7 offset:6144
    v_mfma_f32_16x16x32_bf16 v[172:175], a[208:211], a[172:175], v[172:175]
    v_mfma_f32_16x16x32_bf16 v[172:175], a[212:215], a[188:191], v[172:175]
    s_waitcnt lgkmcnt(15)
    v_mfma_f32_16x16x32_bf16 v[176:179], a[216:219], a[160:163], v[176:179]
    ds_read_b64_tr_b16 a[208:209], v21 offset:0
    ds_read_b64_tr_b16 a[210:211], v21 offset:1024
    v_mfma_f32_16x16x32_bf16 v[176:179], a[220:223], a[176:179], v[176:179]
    ds_read_b64_tr_b16 a[212:213], v21 offset:16384
    ds_read_b64_tr_b16 a[214:215], v21 offset:17408
    v_mfma_f32_16x16x32_bf16 v[180:183], a[216:219], a[164:167], v[180:183]
    v_mfma_f32_16x16x32_bf16 v[180:183], a[220:223], a[180:183], v[180:183]
    v_mfma_f32_16x16x32_bf16 v[184:187], a[216:219], a[168:171], v[184:187]
    v_mfma_f32_16x16x32_bf16 v[184:187], a[220:223], a[184:187], v[184:187]
    v_mfma_f32_16x16x32_bf16 v[188:191], a[216:219], a[172:175], v[188:191]
    v_mfma_f32_16x16x32_bf16 v[188:191], a[220:223], a[188:191], v[188:191]
    s_waitcnt lgkmcnt(15)
    v_mfma_f32_16x16x32_bf16 v[192:195], a[192:195], a[160:163], v[192:195]
    ds_read_b64_tr_b16 a[216:217], v21 offset:8
    ds_read_b64_tr_b16 a[218:219], v21 offset:1032
    v_mfma_f32_16x16x32_bf16 v[192:195], a[196:199], a[176:179], v[192:195]
    s_mov_b32 s57, 640
    ds_read_b64_tr_b16 a[220:221], v21 offset:16392
    ds_read_b64_tr_b16 a[222:223], v21 offset:17416
    v_mfma_f32_16x16x32_bf16 v[196:199], a[192:195], a[164:167], v[196:199]
    s_waitcnt lgkmcnt(8)
    s_mov_b32 m0, s95
    v_mfma_f32_16x16x32_bf16 v[196:199], a[196:199], a[180:183], v[196:199]
    buffer_load_dwordx4 v11, s[8:11], s57 offen offset:0 lds
    v_mfma_f32_16x16x32_bf16 v[200:203], a[192:195], a[168:171], v[200:203]
    v_mfma_f32_16x16x32_bf16 v[200:203], a[196:199], a[184:187], v[200:203]
    v_mfma_f32_16x16x32_bf16 v[204:207], a[192:195], a[172:175], v[204:207]
    v_mfma_f32_16x16x32_bf16 v[204:207], a[196:199], a[188:191], v[204:207]
    s_waitcnt lgkmcnt(12)
    buffer_load_dwordx4 v12, s[8:11], s57 offen offset:1024 lds
    v_mfma_f32_16x16x32_bf16 v[208:211], a[200:203], a[160:163], v[208:211]
    ds_read_b64_tr_b16 a[192:193], v22 offset:0
    ds_read_b64_tr_b16 a[194:195], v22 offset:512
    v_mfma_f32_16x16x32_bf16 v[208:211], a[204:207], a[176:179], v[208:211]
    ds_read_b64_tr_b16 a[196:197], v22 offset:16384
    ds_read_b64_tr_b16 a[198:199], v22 offset:16896
    v_mfma_f32_16x16x32_bf16 v[212:215], a[200:203], a[164:167], v[212:215]
    v_mfma_f32_16x16x32_bf16 v[212:215], a[204:207], a[180:183], v[212:215]
    buffer_load_dwordx4 v13, s[8:11], s57 offen offset:2048 lds
    v_mfma_f32_16x16x32_bf16 v[216:219], a[200:203], a[168:171], v[216:219]
    v_mfma_f32_16x16x32_bf16 v[216:219], a[204:207], a[184:187], v[216:219]
    v_mfma_f32_16x16x32_bf16 v[220:223], a[200:203], a[172:175], v[220:223]
    v_mfma_f32_16x16x32_bf16 v[220:223], a[204:207], a[188:191], v[220:223]
    s_waitcnt lgkmcnt(8)
    buffer_load_dwordx4 v14, s[8:11], s57 offen offset:3072 lds
    v_mfma_f32_16x16x32_bf16 v[224:227], a[208:211], a[160:163], v[224:227]
    ds_read_b64_tr_b16 a[200:201], v23 offset:0
    ds_read_b64_tr_b16 a[202:203], v23 offset:512
    v_mfma_f32_16x16x32_bf16 v[224:227], a[212:215], a[176:179], v[224:227]
    ds_read_b64_tr_b16 a[204:205], v23 offset:16384
    ds_read_b64_tr_b16 a[206:207], v23 offset:16896
    v_mfma_f32_16x16x32_bf16 v[228:231], a[208:211], a[164:167], v[228:231]
    s_add_u32 m0, s95, 4096
    v_mfma_f32_16x16x32_bf16 v[228:231], a[212:215], a[180:183], v[228:231]
    s_add_u32 s57, s57, 32768
    ds_read_b64_tr_b16 a[224:225], v26 offset:0
    ds_read_b64_tr_b16 a[226:227], v27 offset:0
    v_mfma_f32_16x16x32_bf16 v[232:235], a[208:211], a[168:171], v[232:235]
    buffer_load_dwordx4 v11, s[8:11], s57 offen offset:0 lds
    v_mfma_f32_16x16x32_bf16 v[232:235], a[212:215], a[184:187], v[232:235]
    ds_read_b64_tr_b16 a[228:229], v26 offset:16384
    ds_read_b64_tr_b16 a[230:231], v27 offset:16384
    v_mfma_f32_16x16x32_bf16 v[236:239], a[208:211], a[172:175], v[236:239]
    v_mfma_f32_16x16x32_bf16 v[236:239], a[212:215], a[188:191], v[236:239]
    s_waitcnt lgkmcnt(12)
    v_mfma_f32_16x16x32_bf16 v[240:243], a[216:219], a[160:163], v[240:243]
    ds_read_b64_tr_b16 a[208:209], v24 offset:0
    ds_read_b64_tr_b16 a[210:211], v24 offset:512
    v_mfma_f32_16x16x32_bf16 v[240:243], a[220:223], a[176:179], v[240:243]
    ds_read_b64_tr_b16 a[212:213], v24 offset:16384
    ds_read_b64_tr_b16 a[214:215], v24 offset:16896
    v_mfma_f32_16x16x32_bf16 v[244:247], a[216:219], a[164:167], v[244:247]
    buffer_load_dwordx4 v12, s[8:11], s57 offen offset:1024 lds
    v_mfma_f32_16x16x32_bf16 v[244:247], a[220:223], a[180:183], v[244:247]
    ds_read_b64_tr_b16 a[232:233], v28 offset:0
    ds_read_b64_tr_b16 a[234:235], v29 offset:0
    v_mfma_f32_16x16x32_bf16 v[248:251], a[216:219], a[168:171], v[248:251]
    v_mfma_f32_16x16x32_bf16 v[248:251], a[220:223], a[184:187], v[248:251]
    ds_read_b64_tr_b16 a[236:237], v28 offset:16384
    ds_read_b64_tr_b16 a[238:239], v29 offset:16384
    v_mfma_f32_16x16x32_bf16 v[252:255], a[216:219], a[172:175], v[252:255]
    buffer_load_dwordx4 v13, s[8:11], s57 offen offset:2048 lds
    v_mfma_f32_16x16x32_bf16 v[252:255], a[220:223], a[188:191], v[252:255]
    s_waitcnt lgkmcnt(15)
    v_mfma_f32_16x16x32_bf16 a[0:3], a[192:195], a[160:163], a[0:3]
    ds_read_b64_tr_b16 a[216:217], v25 offset:0
    ds_read_b64_tr_b16 a[218:219], v25 offset:512
    v_mfma_f32_16x16x32_bf16 a[0:3], a[196:199], a[176:179], a[0:3]
    ds_read_b64_tr_b16 a[220:221], v25 offset:16384
    ds_read_b64_tr_b16 a[222:223], v25 offset:16896
    v_mfma_f32_16x16x32_bf16 a[4:7], a[192:195], a[164:167], a[4:7]
    buffer_load_dwordx4 v14, s[8:11], s57 offen offset:3072 lds
    v_mfma_f32_16x16x32_bf16 a[4:7], a[196:199], a[180:183], a[4:7]
    ds_read_b64_tr_b16 a[240:241], v30 offset:0
    ds_read_b64_tr_b16 a[242:243], v31 offset:0
    v_mfma_f32_16x16x32_bf16 a[8:11], a[192:195], a[168:171], a[8:11]
    v_mfma_f32_16x16x32_bf16 a[8:11], a[196:199], a[184:187], a[8:11]
    s_add_u32 m0, s56, 131072
    ds_read_b64_tr_b16 a[244:245], v30 offset:16384
    ds_read_b64_tr_b16 a[246:247], v31 offset:16384
    v_mfma_f32_16x16x32_bf16 a[12:15], a[192:195], a[172:175], a[12:15]
    buffer_load_dwordx4 v46, s[24:27], s56 offen offset:0 lds
    v_mfma_f32_16x16x32_bf16 a[12:15], a[196:199], a[188:191], a[12:15]
    s_waitcnt lgkmcnt(15)
    v_mfma_f32_16x16x32_bf16 a[16:19], a[200:203], a[160:163], a[16:19]
    ds_read_b64_tr_b16 a[192:193], v22 offset:1024
    ds_read_b64_tr_b16 a[194:195], v22 offset:1536
    v_mfma_f32_16x16x32_bf16 a[16:19], a[204:207], a[176:179], a[16:19]
    ds_read_b64_tr_b16 a[196:197], v22 offset:17408
    ds_read_b64_tr_b16 a[198:199], v22 offset:17920
    v_mfma_f32_16x16x32_bf16 a[20:23], a[200:203], a[164:167], a[20:23]
    buffer_load_dwordx4 v47, s[24:27], s56 offen offset:1024 lds
    v_mfma_f32_16x16x32_bf16 a[20:23], a[204:207], a[180:183], a[20:23]
    ds_read_b64_tr_b16 a[248:249], v32 offset:0
    ds_read_b64_tr_b16 a[250:251], v33 offset:0
    v_mfma_f32_16x16x32_bf16 a[24:27], a[200:203], a[168:171], a[24:27]
    v_mfma_f32_16x16x32_bf16 a[24:27], a[204:207], a[184:187], a[24:27]
    ds_read_b64_tr_b16 a[252:253], v32 offset:16384
    ds_read_b64_tr_b16 a[254:255], v33 offset:16384
    v_mfma_f32_16x16x32_bf16 a[28:31], a[200:203], a[172:175], a[28:31]
    buffer_load_dwordx4 v46, s[24:27], s56 offen offset:2048 lds
    v_mfma_f32_16x16x32_bf16 a[28:31], a[204:207], a[188:191], a[28:31]
    s_waitcnt lgkmcnt(15)
    v_mfma_f32_16x16x32_bf16 a[32:35], a[208:211], a[160:163], a[32:35]
    ds_read_b64_tr_b16 a[200:201], v23 offset:1024
    ds_read_b64_tr_b16 a[202:203], v23 offset:1536
    v_mfma_f32_16x16x32_bf16 a[32:35], a[212:215], a[176:179], a[32:35]
    ds_read_b64_tr_b16 a[204:205], v23 offset:17408
    ds_read_b64_tr_b16 a[206:207], v23 offset:17920
    v_mfma_f32_16x16x32_bf16 a[36:39], a[208:211], a[164:167], a[36:39]
    buffer_load_dwordx4 v47, s[24:27], s56 offen offset:3072 lds
    v_mfma_f32_16x16x32_bf16 a[36:39], a[212:215], a[180:183], a[36:39]
    v_mfma_f32_16x16x32_bf16 a[40:43], a[208:211], a[168:171], a[40:43]
    v_mfma_f32_16x16x32_bf16 a[40:43], a[212:215], a[184:187], a[40:43]
    v_mfma_f32_16x16x32_bf16 a[44:47], a[208:211], a[172:175], a[44:47]
    v_mfma_f32_16x16x32_bf16 a[44:47], a[212:215], a[188:191], a[44:47]
    s_waitcnt lgkmcnt(15)
    v_mfma_f32_16x16x32_bf16 a[48:51], a[216:219], a[160:163], a[48:51]
    ds_read_b64_tr_b16 a[208:209], v24 offset:1024
    ds_read_b64_tr_b16 a[210:211], v24 offset:1536
    v_mfma_f32_16x16x32_bf16 a[48:51], a[220:223], a[176:179], a[48:51]
    ds_read_b64_tr_b16 a[212:213], v24 offset:17408
    ds_read_b64_tr_b16 a[214:215], v24 offset:17920
    v_mfma_f32_16x16x32_bf16 a[52:55], a[216:219], a[164:167], a[52:55]
    v_mfma_f32_16x16x32_bf16 a[52:55], a[220:223], a[180:183], a[52:55]
    v_mfma_f32_16x16x32_bf16 a[56:59], a[216:219], a[168:171], a[56:59]
    v_mfma_f32_16x16x32_bf16 a[56:59], a[220:223], a[184:187], a[56:59]
    v_mfma_f32_16x16x32_bf16 a[60:63], a[216:219], a[172:175], a[60:63]
    v_mfma_f32_16x16x32_bf16 a[60:63], a[220:223], a[188:191], a[60:63]
    s_waitcnt lgkmcnt(12)
    v_mfma_f32_16x16x32_bf16 a[64:67], a[192:195], a[160:163], a[64:67]
    ds_read_b64_tr_b16 a[216:217], v25 offset:1024
    ds_read_b64_tr_b16 a[218:219], v25 offset:1536
    v_mfma_f32_16x16x32_bf16 a[64:67], a[196:199], a[176:179], a[64:67]
    ds_read_b64_tr_b16 a[220:221], v25 offset:17408
    ds_read_b64_tr_b16 a[222:223], v25 offset:17920
    v_mfma_f32_16x16x32_bf16 a[68:71], a[192:195], a[164:167], a[68:71]
    v_mfma_f32_16x16x32_bf16 a[68:71], a[196:199], a[180:183], a[68:71]
    v_mfma_f32_16x16x32_bf16 a[72:75], a[192:195], a[168:171], a[72:75]
    v_mfma_f32_16x16x32_bf16 a[72:75], a[196:199], a[184:187], a[72:75]
    v_mfma_f32_16x16x32_bf16 a[76:79], a[192:195], a[172:175], a[76:79]
    v_mfma_f32_16x16x32_bf16 a[76:79], a[196:199], a[188:191], a[76:79]
    s_waitcnt lgkmcnt(8)
    s_waitcnt lgkmcnt(0)
    s_waitcnt vmcnt(28)
    s_barrier
    v_mfma_f32_16x16x32_bf16 a[80:83], a[200:203], a[160:163], a[80:83]
    s_mov_b32 s58, 3145728
    ds_read_b64_tr_b16 a[192:193], v18 offset:32768
    ds_read_b64_tr_b16 a[194:195], v18 offset:33792
    v_mfma_f32_16x16x32_bf16 a[80:83], a[204:207], a[176:179], a[80:83]
    s_mov_b32 s59, 1376256
    ds_read_b64_tr_b16 a[196:197], v18 offset:49152
    ds_read_b64_tr_b16 a[198:199], v18 offset:50176
    v_mfma_f32_16x16x32_bf16 a[84:87], a[200:203], a[164:167], a[84:87]
    s_add_u32 m0, s56, 0
    v_mfma_f32_16x16x32_bf16 a[84:87], a[204:207], a[180:183], a[84:87]
    buffer_load_dwordx4 v15, s[12:15], s58 offen lds
    v_mfma_f32_16x16x32_bf16 a[88:91], a[200:203], a[168:171], a[88:91]
    v_mfma_f32_16x16x32_bf16 a[88:91], a[204:207], a[184:187], a[88:91]
    v_mfma_f32_16x16x32_bf16 a[92:95], a[200:203], a[172:175], a[92:95]
    v_mfma_f32_16x16x32_bf16 a[92:95], a[204:207], a[188:191], a[92:95]
    s_waitcnt lgkmcnt(8)
    buffer_load_dwordx4 v16, s[12:15], s58 offen offset:1024 lds
    v_mfma_f32_16x16x32_bf16 a[96:99], a[208:211], a[160:163], a[96:99]
    ds_read_b64_tr_b16 a[200:201], v18 offset:32776
    ds_read_b64_tr_b16 a[202:203], v18 offset:33800
    v_mfma_f32_16x16x32_bf16 a[96:99], a[212:215], a[176:179], a[96:99]
    ds_read_b64_tr_b16 a[204:205], v18 offset:49160
    ds_read_b64_tr_b16 a[206:207], v18 offset:50184
    v_mfma_f32_16x16x32_bf16 a[100:103], a[208:211], a[164:167], a[100:103]
    s_add_u32 m0, s56, 2048
    v_mfma_f32_16x16x32_bf16 a[100:103], a[212:215], a[180:183], a[100:103]
    buffer_load_dwordx4 v17, s[16:19], s59 offen lds
    v_mfma_f32_16x16x32_bf16 a[104:107], a[208:211], a[168:171], a[104:107]
    v_mfma_f32_16x16x32_bf16 a[104:107], a[212:215], a[184:187], a[104:107]
    v_mfma_f32_16x16x32_bf16 a[108:111], a[208:211], a[172:175], a[108:111]
    s_add_u32 m0, s56, 3072
    v_mfma_f32_16x16x32_bf16 a[108:111], a[212:215], a[188:191], a[108:111]
    s_waitcnt lgkmcnt(8)
    buffer_load_dwordx4 v17, s[20:23], s59 offen lds
    v_mfma_f32_16x16x32_bf16 a[112:115], a[216:219], a[160:163], a[112:115]
    ds_read_b64_tr_b16 a[208:209], v19 offset:32768
    ds_read_b64_tr_b16 a[210:211], v19 offset:33792
    v_mfma_f32_16x16x32_bf16 a[112:115], a[220:223], a[176:179], a[112:115]
    s_add_u32 m0, s56, 16384
    ds_read_b64_tr_b16 a[212:213], v19 offset:49152
    ds_read_b64_tr_b16 a[214:215], v19 offset:50176
    v_mfma_f32_16x16x32_bf16 a[116:119], a[216:219], a[164:167], a[116:119]
    s_add_u32 s58, s58, 262144
    v_mfma_f32_16x16x32_bf16 a[116:119], a[220:223], a[180:183], a[116:119]
    buffer_load_dwordx4 v15, s[12:15], s58 offen lds
    v_mfma_f32_16x16x32_bf16 a[120:123], a[216:219], a[168:171], a[120:123]
    v_mfma_f32_16x16x32_bf16 a[120:123], a[220:223], a[184:187], a[120:123]
    v_mfma_f32_16x16x32_bf16 a[124:127], a[216:219], a[172:175], a[124:127]
    v_mfma_f32_16x16x32_bf16 a[124:127], a[220:223], a[188:191], a[124:127]
    s_waitcnt lgkmcnt(15)
    buffer_load_dwordx4 v16, s[12:15], s58 offen offset:1024 lds
    v_mfma_f32_16x16x32_bf16 v[112:115], a[224:227], v[104:107], v[112:115]
    v_mfma_f32_16x16x32_bf16 v[112:115], a[228:231], v[104:107], v[112:115]
    s_add_u32 m0, s56, 18432
    v_mfma_f32_16x16x32_bf16 v[116:119], a[232:235], v[104:107], v[116:119]
    s_add_u32 s59, s59, 114688
    v_mfma_f32_16x16x32_bf16 v[116:119], a[236:239], v[104:107], v[116:119]
    buffer_load_dwordx4 v17, s[16:19], s59 offen lds
    v_mfma_f32_16x16x32_bf16 v[120:123], a[240:243], v[104:107], v[120:123]
    v_mfma_f32_16x16x32_bf16 v[120:123], a[244:247], v[104:107], v[120:123]
    v_mfma_f32_16x16x32_bf16 v[124:127], a[248:251], v[104:107], v[124:127]
    s_add_u32 m0, s56, 19456
    v_mfma_f32_16x16x32_bf16 v[124:127], a[252:255], v[104:107], v[124:127]
    s_waitcnt lgkmcnt(8)
    buffer_load_dwordx4 v17, s[20:23], s59 offen lds
    v_mfma_f32_16x16x32_bf16 v[128:131], a[192:195], a[128:131], v[128:131]
    ds_read_b64_tr_b16 a[216:217], v19 offset:32776
    ds_read_b64_tr_b16 a[218:219], v19 offset:33800
    v_mfma_f32_16x16x32_bf16 v[128:131], a[196:199], a[144:147], v[128:131]
    ds_read_b64_tr_b16 a[220:221], v19 offset:49160
    ds_read_b64_tr_b16 a[222:223], v19 offset:50184
    v_mfma_f32_16x16x32_bf16 v[132:135], a[192:195], a[132:135], v[132:135]
    v_mfma_f32_16x16x32_bf16 v[132:135], a[196:199], a[148:151], v[132:135]
    v_mfma_f32_16x16x32_bf16 v[136:139], a[192:195], a[136:139], v[136:139]
    v_mfma_f32_16x16x32_bf16 v[136:139], a[196:199], a[152:155], v[136:139]
    v_mfma_f32_16x16x32_bf16 v[140:143], a[192:195], a[140:143], v[140:143]
    v_mfma_f32_16x16x32_bf16 v[140:143], a[196:199], a[156:159], v[140:143]
    s_waitcnt lgkmcnt(8)
    v_mfma_f32_16x16x32_bf16 v[144:147], a[200:203], a[128:131], v[144:147]
    ds_read_b64_tr_b16 a[192:193], v20 offset:32768
    ds_read_b64_tr_b16 a[194:195], v20 offset:33792
    v_mfma_f32_16x16x32_bf16 v[144:147], a[204:207], a[144:147], v[144:147]
    ds_read_b64_tr_b16 a[196:197], v20 offset:49152
    ds_read_b64_tr_b16 a[198:199], v20 offset:50176
    v_mfma_f32_16x16x32_bf16 v[148:151], a[200:203], a[132:135], v[148:151]
    s_waitcnt vmcnt(12)
    v_mfma_f32_16x16x32_bf16 v[148:151], a[204:207], a[148:151], v[148:151]
    ds_read_b128 a[160:163], v6 offset:0
    ds_read_b128 a[164:167], v6 offset:2048
    v_mfma_f32_16x16x32_bf16 v[152:155], a[200:203], a[136:139], v[152:155]
    v_mfma_f32_16x16x32_bf16 v[152:155], a[204:207], a[152:155], v[152:155]
    ds_read_b128 a[168:171], v6 offset:4096
    ds_read_b128 a[172:175], v6 offset:6144
    v_mfma_f32_16x16x32_bf16 v[156:159], a[200:203], a[140:143], v[156:159]
    v_mfma_f32_16x16x32_bf16 v[156:159], a[204:207], a[156:159], v[156:159]
    s_waitcnt lgkmcnt(12)
    v_mfma_f32_16x16x32_bf16 v[160:163], a[208:211], a[128:131], v[160:163]
    ds_read_b64_tr_b16 a[200:201], v20 offset:32776
    ds_read_b64_tr_b16 a[202:203], v20 offset:33800
    v_mfma_f32_16x16x32_bf16 v[160:163], a[212:215], a[144:147], v[160:163]
    ds_read_b64_tr_b16 a[204:205], v20 offset:49160
    ds_read_b64_tr_b16 a[206:207], v20 offset:50184
    v_mfma_f32_16x16x32_bf16 v[164:167], a[208:211], a[132:135], v[164:167]
    v_mfma_f32_16x16x32_bf16 v[164:167], a[212:215], a[148:151], v[164:167]
    ds_read_b128 a[176:179], v7 offset:0
    ds_read_b128 a[180:183], v7 offset:2048
    v_mfma_f32_16x16x32_bf16 v[168:171], a[208:211], a[136:139], v[168:171]
    v_mfma_f32_16x16x32_bf16 v[168:171], a[212:215], a[152:155], v[168:171]
    ds_read_b128 a[184:187], v7 offset:4096
    ds_read_b128 a[188:191], v7 offset:6144
    v_mfma_f32_16x16x32_bf16 v[172:175], a[208:211], a[140:143], v[172:175]
    v_mfma_f32_16x16x32_bf16 v[172:175], a[212:215], a[156:159], v[172:175]
    s_waitcnt lgkmcnt(15)
    v_mfma_f32_16x16x32_bf16 v[176:179], a[216:219], a[128:131], v[176:179]
    ds_read_b64_tr_b16 a[208:209], v21 offset:32768
    ds_read_b64_tr_b16 a[210:211], v21 offset:33792
    v_mfma_f32_16x16x32_bf16 v[176:179], a[220:223], a[144:147], v[176:179]
    ds_read_b64_tr_b16 a[212:213], v21 offset:49152
    ds_read_b64_tr_b16 a[214:215], v21 offset:50176
    v_mfma_f32_16x16x32_bf16 v[180:183], a[216:219], a[132:135], v[180:183]
    v_mfma_f32_16x16x32_bf16 v[180:183], a[220:223], a[148:151], v[180:183]
    v_mfma_f32_16x16x32_bf16 v[184:187], a[216:219], a[136:139], v[184:187]
    v_mfma_f32_16x16x32_bf16 v[184:187], a[220:223], a[152:155], v[184:187]
    v_mfma_f32_16x16x32_bf16 v[188:191], a[216:219], a[140:143], v[188:191]
    v_mfma_f32_16x16x32_bf16 v[188:191], a[220:223], a[156:159], v[188:191]
    s_waitcnt lgkmcnt(15)
    v_mfma_f32_16x16x32_bf16 v[192:195], a[192:195], a[128:131], v[192:195]
    ds_read_b64_tr_b16 a[216:217], v21 offset:32776
    ds_read_b64_tr_b16 a[218:219], v21 offset:33800
    v_mfma_f32_16x16x32_bf16 v[192:195], a[196:199], a[144:147], v[192:195]
    s_mov_b32 s57, 768
    ds_read_b64_tr_b16 a[220:221], v21 offset:49160
    ds_read_b64_tr_b16 a[222:223], v21 offset:50184
    v_mfma_f32_16x16x32_bf16 v[196:199], a[192:195], a[132:135], v[196:199]
    s_waitcnt lgkmcnt(8)
    s_mov_b32 m0, s95
    v_mfma_f32_16x16x32_bf16 v[196:199], a[196:199], a[148:151], v[196:199]
    buffer_load_dwordx4 v11, s[8:11], s57 offen offset:0 lds
    v_mfma_f32_16x16x32_bf16 v[200:203], a[192:195], a[136:139], v[200:203]
    v_mfma_f32_16x16x32_bf16 v[200:203], a[196:199], a[152:155], v[200:203]
    v_mfma_f32_16x16x32_bf16 v[204:207], a[192:195], a[140:143], v[204:207]
    v_mfma_f32_16x16x32_bf16 v[204:207], a[196:199], a[156:159], v[204:207]
    s_waitcnt lgkmcnt(12)
    buffer_load_dwordx4 v12, s[8:11], s57 offen offset:1024 lds
    v_mfma_f32_16x16x32_bf16 v[208:211], a[200:203], a[128:131], v[208:211]
    ds_read_b64_tr_b16 a[192:193], v22 offset:32768
    ds_read_b64_tr_b16 a[194:195], v22 offset:33280
    v_mfma_f32_16x16x32_bf16 v[208:211], a[204:207], a[144:147], v[208:211]
    ds_read_b64_tr_b16 a[196:197], v22 offset:49152
    ds_read_b64_tr_b16 a[198:199], v22 offset:49664
    v_mfma_f32_16x16x32_bf16 v[212:215], a[200:203], a[132:135], v[212:215]
    v_mfma_f32_16x16x32_bf16 v[212:215], a[204:207], a[148:151], v[212:215]
    buffer_load_dwordx4 v13, s[8:11], s57 offen offset:2048 lds
    v_mfma_f32_16x16x32_bf16 v[216:219], a[200:203], a[136:139], v[216:219]
    v_mfma_f32_16x16x32_bf16 v[216:219], a[204:207], a[152:155], v[216:219]
    v_mfma_f32_16x16x32_bf16 v[220:223], a[200:203], a[140:143], v[220:223]
    v_mfma_f32_16x16x32_bf16 v[220:223], a[204:207], a[156:159], v[220:223]
    s_waitcnt lgkmcnt(8)
    buffer_load_dwordx4 v14, s[8:11], s57 offen offset:3072 lds
    v_mfma_f32_16x16x32_bf16 v[224:227], a[208:211], a[128:131], v[224:227]
    ds_read_b64_tr_b16 a[200:201], v23 offset:32768
    ds_read_b64_tr_b16 a[202:203], v23 offset:33280
    v_mfma_f32_16x16x32_bf16 v[224:227], a[212:215], a[144:147], v[224:227]
    ds_read_b64_tr_b16 a[204:205], v23 offset:49152
    ds_read_b64_tr_b16 a[206:207], v23 offset:49664
    v_mfma_f32_16x16x32_bf16 v[228:231], a[208:211], a[132:135], v[228:231]
    s_add_u32 m0, s95, 4096
    v_mfma_f32_16x16x32_bf16 v[228:231], a[212:215], a[148:151], v[228:231]
    s_add_u32 s57, s57, 32768
    ds_read_b64_tr_b16 a[224:225], v26 offset:32768
    ds_read_b64_tr_b16 a[226:227], v27 offset:32768
    v_mfma_f32_16x16x32_bf16 v[232:235], a[208:211], a[136:139], v[232:235]
    buffer_load_dwordx4 v11, s[8:11], s57 offen offset:0 lds
    v_mfma_f32_16x16x32_bf16 v[232:235], a[212:215], a[152:155], v[232:235]
    ds_read_b64_tr_b16 a[228:229], v26 offset:49152
    ds_read_b64_tr_b16 a[230:231], v27 offset:49152
    v_mfma_f32_16x16x32_bf16 v[236:239], a[208:211], a[140:143], v[236:239]
    v_mfma_f32_16x16x32_bf16 v[236:239], a[212:215], a[156:159], v[236:239]
    s_waitcnt lgkmcnt(12)
    v_mfma_f32_16x16x32_bf16 v[240:243], a[216:219], a[128:131], v[240:243]
    ds_read_b64_tr_b16 a[208:209], v24 offset:32768
    ds_read_b64_tr_b16 a[210:211], v24 offset:33280
    v_mfma_f32_16x16x32_bf16 v[240:243], a[220:223], a[144:147], v[240:243]
    ds_read_b64_tr_b16 a[212:213], v24 offset:49152
    ds_read_b64_tr_b16 a[214:215], v24 offset:49664
    v_mfma_f32_16x16x32_bf16 v[244:247], a[216:219], a[132:135], v[244:247]
    buffer_load_dwordx4 v12, s[8:11], s57 offen offset:1024 lds
    v_mfma_f32_16x16x32_bf16 v[244:247], a[220:223], a[148:151], v[244:247]
    ds_read_b64_tr_b16 a[232:233], v28 offset:32768
    ds_read_b64_tr_b16 a[234:235], v29 offset:32768
    v_mfma_f32_16x16x32_bf16 v[248:251], a[216:219], a[136:139], v[248:251]
    v_mfma_f32_16x16x32_bf16 v[248:251], a[220:223], a[152:155], v[248:251]
    ds_read_b64_tr_b16 a[236:237], v28 offset:49152
    ds_read_b64_tr_b16 a[238:239], v29 offset:49152
    v_mfma_f32_16x16x32_bf16 v[252:255], a[216:219], a[140:143], v[252:255]
    buffer_load_dwordx4 v13, s[8:11], s57 offen offset:2048 lds
    v_mfma_f32_16x16x32_bf16 v[252:255], a[220:223], a[156:159], v[252:255]
    s_waitcnt lgkmcnt(15)
    v_mfma_f32_16x16x32_bf16 a[0:3], a[192:195], a[128:131], a[0:3]
    ds_read_b64_tr_b16 a[216:217], v25 offset:32768
    ds_read_b64_tr_b16 a[218:219], v25 offset:33280
    v_mfma_f32_16x16x32_bf16 a[0:3], a[196:199], a[144:147], a[0:3]
    ds_read_b64_tr_b16 a[220:221], v25 offset:49152
    ds_read_b64_tr_b16 a[222:223], v25 offset:49664
    v_mfma_f32_16x16x32_bf16 a[4:7], a[192:195], a[132:135], a[4:7]
    buffer_load_dwordx4 v14, s[8:11], s57 offen offset:3072 lds
    v_mfma_f32_16x16x32_bf16 a[4:7], a[196:199], a[148:151], a[4:7]
    ds_read_b64_tr_b16 a[240:241], v30 offset:32768
    ds_read_b64_tr_b16 a[242:243], v31 offset:32768
    v_mfma_f32_16x16x32_bf16 a[8:11], a[192:195], a[136:139], a[8:11]
    v_mfma_f32_16x16x32_bf16 a[8:11], a[196:199], a[152:155], a[8:11]
    ds_read_b64_tr_b16 a[244:245], v30 offset:49152
    ds_read_b64_tr_b16 a[246:247], v31 offset:49152
    v_mfma_f32_16x16x32_bf16 a[12:15], a[192:195], a[140:143], a[12:15]
    v_mfma_f32_16x16x32_bf16 a[12:15], a[196:199], a[156:159], a[12:15]
    s_waitcnt lgkmcnt(15)
    v_mfma_f32_16x16x32_bf16 a[16:19], a[200:203], a[128:131], a[16:19]
    ds_read_b64_tr_b16 a[192:193], v22 offset:33792
    ds_read_b64_tr_b16 a[194:195], v22 offset:34304
    v_mfma_f32_16x16x32_bf16 a[16:19], a[204:207], a[144:147], a[16:19]
    ds_read_b64_tr_b16 a[196:197], v22 offset:50176
    ds_read_b64_tr_b16 a[198:199], v22 offset:50688
    v_mfma_f32_16x16x32_bf16 a[20:23], a[200:203], a[132:135], a[20:23]
    v_mfma_f32_16x16x32_bf16 a[20:23], a[204:207], a[148:151], a[20:23]
    ds_read_b64_tr_b16 a[248:249], v32 offset:32768
    ds_read_b64_tr_b16 a[250:251], v33 offset:32768
    v_mfma_f32_16x16x32_bf16 a[24:27], a[200:203], a[136:139], a[24:27]
    v_mfma_f32_16x16x32_bf16 a[24:27], a[204:207], a[152:155], a[24:27]
    ds_read_b64_tr_b16 a[252:253], v32 offset:49152
    ds_read_b64_tr_b16 a[254:255], v33 offset:49152
    v_mfma_f32_16x16x32_bf16 a[28:31], a[200:203], a[140:143], a[28:31]
    v_mfma_f32_16x16x32_bf16 a[28:31], a[204:207], a[156:159], a[28:31]
    s_waitcnt lgkmcnt(15)
    v_mfma_f32_16x16x32_bf16 a[32:35], a[208:211], a[128:131], a[32:35]
    ds_read_b64_tr_b16 a[200:201], v23 offset:33792
    ds_read_b64_tr_b16 a[202:203], v23 offset:34304
    v_mfma_f32_16x16x32_bf16 a[32:35], a[212:215], a[144:147], a[32:35]
    ds_read_b64_tr_b16 a[204:205], v23 offset:50176
    ds_read_b64_tr_b16 a[206:207], v23 offset:50688
    v_mfma_f32_16x16x32_bf16 a[36:39], a[208:211], a[132:135], a[36:39]
    v_mfma_f32_16x16x32_bf16 a[36:39], a[212:215], a[148:151], a[36:39]
    v_xor_b32 v26, 0x10000, v26
    v_xor_b32 v27, 0x10000, v27
    v_mfma_f32_16x16x32_bf16 a[40:43], a[208:211], a[136:139], a[40:43]
    v_mfma_f32_16x16x32_bf16 a[40:43], a[212:215], a[152:155], a[40:43]
    v_xor_b32 v28, 0x10000, v28
    v_xor_b32 v29, 0x10000, v29
    v_mfma_f32_16x16x32_bf16 a[44:47], a[208:211], a[140:143], a[44:47]
    v_mfma_f32_16x16x32_bf16 a[44:47], a[212:215], a[156:159], a[44:47]
    s_waitcnt lgkmcnt(15)
    v_mfma_f32_16x16x32_bf16 a[48:51], a[216:219], a[128:131], a[48:51]
    ds_read_b64_tr_b16 a[208:209], v24 offset:33792
    ds_read_b64_tr_b16 a[210:211], v24 offset:34304
    v_mfma_f32_16x16x32_bf16 a[48:51], a[220:223], a[144:147], a[48:51]
    ds_read_b64_tr_b16 a[212:213], v24 offset:50176
    ds_read_b64_tr_b16 a[214:215], v24 offset:50688
    v_mfma_f32_16x16x32_bf16 a[52:55], a[216:219], a[132:135], a[52:55]
    v_mfma_f32_16x16x32_bf16 a[52:55], a[220:223], a[148:151], a[52:55]
    v_xor_b32 v30, 0x10000, v30
    v_xor_b32 v31, 0x10000, v31
    v_mfma_f32_16x16x32_bf16 a[56:59], a[216:219], a[136:139], a[56:59]
    v_mfma_f32_16x16x32_bf16 a[56:59], a[220:223], a[152:155], a[56:59]
    v_xor_b32 v32, 0x10000, v32
    v_xor_b32 v33, 0x10000, v33
    v_mfma_f32_16x16x32_bf16 a[60:63], a[216:219], a[140:143], a[60:63]
    v_mfma_f32_16x16x32_bf16 a[60:63], a[220:223], a[156:159], a[60:63]
    s_waitcnt lgkmcnt(12)
    v_mfma_f32_16x16x32_bf16 a[64:67], a[192:195], a[128:131], a[64:67]
    ds_read_b64_tr_b16 a[216:217], v25 offset:33792
    ds_read_b64_tr_b16 a[218:219], v25 offset:34304
    v_mfma_f32_16x16x32_bf16 a[64:67], a[196:199], a[144:147], a[64:67]
    ds_read_b64_tr_b16 a[220:221], v25 offset:50176
    ds_read_b64_tr_b16 a[222:223], v25 offset:50688
    v_mfma_f32_16x16x32_bf16 a[68:71], a[192:195], a[132:135], a[68:71]
    v_xor_b32 v18, 0x10000, v18
    v_xor_b32 v19, 0x10000, v19
    v_mfma_f32_16x16x32_bf16 a[68:71], a[196:199], a[148:151], a[68:71]
    v_xor_b32 v20, 0x10000, v20
    v_xor_b32 v21, 0x10000, v21
    v_mfma_f32_16x16x32_bf16 a[72:75], a[192:195], a[136:139], a[72:75]
    v_xor_b32 v22, 0x10000, v22
    v_xor_b32 v23, 0x10000, v23
    v_mfma_f32_16x16x32_bf16 a[72:75], a[196:199], a[152:155], a[72:75]
    v_xor_b32 v24, 0x10000, v24
    v_xor_b32 v25, 0x10000, v25
    v_mfma_f32_16x16x32_bf16 a[76:79], a[192:195], a[140:143], a[76:79]
    v_mfma_f32_16x16x32_bf16 a[76:79], a[196:199], a[156:159], a[76:79]
    s_waitcnt lgkmcnt(8)
    s_waitcnt lgkmcnt(0)
    s_waitcnt vmcnt(28)
    s_barrier
    v_mfma_f32_16x16x32_bf16 a[80:83], a[200:203], a[128:131], a[80:83]
    s_mov_b32 s58, 3670016
    ds_read_b64_tr_b16 a[192:193], v18 offset:0
    ds_read_b64_tr_b16 a[194:195], v18 offset:1024
    v_mfma_f32_16x16x32_bf16 a[80:83], a[204:207], a[144:147], a[80:83]
    s_mov_b32 s59, 1605632
    ds_read_b64_tr_b16 a[196:197], v18 offset:16384
    ds_read_b64_tr_b16 a[198:199], v18 offset:17408
    v_mfma_f32_16x16x32_bf16 a[84:87], a[200:203], a[132:135], a[84:87]
    s_add_u32 m0, s56, 32768
    v_mfma_f32_16x16x32_bf16 a[84:87], a[204:207], a[148:151], a[84:87]
    buffer_load_dwordx4 v15, s[12:15], s58 offen lds
    v_mfma_f32_16x16x32_bf16 a[88:91], a[200:203], a[136:139], a[88:91]
    v_mfma_f32_16x16x32_bf16 a[88:91], a[204:207], a[152:155], a[88:91]
    v_mfma_f32_16x16x32_bf16 a[92:95], a[200:203], a[140:143], a[92:95]
    v_mfma_f32_16x16x32_bf16 a[92:95], a[204:207], a[156:159], a[92:95]
    s_waitcnt lgkmcnt(8)
    buffer_load_dwordx4 v16, s[12:15], s58 offen offset:1024 lds
    v_mfma_f32_16x16x32_bf16 a[96:99], a[208:211], a[128:131], a[96:99]
    ds_read_b64_tr_b16 a[200:201], v18 offset:8
    ds_read_b64_tr_b16 a[202:203], v18 offset:1032
    v_mfma_f32_16x16x32_bf16 a[96:99], a[212:215], a[144:147], a[96:99]
    ds_read_b64_tr_b16 a[204:205], v18 offset:16392
    ds_read_b64_tr_b16 a[206:207], v18 offset:17416
    v_mfma_f32_16x16x32_bf16 a[100:103], a[208:211], a[132:135], a[100:103]
    s_add_u32 m0, s56, 34816
    v_mfma_f32_16x16x32_bf16 a[100:103], a[212:215], a[148:151], a[100:103]
    buffer_load_dwordx4 v17, s[16:19], s59 offen lds
    v_mfma_f32_16x16x32_bf16 a[104:107], a[208:211], a[136:139], a[104:107]
    v_mfma_f32_16x16x32_bf16 a[104:107], a[212:215], a[152:155], a[104:107]
    v_mfma_f32_16x16x32_bf16 a[108:111], a[208:211], a[140:143], a[108:111]
    s_add_u32 m0, s56, 35840
    v_mfma_f32_16x16x32_bf16 a[108:111], a[212:215], a[156:159], a[108:111]
    s_waitcnt lgkmcnt(8)
    buffer_load_dwordx4 v17, s[20:23], s59 offen lds
    v_mfma_f32_16x16x32_bf16 a[112:115], a[216:219], a[128:131], a[112:115]
    ds_read_b64_tr_b16 a[208:209], v19 offset:0
    ds_read_b64_tr_b16 a[210:211], v19 offset:1024
    v_mfma_f32_16x16x32_bf16 a[112:115], a[220:223], a[144:147], a[112:115]
    s_add_u32 m0, s56, 49152
    ds_read_b64_tr_b16 a[212:213], v19 offset:16384
    ds_read_b64_tr_b16 a[214:215], v19 offset:17408
    v_mfma_f32_16x16x32_bf16 a[116:119], a[216:219], a[132:135], a[116:119]
    s_add_u32 s58, s58, 262144
    v_mfma_f32_16x16x32_bf16 a[116:119], a[220:223], a[148:151], a[116:119]
    buffer_load_dwordx4 v15, s[12:15], s58 offen lds
    v_mfma_f32_16x16x32_bf16 a[120:123], a[216:219], a[136:139], a[120:123]
    v_mfma_f32_16x16x32_bf16 a[120:123], a[220:223], a[152:155], a[120:123]
    v_mfma_f32_16x16x32_bf16 a[124:127], a[216:219], a[140:143], a[124:127]
    v_mfma_f32_16x16x32_bf16 a[124:127], a[220:223], a[156:159], a[124:127]
    s_waitcnt lgkmcnt(15)
    buffer_load_dwordx4 v16, s[12:15], s58 offen offset:1024 lds
    v_mfma_f32_16x16x32_bf16 v[112:115], a[224:227], v[104:107], v[112:115]
    v_mfma_f32_16x16x32_bf16 v[112:115], a[228:231], v[104:107], v[112:115]
    s_add_u32 m0, s56, 51200
    v_mfma_f32_16x16x32_bf16 v[116:119], a[232:235], v[104:107], v[116:119]
    s_add_u32 s59, s59, 114688
    v_mfma_f32_16x16x32_bf16 v[116:119], a[236:239], v[104:107], v[116:119]
    buffer_load_dwordx4 v17, s[16:19], s59 offen lds
    v_mfma_f32_16x16x32_bf16 v[120:123], a[240:243], v[104:107], v[120:123]
    v_mfma_f32_16x16x32_bf16 v[120:123], a[244:247], v[104:107], v[120:123]
    v_mfma_f32_16x16x32_bf16 v[124:127], a[248:251], v[104:107], v[124:127]
    s_add_u32 m0, s56, 52224
    v_mfma_f32_16x16x32_bf16 v[124:127], a[252:255], v[104:107], v[124:127]
    s_waitcnt lgkmcnt(8)
    buffer_load_dwordx4 v17, s[20:23], s59 offen lds
    v_mfma_f32_16x16x32_bf16 v[128:131], a[192:195], a[160:163], v[128:131]
    ds_read_b64_tr_b16 a[216:217], v19 offset:8
    ds_read_b64_tr_b16 a[218:219], v19 offset:1032
    v_mfma_f32_16x16x32_bf16 v[128:131], a[196:199], a[176:179], v[128:131]
    ds_read_b64_tr_b16 a[220:221], v19 offset:16392
    ds_read_b64_tr_b16 a[222:223], v19 offset:17416
    v_mfma_f32_16x16x32_bf16 v[132:135], a[192:195], a[164:167], v[132:135]
    v_mfma_f32_16x16x32_bf16 v[132:135], a[196:199], a[180:183], v[132:135]
    v_mfma_f32_16x16x32_bf16 v[136:139], a[192:195], a[168:171], v[136:139]
    v_mfma_f32_16x16x32_bf16 v[136:139], a[196:199], a[184:187], v[136:139]
    v_mfma_f32_16x16x32_bf16 v[140:143], a[192:195], a[172:175], v[140:143]
    v_mfma_f32_16x16x32_bf16 v[140:143], a[196:199], a[188:191], v[140:143]
    s_waitcnt lgkmcnt(8)
    v_mfma_f32_16x16x32_bf16 v[144:147], a[200:203], a[160:163], v[144:147]
    ds_read_b64_tr_b16 a[192:193], v20 offset:0
    ds_read_b64_tr_b16 a[194:195], v20 offset:1024
    v_mfma_f32_16x16x32_bf16 v[144:147], a[204:207], a[176:179], v[144:147]
    ds_read_b64_tr_b16 a[196:197], v20 offset:16384
    ds_read_b64_tr_b16 a[198:199], v20 offset:17408
    v_mfma_f32_16x16x32_bf16 v[148:151], a[200:203], a[164:167], v[148:151]
    s_waitcnt vmcnt(8)
    v_mfma_f32_16x16x32_bf16 v[148:151], a[204:207], a[180:183], v[148:151]
    ds_read_b128 a[128:131], v6 offset:0
    ds_read_b128 a[132:135], v6 offset:2048
    v_mfma_f32_16x16x32_bf16 v[152:155], a[200:203], a[168:171], v[152:155]
    v_mfma_f32_16x16x32_bf16 v[152:155], a[204:207], a[184:187], v[152:155]
    ds_read_b128 a[136:139], v6 offset:4096
    ds_read_b128 a[140:143], v6 offset:6144
    v_mfma_f32_16x16x32_bf16 v[156:159], a[200:203], a[172:175], v[156:159]
    v_mfma_f32_16x16x32_bf16 v[156:159], a[204:207], a[188:191], v[156:159]
    s_waitcnt lgkmcnt(12)
    v_mfma_f32_16x16x32_bf16 v[160:163], a[208:211], a[160:163], v[160:163]
    ds_read_b64_tr_b16 a[200:201], v20 offset:8
    ds_read_b64_tr_b16 a[202:203], v20 offset:1032
    v_mfma_f32_16x16x32_bf16 v[160:163], a[212:215], a[176:179], v[160:163]
    ds_read_b64_tr_b16 a[204:205], v20 offset:16392
    ds_read_b64_tr_b16 a[206:207], v20 offset:17416
    v_mfma_f32_16x16x32_bf16 v[164:167], a[208:211], a[164:167], v[164:167]
    v_mfma_f32_16x16x32_bf16 v[164:167], a[212:215], a[180:183], v[164:167]
    ds_read_b128 a[144:147], v7 offset:0
    ds_read_b128 a[148:151], v7 offset:2048
    v_mfma_f32_16x16x32_bf16 v[168:171], a[208:211], a[168:171], v[168:171]
    s_lshl_b32 s54, s41, 2
    v_mov_b32 v74, s54
    buffer_load_dword v73, v74, s[72:75], 0 offen sc1
    v_mfma_f32_16x16x32_bf16 v[168:171], a[212:215], a[184:187], v[168:171]
    ds_read_b128 a[152:155], v7 offset:4096
    ds_read_b128 a[156:159], v7 offset:6144
    v_mfma_f32_16x16x32_bf16 v[172:175], a[208:211], a[172:175], v[172:175]
    v_mfma_f32_16x16x32_bf16 v[172:175], a[212:215], a[188:191], v[172:175]
    s_waitcnt lgkmcnt(15)
    v_mfma_f32_16x16x32_bf16 v[176:179], a[216:219], a[160:163], v[176:179]
    ds_read_b64_tr_b16 a[208:209], v21 offset:0
    ds_read_b64_tr_b16 a[210:211], v21 offset:1024
    v_mfma_f32_16x16x32_bf16 v[176:179], a[220:223], a[176:179], v[176:179]
    ds_read_b64_tr_b16 a[212:213], v21 offset:16384
    ds_read_b64_tr_b16 a[214:215], v21 offset:17408
    v_mfma_f32_16x16x32_bf16 v[180:183], a[216:219], a[164:167], v[180:183]
    v_mfma_f32_16x16x32_bf16 v[180:183], a[220:223], a[180:183], v[180:183]
    v_mfma_f32_16x16x32_bf16 v[184:187], a[216:219], a[168:171], v[184:187]
    v_mfma_f32_16x16x32_bf16 v[184:187], a[220:223], a[184:187], v[184:187]
    v_mfma_f32_16x16x32_bf16 v[188:191], a[216:219], a[172:175], v[188:191]
    v_mfma_f32_16x16x32_bf16 v[188:191], a[220:223], a[188:191], v[188:191]
    s_waitcnt lgkmcnt(15)
    v_mfma_f32_16x16x32_bf16 v[192:195], a[192:195], a[160:163], v[192:195]
    ds_read_b64_tr_b16 a[216:217], v21 offset:8
    ds_read_b64_tr_b16 a[218:219], v21 offset:1032
    v_mfma_f32_16x16x32_bf16 v[192:195], a[196:199], a[176:179], v[192:195]
    s_mov_b32 s57, 896
    ds_read_b64_tr_b16 a[220:221], v21 offset:16392
    ds_read_b64_tr_b16 a[222:223], v21 offset:17416
    v_mfma_f32_16x16x32_bf16 v[196:199], a[192:195], a[164:167], v[196:199]
    s_waitcnt lgkmcnt(8)
    s_mov_b32 m0, s95
    v_mfma_f32_16x16x32_bf16 v[196:199], a[196:199], a[180:183], v[196:199]
    buffer_load_dwordx4 v11, s[8:11], s57 offen offset:0 lds
    v_mfma_f32_16x16x32_bf16 v[200:203], a[192:195], a[168:171], v[200:203]
    v_mfma_f32_16x16x32_bf16 v[200:203], a[196:199], a[184:187], v[200:203]
    v_mfma_f32_16x16x32_bf16 v[204:207], a[192:195], a[172:175], v[204:207]
    v_mfma_f32_16x16x32_bf16 v[204:207], a[196:199], a[188:191], v[204:207]
    s_waitcnt lgkmcnt(12)
    buffer_load_dwordx4 v12, s[8:11], s57 offen offset:1024 lds
    v_mfma_f32_16x16x32_bf16 v[208:211], a[200:203], a[160:163], v[208:211]
    ds_read_b64_tr_b16 a[192:193], v22 offset:0
    ds_read_b64_tr_b16 a[194:195], v22 offset:512
    v_mfma_f32_16x16x32_bf16 v[208:211], a[204:207], a[176:179], v[208:211]
    ds_read_b64_tr_b16 a[196:197], v22 offset:16384
    ds_read_b64_tr_b16 a[198:199], v22 offset:16896
    v_mfma_f32_16x16x32_bf16 v[212:215], a[200:203], a[164:167], v[212:215]
    v_mfma_f32_16x16x32_bf16 v[212:215], a[204:207], a[180:183], v[212:215]
    buffer_load_dwordx4 v13, s[8:11], s57 offen offset:2048 lds
    v_mfma_f32_16x16x32_bf16 v[216:219], a[200:203], a[168:171], v[216:219]
    v_mfma_f32_16x16x32_bf16 v[216:219], a[204:207], a[184:187], v[216:219]
    v_mfma_f32_16x16x32_bf16 v[220:223], a[200:203], a[172:175], v[220:223]
    v_mfma_f32_16x16x32_bf16 v[220:223], a[204:207], a[188:191], v[220:223]
    s_waitcnt lgkmcnt(8)
    buffer_load_dwordx4 v14, s[8:11], s57 offen offset:3072 lds
    v_mfma_f32_16x16x32_bf16 v[224:227], a[208:211], a[160:163], v[224:227]
    ds_read_b64_tr_b16 a[200:201], v23 offset:0
    ds_read_b64_tr_b16 a[202:203], v23 offset:512
    v_mfma_f32_16x16x32_bf16 v[224:227], a[212:215], a[176:179], v[224:227]
    ds_read_b64_tr_b16 a[204:205], v23 offset:16384
    ds_read_b64_tr_b16 a[206:207], v23 offset:16896
    v_mfma_f32_16x16x32_bf16 v[228:231], a[208:211], a[164:167], v[228:231]
    s_add_u32 m0, s95, 4096
    v_mfma_f32_16x16x32_bf16 v[228:231], a[212:215], a[180:183], v[228:231]
    s_add_u32 s57, s57, 32768
    ds_read_b64_tr_b16 a[224:225], v26 offset:0
    ds_read_b64_tr_b16 a[226:227], v27 offset:0
    v_mfma_f32_16x16x32_bf16 v[232:235], a[208:211], a[168:171], v[232:235]
    buffer_load_dwordx4 v11, s[8:11], s57 offen offset:0 lds
    v_mfma_f32_16x16x32_bf16 v[232:235], a[212:215], a[184:187], v[232:235]
    ds_read_b64_tr_b16 a[228:229], v26 offset:16384
    ds_read_b64_tr_b16 a[230:231], v27 offset:16384
    v_mfma_f32_16x16x32_bf16 v[236:239], a[208:211], a[172:175], v[236:239]
    v_mfma_f32_16x16x32_bf16 v[236:239], a[212:215], a[188:191], v[236:239]
    s_waitcnt lgkmcnt(12)
    v_mfma_f32_16x16x32_bf16 v[240:243], a[216:219], a[160:163], v[240:243]
    ds_read_b64_tr_b16 a[208:209], v24 offset:0
    ds_read_b64_tr_b16 a[210:211], v24 offset:512
    v_mfma_f32_16x16x32_bf16 v[240:243], a[220:223], a[176:179], v[240:243]
    ds_read_b64_tr_b16 a[212:213], v24 offset:16384
    ds_read_b64_tr_b16 a[214:215], v24 offset:16896
    v_mfma_f32_16x16x32_bf16 v[244:247], a[216:219], a[164:167], v[244:247]
    buffer_load_dwordx4 v12, s[8:11], s57 offen offset:1024 lds
    v_mfma_f32_16x16x32_bf16 v[244:247], a[220:223], a[180:183], v[244:247]
    ds_read_b64_tr_b16 a[232:233], v28 offset:0
    ds_read_b64_tr_b16 a[234:235], v29 offset:0
    v_mfma_f32_16x16x32_bf16 v[248:251], a[216:219], a[168:171], v[248:251]
    v_mfma_f32_16x16x32_bf16 v[248:251], a[220:223], a[184:187], v[248:251]
    ds_read_b64_tr_b16 a[236:237], v28 offset:16384
    ds_read_b64_tr_b16 a[238:239], v29 offset:16384
    v_mfma_f32_16x16x32_bf16 v[252:255], a[216:219], a[172:175], v[252:255]
    buffer_load_dwordx4 v13, s[8:11], s57 offen offset:2048 lds
    v_mfma_f32_16x16x32_bf16 v[252:255], a[220:223], a[188:191], v[252:255]
    s_waitcnt lgkmcnt(15)
    v_mfma_f32_16x16x32_bf16 a[0:3], a[192:195], a[160:163], a[0:3]
    ds_read_b64_tr_b16 a[216:217], v25 offset:0
    ds_read_b64_tr_b16 a[218:219], v25 offset:512
    v_mfma_f32_16x16x32_bf16 a[0:3], a[196:199], a[176:179], a[0:3]
    ds_read_b64_tr_b16 a[220:221], v25 offset:16384
    ds_read_b64_tr_b16 a[222:223], v25 offset:16896
    v_mfma_f32_16x16x32_bf16 a[4:7], a[192:195], a[164:167], a[4:7]
    buffer_load_dwordx4 v14, s[8:11], s57 offen offset:3072 lds
    v_mfma_f32_16x16x32_bf16 a[4:7], a[196:199], a[180:183], a[4:7]
    ds_read_b64_tr_b16 a[240:241], v30 offset:0
    ds_read_b64_tr_b16 a[242:243], v31 offset:0
    v_mfma_f32_16x16x32_bf16 a[8:11], a[192:195], a[168:171], a[8:11]
    v_mfma_f32_16x16x32_bf16 a[8:11], a[196:199], a[184:187], a[8:11]
    ds_read_b64_tr_b16 a[244:245], v30 offset:16384
    ds_read_b64_tr_b16 a[246:247], v31 offset:16384
    v_mfma_f32_16x16x32_bf16 a[12:15], a[192:195], a[172:175], a[12:15]
    v_mfma_f32_16x16x32_bf16 a[12:15], a[196:199], a[188:191], a[12:15]
    s_waitcnt lgkmcnt(15)
    v_mfma_f32_16x16x32_bf16 a[16:19], a[200:203], a[160:163], a[16:19]
    ds_read_b64_tr_b16 a[192:193], v22 offset:1024
    ds_read_b64_tr_b16 a[194:195], v22 offset:1536
    v_mfma_f32_16x16x32_bf16 a[16:19], a[204:207], a[176:179], a[16:19]
    ds_read_b64_tr_b16 a[196:197], v22 offset:17408
    ds_read_b64_tr_b16 a[198:199], v22 offset:17920
    v_mfma_f32_16x16x32_bf16 a[20:23], a[200:203], a[164:167], a[20:23]
    v_mfma_f32_16x16x32_bf16 a[20:23], a[204:207], a[180:183], a[20:23]
    ds_read_b64_tr_b16 a[248:249], v32 offset:0
    ds_read_b64_tr_b16 a[250:251], v33 offset:0
    v_mfma_f32_16x16x32_bf16 a[24:27], a[200:203], a[168:171], a[24:27]
    v_mfma_f32_16x16x32_bf16 a[24:27], a[204:207], a[184:187], a[24:27]
    ds_read_b64_tr_b16 a[252:253], v32 offset:16384
    ds_read_b64_tr_b16 a[254:255], v33 offset:16384
    v_mfma_f32_16x16x32_bf16 a[28:31], a[200:203], a[172:175], a[28:31]
    v_mfma_f32_16x16x32_bf16 a[28:31], a[204:207], a[188:191], a[28:31]
    s_waitcnt lgkmcnt(15)
    v_mfma_f32_16x16x32_bf16 a[32:35], a[208:211], a[160:163], a[32:35]
    ds_read_b64_tr_b16 a[200:201], v23 offset:1024
    ds_read_b64_tr_b16 a[202:203], v23 offset:1536
    v_mfma_f32_16x16x32_bf16 a[32:35], a[212:215], a[176:179], a[32:35]
    ds_read_b64_tr_b16 a[204:205], v23 offset:17408
    ds_read_b64_tr_b16 a[206:207], v23 offset:17920
    v_mfma_f32_16x16x32_bf16 a[36:39], a[208:211], a[164:167], a[36:39]
    v_mfma_f32_16x16x32_bf16 a[36:39], a[212:215], a[180:183], a[36:39]
    v_xor_b32 v26, 0x10000, v26
    v_xor_b32 v27, 0x10000, v27
    v_mfma_f32_16x16x32_bf16 a[40:43], a[208:211], a[168:171], a[40:43]
    v_mfma_f32_16x16x32_bf16 a[40:43], a[212:215], a[184:187], a[40:43]
    v_xor_b32 v28, 0x10000, v28
    v_xor_b32 v29, 0x10000, v29
    v_mfma_f32_16x16x32_bf16 a[44:47], a[208:211], a[172:175], a[44:47]
    v_mfma_f32_16x16x32_bf16 a[44:47], a[212:215], a[188:191], a[44:47]
    s_waitcnt lgkmcnt(15)
    v_mfma_f32_16x16x32_bf16 a[48:51], a[216:219], a[160:163], a[48:51]
    ds_read_b64_tr_b16 a[208:209], v24 offset:1024
    ds_read_b64_tr_b16 a[210:211], v24 offset:1536
    v_mfma_f32_16x16x32_bf16 a[48:51], a[220:223], a[176:179], a[48:51]
    ds_read_b64_tr_b16 a[212:213], v24 offset:17408
    ds_read_b64_tr_b16 a[214:215], v24 offset:17920
    v_mfma_f32_16x16x32_bf16 a[52:55], a[216:219], a[164:167], a[52:55]
    v_mfma_f32_16x16x32_bf16 a[52:55], a[220:223], a[180:183], a[52:55]
    v_xor_b32 v30, 0x10000, v30
    v_xor_b32 v31, 0x10000, v31
    v_mfma_f32_16x16x32_bf16 a[56:59], a[216:219], a[168:171], a[56:59]
    v_mfma_f32_16x16x32_bf16 a[56:59], a[220:223], a[184:187], a[56:59]
    v_xor_b32 v32, 0x10000, v32
    v_xor_b32 v33, 0x10000, v33
    v_mfma_f32_16x16x32_bf16 a[60:63], a[216:219], a[172:175], a[60:63]
    v_mfma_f32_16x16x32_bf16 a[60:63], a[220:223], a[188:191], a[60:63]
    s_waitcnt lgkmcnt(12)
    v_mfma_f32_16x16x32_bf16 a[64:67], a[192:195], a[160:163], a[64:67]
    ds_read_b64_tr_b16 a[216:217], v25 offset:1024
    ds_read_b64_tr_b16 a[218:219], v25 offset:1536
    v_mfma_f32_16x16x32_bf16 a[64:67], a[196:199], a[176:179], a[64:67]
    ds_read_b64_tr_b16 a[220:221], v25 offset:17408
    ds_read_b64_tr_b16 a[222:223], v25 offset:17920
    v_mfma_f32_16x16x32_bf16 a[68:71], a[192:195], a[164:167], a[68:71]
    v_xor_b32 v18, 0x10000, v18
    v_xor_b32 v19, 0x10000, v19
    v_mfma_f32_16x16x32_bf16 a[68:71], a[196:199], a[180:183], a[68:71]
    v_xor_b32 v20, 0x10000, v20
    v_xor_b32 v21, 0x10000, v21
    v_mfma_f32_16x16x32_bf16 a[72:75], a[192:195], a[168:171], a[72:75]
    v_xor_b32 v22, 0x10000, v22
    v_xor_b32 v23, 0x10000, v23
    v_mfma_f32_16x16x32_bf16 a[72:75], a[196:199], a[184:187], a[72:75]
    v_xor_b32 v24, 0x10000, v24
    v_xor_b32 v25, 0x10000, v25
    v_mfma_f32_16x16x32_bf16 a[76:79], a[192:195], a[172:175], a[76:79]
    v_mfma_f32_16x16x32_bf16 a[76:79], a[196:199], a[188:191], a[76:79]
    s_waitcnt lgkmcnt(8)
    s_waitcnt lgkmcnt(0)
    s_waitcnt vmcnt(25)
    s_barrier
    v_mfma_f32_16x16x32_bf16 a[80:83], a[200:203], a[160:163], a[80:83]
    ds_read_b64_tr_b16 a[192:193], v18 offset:0
    ds_read_b64_tr_b16 a[194:195], v18 offset:1024
    v_mfma_f32_16x16x32_bf16 a[80:83], a[204:207], a[176:179], a[80:83]
    s_add_u32 m0, s95, -32768
    ds_read_b64_tr_b16 a[196:197], v18 offset:16384
    ds_read_b64_tr_b16 a[198:199], v18 offset:17408
    v_mfma_f32_16x16x32_bf16 a[84:87], a[200:203], a[164:167], a[84:87]
    buffer_load_dwordx4 v46, s[28:31], s47 offen offset:0 lds
    v_mfma_f32_16x16x32_bf16 a[84:87], a[204:207], a[180:183], a[84:87]
    v_mfma_f32_16x16x32_bf16 a[88:91], a[200:203], a[168:171], a[88:91]
    v_mfma_f32_16x16x32_bf16 a[88:91], a[204:207], a[184:187], a[88:91]
    v_mfma_f32_16x16x32_bf16 a[92:95], a[200:203], a[172:175], a[92:95]
    buffer_load_dwordx4 v47, s[28:31], s47 offen offset:1024 lds
    v_mfma_f32_16x16x32_bf16 a[92:95], a[204:207], a[188:191], a[92:95]
    s_waitcnt lgkmcnt(8)
    v_mfma_f32_16x16x32_bf16 a[96:99], a[208:211], a[160:163], a[96:99]
    ds_read_b64_tr_b16 a[200:201], v18 offset:8
    ds_read_b64_tr_b16 a[202:203], v18 offset:1032
    v_mfma_f32_16x16x32_bf16 a[96:99], a[212:215], a[176:179], a[96:99]
    ds_read_b64_tr_b16 a[204:205], v18 offset:16392
    ds_read_b64_tr_b16 a[206:207], v18 offset:17416
    v_mfma_f32_16x16x32_bf16 a[100:103], a[208:211], a[164:167], a[100:103]
    buffer_load_dwordx4 v46, s[28:31], s47 offen offset:2048 lds
    v_mfma_f32_16x16x32_bf16 a[100:103], a[212:215], a[180:183], a[100:103]
    v_mfma_f32_16x16x32_bf16 a[104:107], a[208:211], a[168:171], a[104:107]
    v_mfma_f32_16x16x32_bf16 a[104:107], a[212:215], a[184:187], a[104:107]
    v_mfma_f32_16x16x32_bf16 a[108:111], a[208:211], a[172:175], a[108:111]
    buffer_load_dwordx4 v47, s[28:31], s47 offen offset:3072 lds
    v_mfma_f32_16x16x32_bf16 a[108:111], a[212:215], a[188:191], a[108:111]
    s_waitcnt lgkmcnt(8)
    v_mfma_f32_16x16x32_bf16 a[112:115], a[216:219], a[160:163], a[112:115]
    s_add_u32 m0, s95, -28672
    ds_read_b64_tr_b16 a[208:209], v19 offset:0
    ds_read_b64_tr_b16 a[210:211], v19 offset:1024
    v_mfma_f32_16x16x32_bf16 a[112:115], a[220:223], a[176:179], a[112:115]
    s_add_u32 s47, s47, 4096
    ds_read_b64_tr_b16 a[212:213], v19 offset:16384
    ds_read_b64_tr_b16 a[214:215], v19 offset:17408
    v_mfma_f32_16x16x32_bf16 a[116:119], a[216:219], a[164:167], a[116:119]
    buffer_load_dwordx4 v46, s[28:31], s47 offen offset:0 lds
    v_mfma_f32_16x16x32_bf16 a[116:119], a[220:223], a[180:183], a[116:119]
    v_mfma_f32_16x16x32_bf16 a[120:123], a[216:219], a[168:171], a[120:123]
    v_mfma_f32_16x16x32_bf16 a[120:123], a[220:223], a[184:187], a[120:123]
    v_mfma_f32_16x16x32_bf16 a[124:127], a[216:219], a[172:175], a[124:127]
    buffer_load_dwordx4 v47, s[28:31], s47 offen offset:1024 lds
    v_mfma_f32_16x16x32_bf16 a[124:127], a[220:223], a[188:191], a[124:127]
    s_waitcnt lgkmcnt(15)
    v_mfma_f32_16x16x32_bf16 v[112:115], a[224:227], v[104:107], v[112:115]
    v_mfma_f32_16x16x32_bf16 v[112:115], a[228:231], v[104:107], v[112:115]
    v_mfma_f32_16x16x32_bf16 v[116:119], a[232:235], v[104:107], v[116:119]
    buffer_load_dwordx4 v46, s[28:31], s47 offen offset:2048 lds
    v_mfma_f32_16x16x32_bf16 v[116:119], a[236:239], v[104:107], v[116:119]
    v_mfma_f32_16x16x32_bf16 v[120:123], a[240:243], v[104:107], v[120:123]
    v_mfma_f32_16x16x32_bf16 v[120:123], a[244:247], v[104:107], v[120:123]
    v_mfma_f32_16x16x32_bf16 v[124:127], a[248:251], v[104:107], v[124:127]
    buffer_load_dwordx4 v47, s[28:31], s47 offen offset:3072 lds
    v_mfma_f32_16x16x32_bf16 v[124:127], a[252:255], v[104:107], v[124:127]
    s_waitcnt lgkmcnt(8)
    v_mfma_f32_16x16x32_bf16 v[128:131], a[192:195], a[128:131], v[128:131]
    ds_read_b64_tr_b16 a[216:217], v19 offset:8
    ds_read_b64_tr_b16 a[218:219], v19 offset:1032
    v_mfma_f32_16x16x32_bf16 v[128:131], a[196:199], a[144:147], v[128:131]
    ds_read_b64_tr_b16 a[220:221], v19 offset:16392
    ds_read_b64_tr_b16 a[222:223], v19 offset:17416
    v_mfma_f32_16x16x32_bf16 v[132:135], a[192:195], a[132:135], v[132:135]
    v_mfma_f32_16x16x32_bf16 v[132:135], a[196:199], a[148:151], v[132:135]
    v_mfma_f32_16x16x32_bf16 v[136:139], a[192:195], a[136:139], v[136:139]
    v_mfma_f32_16x16x32_bf16 v[136:139], a[196:199], a[152:155], v[136:139]
    v_mfma_f32_16x16x32_bf16 v[140:143], a[192:195], a[140:143], v[140:143]
    v_mfma_f32_16x16x32_bf16 v[140:143], a[196:199], a[156:159], v[140:143]
    s_waitcnt lgkmcnt(8)
    v_mfma_f32_16x16x32_bf16 v[144:147], a[200:203], a[128:131], v[144:147]
    ds_read_b64_tr_b16 a[192:193], v20 offset:0
    ds_read_b64_tr_b16 a[194:195], v20 offset:1024
    v_mfma_f32_16x16x32_bf16 v[144:147], a[204:207], a[144:147], v[144:147]
    ds_read_b64_tr_b16 a[196:197], v20 offset:16384
    ds_read_b64_tr_b16 a[198:199], v20 offset:17408
    v_mfma_f32_16x16x32_bf16 v[148:151], a[200:203], a[132:135], v[148:151]
    s_waitcnt vmcnt(8)
    v_mfma_f32_16x16x32_bf16 v[148:151], a[204:207], a[148:151], v[148:151]
    ds_read_b128 a[160:163], v6 offset:0
    ds_read_b128 a[164:167], v6 offset:2048
    v_mfma_f32_16x16x32_bf16 v[152:155], a[200:203], a[136:139], v[152:155]
    v_mfma_f32_16x16x32_bf16 v[152:155], a[204:207], a[152:155], v[152:155]
    ds_read_b128 a[168:171], v6 offset:4096
    ds_read_b128 a[172:175], v6 offset:6144
    v_mfma_f32_16x16x32_bf16 v[156:159], a[200:203], a[140:143], v[156:159]
    v_mfma_f32_16x16x32_bf16 v[156:159], a[204:207], a[156:159], v[156:159]
    s_waitcnt lgkmcnt(12)
    v_mfma_f32_16x16x32_bf16 v[160:163], a[208:211], a[128:131], v[160:163]
    ds_read_b64_tr_b16 a[200:201], v20 offset:8
    ds_read_b64_tr_b16 a[202:203], v20 offset:1032
    v_mfma_f32_16x16x32_bf16 v[160:163], a[212:215], a[144:147], v[160:163]
    ds_read_b64_tr_b16 a[204:205], v20 offset:16392
    ds_read_b64_tr_b16 a[206:207], v20 offset:17416
    v_mfma_f32_16x16x32_bf16 v[164:167], a[208:211], a[132:135], v[164:167]
    v_mfma_f32_16x16x32_bf16 v[164:167], a[212:215], a[148:151], v[164:167]
    ds_read_b128 a[176:179], v7 offset:0
    ds_read_b128 a[180:183], v7 offset:2048
    v_mfma_f32_16x16x32_bf16 v[168:171], a[208:211], a[136:139], v[168:171]
    s_waitcnt vmcnt(16)
    v_readfirstlane_b32 s96, v73
    s_nop 3
    s_cmp_ge_u32 s96, 32
    s_cbranch_scc1 KF_pxA
    v_mov_b32 v2, v74
    s_mov_b32 s97, 0
KF_px:
    buffer_load_dword v3, v2, s[72:75], 0 offen sc1
    s_waitcnt vmcnt(0)
    v_readfirstlane_b32 s96, v3
    s_add_u32 s97, s97, 1
    s_nop 3
    s_cmp_ge_u32 s96, 32
    s_cbranch_scc1 KF_px_ok
    s_cmp_ge_u32 s97, 20000
    s_cbranch_scc1 KF_px_ok
    s_sleep 8
    s_branch KF_px
KF_px_ok:
KF_pxA:
    s_lshl_b32 s54, s42, 9
    v_and_b32 v74, 15, v1
    v_lshlrev_b32 v74, 3, v74
    buffer_load_dwordx2 v[96:97], v74, s[76:79], s54 offen offset:0 sc1
    buffer_load_dwordx2 v[98:99], v74, s[76:79], s54 offen offset:128 sc1
    buffer_load_dwordx2 v[100:101], v74, s[76:79], s54 offen offset:256 sc1
    buffer_load_dwordx2 v[102:103], v74, s[76:79], s54 offen offset:384 sc1
    v_mfma_f32_16x16x32_bf16 v[168:171], a[212:215], a[152:155], v[168:171]
    ds_read_b128 a[184:187], v7 offset:4096
    ds_read_b128 a[188:191], v7 offset:6144
    v_mfma_f32_16x16x32_bf16 v[172:175], a[208:211], a[140:143], v[172:175]
    v_mfma_f32_16x16x32_bf16 v[172:175], a[212:215], a[156:159], v[172:175]
    s_waitcnt lgkmcnt(15)
    v_mfma_f32_16x16x32_bf16 v[176:179], a[216:219], a[128:131], v[176:179]
    ds_read_b64_tr_b16 a[208:209], v21 offset:0
    ds_read_b64_tr_b16 a[210:211], v21 offset:1024
    v_mfma_f32_16x16x32_bf16 v[176:179], a[220:223], a[144:147], v[176:179]
    ds_read_b64_tr_b16 a[212:213], v21 offset:16384
    ds_read_b64_tr_b16 a[214:215], v21 offset:17408
    v_mfma_f32_16x16x32_bf16 v[180:183], a[216:219], a[132:135], v[180:183]
    v_mfma_f32_16x16x32_bf16 v[180:183], a[220:223], a[148:151], v[180:183]
    v_mfma_f32_16x16x32_bf16 v[184:187], a[216:219], a[136:139], v[184:187]
    v_mfma_f32_16x16x32_bf16 v[184:187], a[220:223], a[152:155], v[184:187]
    v_mfma_f32_16x16x32_bf16 v[188:191], a[216:219], a[140:143], v[188:191]
    v_mfma_f32_16x16x32_bf16 v[188:191], a[220:223], a[156:159], v[188:191]
    s_waitcnt lgkmcnt(15)
    v_mfma_f32_16x16x32_bf16 v[192:195], a[192:195], a[128:131], v[192:195]
    ds_read_b64_tr_b16 a[216:217], v21 offset:8
    ds_read_b64_tr_b16 a[218:219], v21 offset:1032
    v_mfma_f32_16x16x32_bf16 v[192:195], a[196:199], a[144:147], v[192:195]
    ds_read_b64_tr_b16 a[220:221], v21 offset:16392
    ds_read_b64_tr_b16 a[222:223], v21 offset:17416
    v_mfma_f32_16x16x32_bf16 v[196:199], a[192:195], a[132:135], v[196:199]
    v_mfma_f32_16x16x32_bf16 v[196:199], a[196:199], a[148:151], v[196:199]
    v_mfma_f32_16x16x32_bf16 v[200:203], a[192:195], a[136:139], v[200:203]
    v_mfma_f32_16x16x32_bf16 v[200:203], a[196:199], a[152:155], v[200:203]
    v_mfma_f32_16x16x32_bf16 v[204:207], a[192:195], a[140:143], v[204:207]
    v_mfma_f32_16x16x32_bf16 v[204:207], a[196:199], a[156:159], v[204:207]
    s_waitcnt lgkmcnt(12)
    v_mfma_f32_16x16x32_bf16 v[208:211], a[200:203], a[128:131], v[208:211]
    ds_read_b64_tr_b16 a[192:193], v22 offset:0
    ds_read_b64_tr_b16 a[194:195], v22 offset:512
    v_mfma_f32_16x16x32_bf16 v[208:211], a[204:207], a[144:147], v[208:211]
    ds_read_b64_tr_b16 a[196:197], v22 offset:16384
    ds_read_b64_tr_b16 a[198:199], v22 offset:16896
    v_mfma_f32_16x16x32_bf16 v[212:215], a[200:203], a[132:135], v[212:215]
    v_mfma_f32_16x16x32_bf16 v[212:215], a[204:207], a[148:151], v[212:215]
    v_mfma_f32_16x16x32_bf16 v[216:219], a[200:203], a[136:139], v[216:219]
    v_mfma_f32_16x16x32_bf16 v[216:219], a[204:207], a[152:155], v[216:219]
    v_mfma_f32_16x16x32_bf16 v[220:223], a[200:203], a[140:143], v[220:223]
    v_mfma_f32_16x16x32_bf16 v[220:223], a[204:207], a[156:159], v[220:223]
    s_waitcnt lgkmcnt(8)
    v_mfma_f32_16x16x32_bf16 v[224:227], a[208:211], a[128:131], v[224:227]
    ds_read_b64_tr_b16 a[200:201], v23 offset:0
    ds_read_b64_tr_b16 a[202:203], v23 offset:512
    v_mfma_f32_16x16x32_bf16 v[224:227], a[212:215], a[144:147], v[224:227]
    ds_read_b64_tr_b16 a[204:205], v23 offset:16384
    ds_read_b64_tr_b16 a[206:207], v23 offset:16896
    v_mfma_f32_16x16x32_bf16 v[228:231], a[208:211], a[132:135], v[228:231]
    v_mfma_f32_16x16x32_bf16 v[228:231], a[212:215], a[148:151], v[228:231]
    ds_read_b64_tr_b16 a[224:225], v26 offset:0
    ds_read_b64_tr_b16 a[226:227], v27 offset:0
    v_mfma_f32_16x16x32_bf16 v[232:235], a[208:211], a[136:139], v[232:235]
    v_mfma_f32_16x16x32_bf16 v[232:235], a[212:215], a[152:155], v[232:235]
    ds_read_b64_tr_b16 a[228:229], v26 offset:16384
    ds_read_b64_tr_b16 a[230:231], v27 offset:16384
    v_mfma_f32_16x16x32_bf16 v[236:239], a[208:211], a[140:143], v[236:239]
    v_mfma_f32_16x16x32_bf16 v[236:239], a[212:215], a[156:159], v[236:239]
    s_waitcnt lgkmcnt(12)
    v_mfma_f32_16x16x32_bf16 v[240:243], a[216:219], a[128:131], v[240:243]
    ds_read_b64_tr_b16 a[208:209], v24 offset:0
    ds_read_b64_tr_b16 a[210:211], v24 offset:512
    v_mfma_f32_16x16x32_bf16 v[240:243], a[220:223], a[144:147], v[240:243]
    ds_read_b64_tr_b16 a[212:213], v24 offset:16384
    ds_read_b64_tr_b16 a[214:215], v24 offset:16896
    v_mfma_f32_16x16x32_bf16 v[244:247], a[216:219], a[132:135], v[244:247]
    v_mfma_f32_16x16x32_bf16 v[244:247], a[220:223], a[148:151], v[244:247]
    ds_read_b64_tr_b16 a[232:233], v28 offset:0
    ds_read_b64_tr_b16 a[234:235], v29 offset:0
    v_mfma_f32_16x16x32_bf16 v[248:251], a[216:219], a[136:139], v[248:251]
    v_mfma_f32_16x16x32_bf16 v[248:251], a[220:223], a[152:155], v[248:251]
    ds_read_b64_tr_b16 a[236:237], v28 offset:16384
    ds_read_b64_tr_b16 a[238:239], v29 offset:16384
    v_mfma_f32_16x16x32_bf16 v[252:255], a[216:219], a[140:143], v[252:255]
    v_mfma_f32_16x16x32_bf16 v[252:255], a[220:223], a[156:159], v[252:255]
    s_waitcnt lgkmcnt(15)
    v_mfma_f32_16x16x32_bf16 a[0:3], a[192:195], a[128:131], a[0:3]
    ds_read_b64_tr_b16 a[216:217], v25 offset:0
    ds_read_b64_tr_b16 a[218:219], v25 offset:512
    v_mfma_f32_16x16x32_bf16 a[0:3], a[196:199], a[144:147], a[0:3]
    ds_read_b64_tr_b16 a[220:221], v25 offset:16384
    ds_read_b64_tr_b16 a[222:223], v25 offset:16896
    v_mfma_f32_16x16x32_bf16 a[4:7], a[192:195], a[132:135], a[4:7]
    v_mfma_f32_16x16x32_bf16 a[4:7], a[196:199], a[148:151], a[4:7]
    ds_read_b64_tr_b16 a[240:241], v30 offset:0
    ds_read_b64_tr_b16 a[242:243], v31 offset:0
    v_mfma_f32_16x16x32_bf16 a[8:11], a[192:195], a[136:139], a[8:11]
    v_mfma_f32_16x16x32_bf16 a[8:11], a[196:199], a[152:155], a[8:11]
    ds_read_b64_tr_b16 a[244:245], v30 offset:16384
    ds_read_b64_tr_b16 a[246:247], v31 offset:16384
    v_mfma_f32_16x16x32_bf16 a[12:15], a[192:195], a[140:143], a[12:15]
    v_mfma_f32_16x16x32_bf16 a[12:15], a[196:199], a[156:159], a[12:15]
    s_waitcnt lgkmcnt(15)
    v_mfma_f32_16x16x32_bf16 a[16:19], a[200:203], a[128:131], a[16:19]
    ds_read_b64_tr_b16 a[192:193], v22 offset:1024
    ds_read_b64_tr_b16 a[194:195], v22 offset:1536
    v_mfma_f32_16x16x32_bf16 a[16:19], a[204:207], a[144:147], a[16:19]
    ds_read_b64_tr_b16 a[196:197], v22 offset:17408
    ds_read_b64_tr_b16 a[198:199], v22 offset:17920
    v_mfma_f32_16x16x32_bf16 a[20:23], a[200:203], a[132:135], a[20:23]
    v_mfma_f32_16x16x32_bf16 a[20:23], a[204:207], a[148:151], a[20:23]
    ds_read_b64_tr_b16 a[248:249], v32 offset:0
    ds_read_b64_tr_b16 a[250:251], v33 offset:0
    v_mfma_f32_16x16x32_bf16 a[24:27], a[200:203], a[136:139], a[24:27]
    v_mfma_f32_16x16x32_bf16 a[24:27], a[204:207], a[152:155], a[24:27]
    ds_read_b64_tr_b16 a[252:253], v32 offset:16384
    ds_read_b64_tr_b16 a[254:255], v33 offset:16384
    v_mfma_f32_16x16x32_bf16 a[28:31], a[200:203], a[140:143], a[28:31]
    v_mfma_f32_16x16x32_bf16 a[28:31], a[204:207], a[156:159], a[28:31]
    s_waitcnt lgkmcnt(15)
    v_mfma_f32_16x16x32_bf16 a[32:35], a[208:211], a[128:131], a[32:35]
    ds_read_b64_tr_b16 a[200:201], v23 offset:1024
    ds_read_b64_tr_b16 a[202:203], v23 offset:1536
    v_mfma_f32_16x16x32_bf16 a[32:35], a[212:215], a[144:147], a[32:35]
    ds_read_b64_tr_b16 a[204:205], v23 offset:17408
    ds_read_b64_tr_b16 a[206:207], v23 offset:17920
    v_mfma_f32_16x16x32_bf16 a[36:39], a[208:211], a[132:135], a[36:39]
    v_mfma_f32_16x16x32_bf16 a[36:39], a[212:215], a[148:151], a[36:39]
    v_mfma_f32_16x16x32_bf16 a[40:43], a[208:211], a[136:139], a[40:43]
    v_mfma_f32_16x16x32_bf16 a[40:43], a[212:215], a[152:155], a[40:43]
    v_mfma_f32_16x16x32_bf16 a[44:47], a[208:211], a[140:143], a[44:47]
    v_mfma_f32_16x16x32_bf16 a[44:47], a[212:215], a[156:159], a[44:47]
    s_waitcnt lgkmcnt(15)
    v_mfma_f32_16x16x32_bf16 a[48:51], a[216:219], a[128:131], a[48:51]
    ds_read_b64_tr_b16 a[208:209], v24 offset:1024
    ds_read_b64_tr_b16 a[210:211], v24 offset:1536
    v_mfma_f32_16x16x32_bf16 a[48:51], a[220:223], a[144:147], a[48:51]
    ds_read_b64_tr_b16 a[212:213], v24 offset:17408
    ds_read_b64_tr_b16 a[214:215], v24 offset:17920
    v_mfma_f32_16x16x32_bf16 a[52:55], a[216:219], a[132:135], a[52:55]
    v_mfma_f32_16x16x32_bf16 a[52:55], a[220:223], a[148:151], a[52:55]
    v_mfma_f32_16x16x32_bf16 a[56:59], a[216:219], a[136:139], a[56:59]
    v_mfma_f32_16x16x32_bf16 a[56:59], a[220:223], a[152:155], a[56:59]
    v_mfma_f32_16x16x32_bf16 a[60:63], a[216:219], a[140:143], a[60:63]
    v_mfma_f32_16x16x32_bf16 a[60:63], a[220:223], a[156:159], a[60:63]
    s_waitcnt lgkmcnt(12)
    v_mfma_f32_16x16x32_bf16 a[64:67], a[192:195], a[128:131], a[64:67]
    ds_read_b64_tr_b16 a[216:217], v25 offset:1024
    ds_read_b64_tr_b16 a[218:219], v25 offset:1536
    v_mfma_f32_16x16x32_bf16 a[64:67], a[196:199], a[144:147], a[64:67]
    ds_read_b64_tr_b16 a[220:221], v25 offset:17408
    ds_read_b64_tr_b16 a[222:223], v25 offset:17920
    v_mfma_f32_16x16x32_bf16 a[68:71], a[192:195], a[132:135], a[68:71]
    v_mfma_f32_16x16x32_bf16 a[68:71], a[196:199], a[148:151], a[68:71]
    v_mfma_f32_16x16x32_bf16 a[72:75], a[192:195], a[136:139], a[72:75]
    v_mfma_f32_16x16x32_bf16 a[72:75], a[196:199], a[152:155], a[72:75]
    v_mfma_f32_16x16x32_bf16 a[76:79], a[192:195], a[140:143], a[76:79]
    v_mfma_f32_16x16x32_bf16 a[76:79], a[196:199], a[156:159], a[76:79]
    s_waitcnt lgkmcnt(8)
    s_waitcnt lgkmcnt(0)
    s_waitcnt vmcnt(21)
    s_barrier
    v_mfma_f32_16x16x32_bf16 a[80:83], a[200:203], a[128:131], a[80:83]
    ds_read_b64_tr_b16 a[192:193], v18 offset:32768
    ds_read_b64_tr_b16 a[194:195], v18 offset:33792
    v_mfma_f32_16x16x32_bf16 a[80:83], a[204:207], a[144:147], a[80:83]
    s_add_u32 m0, s95, -98304
    ds_read_b64_tr_b16 a[196:197], v18 offset:49152
    ds_read_b64_tr_b16 a[198:199], v18 offset:50176
    v_mfma_f32_16x16x32_bf16 a[84:87], a[200:203], a[132:135], a[84:87]
    buffer_load_dwordx4 v46, s[24:27], s48 offen offset:0 lds
    v_mfma_f32_16x16x32_bf16 a[84:87], a[204:207], a[148:151], a[84:87]
    v_mfma_f32_16x16x32_bf16 a[88:91], a[200:203], a[136:139], a[88:91]
    v_mfma_f32_16x16x32_bf16 a[88:91], a[204:207], a[152:155], a[88:91]
    v_mfma_f32_16x16x32_bf16 a[92:95], a[200:203], a[140:143], a[92:95]
    buffer_load_dwordx4 v47, s[24:27], s48 offen offset:1024 lds
    v_mfma_f32_16x16x32_bf16 a[92:95], a[204:207], a[156:159], a[92:95]
    s_waitcnt lgkmcnt(8)
    v_mfma_f32_16x16x32_bf16 a[96:99], a[208:211], a[128:131], a[96:99]
    ds_read_b64_tr_b16 a[200:201], v18 offset:32776
    ds_read_b64_tr_b16 a[202:203], v18 offset:33800
    v_mfma_f32_16x16x32_bf16 a[96:99], a[212:215], a[144:147], a[96:99]
    ds_read_b64_tr_b16 a[204:205], v18 offset:49160
    ds_read_b64_tr_b16 a[206:207], v18 offset:50184
    v_mfma_f32_16x16x32_bf16 a[100:103], a[208:211], a[132:135], a[100:103]
    buffer_load_dwordx4 v46, s[24:27], s48 offen offset:2048 lds
    v_mfma_f32_16x16x32_bf16 a[100:103], a[212:215], a[148:151], a[100:103]
    v_mfma_f32_16x16x32_bf16 a[104:107], a[208:211], a[136:139], a[104:107]
    v_mfma_f32_16x16x32_bf16 a[104:107], a[212:215], a[152:155], a[104:107]
    v_mfma_f32_16x16x32_bf16 a[108:111], a[208:211], a[140:143], a[108:111]
    buffer_load_dwordx4 v47, s[24:27], s48 offen offset:3072 lds
    v_mfma_f32_16x16x32_bf16 a[108:111], a[212:215], a[156:159], a[108:111]
    s_waitcnt lgkmcnt(8)
    v_mfma_f32_16x16x32_bf16 a[112:115], a[216:219], a[128:131], a[112:115]
    s_add_u32 m0, s95, -94208
    ds_read_b64_tr_b16 a[208:209], v19 offset:32768
    ds_read_b64_tr_b16 a[210:211], v19 offset:33792
    v_mfma_f32_16x16x32_bf16 a[112:115], a[220:223], a[144:147], a[112:115]
    s_add_u32 s48, s48, 4096
    ds_read_b64_tr_b16 a[212:213], v19 offset:49152
    ds_read_b64_tr_b16 a[214:215], v19 offset:50176
    v_mfma_f32_16x16x32_bf16 a[116:119], a[216:219], a[132:135], a[116:119]
    buffer_load_dwordx4 v46, s[24:27], s48 offen offset:0 lds
    v_mfma_f32_16x16x32_bf16 a[116:119], a[220:223], a[148:151], a[116:119]
    v_mfma_f32_16x16x32_bf16 a[120:123], a[216:219], a[136:139], a[120:123]
    v_mfma_f32_16x16x32_bf16 a[120:123], a[220:223], a[152:155], a[120:123]
    v_mfma_f32_16x16x32_bf16 a[124:127], a[216:219], a[140:143], a[124:127]
    buffer_load_dwordx4 v47, s[24:27], s48 offen offset:1024 lds
    v_mfma_f32_16x16x32_bf16 a[124:127], a[220:223], a[156:159], a[124:127]
    s_waitcnt lgkmcnt(15)
    v_mfma_f32_16x16x32_bf16 v[112:115], a[224:227], v[104:107], v[112:115]
    v_mfma_f32_16x16x32_bf16 v[112:115], a[228:231], v[104:107], v[112:115]
    v_mfma_f32_16x16x32_bf16 v[116:119], a[232:235], v[104:107], v[116:119]
    buffer_load_dwordx4 v46, s[24:27], s48 offen offset:2048 lds
    v_mfma_f32_16x16x32_bf16 v[116:119], a[236:239], v[104:107], v[116:119]
    v_mfma_f32_16x16x32_bf16 v[120:123], a[240:243], v[104:107], v[120:123]
    v_mfma_f32_16x16x32_bf16 v[120:123], a[244:247], v[104:107], v[120:123]
    v_mfma_f32_16x16x32_bf16 v[124:127], a[248:251], v[104:107], v[124:127]
    buffer_load_dwordx4 v47, s[24:27], s48 offen offset:3072 lds
    v_mfma_f32_16x16x32_bf16 v[124:127], a[252:255], v[104:107], v[124:127]
    s_waitcnt lgkmcnt(8)
    v_mfma_f32_16x16x32_bf16 v[128:131], a[192:195], a[160:163], v[128:131]
    ds_read_b64_tr_b16 a[216:217], v19 offset:32776
    ds_read_b64_tr_b16 a[218:219], v19 offset:33800
    v_mfma_f32_16x16x32_bf16 v[128:131], a[196:199], a[176:179], v[128:131]
    ds_read_b64_tr_b16 a[220:221], v19 offset:49160
    ds_read_b64_tr_b16 a[222:223], v19 offset:50184
    v_mfma_f32_16x16x32_bf16 v[132:135], a[192:195], a[164:167], v[132:135]
    v_mfma_f32_16x16x32_bf16 v[132:135], a[196:199], a[180:183], v[132:135]
    v_mfma_f32_16x16x32_bf16 v[136:139], a[192:195], a[168:171], v[136:139]
    v_mfma_f32_16x16x32_bf16 v[136:139], a[196:199], a[184:187], v[136:139]
    v_mfma_f32_16x16x32_bf16 v[140:143], a[192:195], a[172:175], v[140:143]
    v_mfma_f32_16x16x32_bf16 v[140:143], a[196:199], a[188:191], v[140:143]
    s_waitcnt lgkmcnt(8)
    v_mfma_f32_16x16x32_bf16 v[144:147], a[200:203], a[160:163], v[144:147]
    ds_read_b64_tr_b16 a[192:193], v20 offset:32768
    ds_read_b64_tr_b16 a[194:195], v20 offset:33792
    v_mfma_f32_16x16x32_bf16 v[144:147], a[204:207], a[176:179], v[144:147]
    ds_read_b64_tr_b16 a[196:197], v20 offset:49152
    ds_read_b64_tr_b16 a[198:199], v20 offset:50176
    v_mfma_f32_16x16x32_bf16 v[148:151], a[200:203], a[164:167], v[148:151]
    v_mfma_f32_16x16x32_bf16 v[148:151], a[204:207], a[180:183], v[148:151]
    v_mfma_f32_16x16x32_bf16 v[152:155], a[200:203], a[168:171], v[152:155]
    v_mfma_f32_16x16x32_bf16 v[152:155], a[204:207], a[184:187], v[152:155]
    v_mfma_f32_16x16x32_bf16 v[156:159], a[200:203], a[172:175], v[156:159]
    v_mfma_f32_16x16x32_bf16 v[156:159], a[204:207], a[188:191], v[156:159]
    s_waitcnt lgkmcnt(8)
    v_mfma_f32_16x16x32_bf16 v[160:163], a[208:211], a[160:163], v[160:163]
    ds_read_b64_tr_b16 a[200:201], v20 offset:32776
    ds_read_b64_tr_b16 a[202:203], v20 offset:33800
    v_mfma_f32_16x16x32_bf16 v[160:163], a[212:215], a[176:179], v[160:163]
    ds_read_b64_tr_b16 a[204:205], v20 offset:49160
    ds_read_b64_tr_b16 a[206:207], v20 offset:50184
    v_mfma_f32_16x16x32_bf16 v[164:167], a[208:211], a[164:167], v[164:167]
    v_mfma_f32_16x16x32_bf16 v[164:167], a[212:215], a[180:183], v[164:167]
    v_mfma_f32_16x16x32_bf16 v[168:171], a[208:211], a[168:171], v[168:171]
    v_mfma_f32_16x16x32_bf16 v[168:171], a[212:215], a[184:187], v[168:171]
    v_mfma_f32_16x16x32_bf16 v[172:175], a[208:211], a[172:175], v[172:175]
    v_mfma_f32_16x16x32_bf16 v[172:175], a[212:215], a[188:191], v[172:175]
    s_waitcnt lgkmcnt(8)
    v_mfma_f32_16x16x32_bf16 v[176:179], a[216:219], a[160:163], v[176:179]
    ds_read_b64_tr_b16 a[208:209], v21 offset:32768
    ds_read_b64_tr_b16 a[210:211], v21 offset:33792
    v_mfma_f32_16x16x32_bf16 v[176:179], a[220:223], a[176:179], v[176:179]
    ds_read_b64_tr_b16 a[212:213], v21 offset:49152
    ds_read_b64_tr_b16 a[214:215], v21 offset:50176
    v_mfma_f32_16x16x32_bf16 v[180:183], a[216:219], a[164:167], v[180:183]
    v_mfma_f32_16x16x32_bf16 v[180:183], a[220:223], a[180:183], v[180:183]
    v_mfma_f32_16x16x32_bf16 v[184:187], a[216:219], a[168:171], v[184:187]
    v_mfma_f32_16x16x32_bf16 v[184:187], a[220:223], a[184:187], v[184:187]
    v_mfma_f32_16x16x32_bf16 v[188:191], a[216:219], a[172:175], v[188:191]
    v_mfma_f32_16x16x32_bf16 v[188:191], a[220:223], a[188:191], v[188:191]
    s_waitcnt lgkmcnt(8)
    v_mfma_f32_16x16x32_bf16 v[192:195], a[192:195], a[160:163], v[192:195]
    ds_read_b64_tr_b16 a[216:217], v21 offset:32776
    ds_read_b64_tr_b16 a[218:219], v21 offset:33800
    v_mfma_f32_16x16x32_bf16 v[192:195], a[196:199], a[176:179], v[192:195]
    ds_read_b64_tr_b16 a[220:221], v21 offset:49160
    ds_read_b64_tr_b16 a[222:223], v21 offset:50184
    v_mfma_f32_16x16x32_bf16 v[196:199], a[192:195], a[164:167], v[196:199]
    v_mfma_f32_16x16x32_bf16 v[196:199], a[196:199], a[180:183], v[196:199]
    v_mfma_f32_16x16x32_bf16 v[200:203], a[192:195], a[168:171], v[200:203]
    v_mfma_f32_16x16x32_bf16 v[200:203], a[196:199], a[184:187], v[200:203]
    v_mfma_f32_16x16x32_bf16 v[204:207], a[192:195], a[172:175], v[204:207]
    v_mfma_f32_16x16x32_bf16 v[204:207], a[196:199], a[188:191], v[204:207]
    s_waitcnt lgkmcnt(8)
    v_mfma_f32_16x16x32_bf16 v[208:211], a[200:203], a[160:163], v[208:211]
    ds_read_b64_tr_b16 a[192:193], v22 offset:32768
    ds_read_b64_tr_b16 a[194:195], v22 offset:33280
    v_mfma_f32_16x16x32_bf16 v[208:211], a[204:207], a[176:179], v[208:211]
    ds_read_b64_tr_b16 a[196:197], v22 offset:49152
    ds_read_b64_tr_b16 a[198:199], v22 offset:49664
    v_mfma_f32_16x16x32_bf16 v[212:215], a[200:203], a[164:167], v[212:215]
    v_mfma_f32_16x16x32_bf16 v[212:215], a[204:207], a[180:183], v[212:215]
    v_mfma_f32_16x16x32_bf16 v[216:219], a[200:203], a[168:171], v[216:219]
    v_mfma_f32_16x16x32_bf16 v[216:219], a[204:207], a[184:187], v[216:219]
    v_mfma_f32_16x16x32_bf16 v[220:223], a[200:203], a[172:175], v[220:223]
    v_mfma_f32_16x16x32_bf16 v[220:223], a[204:207], a[188:191], v[220:223]
    s_waitcnt lgkmcnt(8)
    v_mfma_f32_16x16x32_bf16 v[224:227], a[208:211], a[160:163], v[224:227]
    ds_read_b64_tr_b16 a[200:201], v23 offset:32768
    ds_read_b64_tr_b16 a[202:203], v23 offset:33280
    v_mfma_f32_16x16x32_bf16 v[224:227], a[212:215], a[176:179], v[224:227]
    ds_read_b64_tr_b16 a[204:205], v23 offset:49152
    ds_read_b64_tr_b16 a[206:207], v23 offset:49664
    v_mfma_f32_16x16x32_bf16 v[228:231], a[208:211], a[164:167], v[228:231]
    v_mfma_f32_16x16x32_bf16 v[228:231], a[212:215], a[180:183], v[228:231]
    ds_read_b64_tr_b16 a[224:225], v26 offset:32768
    ds_read_b64_tr_b16 a[226:227], v27 offset:32768
    v_mfma_f32_16x16x32_bf16 v[232:235], a[208:211], a[168:171], v[232:235]
    v_mfma_f32_16x16x32_bf16 v[232:235], a[212:215], a[184:187], v[232:235]
    ds_read_b64_tr_b16 a[228:229], v26 offset:49152
    ds_read_b64_tr_b16 a[230:231], v27 offset:49152
    v_mfma_f32_16x16x32_bf16 v[236:239], a[208:211], a[172:175], v[236:239]
    v_mfma_f32_16x16x32_bf16 v[236:239], a[212:215], a[188:191], v[236:239]
    s_waitcnt lgkmcnt(12)
    v_mfma_f32_16x16x32_bf16 v[240:243], a[216:219], a[160:163], v[240:243]
    ds_read_b64_tr_b16 a[208:209], v24 offset:32768
    ds_read_b64_tr_b16 a[210:211], v24 offset:33280
    v_mfma_f32_16x16x32_bf16 v[240:243], a[220:223], a[176:179], v[240:243]
    ds_read_b64_tr_b16 a[212:213], v24 offset:49152
    ds_read_b64_tr_b16 a[214:215], v24 offset:49664
    v_mfma_f32_16x16x32_bf16 v[244:247], a[216:219], a[164:167], v[244:247]
    v_mfma_f32_16x16x32_bf16 v[244:247], a[220:223], a[180:183], v[244:247]
    ds_read_b64_tr_b16 a[232:233], v28 offset:32768
    ds_read_b64_tr_b16 a[234:235], v29 offset:32768
    v_mfma_f32_16x16x32_bf16 v[248:251], a[216:219], a[168:171], v[248:251]
    v_mfma_f32_16x16x32_bf16 v[248:251], a[220:223], a[184:187], v[248:251]
    ds_read_b64_tr_b16 a[236:237], v28 offset:49152
    ds_read_b64_tr_b16 a[238:239], v29 offset:49152
    v_mfma_f32_16x16x32_bf16 v[252:255], a[216:219], a[172:175], v[252:255]
    v_mfma_f32_16x16x32_bf16 v[252:255], a[220:223], a[188:191], v[252:255]
    s_waitcnt lgkmcnt(15)
    v_mfma_f32_16x16x32_bf16 a[0:3], a[192:195], a[160:163], a[0:3]
    ds_read_b64_tr_b16 a[216:217], v25 offset:32768
    ds_read_b64_tr_b16 a[218:219], v25 offset:33280
    v_mfma_f32_16x16x32_bf16 a[0:3], a[196:199], a[176:179], a[0:3]
    ds_read_b64_tr_b16 a[220:221], v25 offset:49152
    ds_read_b64_tr_b16 a[222:223], v25 offset:49664
    v_mfma_f32_16x16x32_bf16 a[4:7], a[192:195], a[164:167], a[4:7]
    v_mfma_f32_16x16x32_bf16 a[4:7], a[196:199], a[180:183], a[4:7]
    ds_read_b64_tr_b16 a[240:241], v30 offset:32768
    ds_read_b64_tr_b16 a[242:243], v31 offset:32768
    v_mfma_f32_16x16x32_bf16 a[8:11], a[192:195], a[168:171], a[8:11]
    v_mfma_f32_16x16x32_bf16 a[8:11], a[196:199], a[184:187], a[8:11]
    ds_read_b64_tr_b16 a[244:245], v30 offset:49152
    ds_read_b64_tr_b16 a[246:247], v31 offset:49152
    v_mfma_f32_16x16x32_bf16 a[12:15], a[192:195], a[172:175], a[12:15]
    v_mfma_f32_16x16x32_bf16 a[12:15], a[196:199], a[188:191], a[12:15]
    s_waitcnt lgkmcnt(15)
    v_mfma_f32_16x16x32_bf16 a[16:19], a[200:203], a[160:163], a[16:19]
    ds_read_b64_tr_b16 a[192:193], v22 offset:33792
    ds_read_b64_tr_b16 a[194:195], v22 offset:34304
    v_mfma_f32_16x16x32_bf16 a[16:19], a[204:207], a[176:179], a[16:19]
    ds_read_b64_tr_b16 a[196:197], v22 offset:50176
    ds_read_b64_tr_b16 a[198:199], v22 offset:50688
    v_mfma_f32_16x16x32_bf16 a[20:23], a[200:203], a[164:167], a[20:23]
    v_mfma_f32_16x16x32_bf16 a[20:23], a[204:207], a[180:183], a[20:23]
    ds_read_b64_tr_b16 a[248:249], v32 offset:32768
    ds_read_b64_tr_b16 a[250:251], v33 offset:32768
    v_mfma_f32_16x16x32_bf16 a[24:27], a[200:203], a[168:171], a[24:27]
    v_mfma_f32_16x16x32_bf16 a[24:27], a[204:207], a[184:187], a[24:27]
    ds_read_b64_tr_b16 a[252:253], v32 offset:49152
    ds_read_b64_tr_b16 a[254:255], v33 offset:49152
    v_mfma_f32_16x16x32_bf16 a[28:31], a[200:203], a[172:175], a[28:31]
    v_mfma_f32_16x16x32_bf16 a[28:31], a[204:207], a[188:191], a[28:31]
    s_waitcnt lgkmcnt(15)
    v_mfma_f32_16x16x32_bf16 a[32:35], a[208:211], a[160:163], a[32:35]
    ds_read_b64_tr_b16 a[200:201], v23 offset:33792
    ds_read_b64_tr_b16 a[202:203], v23 offset:34304
    v_mfma_f32_16x16x32_bf16 a[32:35], a[212:215], a[176:179], a[32:35]
    ds_read_b64_tr_b16 a[204:205], v23 offset:50176
    ds_read_b64_tr_b16 a[206:207], v23 offset:50688
    v_mfma_f32_16x16x32_bf16 a[36:39], a[208:211], a[164:167], a[36:39]
    v_mfma_f32_16x16x32_bf16 a[36:39], a[212:215], a[180:183], a[36:39]
    v_mfma_f32_16x16x32_bf16 a[40:43], a[208:211], a[168:171], a[40:43]
    v_mfma_f32_16x16x32_bf16 a[40:43], a[212:215], a[184:187], a[40:43]
    v_mfma_f32_16x16x32_bf16 a[44:47], a[208:211], a[172:175], a[44:47]
    v_mfma_f32_16x16x32_bf16 a[44:47], a[212:215], a[188:191], a[44:47]
    s_waitcnt lgkmcnt(15)
    v_mfma_f32_16x16x32_bf16 a[48:51], a[216:219], a[160:163], a[48:51]
    ds_read_b64_tr_b16 a[208:209], v24 offset:33792
    ds_read_b64_tr_b16 a[210:211], v24 offset:34304
    v_mfma_f32_16x16x32_bf16 a[48:51], a[220:223], a[176:179], a[48:51]
    ds_read_b64_tr_b16 a[212:213], v24 offset:50176
    ds_read_b64_tr_b16 a[214:215], v24 offset:50688
    v_mfma_f32_16x16x32_bf16 a[52:55], a[216:219], a[164:167], a[52:55]
    v_mfma_f32_16x16x32_bf16 a[52:55], a[220:223], a[180:183], a[52:55]
    v_mfma_f32_16x16x32_bf16 a[56:59], a[216:219], a[168:171], a[56:59]
    v_mfma_f32_16x16x32_bf16 a[56:59], a[220:223], a[184:187], a[56:59]
    v_mfma_f32_16x16x32_bf16 a[60:63], a[216:219], a[172:175], a[60:63]
    v_mfma_f32_16x16x32_bf16 a[60:63], a[220:223], a[188:191], a[60:63]
    s_waitcnt lgkmcnt(12)
    v_mfma_f32_16x16x32_bf16 a[64:67], a[192:195], a[160:163], a[64:67]
    ds_read_b64_tr_b16 a[216:217], v25 offset:33792
    ds_read_b64_tr_b16 a[218:219], v25 offset:34304
    v_mfma_f32_16x16x32_bf16 a[64:67], a[196:199], a[176:179], a[64:67]
    ds_read_b64_tr_b16 a[220:221], v25 offset:50176
    ds_read_b64_tr_b16 a[222:223], v25 offset:50688
    v_mfma_f32_16x16x32_bf16 a[68:71], a[192:195], a[164:167], a[68:71]
    v_mfma_f32_16x16x32_bf16 a[68:71], a[196:199], a[180:183], a[68:71]
    v_mfma_f32_16x16x32_bf16 a[72:75], a[192:195], a[168:171], a[72:75]
    v_mfma_f32_16x16x32_bf16 a[72:75], a[196:199], a[184:187], a[72:75]
    v_mfma_f32_16x16x32_bf16 a[76:79], a[192:195], a[172:175], a[76:79]
    v_mfma_f32_16x16x32_bf16 a[76:79], a[196:199], a[188:191], a[76:79]
    s_waitcnt lgkmcnt(8)
    s_waitcnt lgkmcnt(0)
    s_barrier
    v_mfma_f32_16x16x32_bf16 a[80:83], a[200:203], a[160:163], a[80:83]
    v_mfma_f32_16x16x32_bf16 a[80:83], a[204:207], a[176:179], a[80:83]
    v_mfma_f32_16x16x32_bf16 a[84:87], a[200:203], a[164:167], a[84:87]
    v_mfma_f32_16x16x32_bf16 a[84:87], a[204:207], a[180:183], a[84:87]
    v_mfma_f32_16x16x32_bf16 a[88:91], a[200:203], a[168:171], a[88:91]
    v_mfma_f32_16x16x32_bf16 a[88:91], a[204:207], a[184:187], a[88:91]
    v_mfma_f32_16x16x32_bf16 a[92:95], a[200:203], a[172:175], a[92:95]
    v_mfma_f32_16x16x32_bf16 a[92:95], a[204:207], a[188:191], a[92:95]
    s_waitcnt lgkmcnt(4)
    v_mfma_f32_16x16x32_bf16 a[96:99], a[208:211], a[160:163], a[96:99]
    v_mfma_f32_16x16x32_bf16 a[96:99], a[212:215], a[176:179], a[96:99]
    v_mfma_f32_16x16x32_bf16 a[100:103], a[208:211], a[164:167], a[100:103]
    v_mfma_f32_16x16x32_bf16 a[100:103], a[212:215], a[180:183], a[100:103]
    v_mfma_f32_16x16x32_bf16 a[104:107], a[208:211], a[168:171], a[104:107]
    v_mfma_f32_16x16x32_bf16 a[104:107], a[212:215], a[184:187], a[104:107]
    v_mfma_f32_16x16x32_bf16 a[108:111], a[208:211], a[172:175], a[108:111]
    v_mfma_f32_16x16x32_bf16 a[108:111], a[212:215], a[188:191], a[108:111]
    s_waitcnt lgkmcnt(0)
    v_mfma_f32_16x16x32_bf16 a[112:115], a[216:219], a[160:163], a[112:115]
    v_mfma_f32_16x16x32_bf16 a[112:115], a[220:223], a[176:179], a[112:115]
    v_mfma_f32_16x16x32_bf16 a[116:119], a[216:219], a[164:167], a[116:119]
    v_mfma_f32_16x16x32_bf16 a[116:119], a[220:223], a[180:183], a[116:119]
    v_mfma_f32_16x16x32_bf16 a[120:123], a[216:219], a[168:171], a[120:123]
    v_mfma_f32_16x16x32_bf16 a[120:123], a[220:223], a[184:187], a[120:123]
    v_mfma_f32_16x16x32_bf16 a[124:127], a[216:219], a[172:175], a[124:127]
    v_mfma_f32_16x16x32_bf16 a[124:127], a[220:223], a[188:191], a[124:127]
    s_waitcnt lgkmcnt(12)
    v_mfma_f32_16x16x32_bf16 v[112:115], a[224:227], v[104:107], v[112:115]
    v_mfma_f32_16x16x32_bf16 v[112:115], a[228:231], v[104:107], v[112:115]
    v_mfma_f32_16x16x32_bf16 v[116:119], a[232:235], v[104:107], v[116:119]
    v_mfma_f32_16x16x32_bf16 v[116:119], a[236:239], v[104:107], v[116:119]
    v_mfma_f32_16x16x32_bf16 v[120:123], a[240:243], v[104:107], v[120:123]
    v_mfma_f32_16x16x32_bf16 v[120:123], a[244:247], v[104:107], v[120:123]
    v_mfma_f32_16x16x32_bf16 v[124:127], a[248:251], v[104:107], v[124:127]
    v_mfma_f32_16x16x32_bf16 v[124:127], a[252:255], v[104:107], v[124:127]
    s_nop 7
    v_lshrrev_b32 v2, 4, v1
    v_lshlrev_b32 v2, 4, v2
    s_lshl_b32 s52, s3, 8
    s_add_u32 s52, s52, 147456
    v_add_u32 v3, s52, v2
    ds_write_b128 v3, v[112:115] offset:0
    ds_write_b128 v3, v[116:119] offset:64
    ds_write_b128 v3, v[120:123] offset:128
    ds_write_b128 v3, v[124:127] offset:192
    v_add_u32 v3, 147456, v2
    s_waitcnt lgkmcnt(0)
    s_barrier
    s_waitcnt vmcnt(8)
    s_mov_b32 s55, 0x3e0293ee
    v_mul_f32 v60, v97, v97
    v_mul_f32 v61, s55, v97
    v_mul_f32 v62, v99, v99
    v_mul_f32 v63, s55, v99
    v_mul_f32 v64, v101, v101
    v_mul_f32 v65, s55, v101
    v_mul_f32 v66, v103, v103
    v_mul_f32 v67, s55, v103
    s_cmp_ge_u32 s40, 28
    s_cbranch_scc1 KF_noh
    ds_read_b128 v[76:79], v3 offset:512
    ds_read_b128 v[112:115], v3 offset:768
    ds_read_b128 v[80:83], v3 offset:576
    ds_read_b128 v[116:119], v3 offset:832
    ds_read_b128 v[84:87], v3 offset:640
    ds_read_b128 v[120:123], v3 offset:896
    ds_read_b128 v[88:91], v3 offset:704
    ds_read_b128 v[124:127], v3 offset:960
    s_waitcnt lgkmcnt(0)
    v_accvgpr_read_b32 v68, a0
    v_accvgpr_read_b32 v69, a1
    v_accvgpr_read_b32 v70, a2
    v_accvgpr_read_b32 v71, a3
    v_accvgpr_read_b32 v72, a64
    v_accvgpr_read_b32 v73, a65
    v_accvgpr_read_b32 v74, a66
    v_accvgpr_read_b32 v75, a67
    v_pk_fma_f32 v[68:69], v[96:97], v[76:77], v[68:69] op_sel_hi:[0,1,1] neg_lo:[1,0,0] neg_hi:[1,0,0]
    v_pk_fma_f32 v[70:71], v[96:97], v[78:79], v[70:71] op_sel_hi:[0,1,1] neg_lo:[1,0,0] neg_hi:[1,0,0]
    v_pk_fma_f32 v[72:73], v[96:97], v[112:113], v[72:73] op_sel_hi:[0,1,1] neg_lo:[1,0,0] neg_hi:[1,0,0]
    v_pk_fma_f32 v[74:75], v[96:97], v[114:115], v[74:75] op_sel_hi:[0,1,1] neg_lo:[1,0,0] neg_hi:[1,0,0]
    v_max_f32 v68, 0, v68
    v_max_f32 v69, 0, v69
    v_max_f32 v70, 0, v70
    v_max_f32 v71, 0, v71
    v_pk_mul_f32 v[72:73], v[72:73], v[60:61] op_sel_hi:[1,0]
    v_pk_mul_f32 v[74:75], v[74:75], v[60:61] op_sel_hi:[1,0]
    v_pk_mul_f32 v[68:69], v[68:69], v[72:73]
    v_pk_mul_f32 v[70:71], v[70:71], v[74:75]
    v_cvt_pk_bf16_f32 v104, v68, v69
    v_cvt_pk_bf16_f32 v105, v70, v71
    v_accvgpr_read_b32 v68, a16
    v_accvgpr_read_b32 v69, a17
    v_accvgpr_read_b32 v70, a18
    v_accvgpr_read_b32 v71, a19
    v_accvgpr_read_b32 v72, a80
    v_accvgpr_read_b32 v73, a81
    v_accvgpr_read_b32 v74, a82
    v_accvgpr_read_b32 v75, a83
    v_pk_fma_f32 v[68:69], v[96:97], v[80:81], v[68:69] op_sel_hi:[0,1,1] neg_lo:[1,0,0] neg_hi:[1,0,0]
    v_pk_fma_f32 v[70:71], v[96:97], v[82:83], v[70:71] op_sel_hi:[0,1,1] neg_lo:[1,0,0] neg_hi:[1,0,0]
    v_pk_fma_f32 v[72:73], v[96:97], v[116:117], v[72:73] op_sel_hi:[0,1,1] neg_lo:[1,0,0] neg_hi:[1,0,0]
    v_pk_fma_f32 v[74:75], v[96:97], v[118:119], v[74:75] op_sel_hi:[0,1,1] neg_lo:[1,0,0] neg_hi:[1,0,0]
    v_max_f32 v68, 0, v68
    v_max_f32 v69, 0, v69
    v_max_f32 v70, 0, v70
    v_max_f32 v71, 0, v71
    v_pk_mul_f32 v[72:73], v[72:73], v[60:61] op_sel_hi:[1,0]
    v_pk_mul_f32 v[74:75], v[74:75], v[60:61] op_sel_hi:[1,0]
    v_pk_mul_f32 v[68:69], v[68:69], v[72:73]
    v_pk_mul_f32 v[70:71], v[70:71], v[74:75]
    v_cvt_pk_bf16_f32 v106, v68, v69
    v_cvt_pk_bf16_f32 v107, v70, v71
    s_mov_b32 s52, 0
    buffer_store_dwordx4 v[104:107], v10, s[32:35], s52 offen offset:0 sc1
    v_accvgpr_read_b32 v68, a4
    v_accvgpr_read_b32 v69, a5
    v_accvgpr_read_b32 v70, a6
    v_accvgpr_read_b32 v71, a7
    v_accvgpr_read_b32 v72, a68
    v_accvgpr_read_b32 v73, a69
    v_accvgpr_read_b32 v74, a70
    v_accvgpr_read_b32 v75, a71
    v_pk_fma_f32 v[68:69], v[98:99], v[76:77], v[68:69] op_sel_hi:[0,1,1] neg_lo:[1,0,0] neg_hi:[1,0,0]
    v_pk_fma_f32 v[70:71], v[98:99], v[78:79], v[70:71] op_sel_hi:[0,1,1] neg_lo:[1,0,0] neg_hi:[1,0,0]
    v_pk_fma_f32 v[72:73], v[98:99], v[112:113], v[72:73] op_sel_hi:[0,1,1] neg_lo:[1,0,0] neg_hi:[1,0,0]
    v_pk_fma_f32 v[74:75], v[98:99], v[114:115], v[74:75] op_sel_hi:[0,1,1] neg_lo:[1,0,0] neg_hi:[1,0,0]
    v_max_f32 v68, 0, v68
    v_max_f32 v69, 0, v69
    v_max_f32 v70, 0, v70
    v_max_f32 v71, 0, v71
    v_pk_mul_f32 v[72:73], v[72:73], v[62:63] op_sel_hi:[1,0]
    v_pk_mul_f32 v[74:75], v[74:75], v[62:63] op_sel_hi:[1,0]
    v_pk_mul_f32 v[68:69], v[68:69], v[72:73]
    v_pk_mul_f32 v[70:71], v[70:71], v[74:75]
    v_cvt_pk_bf16_f32 v108, v68, v69
    v_cvt_pk_bf16_f32 v109, v70, v71
    v_accvgpr_read_b32 v68, a20
    v_accvgpr_read_b32 v69, a21
    v_accvgpr_read_b32 v70, a22
    v_accvgpr_read_b32 v71, a23
    v_accvgpr_read_b32 v72, a84
    v_accvgpr_read_b32 v73, a85
    v_accvgpr_read_b32 v74, a86
    v_accvgpr_read_b32 v75, a87
    v_pk_fma_f32 v[68:69], v[98:99], v[80:81], v[68:69] op_sel_hi:[0,1,1] neg_lo:[1,0,0] neg_hi:[1,0,0]
    v_pk_fma_f32 v[70:71], v[98:99], v[82:83], v[70:71] op_sel_hi:[0,1,1] neg_lo:[1,0,0] neg_hi:[1,0,0]
    v_pk_fma_f32 v[72:73], v[98:99], v[116:117], v[72:73] op_sel_hi:[0,1,1] neg_lo:[1,0,0] neg_hi:[1,0,0]
    v_pk_fma_f32 v[74:75], v[98:99], v[118:119], v[74:75] op_sel_hi:[0,1,1] neg_lo:[1,0,0] neg_hi:[1,0,0]
    v_max_f32 v68, 0, v68
    v_max_f32 v69, 0, v69
    v_max_f32 v70, 0, v70
    v_max_f32 v71, 0, v71
    v_pk_mul_f32 v[72:73], v[72:73], v[62:63] op_sel_hi:[1,0]
    v_pk_mul_f32 v[74:75], v[74:75], v[62:63] op_sel_hi:[1,0]
    v_pk_mul_f32 v[68:69], v[68:69], v[72:73]
    v_pk_mul_f32 v[70:71], v[70:71], v[74:75]
    v_cvt_pk_bf16_f32 v110, v68, v69
    v_cvt_pk_bf16_f32 v111, v70, v71
    s_mov_b32 s52, 0
    buffer_store_dwordx4 v[108:111], v10, s[32:35], s52 offen offset:1024 sc1
    v_accvgpr_read_b32 v68, a8
    v_accvgpr_read_b32 v69, a9
    v_accvgpr_read_b32 v70, a10
    v_accvgpr_read_b32 v71, a11
    v_accvgpr_read_b32 v72, a72
    v_accvgpr_read_b32 v73, a73
    v_accvgpr_read_b32 v74, a74
    v_accvgpr_read_b32 v75, a75
    v_pk_fma_f32 v[68:69], v[100:101], v[76:77], v[68:69] op_sel_hi:[0,1,1] neg_lo:[1,0,0] neg_hi:[1,0,0]
    v_pk_fma_f32 v[70:71], v[100:101], v[78:79], v[70:71] op_sel_hi:[0,1,1] neg_lo:[1,0,0] neg_hi:[1,0,0]
    v_pk_fma_f32 v[72:73], v[100:101], v[112:113], v[72:73] op_sel_hi:[0,1,1] neg_lo:[1,0,0] neg_hi:[1,0,0]
    v_pk_fma_f32 v[74:75], v[100:101], v[114:115], v[74:75] op_sel_hi:[0,1,1] neg_lo:[1,0,0] neg_hi:[1,0,0]
    v_max_f32 v68, 0, v68
    v_max_f32 v69, 0, v69
    v_max_f32 v70, 0, v70
    v_max_f32 v71, 0, v71
    v_pk_mul_f32 v[72:73], v[72:73], v[64:65] op_sel_hi:[1,0]
    v_pk_mul_f32 v[74:75], v[74:75], v[64:65] op_sel_hi:[1,0]
    v_pk_mul_f32 v[68:69], v[68:69], v[72:73]
    v_pk_mul_f32 v[70:71], v[70:71], v[74:75]
    v_cvt_pk_bf16_f32 v104, v68, v69
    v_cvt_pk_bf16_f32 v105, v70, v71
    v_accvgpr_read_b32 v68, a24
    v_accvgpr_read_b32 v69, a25
    v_accvgpr_read_b32 v70, a26
    v_accvgpr_read_b32 v71, a27
    v_accvgpr_read_b32 v72, a88
    v_accvgpr_read_b32 v73, a89
    v_accvgpr_read_b32 v74, a90
    v_accvgpr_read_b32 v75, a91
    v_pk_fma_f32 v[68:69], v[100:101], v[80:81], v[68:69] op_sel_hi:[0,1,1] neg_lo:[1,0,0] neg_hi:[1,0,0]
    v_pk_fma_f32 v[70:71], v[100:101], v[82:83], v[70:71] op_sel_hi:[0,1,1] neg_lo:[1,0,0] neg_hi:[1,0,0]
    v_pk_fma_f32 v[72:73], v[100:101], v[116:117], v[72:73] op_sel_hi:[0,1,1] neg_lo:[1,0,0] neg_hi:[1,0,0]
    v_pk_fma_f32 v[74:75], v[100:101], v[118:119], v[74:75] op_sel_hi:[0,1,1] neg_lo:[1,0,0] neg_hi:[1,0,0]
    v_max_f32 v68, 0, v68
    v_max_f32 v69, 0, v69
    v_max_f32 v70, 0, v70
    v_max_f32 v71, 0, v71
    v_pk_mul_f32 v[72:73], v[72:73], v[64:65] op_sel_hi:[1,0]
    v_pk_mul_f32 v[74:75], v[74:75], v[64:65] op_sel_hi:[1,0]
    v_pk_mul_f32 v[68:69], v[68:69], v[72:73]
    v_pk_mul_f32 v[70:71], v[70:71], v[74:75]
    v_cvt_pk_bf16_f32 v106, v68, v69
    v_cvt_pk_bf16_f32 v107, v70, v71
    s_mov_b32 s52, 0
    buffer_store_dwordx4 v[104:107], v10, s[32:35], s52 offen offset:2048 sc1
    v_accvgpr_read_b32 v68, a12
    v_accvgpr_read_b32 v69, a13
    v_accvgpr_read_b32 v70, a14
    v_accvgpr_read_b32 v71, a15
    v_accvgpr_read_b32 v72, a76
    v_accvgpr_read_b32 v73, a77
    v_accvgpr_read_b32 v74, a78
    v_accvgpr_read_b32 v75, a79
    v_pk_fma_f32 v[68:69], v[102:103], v[76:77], v[68:69] op_sel_hi:[0,1,1] neg_lo:[1,0,0] neg_hi:[1,0,0]
    v_pk_fma_f32 v[70:71], v[102:103], v[78:79], v[70:71] op_sel_hi:[0,1,1] neg_lo:[1,0,0] neg_hi:[1,0,0]
    v_pk_fma_f32 v[72:73], v[102:103], v[112:113], v[72:73] op_sel_hi:[0,1,1] neg_lo:[1,0,0] neg_hi:[1,0,0]
    v_pk_fma_f32 v[74:75], v[102:103], v[114:115], v[74:75] op_sel_hi:[0,1,1] neg_lo:[1,0,0] neg_hi:[1,0,0]
    v_max_f32 v68, 0, v68
    v_max_f32 v69, 0, v69
    v_max_f32 v70, 0, v70
    v_max_f32 v71, 0, v71
    v_pk_mul_f32 v[72:73], v[72:73], v[66:67] op_sel_hi:[1,0]
    v_pk_mul_f32 v[74:75], v[74:75], v[66:67] op_sel_hi:[1,0]
    v_pk_mul_f32 v[68:69], v[68:69], v[72:73]
    v_pk_mul_f32 v[70:71], v[70:71], v[74:75]
    v_cvt_pk_bf16_f32 v108, v68, v69
    v_cvt_pk_bf16_f32 v109, v70, v71
    v_accvgpr_read_b32 v68, a28
    v_accvgpr_read_b32 v69, a29
    v_accvgpr_read_b32 v70, a30
    v_accvgpr_read_b32 v71, a31
    v_accvgpr_read_b32 v72, a92
    v_accvgpr_read_b32 v73, a93
    v_accvgpr_read_b32 v74, a94
    v_accvgpr_read_b32 v75, a95
    v_pk_fma_f32 v[68:69], v[102:103], v[80:81], v[68:69] op_sel_hi:[0,1,1] neg_lo:[1,0,0] neg_hi:[1,0,0]
    v_pk_fma_f32 v[70:71], v[102:103], v[82:83], v[70:71] op_sel_hi:[0,1,1] neg_lo:[1,0,0] neg_hi:[1,0,0]
    v_pk_fma_f32 v[72:73], v[102:103], v[116:117], v[72:73] op_sel_hi:[0,1,1] neg_lo:[1,0,0] neg_hi:[1,0,0]
    v_pk_fma_f32 v[74:75], v[102:103], v[118:119], v[74:75] op_sel_hi:[0,1,1] neg_lo:[1,0,0] neg_hi:[1,0,0]
    v_max_f32 v68, 0, v68
    v_max_f32 v69, 0, v69
    v_max_f32 v70, 0, v70
    v_max_f32 v71, 0, v71
    v_pk_mul_f32 v[72:73], v[72:73], v[66:67] op_sel_hi:[1,0]
    v_pk_mul_f32 v[74:75], v[74:75], v[66:67] op_sel_hi:[1,0]
    v_pk_mul_f32 v[68:69], v[68:69], v[72:73]
    v_pk_mul_f32 v[70:71], v[70:71], v[74:75]
    v_cvt_pk_bf16_f32 v110, v68, v69
    v_cvt_pk_bf16_f32 v111, v70, v71
    s_mov_b32 s52, 0
    buffer_store_dwordx4 v[108:111], v10, s[32:35], s52 offen offset:3072 sc1
    v_accvgpr_read_b32 v68, a32
    v_accvgpr_read_b32 v69, a33
    v_accvgpr_read_b32 v70, a34
    v_accvgpr_read_b32 v71, a35
    v_accvgpr_read_b32 v72, a96
    v_accvgpr_read_b32 v73, a97
    v_accvgpr_read_b32 v74, a98
    v_accvgpr_read_b32 v75, a99
    v_pk_fma_f32 v[68:69], v[96:97], v[84:85], v[68:69] op_sel_hi:[0,1,1] neg_lo:[1,0,0] neg_hi:[1,0,0]
    v_pk_fma_f32 v[70:71], v[96:97], v[86:87], v[70:71] op_sel_hi:[0,1,1] neg_lo:[1,0,0] neg_hi:[1,0,0]
    v_pk_fma_f32 v[72:73], v[96:97], v[120:121], v[72:73] op_sel_hi:[0,1,1] neg_lo:[1,0,0] neg_hi:[1,0,0]
    v_pk_fma_f32 v[74:75], v[96:97], v[122:123], v[74:75] op_sel_hi:[0,1,1] neg_lo:[1,0,0] neg_hi:[1,0,0]
    v_max_f32 v68, 0, v68
    v_max_f32 v69, 0, v69
    v_max_f32 v70, 0, v70
    v_max_f32 v71, 0, v71
    v_pk_mul_f32 v[72:73], v[72:73], v[60:61] op_sel_hi:[1,0]
    v_pk_mul_f32 v[74:75], v[74:75], v[60:61] op_sel_hi:[1,0]
    v_pk_mul_f32 v[68:69], v[68:69], v[72:73]
    v_pk_mul_f32 v[70:71], v[70:71], v[74:75]
    v_cvt_pk_bf16_f32 v104, v68, v69
    v_cvt_pk_bf16_f32 v105, v70, v71
    v_accvgpr_read_b32 v68, a48
    v_accvgpr_read_b32 v69, a49
    v_accvgpr_read_b32 v70, a50
    v_accvgpr_read_b32 v71, a51
    v_accvgpr_read_b32 v72, a112
    v_accvgpr_read_b32 v73, a113
    v_accvgpr_read_b32 v74, a114
    v_accvgpr_read_b32 v75, a115
    v_pk_fma_f32 v[68:69], v[96:97], v[88:89], v[68:69] op_sel_hi:[0,1,1] neg_lo:[1,0,0] neg_hi:[1,0,0]
    v_pk_fma_f32 v[70:71], v[96:97], v[90:91], v[70:71] op_sel_hi:[0,1,1] neg_lo:[1,0,0] neg_hi:[1,0,0]
    v_pk_fma_f32 v[72:73], v[96:97], v[124:125], v[72:73] op_sel_hi:[0,1,1] neg_lo:[1,0,0] neg_hi:[1,0,0]
    v_pk_fma_f32 v[74:75], v[96:97], v[126:127], v[74:75] op_sel_hi:[0,1,1] neg_lo:[1,0,0] neg_hi:[1,0,0]
    v_max_f32 v68, 0, v68
    v_max_f32 v69, 0, v69
    v_max_f32 v70, 0, v70
    v_max_f32 v71, 0, v71
    v_pk_mul_f32 v[72:73], v[72:73], v[60:61] op_sel_hi:[1,0]
    v_pk_mul_f32 v[74:75], v[74:75], v[60:61] op_sel_hi:[1,0]
    v_pk_mul_f32 v[68:69], v[68:69], v[72:73]
    v_pk_mul_f32 v[70:71], v[70:71], v[74:75]
    v_cvt_pk_bf16_f32 v106, v68, v69
    v_cvt_pk_bf16_f32 v107, v70, v71
    s_mov_b32 s52, 4096
    buffer_store_dwordx4 v[104:107], v10, s[32:35], s52 offen offset:0 sc1
    v_accvgpr_read_b32 v68, a36
    v_accvgpr_read_b32 v69, a37
    v_accvgpr_read_b32 v70, a38
    v_accvgpr_read_b32 v71, a39
    v_accvgpr_read_b32 v72, a100
    v_accvgpr_read_b32 v73, a101
    v_accvgpr_read_b32 v74, a102
    v_accvgpr_read_b32 v75, a103
    v_pk_fma_f32 v[68:69], v[98:99], v[84:85], v[68:69] op_sel_hi:[0,1,1] neg_lo:[1,0,0] neg_hi:[1,0,0]
    v_pk_fma_f32 v[70:71], v[98:99], v[86:87], v[70:71] op_sel_hi:[0,1,1] neg_lo:[1,0,0] neg_hi:[1,0,0]
    v_pk_fma_f32 v[72:73], v[98:99], v[120:121], v[72:73] op_sel_hi:[0,1,1] neg_lo:[1,0,0] neg_hi:[1,0,0]
    v_pk_fma_f32 v[74:75], v[98:99], v[122:123], v[74:75] op_sel_hi:[0,1,1] neg_lo:[1,0,0] neg_hi:[1,0,0]
    v_max_f32 v68, 0, v68
    v_max_f32 v69, 0, v69
    v_max_f32 v70, 0, v70
    v_max_f32 v71, 0, v71
    v_pk_mul_f32 v[72:73], v[72:73], v[62:63] op_sel_hi:[1,0]
    v_pk_mul_f32 v[74:75], v[74:75], v[62:63] op_sel_hi:[1,0]
    v_pk_mul_f32 v[68:69], v[68:69], v[72:73]
    v_pk_mul_f32 v[70:71], v[70:71], v[74:75]
    v_cvt_pk_bf16_f32 v108, v68, v69
    v_cvt_pk_bf16_f32 v109, v70, v71
    v_accvgpr_read_b32 v68, a52
    v_accvgpr_read_b32 v69, a53
    v_accvgpr_read_b32 v70, a54
    v_accvgpr_read_b32 v71, a55
    v_accvgpr_read_b32 v72, a116
    v_accvgpr_read_b32 v73, a117
    v_accvgpr_read_b32 v74, a118
    v_accvgpr_read_b32 v75, a119
    v_pk_fma_f32 v[68:69], v[98:99], v[88:89], v[68:69] op_sel_hi:[0,1,1] neg_lo:[1,0,0] neg_hi:[1,0,0]
    v_pk_fma_f32 v[70:71], v[98:99], v[90:91], v[70:71] op_sel_hi:[0,1,1] neg_lo:[1,0,0] neg_hi:[1,0,0]
    v_pk_fma_f32 v[72:73], v[98:99], v[124:125], v[72:73] op_sel_hi:[0,1,1] neg_lo:[1,0,0] neg_hi:[1,0,0]
    v_pk_fma_f32 v[74:75], v[98:99], v[126:127], v[74:75] op_sel_hi:[0,1,1] neg_lo:[1,0,0] neg_hi:[1,0,0]
    v_max_f32 v68, 0, v68
    v_max_f32 v69, 0, v69
    v_max_f32 v70, 0, v70
    v_max_f32 v71, 0, v71
    v_pk_mul_f32 v[72:73], v[72:73], v[62:63] op_sel_hi:[1,0]
    v_pk_mul_f32 v[74:75], v[74:75], v[62:63] op_sel_hi:[1,0]
    v_pk_mul_f32 v[68:69], v[68:69], v[72:73]
    v_pk_mul_f32 v[70:71], v[70:71], v[74:75]
    v_cvt_pk_bf16_f32 v110, v68, v69
    v_cvt_pk_bf16_f32 v111, v70, v71
    s_mov_b32 s52, 4096
    buffer_store_dwordx4 v[108:111], v10, s[32:35], s52 offen offset:1024 sc1
    v_accvgpr_read_b32 v68, a40
    v_accvgpr_read_b32 v69, a41
    v_accvgpr_read_b32 v70, a42
    v_accvgpr_read_b32 v71, a43
    v_accvgpr_read_b32 v72, a104
    v_accvgpr_read_b32 v73, a105
    v_accvgpr_read_b32 v74, a106
    v_accvgpr_read_b32 v75, a107
    v_pk_fma_f32 v[68:69], v[100:101], v[84:85], v[68:69] op_sel_hi:[0,1,1] neg_lo:[1,0,0] neg_hi:[1,0,0]
    v_pk_fma_f32 v[70:71], v[100:101], v[86:87], v[70:71] op_sel_hi:[0,1,1] neg_lo:[1,0,0] neg_hi:[1,0,0]
    v_pk_fma_f32 v[72:73], v[100:101], v[120:121], v[72:73] op_sel_hi:[0,1,1] neg_lo:[1,0,0] neg_hi:[1,0,0]
    v_pk_fma_f32 v[74:75], v[100:101], v[122:123], v[74:75] op_sel_hi:[0,1,1] neg_lo:[1,0,0] neg_hi:[1,0,0]
    v_max_f32 v68, 0, v68
    v_max_f32 v69, 0, v69
    v_max_f32 v70, 0, v70
    v_max_f32 v71, 0, v71
    v_pk_mul_f32 v[72:73], v[72:73], v[64:65] op_sel_hi:[1,0]
    v_pk_mul_f32 v[74:75], v[74:75], v[64:65] op_sel_hi:[1,0]
    v_pk_mul_f32 v[68:69], v[68:69], v[72:73]
    v_pk_mul_f32 v[70:71], v[70:71], v[74:75]
    v_cvt_pk_bf16_f32 v104, v68, v69
    v_cvt_pk_bf16_f32 v105, v70, v71
    v_accvgpr_read_b32 v68, a56
    v_accvgpr_read_b32 v69, a57
    v_accvgpr_read_b32 v70, a58
    v_accvgpr_read_b32 v71, a59
    v_accvgpr_read_b32 v72, a120
    v_accvgpr_read_b32 v73, a121
    v_accvgpr_read_b32 v74, a122
    v_accvgpr_read_b32 v75, a123
    v_pk_fma_f32 v[68:69], v[100:101], v[88:89], v[68:69] op_sel_hi:[0,1,1] neg_lo:[1,0,0] neg_hi:[1,0,0]
    v_pk_fma_f32 v[70:71], v[100:101], v[90:91], v[70:71] op_sel_hi:[0,1,1] neg_lo:[1,0,0] neg_hi:[1,0,0]
    v_pk_fma_f32 v[72:73], v[100:101], v[124:125], v[72:73] op_sel_hi:[0,1,1] neg_lo:[1,0,0] neg_hi:[1,0,0]
    v_pk_fma_f32 v[74:75], v[100:101], v[126:127], v[74:75] op_sel_hi:[0,1,1] neg_lo:[1,0,0] neg_hi:[1,0,0]
    v_max_f32 v68, 0, v68
    v_max_f32 v69, 0, v69
    v_max_f32 v70, 0, v70
    v_max_f32 v71, 0, v71
    v_pk_mul_f32 v[72:73], v[72:73], v[64:65] op_sel_hi:[1,0]
    v_pk_mul_f32 v[74:75], v[74:75], v[64:65] op_sel_hi:[1,0]
    v_pk_mul_f32 v[68:69], v[68:69], v[72:73]
    v_pk_mul_f32 v[70:71], v[70:71], v[74:75]
    v_cvt_pk_bf16_f32 v106, v68, v69
    v_cvt_pk_bf16_f32 v107, v70, v71
    s_mov_b32 s52, 4096
    buffer_store_dwordx4 v[104:107], v10, s[32:35], s52 offen offset:2048 sc1
    v_accvgpr_read_b32 v68, a44
    v_accvgpr_read_b32 v69, a45
    v_accvgpr_read_b32 v70, a46
    v_accvgpr_read_b32 v71, a47
    v_accvgpr_read_b32 v72, a108
    v_accvgpr_read_b32 v73, a109
    v_accvgpr_read_b32 v74, a110
    v_accvgpr_read_b32 v75, a111
    v_pk_fma_f32 v[68:69], v[102:103], v[84:85], v[68:69] op_sel_hi:[0,1,1] neg_lo:[1,0,0] neg_hi:[1,0,0]
    v_pk_fma_f32 v[70:71], v[102:103], v[86:87], v[70:71] op_sel_hi:[0,1,1] neg_lo:[1,0,0] neg_hi:[1,0,0]
    v_pk_fma_f32 v[72:73], v[102:103], v[120:121], v[72:73] op_sel_hi:[0,1,1] neg_lo:[1,0,0] neg_hi:[1,0,0]
    v_pk_fma_f32 v[74:75], v[102:103], v[122:123], v[74:75] op_sel_hi:[0,1,1] neg_lo:[1,0,0] neg_hi:[1,0,0]
    v_max_f32 v68, 0, v68
    v_max_f32 v69, 0, v69
    v_max_f32 v70, 0, v70
    v_max_f32 v71, 0, v71
    v_pk_mul_f32 v[72:73], v[72:73], v[66:67] op_sel_hi:[1,0]
    v_pk_mul_f32 v[74:75], v[74:75], v[66:67] op_sel_hi:[1,0]
    v_pk_mul_f32 v[68:69], v[68:69], v[72:73]
    v_pk_mul_f32 v[70:71], v[70:71], v[74:75]
    v_cvt_pk_bf16_f32 v108, v68, v69
    v_cvt_pk_bf16_f32 v109, v70, v71
    v_accvgpr_read_b32 v68, a60
    v_accvgpr_read_b32 v69, a61
    v_accvgpr_read_b32 v70, a62
    v_accvgpr_read_b32 v71, a63
    v_accvgpr_read_b32 v72, a124
    v_accvgpr_read_b32 v73, a125
    v_accvgpr_read_b32 v74, a126
    v_accvgpr_read_b32 v75, a127
    v_pk_fma_f32 v[68:69], v[102:103], v[88:89], v[68:69] op_sel_hi:[0,1,1] neg_lo:[1,0,0] neg_hi:[1,0,0]
    v_pk_fma_f32 v[70:71], v[102:103], v[90:91], v[70:71] op_sel_hi:[0,1,1] neg_lo:[1,0,0] neg_hi:[1,0,0]
    v_pk_fma_f32 v[72:73], v[102:103], v[124:125], v[72:73] op_sel_hi:[0,1,1] neg_lo:[1,0,0] neg_hi:[1,0,0]
    v_pk_fma_f32 v[74:75], v[102:103], v[126:127], v[74:75] op_sel_hi:[0,1,1] neg_lo:[1,0,0] neg_hi:[1,0,0]
    v_max_f32 v68, 0, v68
    v_max_f32 v69, 0, v69
    v_max_f32 v70, 0, v70
    v_max_f32 v71, 0, v71
    v_pk_mul_f32 v[72:73], v[72:73], v[66:67] op_sel_hi:[1,0]
    v_pk_mul_f32 v[74:75], v[74:75], v[66:67] op_sel_hi:[1,0]
    v_pk_mul_f32 v[68:69], v[68:69], v[72:73]
    v_pk_mul_f32 v[70:71], v[70:71], v[74:75]
    v_cvt_pk_bf16_f32 v110, v68, v69
    v_cvt_pk_bf16_f32 v111, v70, v71
    s_mov_b32 s52, 4096
    buffer_store_dwordx4 v[108:111], v10, s[32:35], s52 offen offset:3072 sc1
KF_noh:
    ds_read_b128 v[76:79], v3 offset:0
    ds_read_b128 v[80:83], v3 offset:64
    ds_read_b128 v[84:87], v3 offset:128
    ds_read_b128 v[88:91], v3 offset:192
    s_waitcnt lgkmcnt(0)
    v_pk_fma_f32 v[128:129], v[96:97], v[76:77], v[128:129] op_sel_hi:[0,1,1] neg_lo:[1,0,0] neg_hi:[1,0,0]
    v_pk_fma_f32 v[130:131], v[96:97], v[78:79], v[130:131] op_sel_hi:[0,1,1] neg_lo:[1,0,0] neg_hi:[1,0,0]
    v_pk_fma_f32 v[144:145], v[96:97], v[80:81], v[144:145] op_sel_hi:[0,1,1] neg_lo:[1,0,0] neg_hi:[1,0,0]
    v_pk_fma_f32 v[146:147], v[96:97], v[82:83], v[146:147] op_sel_hi:[0,1,1] neg_lo:[1,0,0] neg_hi:[1,0,0]
    v_pk_mul_f32 v[128:129], v[128:129], v[60:61] op_sel:[0,1] op_sel_hi:[1,1]
    v_pk_mul_f32 v[130:131], v[130:131], v[60:61] op_sel:[0,1] op_sel_hi:[1,1]
    v_pk_mul_f32 v[144:145], v[144:145], v[60:61] op_sel:[0,1] op_sel_hi:[1,1]
    v_pk_mul_f32 v[146:147], v[146:147], v[60:61] op_sel:[0,1] op_sel_hi:[1,1]
    v_cvt_pk_bf16_f32 v68, v128, v129
    v_cvt_pk_bf16_f32 v69, v130, v131
    v_cvt_pk_bf16_f32 v70, v144, v145
    v_cvt_pk_bf16_f32 v71, v146, v147
    v_accvgpr_write_b32 a128, v68
    v_accvgpr_write_b32 a129, v69
    v_accvgpr_write_b32 a130, v70
    v_accvgpr_write_b32 a131, v71
    v_pk_fma_f32 v[132:133], v[98:99], v[76:77], v[132:133] op_sel_hi:[0,1,1] neg_lo:[1,0,0] neg_hi:[1,0,0]
    v_pk_fma_f32 v[134:135], v[98:99], v[78:79], v[134:135] op_sel_hi:[0,1,1] neg_lo:[1,0,0] neg_hi:[1,0,0]
    v_pk_fma_f32 v[148:149], v[98:99], v[80:81], v[148:149] op_sel_hi:[0,1,1] neg_lo:[1,0,0] neg_hi:[1,0,0]
    v_pk_fma_f32 v[150:151], v[98:99], v[82:83], v[150:151] op_sel_hi:[0,1,1] neg_lo:[1,0,0] neg_hi:[1,0,0]
    v_pk_mul_f32 v[132:133], v[132:133], v[62:63] op_sel:[0,1] op_sel_hi:[1,1]
    v_pk_mul_f32 v[134:135], v[134:135], v[62:63] op_sel:[0,1] op_sel_hi:[1,1]
    v_pk_mul_f32 v[148:149], v[148:149], v[62:63] op_sel:[0,1] op_sel_hi:[1,1]
    v_pk_mul_f32 v[150:151], v[150:151], v[62:63] op_sel:[0,1] op_sel_hi:[1,1]
    v_cvt_pk_bf16_f32 v72, v132, v133
    v_cvt_pk_bf16_f32 v73, v134, v135
    v_cvt_pk_bf16_f32 v74, v148, v149
    v_cvt_pk_bf16_f32 v75, v150, v151
    v_accvgpr_write_b32 a144, v72
    v_accvgpr_write_b32 a145, v73
    v_accvgpr_write_b32 a146, v74
    v_accvgpr_write_b32 a147, v75
    v_pk_fma_f32 v[136:137], v[100:101], v[76:77], v[136:137] op_sel_hi:[0,1,1] neg_lo:[1,0,0] neg_hi:[1,0,0]
    v_pk_fma_f32 v[138:139], v[100:101], v[78:79], v[138:139] op_sel_hi:[0,1,1] neg_lo:[1,0,0] neg_hi:[1,0,0]
    v_pk_fma_f32 v[152:153], v[100:101], v[80:81], v[152:153] op_sel_hi:[0,1,1] neg_lo:[1,0,0] neg_hi:[1,0,0]
    v_pk_fma_f32 v[154:155], v[100:101], v[82:83], v[154:155] op_sel_hi:[0,1,1] neg_lo:[1,0,0] neg_hi:[1,0,0]
    v_pk_mul_f32 v[136:137], v[136:137], v[64:65] op_sel:[0,1] op_sel_hi:[1,1]
    v_pk_mul_f32 v[138:139], v[138:139], v[64:65] op_sel:[0,1] op_sel_hi:[1,1]
    v_pk_mul_f32 v[152:153], v[152:153], v[64:65] op_sel:[0,1] op_sel_hi:[1,1]
    v_pk_mul_f32 v[154:155], v[154:155], v[64:65] op_sel:[0,1] op_sel_hi:[1,1]
    v_cvt_pk_bf16_f32 v68, v136, v137
    v_cvt_pk_bf16_f32 v69, v138, v139
    v_cvt_pk_bf16_f32 v70, v152, v153
    v_cvt_pk_bf16_f32 v71, v154, v155
    v_accvgpr_write_b32 a160, v68
    v_accvgpr_write_b32 a161, v69
    v_accvgpr_write_b32 a162, v70
    v_accvgpr_write_b32 a163, v71
    v_pk_fma_f32 v[140:141], v[102:103], v[76:77], v[140:141] op_sel_hi:[0,1,1] neg_lo:[1,0,0] neg_hi:[1,0,0]
    v_pk_fma_f32 v[142:143], v[102:103], v[78:79], v[142:143] op_sel_hi:[0,1,1] neg_lo:[1,0,0] neg_hi:[1,0,0]
    v_pk_fma_f32 v[156:157], v[102:103], v[80:81], v[156:157] op_sel_hi:[0,1,1] neg_lo:[1,0,0] neg_hi:[1,0,0]
    v_pk_fma_f32 v[158:159], v[102:103], v[82:83], v[158:159] op_sel_hi:[0,1,1] neg_lo:[1,0,0] neg_hi:[1,0,0]
    v_pk_mul_f32 v[140:141], v[140:141], v[66:67] op_sel:[0,1] op_sel_hi:[1,1]
    v_pk_mul_f32 v[142:143], v[142:143], v[66:67] op_sel:[0,1] op_sel_hi:[1,1]
    v_pk_mul_f32 v[156:157], v[156:157], v[66:67] op_sel:[0,1] op_sel_hi:[1,1]
    v_pk_mul_f32 v[158:159], v[158:159], v[66:67] op_sel:[0,1] op_sel_hi:[1,1]
    v_cvt_pk_bf16_f32 v72, v140, v141
    v_cvt_pk_bf16_f32 v73, v142, v143
    v_cvt_pk_bf16_f32 v74, v156, v157
    v_cvt_pk_bf16_f32 v75, v158, v159
    v_accvgpr_write_b32 a176, v72
    v_accvgpr_write_b32 a177, v73
    v_accvgpr_write_b32 a178, v74
    v_accvgpr_write_b32 a179, v75
    v_pk_fma_f32 v[160:161], v[96:97], v[84:85], v[160:161] op_sel_hi:[0,1,1] neg_lo:[1,0,0] neg_hi:[1,0,0]
    v_pk_fma_f32 v[162:163], v[96:97], v[86:87], v[162:163] op_sel_hi:[0,1,1] neg_lo:[1,0,0] neg_hi:[1,0,0]
    v_pk_fma_f32 v[176:177], v[96:97], v[88:89], v[176:177] op_sel_hi:[0,1,1] neg_lo:[1,0,0] neg_hi:[1,0,0]
    v_pk_fma_f32 v[178:179], v[96:97], v[90:91], v[178:179] op_sel_hi:[0,1,1] neg_lo:[1,0,0] neg_hi:[1,0,0]
    v_pk_mul_f32 v[160:161], v[160:161], v[60:61] op_sel:[0,1] op_sel_hi:[1,1]
    v_pk_mul_f32 v[162:163], v[162:163], v[60:61] op_sel:[0,1] op_sel_hi:[1,1]
    v_pk_mul_f32 v[176:177], v[176:177], v[60:61] op_sel:[0,1] op_sel_hi:[1,1]
    v_pk_mul_f32 v[178:179], v[178:179], v[60:61] op_sel:[0,1] op_sel_hi:[1,1]
    v_cvt_pk_bf16_f32 v68, v160, v161
    v_cvt_pk_bf16_f32 v69, v162, v163
    v_cvt_pk_bf16_f32 v70, v176, v177
    v_cvt_pk_bf16_f32 v71, v178, v179
    v_accvgpr_write_b32 a132, v68
    v_accvgpr_write_b32 a133, v69
    v_accvgpr_write_b32 a134, v70
    v_accvgpr_write_b32 a135, v71
    v_pk_fma_f32 v[164:165], v[98:99], v[84:85], v[164:165] op_sel_hi:[0,1,1] neg_lo:[1,0,0] neg_hi:[1,0,0]
    v_pk_fma_f32 v[166:167], v[98:99], v[86:87], v[166:167] op_sel_hi:[0,1,1] neg_lo:[1,0,0] neg_hi:[1,0,0]
    v_pk_fma_f32 v[180:181], v[98:99], v[88:89], v[180:181] op_sel_hi:[0,1,1] neg_lo:[1,0,0] neg_hi:[1,0,0]
    v_pk_fma_f32 v[182:183], v[98:99], v[90:91], v[182:183] op_sel_hi:[0,1,1] neg_lo:[1,0,0] neg_hi:[1,0,0]
    v_pk_mul_f32 v[164:165], v[164:165], v[62:63] op_sel:[0,1] op_sel_hi:[1,1]
    v_pk_mul_f32 v[166:167], v[166:167], v[62:63] op_sel:[0,1] op_sel_hi:[1,1]
    v_pk_mul_f32 v[180:181], v[180:181], v[62:63] op_sel:[0,1] op_sel_hi:[1,1]
    v_pk_mul_f32 v[182:183], v[182:183], v[62:63] op_sel:[0,1] op_sel_hi:[1,1]
    v_cvt_pk_bf16_f32 v72, v164, v165
    v_cvt_pk_bf16_f32 v73, v166, v167
    v_cvt_pk_bf16_f32 v74, v180, v181
    v_cvt_pk_bf16_f32 v75, v182, v183
    v_accvgpr_write_b32 a148, v72
    v_accvgpr_write_b32 a149, v73
    v_accvgpr_write_b32 a150, v74
    v_accvgpr_write_b32 a151, v75
    v_pk_fma_f32 v[168:169], v[100:101], v[84:85], v[168:169] op_sel_hi:[0,1,1] neg_lo:[1,0,0] neg_hi:[1,0,0]
    v_pk_fma_f32 v[170:171], v[100:101], v[86:87], v[170:171] op_sel_hi:[0,1,1] neg_lo:[1,0,0] neg_hi:[1,0,0]
    v_pk_fma_f32 v[184:185], v[100:101], v[88:89], v[184:185] op_sel_hi:[0,1,1] neg_lo:[1,0,0] neg_hi:[1,0,0]
    v_pk_fma_f32 v[186:187], v[100:101], v[90:91], v[186:187] op_sel_hi:[0,1,1] neg_lo:[1,0,0] neg_hi:[1,0,0]
    v_pk_mul_f32 v[168:169], v[168:169], v[64:65] op_sel:[0,1] op_sel_hi:[1,1]
    v_pk_mul_f32 v[170:171], v[170:171], v[64:65] op_sel:[0,1] op_sel_hi:[1,1]
    v_pk_mul_f32 v[184:185], v[184:185], v[64:65] op_sel:[0,1] op_sel_hi:[1,1]
    v_pk_mul_f32 v[186:187], v[186:187], v[64:65] op_sel:[0,1] op_sel_hi:[1,1]
    v_cvt_pk_bf16_f32 v68, v168, v169
    v_cvt_pk_bf16_f32 v69, v170, v171
    v_cvt_pk_bf16_f32 v70, v184, v185
    v_cvt_pk_bf16_f32 v71, v186, v187
    v_accvgpr_write_b32 a164, v68
    v_accvgpr_write_b32 a165, v69
    v_accvgpr_write_b32 a166, v70
    v_accvgpr_write_b32 a167, v71
    v_pk_fma_f32 v[172:173], v[102:103], v[84:85], v[172:173] op_sel_hi:[0,1,1] neg_lo:[1,0,0] neg_hi:[1,0,0]
    v_pk_fma_f32 v[174:175], v[102:103], v[86:87], v[174:175] op_sel_hi:[0,1,1] neg_lo:[1,0,0] neg_hi:[1,0,0]
    v_pk_fma_f32 v[188:189], v[102:103], v[88:89], v[188:189] op_sel_hi:[0,1,1] neg_lo:[1,0,0] neg_hi:[1,0,0]
    v_pk_fma_f32 v[190:191], v[102:103], v[90:91], v[190:191] op_sel_hi:[0,1,1] neg_lo:[1,0,0] neg_hi:[1,0,0]
    v_pk_mul_f32 v[172:173], v[172:173], v[66:67] op_sel:[0,1] op_sel_hi:[1,1]
    v_pk_mul_f32 v[174:175], v[174:175], v[66:67] op_sel:[0,1] op_sel_hi:[1,1]
    v_pk_mul_f32 v[188:189], v[188:189], v[66:67] op_sel:[0,1] op_sel_hi:[1,1]
    v_pk_mul_f32 v[190:191], v[190:191], v[66:67] op_sel:[0,1] op_sel_hi:[1,1]
    v_cvt_pk_bf16_f32 v72, v172, v173
    v_cvt_pk_bf16_f32 v73, v174, v175
    v_cvt_pk_bf16_f32 v74, v188, v189
    v_cvt_pk_bf16_f32 v75, v190, v191
    v_accvgpr_write_b32 a180, v72
    v_accvgpr_write_b32 a181, v73
    v_accvgpr_write_b32 a182, v74
    v_accvgpr_write_b32 a183, v75
    ds_read_b128 v[76:79], v3 offset:256
    ds_read_b128 v[80:83], v3 offset:320
    ds_read_b128 v[84:87], v3 offset:384
    ds_read_b128 v[88:91], v3 offset:448
    s_waitcnt lgkmcnt(0)
    v_pk_fma_f32 v[192:193], v[96:97], v[76:77], v[192:193] op_sel_hi:[0,1,1] neg_lo:[1,0,0] neg_hi:[1,0,0]
    v_pk_fma_f32 v[194:195], v[96:97], v[78:79], v[194:195] op_sel_hi:[0,1,1] neg_lo:[1,0,0] neg_hi:[1,0,0]
    v_pk_fma_f32 v[208:209], v[96:97], v[80:81], v[208:209] op_sel_hi:[0,1,1] neg_lo:[1,0,0] neg_hi:[1,0,0]
    v_pk_fma_f32 v[210:211], v[96:97], v[82:83], v[210:211] op_sel_hi:[0,1,1] neg_lo:[1,0,0] neg_hi:[1,0,0]
    v_pk_mul_f32 v[192:193], v[192:193], v[60:61] op_sel:[0,1] op_sel_hi:[1,1]
    v_pk_mul_f32 v[194:195], v[194:195], v[60:61] op_sel:[0,1] op_sel_hi:[1,1]
    v_pk_mul_f32 v[208:209], v[208:209], v[60:61] op_sel:[0,1] op_sel_hi:[1,1]
    v_pk_mul_f32 v[210:211], v[210:211], v[60:61] op_sel:[0,1] op_sel_hi:[1,1]
    v_cvt_pk_bf16_f32 v68, v192, v193
    v_cvt_pk_bf16_f32 v69, v194, v195
    v_cvt_pk_bf16_f32 v70, v208, v209
    v_cvt_pk_bf16_f32 v71, v210, v211
    v_accvgpr_write_b32 a136, v68
    v_accvgpr_write_b32 a137, v69
    v_accvgpr_write_b32 a138, v70
    v_accvgpr_write_b32 a139, v71
    v_pk_fma_f32 v[196:197], v[98:99], v[76:77], v[196:197] op_sel_hi:[0,1,1] neg_lo:[1,0,0] neg_hi:[1,0,0]
    v_pk_fma_f32 v[198:199], v[98:99], v[78:79], v[198:199] op_sel_hi:[0,1,1] neg_lo:[1,0,0] neg_hi:[1,0,0]
    v_pk_fma_f32 v[212:213], v[98:99], v[80:81], v[212:213] op_sel_hi:[0,1,1] neg_lo:[1,0,0] neg_hi:[1,0,0]
    v_pk_fma_f32 v[214:215], v[98:99], v[82:83], v[214:215] op_sel_hi:[0,1,1] neg_lo:[1,0,0] neg_hi:[1,0,0]
    v_pk_mul_f32 v[196:197], v[196:197], v[62:63] op_sel:[0,1] op_sel_hi:[1,1]
    v_pk_mul_f32 v[198:199], v[198:199], v[62:63] op_sel:[0,1] op_sel_hi:[1,1]
    v_pk_mul_f32 v[212:213], v[212:213], v[62:63] op_sel:[0,1] op_sel_hi:[1,1]
    v_pk_mul_f32 v[214:215], v[214:215], v[62:63] op_sel:[0,1] op_sel_hi:[1,1]
    v_cvt_pk_bf16_f32 v72, v196, v197
    v_cvt_pk_bf16_f32 v73, v198, v199
    v_cvt_pk_bf16_f32 v74, v212, v213
    v_cvt_pk_bf16_f32 v75, v214, v215
    v_accvgpr_write_b32 a152, v72
    v_accvgpr_write_b32 a153, v73
    v_accvgpr_write_b32 a154, v74
    v_accvgpr_write_b32 a155, v75
    v_pk_fma_f32 v[200:201], v[100:101], v[76:77], v[200:201] op_sel_hi:[0,1,1] neg_lo:[1,0,0] neg_hi:[1,0,0]
    v_pk_fma_f32 v[202:203], v[100:101], v[78:79], v[202:203] op_sel_hi:[0,1,1] neg_lo:[1,0,0] neg_hi:[1,0,0]
    v_pk_fma_f32 v[216:217], v[100:101], v[80:81], v[216:217] op_sel_hi:[0,1,1] neg_lo:[1,0,0] neg_hi:[1,0,0]
    v_pk_fma_f32 v[218:219], v[100:101], v[82:83], v[218:219] op_sel_hi:[0,1,1] neg_lo:[1,0,0] neg_hi:[1,0,0]
    v_pk_mul_f32 v[200:201], v[200:201], v[64:65] op_sel:[0,1] op_sel_hi:[1,1]
    v_pk_mul_f32 v[202:203], v[202:203], v[64:65] op_sel:[0,1] op_sel_hi:[1,1]
    v_pk_mul_f32 v[216:217], v[216:217], v[64:65] op_sel:[0,1] op_sel_hi:[1,1]
    v_pk_mul_f32 v[218:219], v[218:219], v[64:65] op_sel:[0,1] op_sel_hi:[1,1]
    v_cvt_pk_bf16_f32 v68, v200, v201
    v_cvt_pk_bf16_f32 v69, v202, v203
    v_cvt_pk_bf16_f32 v70, v216, v217
    v_cvt_pk_bf16_f32 v71, v218, v219
    v_accvgpr_write_b32 a168, v68
    v_accvgpr_write_b32 a169, v69
    v_accvgpr_write_b32 a170, v70
    v_accvgpr_write_b32 a171, v71
    v_pk_fma_f32 v[204:205], v[102:103], v[76:77], v[204:205] op_sel_hi:[0,1,1] neg_lo:[1,0,0] neg_hi:[1,0,0]
    v_pk_fma_f32 v[206:207], v[102:103], v[78:79], v[206:207] op_sel_hi:[0,1,1] neg_lo:[1,0,0] neg_hi:[1,0,0]
    v_pk_fma_f32 v[220:221], v[102:103], v[80:81], v[220:221] op_sel_hi:[0,1,1] neg_lo:[1,0,0] neg_hi:[1,0,0]
    v_pk_fma_f32 v[222:223], v[102:103], v[82:83], v[222:223] op_sel_hi:[0,1,1] neg_lo:[1,0,0] neg_hi:[1,0,0]
    v_pk_mul_f32 v[204:205], v[204:205], v[66:67] op_sel:[0,1] op_sel_hi:[1,1]
    v_pk_mul_f32 v[206:207], v[206:207], v[66:67] op_sel:[0,1] op_sel_hi:[1,1]
    v_pk_mul_f32 v[220:221], v[220:221], v[66:67] op_sel:[0,1] op_sel_hi:[1,1]
    v_pk_mul_f32 v[222:223], v[222:223], v[66:67] op_sel:[0,1] op_sel_hi:[1,1]
    v_cvt_pk_bf16_f32 v72, v204, v205
    v_cvt_pk_bf16_f32 v73, v206, v207
    v_cvt_pk_bf16_f32 v74, v220, v221
    v_cvt_pk_bf16_f32 v75, v222, v223
    v_accvgpr_write_b32 a184, v72
    v_accvgpr_write_b32 a185, v73
    v_accvgpr_write_b32 a186, v74
    v_accvgpr_write_b32 a187, v75
    v_pk_fma_f32 v[224:225], v[96:97], v[84:85], v[224:225] op_sel_hi:[0,1,1] neg_lo:[1,0,0] neg_hi:[1,0,0]
    v_pk_fma_f32 v[226:227], v[96:97], v[86:87], v[226:227] op_sel_hi:[0,1,1] neg_lo:[1,0,0] neg_hi:[1,0,0]
    v_pk_fma_f32 v[240:241], v[96:97], v[88:89], v[240:241] op_sel_hi:[0,1,1] neg_lo:[1,0,0] neg_hi:[1,0,0]
    v_pk_fma_f32 v[242:243], v[96:97], v[90:91], v[242:243] op_sel_hi:[0,1,1] neg_lo:[1,0,0] neg_hi:[1,0,0]
    v_pk_mul_f32 v[224:225], v[224:225], v[60:61] op_sel:[0,1] op_sel_hi:[1,1]
    v_pk_mul_f32 v[226:227], v[226:227], v[60:61] op_sel:[0,1] op_sel_hi:[1,1]
    v_pk_mul_f32 v[240:241], v[240:241], v[60:61] op_sel:[0,1] op_sel_hi:[1,1]
    v_pk_mul_f32 v[242:243], v[242:243], v[60:61] op_sel:[0,1] op_sel_hi:[1,1]
    v_cvt_pk_bf16_f32 v68, v224, v225
    v_cvt_pk_bf16_f32 v69, v226, v227
    v_cvt_pk_bf16_f32 v70, v240, v241
    v_cvt_pk_bf16_f32 v71, v242, v243
    v_accvgpr_write_b32 a140, v68
    v_accvgpr_write_b32 a141, v69
    v_accvgpr_write_b32 a142, v70
    v_accvgpr_write_b32 a143, v71
    v_pk_fma_f32 v[228:229], v[98:99], v[84:85], v[228:229] op_sel_hi:[0,1,1] neg_lo:[1,0,0] neg_hi:[1,0,0]
    v_pk_fma_f32 v[230:231], v[98:99], v[86:87], v[230:231] op_sel_hi:[0,1,1] neg_lo:[1,0,0] neg_hi:[1,0,0]
    v_pk_fma_f32 v[244:245], v[98:99], v[88:89], v[244:245] op_sel_hi:[0,1,1] neg_lo:[1,0,0] neg_hi:[1,0,0]
    v_pk_fma_f32 v[246:247], v[98:99], v[90:91], v[246:247] op_sel_hi:[0,1,1] neg_lo:[1,0,0] neg_hi:[1,0,0]
    v_pk_mul_f32 v[228:229], v[228:229], v[62:63] op_sel:[0,1] op_sel_hi:[1,1]
    v_pk_mul_f32 v[230:231], v[230:231], v[62:63] op_sel:[0,1] op_sel_hi:[1,1]
    v_pk_mul_f32 v[244:245], v[244:245], v[62:63] op_sel:[0,1] op_sel_hi:[1,1]
    v_pk_mul_f32 v[246:247], v[246:247], v[62:63] op_sel:[0,1] op_sel_hi:[1,1]
    v_cvt_pk_bf16_f32 v72, v228, v229
    v_cvt_pk_bf16_f32 v73, v230, v231
    v_cvt_pk_bf16_f32 v74, v244, v245
    v_cvt_pk_bf16_f32 v75, v246, v247
    v_accvgpr_write_b32 a156, v72
    v_accvgpr_write_b32 a157, v73
    v_accvgpr_write_b32 a158, v74
    v_accvgpr_write_b32 a159, v75
    v_pk_fma_f32 v[232:233], v[100:101], v[84:85], v[232:233] op_sel_hi:[0,1,1] neg_lo:[1,0,0] neg_hi:[1,0,0]
    v_pk_fma_f32 v[234:235], v[100:101], v[86:87], v[234:235] op_sel_hi:[0,1,1] neg_lo:[1,0,0] neg_hi:[1,0,0]
    v_pk_fma_f32 v[248:249], v[100:101], v[88:89], v[248:249] op_sel_hi:[0,1,1] neg_lo:[1,0,0] neg_hi:[1,0,0]
    v_pk_fma_f32 v[250:251], v[100:101], v[90:91], v[250:251] op_sel_hi:[0,1,1] neg_lo:[1,0,0] neg_hi:[1,0,0]
    v_pk_mul_f32 v[232:233], v[232:233], v[64:65] op_sel:[0,1] op_sel_hi:[1,1]
    v_pk_mul_f32 v[234:235], v[234:235], v[64:65] op_sel:[0,1] op_sel_hi:[1,1]
    v_pk_mul_f32 v[248:249], v[248:249], v[64:65] op_sel:[0,1] op_sel_hi:[1,1]
    v_pk_mul_f32 v[250:251], v[250:251], v[64:65] op_sel:[0,1] op_sel_hi:[1,1]
    v_cvt_pk_bf16_f32 v68, v232, v233
    v_cvt_pk_bf16_f32 v69, v234, v235
    v_cvt_pk_bf16_f32 v70, v248, v249
    v_cvt_pk_bf16_f32 v71, v250, v251
    v_accvgpr_write_b32 a172, v68
    v_accvgpr_write_b32 a173, v69
    v_accvgpr_write_b32 a174, v70
    v_accvgpr_write_b32 a175, v71
    v_pk_fma_f32 v[236:237], v[102:103], v[84:85], v[236:237] op_sel_hi:[0,1,1] neg_lo:[1,0,0] neg_hi:[1,0,0]
    v_pk_fma_f32 v[238:239], v[102:103], v[86:87], v[238:239] op_sel_hi:[0,1,1] neg_lo:[1,0,0] neg_hi:[1,0,0]
    v_pk_fma_f32 v[252:253], v[102:103], v[88:89], v[252:253] op_sel_hi:[0,1,1] neg_lo:[1,0,0] neg_hi:[1,0,0]
    v_pk_fma_f32 v[254:255], v[102:103], v[90:91], v[254:255] op_sel_hi:[0,1,1] neg_lo:[1,0,0] neg_hi:[1,0,0]
    v_pk_mul_f32 v[236:237], v[236:237], v[66:67] op_sel:[0,1] op_sel_hi:[1,1]
    v_pk_mul_f32 v[238:239], v[238:239], v[66:67] op_sel:[0,1] op_sel_hi:[1,1]
    v_pk_mul_f32 v[252:253], v[252:253], v[66:67] op_sel:[0,1] op_sel_hi:[1,1]
    v_pk_mul_f32 v[254:255], v[254:255], v[66:67] op_sel:[0,1] op_sel_hi:[1,1]
    v_cvt_pk_bf16_f32 v72, v236, v237
    v_cvt_pk_bf16_f32 v73, v238, v239
    v_cvt_pk_bf16_f32 v74, v252, v253
    v_cvt_pk_bf16_f32 v75, v254, v255
    v_accvgpr_write_b32 a188, v72
    v_accvgpr_write_b32 a189, v73
    v_accvgpr_write_b32 a190, v74
    v_accvgpr_write_b32 a191, v75
    s_and_b32 s88, s2, 3
    s_bfe_u32 s71, s2, 0x10002
    s_lshl_b32 s71, s71, 3
    s_lshr_b32 s52, s2, 5
    s_add_u32 s71, s71, s52
    s_bfe_u32 s89, s2, 0x20003
    s_lshl_b32 s89, s89, 8
    s_lshl_b32 s53, s71, 1
    s_lshr_b32 s52, s3, 1
    s_add_u32 s53, s53, s52
    s_lshl_b32 s52, s53, 19
    s_add_u32 s52, s52, 0x1000000
    s_add_u32 s8, s4, s52
    s_addc_u32 s9, s5, 0
    s_and_b32 s9, s9, 0xffff
    s_mov_b32 s10, 0x80000
    s_mov_b32 s11, 0x20000
    s_mul_i32 s52, s53, 229376
    s_add_u32 s52, s52, 0x400000
    s_add_u32 s12, s4, s52
    s_addc_u32 s13, s5, 0
    s_and_b32 s13, s13, 0xffff
    s_mov_b32 s14, 0x38000
    s_mov_b32 s15, 0x20000
    s_sub_u32 s52, 0x400000, s89
    s_add_u32 s16, s60, s89
    s_addc_u32 s17, s61, 0
    s_and_b32 s17, s17, 0xffff
    s_mov_b32 s18, s52
    s_mov_b32 s19, 0x20000
    s_sub_u32 s52, 0x1c0000, s89
    s_add_u32 s20, s64, s89
    s_addc_u32 s21, s65, 0
    s_and_b32 s21, s21, 0xffff
    s_mov_b32 s22, s52
    s_mov_b32 s23, 0x20000
    s_lshl_b32 s52, s71, 2
    s_lshr_b32 s53, s89, 8
    s_add_u32 s52, s52, s53
    s_lshl_b32 s52, s52, 18
    s_add_u32 s52, s52, 0x2000000
    s_add_u32 s64, s4, s52
    s_addc_u32 s65, s5, 0
    s_and_b32 s65, s65, 0xffff
    s_mov_b32 s66, 0x40000
    s_mov_b32 s67, 0x20000
    s_lshl_b32 s93, s3, 11
    v_lshrrev_b32 v2, 4, v1
    v_and_b32 v3, 15, v1
    s_lshl_b32 s52, s3, 3
    v_add_u32 v60, s52, v2
    v_lshlrev_b32 v60, 10, v60
    v_lshlrev_b32 v61, 1, v2
    v_xor_b32 v62, v3, v61
    v_lshl_add_u32 v11, v62, 4, v60
    v_xor_b32 v62, 8, v62
    v_lshl_add_u32 v12, v62, 4, v60
    v_add_u32 v12, 3072, v12
    s_and_b32 s52, s3, 1
    s_cmp_eq_u32 s52, 0
    s_cbranch_scc0 KF_tr1
    v_mov_b32 v17, v38
    v_mov_b32 v18, v39
    v_mov_b32 v19, v40
    v_mov_b32 v20, v41
    s_branch KF_tr2
KF_tr1:
    v_mov_b32 v17, v42
    v_mov_b32 v18, v43
    v_mov_b32 v19, v44
    v_mov_b32 v20, v45
KF_tr2:
    v_subrev_u32 v13, 0x10000, v17
    v_subrev_u32 v14, 0x10000, v18
    v_subrev_u32 v15, 0x10000, v19
    v_subrev_u32 v16, 0x10000, v20
    v_add_u32 v17, 0x4000, v17
    v_add_u32 v18, 0x4000, v18
    v_add_u32 v19, 0x4000, v19
    v_add_u32 v20, 0x4000, v20
    s_lshr_b32 s52, s3, 1
    s_lshl_b32 s52, s52, 12
    s_add_u32 s52, s52, 8192
    v_add_u32 v21, s52, v10
    v_add_u32 v22, 0x14000, v21
    v_mov_b32 v2, 148480
    v_mov_b32 v3, 0
    ds_write_b32 v2, v3
    v_add_u32 v60, 131072, v34
    v_add_u32 v61, 131072, v35
    v_add_u32 v62, 131072, v36
    v_add_u32 v63, 131072, v37
    ds_read_b128 a[192:195], v60 offset:0
    ds_read_b128 a[196:199], v61 offset:0
    ds_read_b128 a[200:203], v62 offset:0
    ds_read_b128 a[204:207], v63 offset:0
    ds_read_b128 a[208:211], v60 offset:4096
    ds_read_b128 a[212:215], v61 offset:4096
    ds_read_b128 a[216:219], v62 offset:4096
    ds_read_b128 a[220:223], v63 offset:4096
    v_mov_b32 v48, 0
    v_mov_b32 v49, 0
    v_mov_b32 v50, 0
    v_mov_b32 v51, 0
    v_mov_b32 v236, 0x3f803f80
    v_mov_b32 v237, 0x3f803f80
    v_mov_b32 v238, 0x3f803f80
    v_mov_b32 v239, 0x3f803f80
    s_waitcnt lgkmcnt(0)
    v_mfma_f32_16x16x32_bf16 v[76:79], a[192:195], a[128:131], 0
    v_mfma_f32_16x16x32_bf16 v[80:83], a[192:195], a[144:147], 0
    v_mfma_f32_16x16x32_bf16 v[84:87], a[192:195], a[160:163], 0
    v_mfma_f32_16x16x32_bf16 v[88:91], a[192:195], a[176:179], 0
    v_mfma_f32_16x16x32_bf16 v[76:79], a[196:199], a[132:135], v[76:79]
    v_mfma_f32_16x16x32_bf16 v[80:83], a[196:199], a[148:151], v[80:83]
    v_mfma_f32_16x16x32_bf16 v[84:87], a[196:199], a[164:167], v[84:87]
    v_mfma_f32_16x16x32_bf16 v[88:91], a[196:199], a[180:183], v[88:91]
    v_mfma_f32_16x16x32_bf16 v[76:79], a[200:203], a[136:139], v[76:79]
    v_mfma_f32_16x16x32_bf16 v[80:83], a[200:203], a[152:155], v[80:83]
    v_mfma_f32_16x16x32_bf16 v[84:87], a[200:203], a[168:171], v[84:87]
    v_mfma_f32_16x16x32_bf16 v[88:91], a[200:203], a[184:187], v[88:91]
    v_mfma_f32_16x16x32_bf16 v[76:79], a[204:207], a[140:143], v[76:79]
    v_mfma_f32_16x16x32_bf16 v[80:83], a[204:207], a[156:159], v[80:83]
    v_mfma_f32_16x16x32_bf16 v[84:87], a[204:207], a[172:175], v[84:87]
    v_mfma_f32_16x16x32_bf16 v[88:91], a[204:207], a[188:191], v[88:91]
    v_mfma_f32_16x16x32_bf16 v[92:95], a[208:211], a[128:131], 0
    v_mfma_f32_16x16x32_bf16 v[96:99], a[208:211], a[144:147], 0
    v_mfma_f32_16x16x32_bf16 v[100:103], a[208:211], a[160:163], 0
    v_mfma_f32_16x16x32_bf16 v[104:107], a[208:211], a[176:179], 0
    v_mfma_f32_16x16x32_bf16 v[92:95], a[212:215], a[132:135], v[92:95]
    v_mfma_f32_16x16x32_bf16 v[96:99], a[212:215], a[148:151], v[96:99]
    v_mfma_f32_16x16x32_bf16 v[100:103], a[212:215], a[164:167], v[100:103]
    v_mfma_f32_16x16x32_bf16 v[104:107], a[212:215], a[180:183], v[104:107]
    v_mfma_f32_16x16x32_bf16 v[92:95], a[216:219], a[136:139], v[92:95]
    v_mfma_f32_16x16x32_bf16 v[96:99], a[216:219], a[152:155], v[96:99]
    v_mfma_f32_16x16x32_bf16 v[100:103], a[216:219], a[168:171], v[100:103]
    v_mfma_f32_16x16x32_bf16 v[104:107], a[216:219], a[184:187], v[104:107]
    v_mfma_f32_16x16x32_bf16 v[92:95], a[220:223], a[140:143], v[92:95]
    v_mfma_f32_16x16x32_bf16 v[96:99], a[220:223], a[156:159], v[96:99]
    v_mfma_f32_16x16x32_bf16 v[100:103], a[220:223], a[172:175], v[100:103]
    v_mfma_f32_16x16x32_bf16 v[104:107], a[220:223], a[188:191], v[104:107]
    ds_read_b128 a[192:195], v60 offset:8192
    ds_read_b128 a[196:199], v61 offset:8192
    ds_read_b128 a[200:203], v62 offset:8192
    ds_read_b128 a[204:207], v63 offset:8192
    ds_read_b128 a[208:211], v60 offset:12288
    ds_read_b128 a[212:215], v61 offset:12288
    ds_read_b128 a[216:219], v62 offset:12288
    ds_read_b128 a[220:223], v63 offset:12288
    s_nop 7
    v_max3_f32 v68, v76, v77, v78
    v_max3_f32 v68, v68, v79, v92
    v_max3_f32 v68, v68, v93, v94
    v_max_f32 v68, v68, v95
    v_max3_f32 v69, v80, v81, v82
    v_max3_f32 v69, v69, v83, v96
    v_max3_f32 v69, v69, v97, v98
    v_max_f32 v69, v69, v99
    v_max3_f32 v70, v84, v85, v86
    v_max3_f32 v70, v70, v87, v100
    v_max3_f32 v70, v70, v101, v102
    v_max_f32 v70, v70, v103
    v_max3_f32 v71, v88, v89, v90
    v_max3_f32 v71, v71, v91, v104
    v_max3_f32 v71, v71, v105, v106
    v_max_f32 v71, v71, v107
    v_mov_b32 v72, v68
    v_mov_b32 v73, v69
    v_mov_b32 v74, v70
    v_mov_b32 v75, v71
    s_nop 1
    v_permlane16_swap_b32 v68, v72
    v_permlane16_swap_b32 v69, v73
    v_permlane16_swap_b32 v70, v74
    v_permlane16_swap_b32 v71, v75
    s_nop 1
    v_max_f32 v68, v68, v72
    v_max_f32 v69, v69, v73
    v_max_f32 v70, v70, v74
    v_max_f32 v71, v71, v75
    v_mov_b32 v72, v68
    v_mov_b32 v73, v69
    v_mov_b32 v74, v70
    v_mov_b32 v75, v71
    s_nop 1
    v_permlane32_swap_b32 v68, v72
    v_permlane32_swap_b32 v69, v73
    v_permlane32_swap_b32 v70, v74
    v_permlane32_swap_b32 v71, v75
    s_nop 1
    v_max_f32 v68, v68, v72
    v_max_f32 v69, v69, v73
    v_max_f32 v70, v70, v74
    v_max_f32 v71, v71, v75
    v_sub_f32 v140, 0, v68
    v_sub_f32 v141, 0, v68
    v_sub_f32 v142, 0, v68
    v_sub_f32 v143, 0, v68
    v_sub_f32 v144, 0, v69
    v_sub_f32 v145, 0, v69
    v_sub_f32 v146, 0, v69
    v_sub_f32 v147, 0, v69
    v_sub_f32 v148, 0, v70
    v_sub_f32 v149, 0, v70
    v_sub_f32 v150, 0, v70
    v_sub_f32 v151, 0, v70
    v_sub_f32 v152, 0, v71
    v_sub_f32 v153, 0, v71
    v_sub_f32 v154, 0, v71
    v_sub_f32 v155, 0, v71
    v_sub_f32 v76, v76, v68
    v_sub_f32 v77, v77, v68
    v_sub_f32 v78, v78, v68
    v_sub_f32 v79, v79, v68
    v_sub_f32 v80, v80, v69
    v_sub_f32 v81, v81, v69
    v_sub_f32 v82, v82, v69
    v_sub_f32 v83, v83, v69
    v_sub_f32 v84, v84, v70
    v_sub_f32 v85, v85, v70
    v_sub_f32 v86, v86, v70
    v_sub_f32 v87, v87, v70
    v_sub_f32 v88, v88, v71
    v_sub_f32 v89, v89, v71
    v_sub_f32 v90, v90, v71
    v_sub_f32 v91, v91, v71
    v_sub_f32 v92, v92, v68
    v_sub_f32 v93, v93, v68
    v_sub_f32 v94, v94, v68
    v_sub_f32 v95, v95, v68
    v_sub_f32 v96, v96, v69
    v_sub_f32 v97, v97, v69
    v_sub_f32 v98, v98, v69
    v_sub_f32 v99, v99, v69
    v_sub_f32 v100, v100, v70
    v_sub_f32 v101, v101, v70
    v_sub_f32 v102, v102, v70
    v_sub_f32 v103, v103, v70
    v_sub_f32 v104, v104, v71
    v_sub_f32 v105, v105, v71
    v_sub_f32 v106, v106, v71
    v_sub_f32 v107, v107, v71
    s_add_u32 s45, s3, 6
    s_lshl_b32 s45, s45, 13
    s_add_u32 s46, s45, 4096
    s_add_u32 s47, s3, 2
    s_lshl_b32 s47, s47, 13
    s_add_u32 s48, s47, 4096
    s_lshl_b32 s49, s3, 13
    s_add_u32 s49, s49, 0x8000
    s_add_u32 s50, s49, 0x10000
    s_mov_b32 s51, 0
    s_waitcnt vmcnt(0)
    s_barrier
    s_cmp_ge_u32 s40, 28
    s_cbranch_scc1 KF_sigh
    s_lshl_b32 s52, s41, 2
    s_add_u32 s52, s52, 32
    v_mov_b32 v74, s52
    s_cmp_eq_u32 s3, 0
    s_cbranch_scc0 KF_sigh
    s_mov_b64 s[96:97], exec
    s_mov_b64 exec, 1
    v_mov_b32 v3, 1
    buffer_atomic_add v3, v74, s[72:75], 0 offen sc1
    s_mov_b64 exec, s[96:97]
KF_sigh:
    s_lshl_b32 s52, s2, 14
    s_lshl_b32 s53, s3, 12
    s_add_u32 s52, s52, s53
    buffer_load_dwordx4 v[240:243], v10, s[16:19], s52 offen offset:0
    buffer_load_dwordx4 v[240:243], v10, s[16:19], s52 offen offset:1024
    buffer_load_dwordx4 v[240:243], v10, s[16:19], s52 offen offset:2048
    buffer_load_dwordx4 v[240:243], v10, s[16:19], s52 offen offset:3072
    s_mul_i32 s52, s2, 7168
    s_lshl_b32 s53, s3, 11
    s_add_u32 s52, s52, s53
    buffer_load_dwordx4 v[240:243], v10, s[20:23], s52 offen offset:0
    buffer_load_dwordx4 v[240:243], v10, s[20:23], s52 offen offset:1024
    s_waitcnt lgkmcnt(0)
    v_mfma_f32_16x16x32_bf16 v[108:111], a[192:195], a[128:131], v[140:143]
    v_exp_f32 v52, v76
    v_exp_f32 v53, v77
    v_exp_f32 v54, v78
    v_mfma_f32_16x16x32_bf16 v[108:111], a[196:199], a[132:135], v[108:111]
    v_add_f32 v48, v48, v52
    v_exp_f32 v55, v79
    v_add_f32 v48, v48, v53
    v_mfma_f32_16x16x32_bf16 v[108:111], a[200:203], a[136:139], v[108:111]
    v_cvt_pk_bf16_f32 v156, v52, v53
    v_exp_f32 v56, v92
    v_add_f32 v48, v48, v54
    v_mfma_f32_16x16x32_bf16 v[108:111], a[204:207], a[140:143], v[108:111]
    v_exp_f32 v57, v93
    v_add_f32 v48, v48, v55
    v_cvt_pk_bf16_f32 v157, v54, v55
    v_mfma_f32_16x16x32_bf16 v[112:115], a[192:195], a[144:147], v[144:147]
    s_mov_b32 m0, s49
    s_nop 0
    buffer_load_dwordx4 v46, s[24:27], s45 offen offset:0 lds
    v_exp_f32 v58, v94
    v_add_f32 v48, v48, v56
    v_exp_f32 v59, v95
    v_mfma_f32_16x16x32_bf16 v[112:115], a[196:199], a[148:151], v[112:115]
    v_add_f32 v48, v48, v57
    v_cvt_pk_bf16_f32 v158, v56, v57
    v_exp_f32 v52, v80
    v_mfma_f32_16x16x32_bf16 v[112:115], a[200:203], a[152:155], v[112:115]
    v_add_f32 v48, v48, v58
    v_exp_f32 v53, v81
    v_add_f32 v48, v48, v59
    v_mfma_f32_16x16x32_bf16 v[112:115], a[204:207], a[156:159], v[112:115]
    v_cvt_pk_bf16_f32 v159, v58, v59
    v_exp_f32 v54, v82
    v_add_f32 v49, v49, v52
    v_mfma_f32_16x16x32_bf16 v[116:119], a[192:195], a[160:163], v[148:151]
    v_exp_f32 v55, v83
    v_add_f32 v49, v49, v53
    v_cvt_pk_bf16_f32 v160, v52, v53
    v_mfma_f32_16x16x32_bf16 v[116:119], a[196:199], a[164:167], v[116:119]
    buffer_load_dwordx4 v47, s[24:27], s45 offen offset:1024 lds
    v_exp_f32 v56, v96
    v_add_f32 v49, v49, v54
    v_exp_f32 v57, v97
    v_mfma_f32_16x16x32_bf16 v[116:119], a[200:203], a[168:171], v[116:119]
    v_add_f32 v49, v49, v55
    v_cvt_pk_bf16_f32 v161, v54, v55
    v_exp_f32 v58, v98
    v_mfma_f32_16x16x32_bf16 v[116:119], a[204:207], a[172:175], v[116:119]
    v_add_f32 v49, v49, v56
    v_exp_f32 v59, v99
    v_add_f32 v49, v49, v57
    v_mfma_f32_16x16x32_bf16 v[120:123], a[192:195], a[176:179], v[152:155]
    v_cvt_pk_bf16_f32 v162, v56, v57
    v_exp_f32 v52, v84
    v_add_f32 v49, v49, v58
    v_mfma_f32_16x16x32_bf16 v[120:123], a[196:199], a[180:183], v[120:123]
    ds_read_b128 a[192:195], v34 offset:0
    v_exp_f32 v53, v85
    v_add_f32 v49, v49, v59
    v_cvt_pk_bf16_f32 v163, v58, v59
    v_mfma_f32_16x16x32_bf16 v[120:123], a[200:203], a[184:187], v[120:123]
    ds_read_b128 a[196:199], v35 offset:0
    buffer_load_dwordx4 v46, s[24:27], s45 offen offset:2048 lds
    v_exp_f32 v54, v86
    v_exp_f32 v55, v87
    v_cvt_pk_bf16_f32 v164, v52, v53
    v_mfma_f32_16x16x32_bf16 v[120:123], a[204:207], a[188:191], v[120:123]
    ds_read_b128 a[200:203], v36 offset:0
    v_exp_f32 v56, v100
    v_exp_f32 v57, v101
    v_cvt_pk_bf16_f32 v165, v54, v55
    v_mfma_f32_16x16x32_bf16 v[124:127], a[208:211], a[128:131], v[140:143]
    ds_read_b128 a[204:207], v37 offset:0
    v_exp_f32 v58, v102
    v_exp_f32 v59, v103
    v_cvt_pk_bf16_f32 v166, v56, v57
    v_mfma_f32_16x16x32_bf16 v[124:127], a[212:215], a[132:135], v[124:127]
    v_exp_f32 v52, v88
    v_exp_f32 v53, v89
    v_cvt_pk_bf16_f32 v167, v58, v59
    v_mfma_f32_16x16x32_bf16 v[124:127], a[216:219], a[136:139], v[124:127]
    v_exp_f32 v54, v90
    v_exp_f32 v55, v91
    v_cvt_pk_bf16_f32 v168, v52, v53
    v_mfma_f32_16x16x32_bf16 v[124:127], a[220:223], a[140:143], v[124:127]
    buffer_load_dwordx4 v47, s[24:27], s45 offen offset:3072 lds
    v_exp_f32 v56, v104
    v_exp_f32 v57, v105
    v_cvt_pk_bf16_f32 v169, v54, v55
    v_mfma_f32_16x16x32_bf16 v[128:131], a[208:211], a[144:147], v[144:147]
    v_exp_f32 v58, v106
    v_exp_f32 v59, v107
    v_cvt_pk_bf16_f32 v170, v56, v57
    v_mfma_f32_16x16x32_bf16 v[128:131], a[212:215], a[148:151], v[128:131]
    s_nop 0
    v_cvt_pk_bf16_f32 v171, v58, v59
    v_mfma_f32_16x16x32_bf16 v[128:131], a[216:219], a[152:155], v[128:131]
    v_mfma_f32_16x16x32_bf16 v[128:131], a[220:223], a[156:159], v[128:131]
    v_mfma_f32_16x16x32_bf16 v[132:135], a[208:211], a[160:163], v[148:151]
    s_add_u32 m0, s49, 4096
    s_nop 0
    buffer_load_dwordx4 v46, s[24:27], s46 offen offset:0 lds
    v_mfma_f32_16x16x32_bf16 v[132:135], a[212:215], a[164:167], v[132:135]
    v_mfma_f32_16x16x32_bf16 v[132:135], a[216:219], a[168:171], v[132:135]
    v_mfma_f32_16x16x32_bf16 v[132:135], a[220:223], a[172:175], v[132:135]
    v_mfma_f32_16x16x32_bf16 v[136:139], a[208:211], a[176:179], v[152:155]
    v_mfma_f32_16x16x32_bf16 v[136:139], a[212:215], a[180:183], v[136:139]
    ds_read_b128 a[208:211], v34 offset:4096
    buffer_load_dwordx4 v47, s[24:27], s46 offen offset:1024 lds
    v_mfma_f32_16x16x32_bf16 v[136:139], a[216:219], a[184:187], v[136:139]
    ds_read_b128 a[212:215], v35 offset:4096
    v_mfma_f32_16x16x32_bf16 v[136:139], a[220:223], a[188:191], v[136:139]
    ds_read_b128 a[216:219], v36 offset:4096
    ds_read_b128 a[220:223], v37 offset:4096
    s_waitcnt lgkmcnt(0)
    v_mfma_f32_16x16x32_bf16 v[76:79], a[192:195], a[128:131], v[140:143]
    v_exp_f32 v52, v108
    v_exp_f32 v53, v109
    v_exp_f32 v54, v110
    v_mfma_f32_16x16x32_bf16 v[76:79], a[196:199], a[132:135], v[76:79]
    v_add_f32 v48, v48, v52
    v_exp_f32 v55, v111
    v_add_f32 v48, v48, v53
    v_mfma_f32_16x16x32_bf16 v[76:79], a[200:203], a[136:139], v[76:79]
    v_cvt_pk_bf16_f32 v172, v52, v53
    v_exp_f32 v56, v124
    v_add_f32 v48, v48, v54
    v_mfma_f32_16x16x32_bf16 v[76:79], a[204:207], a[140:143], v[76:79]
    v_exp_f32 v57, v125
    v_add_f32 v48, v48, v55
    v_cvt_pk_bf16_f32 v173, v54, v55
    v_mfma_f32_16x16x32_bf16 v[80:83], a[192:195], a[144:147], v[144:147]
    buffer_load_dwordx4 v46, s[24:27], s46 offen offset:2048 lds
    v_exp_f32 v58, v126
    v_add_f32 v48, v48, v56
    v_exp_f32 v59, v127
    v_mfma_f32_16x16x32_bf16 v[80:83], a[196:199], a[148:151], v[80:83]
    v_add_f32 v48, v48, v57
    v_cvt_pk_bf16_f32 v174, v56, v57
    v_exp_f32 v52, v112
    v_mfma_f32_16x16x32_bf16 v[80:83], a[200:203], a[152:155], v[80:83]
    v_add_f32 v48, v48, v58
    v_exp_f32 v53, v113
    v_add_f32 v48, v48, v59
    v_mfma_f32_16x16x32_bf16 v[80:83], a[204:207], a[156:159], v[80:83]
    v_cvt_pk_bf16_f32 v175, v58, v59
    v_exp_f32 v54, v114
    v_add_f32 v49, v49, v52
    v_mfma_f32_16x16x32_bf16 v[84:87], a[192:195], a[160:163], v[148:151]
    v_exp_f32 v55, v115
    v_add_f32 v49, v49, v53
    v_cvt_pk_bf16_f32 v176, v52, v53
    v_mfma_f32_16x16x32_bf16 v[84:87], a[196:199], a[164:167], v[84:87]
    buffer_load_dwordx4 v47, s[24:27], s46 offen offset:3072 lds
    v_exp_f32 v56, v128
    v_add_f32 v49, v49, v54
    v_exp_f32 v57, v129
    v_mfma_f32_16x16x32_bf16 v[84:87], a[200:203], a[168:171], v[84:87]
    v_add_f32 v49, v49, v55
    v_cvt_pk_bf16_f32 v177, v54, v55
    v_exp_f32 v58, v130
    v_mfma_f32_16x16x32_bf16 v[84:87], a[204:207], a[172:175], v[84:87]
    v_add_f32 v49, v49, v56
    v_exp_f32 v59, v131
    v_add_f32 v49, v49, v57
    v_mfma_f32_16x16x32_bf16 v[88:91], a[192:195], a[176:179], v[152:155]
    v_cvt_pk_bf16_f32 v178, v56, v57
    v_exp_f32 v52, v116
    v_add_f32 v49, v49, v58
    v_mfma_f32_16x16x32_bf16 v[88:91], a[196:199], a[180:183], v[88:91]
    ds_read_b128 a[192:195], v34 offset:8192
    v_exp_f32 v53, v117
    v_add_f32 v49, v49, v59
    v_cvt_pk_bf16_f32 v179, v58, v59
    v_mfma_f32_16x16x32_bf16 v[88:91], a[200:203], a[184:187], v[88:91]
    ds_read_b128 a[196:199], v35 offset:8192
    s_mov_b32 m0, s50
    s_nop 0
    buffer_load_dwordx4 v46, s[28:31], s47 offen offset:0 lds
    v_exp_f32 v54, v118
    v_exp_f32 v55, v119
    v_cvt_pk_bf16_f32 v180, v52, v53
    v_mfma_f32_16x16x32_bf16 v[88:91], a[204:207], a[188:191], v[88:91]
    ds_read_b128 a[200:203], v36 offset:8192
    v_exp_f32 v56, v132
    v_exp_f32 v57, v133
    v_cvt_pk_bf16_f32 v181, v54, v55
    v_mfma_f32_16x16x32_bf16 v[92:95], a[208:211], a[128:131], v[140:143]
    ds_read_b128 a[204:207], v37 offset:8192
    v_exp_f32 v58, v134
    v_exp_f32 v59, v135
    v_cvt_pk_bf16_f32 v182, v56, v57
    v_mfma_f32_16x16x32_bf16 v[92:95], a[212:215], a[132:135], v[92:95]
    v_exp_f32 v52, v120
    v_exp_f32 v53, v121
    v_cvt_pk_bf16_f32 v183, v58, v59
    v_mfma_f32_16x16x32_bf16 v[92:95], a[216:219], a[136:139], v[92:95]
    v_exp_f32 v54, v122
    v_exp_f32 v55, v123
    v_cvt_pk_bf16_f32 v184, v52, v53
    v_mfma_f32_16x16x32_bf16 v[92:95], a[220:223], a[140:143], v[92:95]
    buffer_load_dwordx4 v47, s[28:31], s47 offen offset:1024 lds
    v_exp_f32 v56, v136
    v_exp_f32 v57, v137
    v_cvt_pk_bf16_f32 v185, v54, v55
    v_mfma_f32_16x16x32_bf16 v[96:99], a[208:211], a[144:147], v[144:147]
    v_exp_f32 v58, v138
    v_exp_f32 v59, v139
    v_cvt_pk_bf16_f32 v186, v56, v57
    v_mfma_f32_16x16x32_bf16 v[96:99], a[212:215], a[148:151], v[96:99]
    s_nop 0
    v_cvt_pk_bf16_f32 v187, v58, v59
    v_mfma_f32_16x16x32_bf16 v[96:99], a[216:219], a[152:155], v[96:99]
    v_mfma_f32_16x16x32_bf16 v[96:99], a[220:223], a[156:159], v[96:99]
    v_mfma_f32_16x16x32_bf16 v[100:103], a[208:211], a[160:163], v[148:151]
    buffer_load_dwordx4 v46, s[28:31], s47 offen offset:2048 lds
    v_mfma_f32_16x16x32_bf16 v[100:103], a[212:215], a[164:167], v[100:103]
    v_mfma_f32_16x16x32_bf16 v[100:103], a[216:219], a[168:171], v[100:103]
    v_mfma_f32_16x16x32_bf16 v[100:103], a[220:223], a[172:175], v[100:103]
    v_mfma_f32_16x16x32_bf16 v[104:107], a[208:211], a[176:179], v[152:155]
    v_mfma_f32_16x16x32_bf16 v[104:107], a[212:215], a[180:183], v[104:107]
    ds_read_b128 a[208:211], v34 offset:12288
    v_mfma_f32_16x16x32_bf16 v[104:107], a[216:219], a[184:187], v[104:107]
    ds_read_b128 a[212:215], v35 offset:12288
    v_mfma_f32_16x16x32_bf16 v[104:107], a[220:223], a[188:191], v[104:107]
    ds_read_b128 a[216:219], v36 offset:12288
    ds_read_b128 a[220:223], v37 offset:12288
    s_waitcnt lgkmcnt(0)
    v_mfma_f32_16x16x32_bf16 v[108:111], a[192:195], a[128:131], v[140:143]
    v_exp_f32 v52, v76
    v_mfma_f32_16x16x32_bf16 v[108:111], a[196:199], a[132:135], v[108:111]
    ds_read_b64_tr_b16 a[224:225], v38 offset:16384
    ds_read_b64_tr_b16 a[226:227], v38 offset:20480
    ds_read_b64_tr_b16 a[254:255], v41 offset:28672
    v_mfma_f32_16x16x32_bf16 v[108:111], a[200:203], a[136:139], v[108:111]
    v_exp_f32 v53, v77
    v_mfma_f32_16x16x32_bf16 v[108:111], a[204:207], a[140:143], v[108:111]
    ds_read_b64_tr_b16 a[228:229], v38 offset:24576
    v_add_f32 v48, v48, v52
    v_mfma_f32_16x16x32_bf16 v[112:115], a[192:195], a[144:147], v[144:147]
    v_exp_f32 v54, v78
    v_mfma_f32_16x16x32_bf16 v[112:115], a[196:199], a[148:151], v[112:115]
    buffer_load_dwordx4 v47, s[28:31], s47 offen offset:3072 lds
    v_mfma_f32_16x16x32_bf16 v[112:115], a[200:203], a[152:155], v[112:115]
    v_exp_f32 v55, v79
    v_mfma_f32_16x16x32_bf16 v[112:115], a[204:207], a[156:159], v[112:115]
    v_add_f32 v48, v48, v53
    v_cvt_pk_bf16_f32 v188, v52, v53
    v_mfma_f32_16x16x32_bf16 v[116:119], a[192:195], a[160:163], v[148:151]
    v_exp_f32 v56, v92
    v_mfma_f32_16x16x32_bf16 v[116:119], a[196:199], a[164:167], v[116:119]
    v_add_f32 v48, v48, v54
    v_add_f32 v48, v48, v55
    v_mfma_f32_16x16x32_bf16 v[116:119], a[200:203], a[168:171], v[116:119]
    v_exp_f32 v57, v93
    v_mfma_f32_16x16x32_bf16 v[116:119], a[204:207], a[172:175], v[116:119]
    v_cvt_pk_bf16_f32 v189, v54, v55
    v_add_f32 v48, v48, v56
    v_mfma_f32_16x16x32_bf16 v[120:123], a[192:195], a[176:179], v[152:155]
    v_exp_f32 v58, v94
    v_mfma_f32_16x16x32_bf16 v[120:123], a[196:199], a[180:183], v[120:123]
    v_add_f32 v48, v48, v57
    v_cvt_pk_bf16_f32 v190, v56, v57
    v_mfma_f32_16x16x32_bf16 v[120:123], a[200:203], a[184:187], v[120:123]
    s_add_u32 m0, s50, 4096
    v_exp_f32 v59, v95
    v_mfma_f32_16x16x32_bf16 v[120:123], a[204:207], a[188:191], v[120:123]
    buffer_load_dwordx4 v46, s[28:31], s48 offen offset:0 lds
    v_mfma_f32_16x16x32_bf16 v[124:127], a[208:211], a[128:131], v[140:143]
    v_exp_f32 v52, v80
    v_mfma_f32_16x16x32_bf16 v[124:127], a[212:215], a[132:135], v[124:127]
    ds_read_b64_tr_b16 a[230:231], v38 offset:28672
    v_add_f32 v48, v48, v58
    v_mfma_f32_16x16x32_bf16 v[124:127], a[216:219], a[136:139], v[124:127]
    v_exp_f32 v53, v81
    v_mfma_f32_16x16x32_bf16 v[124:127], a[220:223], a[140:143], v[124:127]
    v_add_f32 v48, v48, v59
    v_cvt_pk_bf16_f32 v191, v58, v59
    v_mfma_f32_16x16x32_bf16 v[128:131], a[208:211], a[144:147], v[144:147]
    v_exp_f32 v54, v82
    v_mfma_f32_16x16x32_bf16 v[128:131], a[212:215], a[148:151], v[128:131]
    v_add_f32 v49, v49, v52
    v_add_f32 v49, v49, v53
    v_mfma_f32_16x16x32_bf16 v[128:131], a[216:219], a[152:155], v[128:131]
    v_exp_f32 v55, v83
    v_mfma_f32_16x16x32_bf16 v[128:131], a[220:223], a[156:159], v[128:131]
    ds_read_b64_tr_b16 a[232:233], v39 offset:16384
    v_cvt_pk_bf16_f32 v192, v52, v53
    v_mfma_f32_16x16x32_bf16 v[132:135], a[208:211], a[160:163], v[148:151]
    v_exp_f32 v56, v96
    v_mfma_f32_16x16x32_bf16 v[132:135], a[212:215], a[164:167], v[132:135]
    buffer_load_dwordx4 v47, s[28:31], s48 offen offset:1024 lds
    v_mfma_f32_16x16x32_bf16 v[132:135], a[216:219], a[168:171], v[132:135]
    v_exp_f32 v57, v97
    v_mfma_f32_16x16x32_bf16 v[132:135], a[220:223], a[172:175], v[132:135]
    ds_read_b64_tr_b16 a[234:235], v39 offset:20480
    v_add_f32 v49, v49, v54
    v_mfma_f32_16x16x32_bf16 v[136:139], a[208:211], a[176:179], v[152:155]
    v_exp_f32 v58, v98
    v_mfma_f32_16x16x32_bf16 v[136:139], a[212:215], a[180:183], v[136:139]
    ds_read_b64_tr_b16 a[236:237], v39 offset:24576
    ds_read_b64_tr_b16 a[238:239], v39 offset:28672
    v_mfma_f32_16x16x32_bf16 v[136:139], a[216:219], a[184:187], v[136:139]
    v_exp_f32 v59, v99
    v_mfma_f32_16x16x32_bf16 v[136:139], a[220:223], a[188:191], v[136:139]
    s_waitcnt lgkmcnt(7)
    v_add_f32 v49, v49, v55
    v_cvt_pk_bf16_f32 v193, v54, v55
    v_mfma_f32_16x16x32_bf16 a[0:3], a[224:227], v[156:159], 0
    s_waitcnt lgkmcnt(4)
    v_exp_f32 v52, v84
    v_mfma_f32_16x16x32_bf16 a[0:3], a[228:231], v[172:175], a[0:3]
    v_add_f32 v49, v49, v56
    v_add_f32 v49, v49, v57
    v_mfma_f32_16x16x32_bf16 a[4:7], a[224:227], v[160:163], 0
    v_exp_f32 v53, v85
    v_mfma_f32_16x16x32_bf16 a[4:7], a[228:231], v[176:179], a[4:7]
    buffer_load_dwordx4 v46, s[28:31], s48 offen offset:2048 lds
    v_mfma_f32_16x16x32_bf16 a[8:11], a[224:227], v[164:167], 0
    v_exp_f32 v54, v86
    v_mfma_f32_16x16x32_bf16 a[8:11], a[228:231], v[180:183], a[8:11]
    ds_read_b64_tr_b16 a[240:241], v40 offset:16384
    v_cvt_pk_bf16_f32 v194, v56, v57
    v_mfma_f32_16x16x32_bf16 a[12:15], a[224:227], v[168:171], 0
    v_exp_f32 v55, v87
    v_mfma_f32_16x16x32_bf16 a[12:15], a[228:231], v[184:187], a[12:15]
    s_waitcnt lgkmcnt(3)
    ds_read_b64_tr_b16 a[242:243], v40 offset:20480
    v_add_f32 v49, v49, v58
    v_mfma_f32_16x16x32_bf16 a[16:19], a[232:235], v[156:159], 0
    s_waitcnt lgkmcnt(2)
    v_exp_f32 v56, v100
    v_mfma_f32_16x16x32_bf16 a[16:19], a[236:239], v[172:175], a[16:19]
    ds_read_b64_tr_b16 a[244:245], v40 offset:24576
    ds_read_b64_tr_b16 a[246:247], v40 offset:28672
    v_mfma_f32_16x16x32_bf16 a[20:23], a[232:235], v[160:163], 0
    v_exp_f32 v57, v101
    v_mfma_f32_16x16x32_bf16 a[20:23], a[236:239], v[176:179], a[20:23]
    v_add_f32 v49, v49, v59
    v_cvt_pk_bf16_f32 v195, v58, v59
    v_mfma_f32_16x16x32_bf16 a[24:27], a[232:235], v[164:167], 0
    v_exp_f32 v58, v102
    v_mfma_f32_16x16x32_bf16 a[24:27], a[236:239], v[180:183], a[24:27]
    buffer_load_dwordx4 v47, s[28:31], s48 offen offset:3072 lds
    v_mfma_f32_16x16x32_bf16 a[28:31], a[232:235], v[168:171], 0
    v_exp_f32 v59, v103
    v_mfma_f32_16x16x32_bf16 a[28:31], a[236:239], v[184:187], a[28:31]
    s_waitcnt lgkmcnt(2)
    ds_read_b64_tr_b16 a[248:249], v41 offset:16384
    v_cvt_pk_bf16_f32 v196, v52, v53
    v_mfma_f32_16x16x32_bf16 a[32:35], a[240:243], v[156:159], 0
    s_waitcnt lgkmcnt(1)
    v_exp_f32 v52, v88
    v_mfma_f32_16x16x32_bf16 a[32:35], a[244:247], v[172:175], a[32:35]
    ds_read_b64_tr_b16 a[250:251], v41 offset:20480
    ds_read_b64_tr_b16 a[252:253], v41 offset:24576
    v_mfma_f32_16x16x32_bf16 a[36:39], a[240:243], v[160:163], 0
    v_exp_f32 v53, v89
    v_mfma_f32_16x16x32_bf16 a[36:39], a[244:247], v[176:179], a[36:39]
    v_cvt_pk_bf16_f32 v197, v54, v55
    v_cvt_pk_bf16_f32 v198, v56, v57
    v_mfma_f32_16x16x32_bf16 a[40:43], a[240:243], v[164:167], 0
    v_exp_f32 v54, v90
    v_mfma_f32_16x16x32_bf16 a[40:43], a[244:247], v[180:183], a[40:43]
    v_cvt_pk_bf16_f32 v199, v58, v59
    v_cvt_pk_bf16_f32 v200, v52, v53
    v_mfma_f32_16x16x32_bf16 a[44:47], a[240:243], v[168:171], 0
    v_exp_f32 v55, v91
    v_mfma_f32_16x16x32_bf16 a[44:47], a[244:247], v[184:187], a[44:47]
    s_waitcnt lgkmcnt(1)
    ds_read_b128 a[192:195], v34 offset:16384
    ds_read_b128 a[196:199], v35 offset:16384
    v_mfma_f32_16x16x32_bf16 a[48:51], a[248:251], v[156:159], 0
    s_waitcnt lgkmcnt(2)
    v_exp_f32 v56, v104
    v_mfma_f32_16x16x32_bf16 a[48:51], a[252:255], v[172:175], a[48:51]
    ds_read_b128 a[200:203], v36 offset:16384
    ds_read_b128 a[204:207], v37 offset:16384
    v_mfma_f32_16x16x32_bf16 a[52:55], a[248:251], v[160:163], 0
    v_exp_f32 v57, v105
    v_mfma_f32_16x16x32_bf16 a[52:55], a[252:255], v[176:179], a[52:55]
    ds_read_b128 a[208:211], v34 offset:20480
    ds_read_b128 a[212:215], v35 offset:20480
    v_mfma_f32_16x16x32_bf16 a[56:59], a[248:251], v[164:167], 0
    v_exp_f32 v58, v106
    v_mfma_f32_16x16x32_bf16 a[56:59], a[252:255], v[180:183], a[56:59]
    ds_read_b128 a[216:219], v36 offset:20480
    ds_read_b128 a[220:223], v37 offset:20480
    v_mfma_f32_16x16x32_bf16 a[60:63], a[248:251], v[168:171], 0
    v_exp_f32 v59, v107
    v_mfma_f32_16x16x32_bf16 a[60:63], a[252:255], v[184:187], a[60:63]
    v_cvt_pk_bf16_f32 v201, v54, v55
    v_cvt_pk_bf16_f32 v202, v56, v57
    v_mfma_f32_16x16x32_bf16 v[228:231], v[236:239], v[164:167], 0
    v_mfma_f32_16x16x32_bf16 v[228:231], v[236:239], v[180:183], v[228:231]
    s_waitcnt lgkmcnt(7)
    v_cvt_pk_bf16_f32 v203, v58, v59
    v_mfma_f32_16x16x32_bf16 v[76:79], a[192:195], a[128:131], v[140:143]
    s_waitcnt lgkmcnt(6)
    v_exp_f32 v52, v108
    v_mfma_f32_16x16x32_bf16 v[76:79], a[196:199], a[132:135], v[76:79]
    s_waitcnt lgkmcnt(5)
    ds_read_b64_tr_b16 a[224:225], v42 offset:16384
    ds_read_b64_tr_b16 a[226:227], v42 offset:20480
    v_mfma_f32_16x16x32_bf16 v[76:79], a[200:203], a[136:139], v[76:79]
    s_waitcnt lgkmcnt(6)
    v_exp_f32 v53, v109
    v_mfma_f32_16x16x32_bf16 v[76:79], a[204:207], a[140:143], v[76:79]
    ds_read_b64_tr_b16 a[228:229], v42 offset:24576
    v_add_f32 v48, v48, v52
    v_mfma_f32_16x16x32_bf16 v[80:83], a[192:195], a[144:147], v[144:147]
    v_exp_f32 v54, v110
    v_mfma_f32_16x16x32_bf16 v[80:83], a[196:199], a[148:151], v[80:83]
    v_add_f32 v48, v48, v53
    v_cvt_pk_bf16_f32 v204, v52, v53
    v_mfma_f32_16x16x32_bf16 v[80:83], a[200:203], a[152:155], v[80:83]
    v_exp_f32 v55, v111
    v_mfma_f32_16x16x32_bf16 v[80:83], a[204:207], a[156:159], v[80:83]
    ds_read_b64_tr_b16 a[230:231], v42 offset:28672
    v_add_f32 v48, v48, v54
    v_mfma_f32_16x16x32_bf16 v[84:87], a[192:195], a[160:163], v[148:151]
    v_exp_f32 v56, v124
    v_mfma_f32_16x16x32_bf16 v[84:87], a[196:199], a[164:167], v[84:87]
    v_add_f32 v48, v48, v55
    v_cvt_pk_bf16_f32 v205, v54, v55
    v_mfma_f32_16x16x32_bf16 v[84:87], a[200:203], a[168:171], v[84:87]
    v_exp_f32 v57, v125
    v_mfma_f32_16x16x32_bf16 v[84:87], a[204:207], a[172:175], v[84:87]
    ds_read_b64_tr_b16 a[232:233], v43 offset:16384
    v_add_f32 v48, v48, v56
    v_mfma_f32_16x16x32_bf16 v[88:91], a[192:195], a[176:179], v[152:155]
    v_exp_f32 v58, v126
    v_mfma_f32_16x16x32_bf16 v[88:91], a[196:199], a[180:183], v[88:91]
    v_add_f32 v48, v48, v57
    v_cvt_pk_bf16_f32 v206, v56, v57
    v_mfma_f32_16x16x32_bf16 v[88:91], a[200:203], a[184:187], v[88:91]
    v_exp_f32 v59, v127
    v_mfma_f32_16x16x32_bf16 v[88:91], a[204:207], a[188:191], v[88:91]
    s_waitcnt lgkmcnt(8)
    ds_read_b64_tr_b16 a[234:235], v43 offset:20480
    v_add_f32 v48, v48, v58
    v_mfma_f32_16x16x32_bf16 v[92:95], a[208:211], a[128:131], v[140:143]
    s_waitcnt lgkmcnt(8)
    v_exp_f32 v52, v112
    v_mfma_f32_16x16x32_bf16 v[92:95], a[212:215], a[132:135], v[92:95]
    s_waitcnt lgkmcnt(7)
    v_add_f32 v48, v48, v59
    v_cvt_pk_bf16_f32 v207, v58, v59
    v_mfma_f32_16x16x32_bf16 v[92:95], a[216:219], a[136:139], v[92:95]
    s_waitcnt lgkmcnt(6)
    v_exp_f32 v53, v113
    v_mfma_f32_16x16x32_bf16 v[92:95], a[220:223], a[140:143], v[92:95]
    ds_read_b64_tr_b16 a[236:237], v43 offset:24576
    v_add_f32 v49, v49, v52
    v_mfma_f32_16x16x32_bf16 v[96:99], a[208:211], a[144:147], v[144:147]
    v_exp_f32 v54, v114
    v_mfma_f32_16x16x32_bf16 v[96:99], a[212:215], a[148:151], v[96:99]
    v_add_f32 v49, v49, v53
    v_cvt_pk_bf16_f32 v208, v52, v53
    v_mfma_f32_16x16x32_bf16 v[96:99], a[216:219], a[152:155], v[96:99]
    v_exp_f32 v55, v115
    v_mfma_f32_16x16x32_bf16 v[96:99], a[220:223], a[156:159], v[96:99]
    ds_read_b64_tr_b16 a[238:239], v43 offset:28672
    v_add_f32 v49, v49, v54
    v_mfma_f32_16x16x32_bf16 v[100:103], a[208:211], a[160:163], v[148:151]
    v_exp_f32 v56, v128
    v_mfma_f32_16x16x32_bf16 v[100:103], a[212:215], a[164:167], v[100:103]
    v_add_f32 v49, v49, v55
    v_cvt_pk_bf16_f32 v209, v54, v55
    v_mfma_f32_16x16x32_bf16 v[100:103], a[216:219], a[168:171], v[100:103]
    v_exp_f32 v57, v129
    v_mfma_f32_16x16x32_bf16 v[100:103], a[220:223], a[172:175], v[100:103]
    ds_read_b64_tr_b16 a[240:241], v44 offset:16384
    v_add_f32 v49, v49, v56
    v_mfma_f32_16x16x32_bf16 v[104:107], a[208:211], a[176:179], v[152:155]
    v_exp_f32 v58, v130
    v_mfma_f32_16x16x32_bf16 v[104:107], a[212:215], a[180:183], v[104:107]
    v_add_f32 v49, v49, v57
    v_cvt_pk_bf16_f32 v210, v56, v57
    v_mfma_f32_16x16x32_bf16 v[104:107], a[216:219], a[184:187], v[104:107]
    v_exp_f32 v59, v131
    v_mfma_f32_16x16x32_bf16 v[104:107], a[220:223], a[188:191], v[104:107]
    s_waitcnt lgkmcnt(7)
    ds_read_b64_tr_b16 a[242:243], v44 offset:20480
    v_add_f32 v49, v49, v58
    v_mfma_f32_16x16x32_bf16 a[64:67], a[224:227], v[156:159], 0
    s_waitcnt lgkmcnt(6)
    v_exp_f32 v52, v116
    v_mfma_f32_16x16x32_bf16 a[64:67], a[228:231], v[172:175], a[64:67]
    ds_read_b64_tr_b16 a[244:245], v44 offset:24576
    ds_read_b64_tr_b16 a[246:247], v44 offset:28672
    v_mfma_f32_16x16x32_bf16 a[68:71], a[224:227], v[160:163], 0
    v_exp_f32 v53, v117
    v_mfma_f32_16x16x32_bf16 a[68:71], a[228:231], v[176:179], a[68:71]
    v_add_f32 v49, v49, v59
    v_cvt_pk_bf16_f32 v211, v58, v59
    v_mfma_f32_16x16x32_bf16 a[72:75], a[224:227], v[164:167], 0
    v_exp_f32 v54, v118
    v_mfma_f32_16x16x32_bf16 a[72:75], a[228:231], v[180:183], a[72:75]
    ds_read_b64_tr_b16 a[248:249], v45 offset:16384
    v_cvt_pk_bf16_f32 v212, v52, v53
    v_mfma_f32_16x16x32_bf16 a[76:79], a[224:227], v[168:171], 0
    v_exp_f32 v55, v119
    v_mfma_f32_16x16x32_bf16 a[76:79], a[228:231], v[184:187], a[76:79]
    s_waitcnt lgkmcnt(7)
    ds_read_b64_tr_b16 a[250:251], v45 offset:20480
    ds_read_b64_tr_b16 a[252:253], v45 offset:24576
    v_mfma_f32_16x16x32_bf16 a[80:83], a[232:235], v[156:159], 0
    s_waitcnt lgkmcnt(7)
    v_exp_f32 v56, v132
    v_mfma_f32_16x16x32_bf16 a[80:83], a[236:239], v[172:175], a[80:83]
    ds_read_b64_tr_b16 a[254:255], v45 offset:28672
    v_cvt_pk_bf16_f32 v213, v54, v55
    v_mfma_f32_16x16x32_bf16 a[84:87], a[232:235], v[160:163], 0
    v_exp_f32 v57, v133
    v_mfma_f32_16x16x32_bf16 a[84:87], a[236:239], v[176:179], a[84:87]
    ds_read_b128 a[192:195], v34 offset:24576
    ds_read_b128 a[196:199], v35 offset:24576
    v_mfma_f32_16x16x32_bf16 a[88:91], a[232:235], v[164:167], 0
    v_exp_f32 v58, v134
    v_mfma_f32_16x16x32_bf16 a[88:91], a[236:239], v[180:183], a[88:91]
    ds_read_b128 a[200:203], v36 offset:24576
    v_cvt_pk_bf16_f32 v214, v56, v57
    v_mfma_f32_16x16x32_bf16 a[92:95], a[232:235], v[168:171], 0
    v_exp_f32 v59, v135
    v_mfma_f32_16x16x32_bf16 a[92:95], a[236:239], v[184:187], a[92:95]
    s_waitcnt lgkmcnt(9)
    ds_read_b128 a[204:207], v37 offset:24576
    ds_read_b128 a[208:211], v34 offset:28672
    v_mfma_f32_16x16x32_bf16 a[96:99], a[240:243], v[156:159], 0
    s_waitcnt lgkmcnt(9)
    v_exp_f32 v52, v120
    v_mfma_f32_16x16x32_bf16 a[96:99], a[244:247], v[172:175], a[96:99]
    ds_read_b128 a[212:215], v35 offset:28672
    v_cvt_pk_bf16_f32 v215, v58, v59
    v_mfma_f32_16x16x32_bf16 a[100:103], a[240:243], v[160:163], 0
    v_exp_f32 v53, v121
    v_mfma_f32_16x16x32_bf16 a[100:103], a[244:247], v[176:179], a[100:103]
    ds_read_b128 a[216:219], v36 offset:28672
    ds_read_b128 a[220:223], v37 offset:28672
    v_mfma_f32_16x16x32_bf16 a[104:107], a[240:243], v[164:167], 0
    v_exp_f32 v54, v122
    v_mfma_f32_16x16x32_bf16 a[104:107], a[244:247], v[180:183], a[104:107]
    v_cvt_pk_bf16_f32 v216, v52, v53
    v_mfma_f32_16x16x32_bf16 a[108:111], a[240:243], v[168:171], 0
    v_exp_f32 v55, v123
    v_mfma_f32_16x16x32_bf16 a[108:111], a[244:247], v[184:187], a[108:111]
    s_waitcnt lgkmcnt(10)
    v_mfma_f32_16x16x32_bf16 a[112:115], a[248:251], v[156:159], 0
    s_waitcnt lgkmcnt(8)
    v_exp_f32 v56, v136
    v_mfma_f32_16x16x32_bf16 a[112:115], a[252:255], v[172:175], a[112:115]
    v_cvt_pk_bf16_f32 v217, v54, v55
    v_mfma_f32_16x16x32_bf16 a[116:119], a[248:251], v[160:163], 0
    v_exp_f32 v57, v137
    v_mfma_f32_16x16x32_bf16 a[116:119], a[252:255], v[176:179], a[116:119]
    v_mfma_f32_16x16x32_bf16 a[120:123], a[248:251], v[164:167], 0
    v_exp_f32 v58, v138
    v_mfma_f32_16x16x32_bf16 a[120:123], a[252:255], v[180:183], a[120:123]
    v_cvt_pk_bf16_f32 v218, v56, v57
    v_mfma_f32_16x16x32_bf16 a[124:127], a[248:251], v[168:171], 0
    v_exp_f32 v59, v139
    v_mfma_f32_16x16x32_bf16 a[124:127], a[252:255], v[184:187], a[124:127]
    v_mfma_f32_16x16x32_bf16 v[232:235], v[236:239], v[168:171], 0
    v_mfma_f32_16x16x32_bf16 v[232:235], v[236:239], v[184:187], v[232:235]
    v_cvt_pk_bf16_f32 v219, v58, v59
    s_add_u32 s45, s45, 0x8000
    s_add_u32 s46, s46, 0x8000
    s_add_u32 s47, s47, 0x8000
    s_add_u32 s48, s48, 0x8000
    s_xor_b32 s49, s49, 0x8000
    s_xor_b32 s50, s50, 0x8000
    s_add_u32 s51, s51, 1
    s_waitcnt vmcnt(0)
    s_barrier
KF_loop:
    v_mfma_f32_16x16x32_bf16 v[108:111], a[192:195], a[128:131], v[140:143]
    s_waitcnt lgkmcnt(6)
    v_exp_f32 v52, v76
    v_mfma_f32_16x16x32_bf16 v[108:111], a[196:199], a[132:135], v[108:111]
    s_waitcnt lgkmcnt(5)
    ds_read_b64_tr_b16 a[224:225], v38 offset:32768
    ds_read_b64_tr_b16 a[226:227], v38 offset:36864
    ds_read_b64_tr_b16 a[254:255], v41 offset:45056
    v_mfma_f32_16x16x32_bf16 v[108:111], a[200:203], a[136:139], v[108:111]
    s_waitcnt lgkmcnt(7)
    v_exp_f32 v53, v77
    v_mfma_f32_16x16x32_bf16 v[108:111], a[204:207], a[140:143], v[108:111]
    ds_read_b64_tr_b16 a[228:229], v38 offset:40960
    v_add_f32 v48, v48, v52
    v_mfma_f32_16x16x32_bf16 v[112:115], a[192:195], a[144:147], v[144:147]
    s_mov_b32 m0, s49
    v_exp_f32 v54, v78
    v_mfma_f32_16x16x32_bf16 v[112:115], a[196:199], a[148:151], v[112:115]
    buffer_load_dwordx4 v46, s[24:27], s45 offen offset:0 lds
    v_mfma_f32_16x16x32_bf16 v[112:115], a[200:203], a[152:155], v[112:115]
    v_exp_f32 v55, v79
    v_mfma_f32_16x16x32_bf16 v[112:115], a[204:207], a[156:159], v[112:115]
    v_add_f32 v48, v48, v53
    v_cvt_pk_bf16_f32 v156, v52, v53
    v_mfma_f32_16x16x32_bf16 v[116:119], a[192:195], a[160:163], v[148:151]
    v_exp_f32 v56, v92
    v_mfma_f32_16x16x32_bf16 v[116:119], a[196:199], a[164:167], v[116:119]
    v_add_f32 v48, v48, v54
    v_add_f32 v48, v48, v55
    v_mfma_f32_16x16x32_bf16 v[116:119], a[200:203], a[168:171], v[116:119]
    v_exp_f32 v57, v93
    v_mfma_f32_16x16x32_bf16 v[116:119], a[204:207], a[172:175], v[116:119]
    v_cvt_pk_bf16_f32 v157, v54, v55
    v_add_f32 v48, v48, v56
    v_mfma_f32_16x16x32_bf16 v[120:123], a[192:195], a[176:179], v[152:155]
    v_exp_f32 v58, v94
    v_mfma_f32_16x16x32_bf16 v[120:123], a[196:199], a[180:183], v[120:123]
    v_add_f32 v48, v48, v57
    v_cvt_pk_bf16_f32 v158, v56, v57
    v_mfma_f32_16x16x32_bf16 v[120:123], a[200:203], a[184:187], v[120:123]
    v_exp_f32 v59, v95
    v_mfma_f32_16x16x32_bf16 v[120:123], a[204:207], a[188:191], v[120:123]
    s_waitcnt lgkmcnt(7)
    buffer_load_dwordx4 v47, s[24:27], s45 offen offset:1024 lds
    v_mfma_f32_16x16x32_bf16 v[124:127], a[208:211], a[128:131], v[140:143]
    s_waitcnt lgkmcnt(6)
    v_exp_f32 v52, v80
    v_mfma_f32_16x16x32_bf16 v[124:127], a[212:215], a[132:135], v[124:127]
    s_waitcnt lgkmcnt(5)
    ds_read_b64_tr_b16 a[230:231], v38 offset:45056
    v_add_f32 v48, v48, v58
    v_mfma_f32_16x16x32_bf16 v[124:127], a[216:219], a[136:139], v[124:127]
    s_waitcnt lgkmcnt(5)
    v_exp_f32 v53, v81
    v_mfma_f32_16x16x32_bf16 v[124:127], a[220:223], a[140:143], v[124:127]
    v_add_f32 v48, v48, v59
    v_cvt_pk_bf16_f32 v159, v58, v59
    v_mfma_f32_16x16x32_bf16 v[128:131], a[208:211], a[144:147], v[144:147]
    v_exp_f32 v54, v82
    v_mfma_f32_16x16x32_bf16 v[128:131], a[212:215], a[148:151], v[128:131]
    v_add_f32 v49, v49, v52
    v_add_f32 v49, v49, v53
    v_mfma_f32_16x16x32_bf16 v[128:131], a[216:219], a[152:155], v[128:131]
    v_exp_f32 v55, v83
    v_mfma_f32_16x16x32_bf16 v[128:131], a[220:223], a[156:159], v[128:131]
    ds_read_b64_tr_b16 a[232:233], v39 offset:32768
    v_cvt_pk_bf16_f32 v160, v52, v53
    v_mfma_f32_16x16x32_bf16 v[132:135], a[208:211], a[160:163], v[148:151]
    v_exp_f32 v56, v96
    v_mfma_f32_16x16x32_bf16 v[132:135], a[212:215], a[164:167], v[132:135]
    buffer_load_dwordx4 v46, s[24:27], s45 offen offset:2048 lds
    v_mfma_f32_16x16x32_bf16 v[132:135], a[216:219], a[168:171], v[132:135]
    v_exp_f32 v57, v97
    v_mfma_f32_16x16x32_bf16 v[132:135], a[220:223], a[172:175], v[132:135]
    ds_read_b64_tr_b16 a[234:235], v39 offset:36864
    v_add_f32 v49, v49, v54
    v_mfma_f32_16x16x32_bf16 v[136:139], a[208:211], a[176:179], v[152:155]
    v_exp_f32 v58, v98
    v_mfma_f32_16x16x32_bf16 v[136:139], a[212:215], a[180:183], v[136:139]
    ds_read_b64_tr_b16 a[236:237], v39 offset:40960
    ds_read_b64_tr_b16 a[238:239], v39 offset:45056
    v_mfma_f32_16x16x32_bf16 v[136:139], a[216:219], a[184:187], v[136:139]
    v_exp_f32 v59, v99
    v_mfma_f32_16x16x32_bf16 v[136:139], a[220:223], a[188:191], v[136:139]
    s_waitcnt lgkmcnt(7)
    v_add_f32 v49, v49, v55
    v_cvt_pk_bf16_f32 v161, v54, v55
    v_mfma_f32_16x16x32_bf16 a[0:3], a[224:227], v[188:191], a[0:3]
    s_waitcnt lgkmcnt(4)
    v_exp_f32 v52, v84
    v_mfma_f32_16x16x32_bf16 a[0:3], a[228:231], v[204:207], a[0:3]
    v_add_f32 v49, v49, v56
    v_add_f32 v49, v49, v57
    v_mfma_f32_16x16x32_bf16 a[4:7], a[224:227], v[192:195], a[4:7]
    v_exp_f32 v53, v85
    v_mfma_f32_16x16x32_bf16 a[4:7], a[228:231], v[208:211], a[4:7]
    buffer_load_dwordx4 v47, s[24:27], s45 offen offset:3072 lds
    v_mfma_f32_16x16x32_bf16 a[8:11], a[224:227], v[196:199], a[8:11]
    v_exp_f32 v54, v86
    v_mfma_f32_16x16x32_bf16 a[8:11], a[228:231], v[212:215], a[8:11]
    ds_read_b64_tr_b16 a[240:241], v40 offset:32768
    v_cvt_pk_bf16_f32 v162, v56, v57
    v_mfma_f32_16x16x32_bf16 a[12:15], a[224:227], v[200:203], a[12:15]
    v_exp_f32 v55, v87
    v_mfma_f32_16x16x32_bf16 a[12:15], a[228:231], v[216:219], a[12:15]
    s_waitcnt lgkmcnt(3)
    ds_read_b64_tr_b16 a[242:243], v40 offset:36864
    v_add_f32 v49, v49, v58
    v_mfma_f32_16x16x32_bf16 a[16:19], a[232:235], v[188:191], a[16:19]
    s_waitcnt lgkmcnt(2)
    v_exp_f32 v56, v100
    v_mfma_f32_16x16x32_bf16 a[16:19], a[236:239], v[204:207], a[16:19]
    ds_read_b64_tr_b16 a[244:245], v40 offset:40960
    ds_read_b64_tr_b16 a[246:247], v40 offset:45056
    v_mfma_f32_16x16x32_bf16 a[20:23], a[232:235], v[192:195], a[20:23]
    v_exp_f32 v57, v101
    v_mfma_f32_16x16x32_bf16 a[20:23], a[236:239], v[208:211], a[20:23]
    v_add_f32 v49, v49, v59
    v_cvt_pk_bf16_f32 v163, v58, v59
    v_mfma_f32_16x16x32_bf16 a[24:27], a[232:235], v[196:199], a[24:27]
    s_add_u32 m0, s49, 4096
    v_exp_f32 v58, v102
    v_mfma_f32_16x16x32_bf16 a[24:27], a[236:239], v[212:215], a[24:27]
    buffer_load_dwordx4 v46, s[24:27], s46 offen offset:0 lds
    v_mfma_f32_16x16x32_bf16 a[28:31], a[232:235], v[200:203], a[28:31]
    v_exp_f32 v59, v103
    v_mfma_f32_16x16x32_bf16 a[28:31], a[236:239], v[216:219], a[28:31]
    s_waitcnt lgkmcnt(2)
    ds_read_b64_tr_b16 a[248:249], v41 offset:32768
    v_cvt_pk_bf16_f32 v164, v52, v53
    v_mfma_f32_16x16x32_bf16 a[32:35], a[240:243], v[188:191], a[32:35]
    s_waitcnt lgkmcnt(1)
    v_exp_f32 v52, v88
    v_mfma_f32_16x16x32_bf16 a[32:35], a[244:247], v[204:207], a[32:35]
    ds_read_b64_tr_b16 a[250:251], v41 offset:36864
    ds_read_b64_tr_b16 a[252:253], v41 offset:40960
    v_mfma_f32_16x16x32_bf16 a[36:39], a[240:243], v[192:195], a[36:39]
    v_exp_f32 v53, v89
    v_mfma_f32_16x16x32_bf16 a[36:39], a[244:247], v[208:211], a[36:39]
    v_cvt_pk_bf16_f32 v165, v54, v55
    v_cvt_pk_bf16_f32 v166, v56, v57
    v_mfma_f32_16x16x32_bf16 a[40:43], a[240:243], v[196:199], a[40:43]
    v_exp_f32 v54, v90
    v_mfma_f32_16x16x32_bf16 a[40:43], a[244:247], v[212:215], a[40:43]
    v_cvt_pk_bf16_f32 v167, v58, v59
    v_cvt_pk_bf16_f32 v168, v52, v53
    v_mfma_f32_16x16x32_bf16 a[44:47], a[240:243], v[200:203], a[44:47]
    v_exp_f32 v55, v91
    v_mfma_f32_16x16x32_bf16 a[44:47], a[244:247], v[216:219], a[44:47]
    s_waitcnt lgkmcnt(1)
    buffer_load_dwordx4 v47, s[24:27], s46 offen offset:1024 lds
    v_mfma_f32_16x16x32_bf16 a[48:51], a[248:251], v[188:191], a[48:51]
    s_waitcnt lgkmcnt(0)
    v_exp_f32 v56, v104
    v_mfma_f32_16x16x32_bf16 a[48:51], a[252:255], v[204:207], a[48:51]
    ds_read_b128 a[192:195], v34 offset:32768
    ds_read_b128 a[196:199], v35 offset:32768
    v_mfma_f32_16x16x32_bf16 a[52:55], a[248:251], v[192:195], a[52:55]
    v_exp_f32 v57, v105
    v_mfma_f32_16x16x32_bf16 a[52:55], a[252:255], v[208:211], a[52:55]
    ds_read_b128 a[200:203], v36 offset:32768
    ds_read_b128 a[204:207], v37 offset:32768
    v_mfma_f32_16x16x32_bf16 a[56:59], a[248:251], v[196:199], a[56:59]
    v_exp_f32 v58, v106
    v_mfma_f32_16x16x32_bf16 a[56:59], a[252:255], v[212:215], a[56:59]
    ds_read_b128 a[208:211], v34 offset:36864
    ds_read_b128 a[212:215], v35 offset:36864
    v_mfma_f32_16x16x32_bf16 a[60:63], a[248:251], v[200:203], a[60:63]
    v_exp_f32 v59, v107
    v_mfma_f32_16x16x32_bf16 a[60:63], a[252:255], v[216:219], a[60:63]
    ds_read_b128 a[216:219], v36 offset:36864
    ds_read_b128 a[220:223], v37 offset:36864
    v_mfma_f32_16x16x32_bf16 v[228:231], v[236:239], v[196:199], v[228:231]
    v_cvt_pk_bf16_f32 v169, v54, v55
    v_cvt_pk_bf16_f32 v170, v56, v57
    v_mfma_f32_16x16x32_bf16 v[228:231], v[236:239], v[212:215], v[228:231]
    s_waitcnt lgkmcnt(7)
    v_cvt_pk_bf16_f32 v171, v58, v59
    v_mfma_f32_16x16x32_bf16 v[76:79], a[192:195], a[128:131], v[140:143]
    s_waitcnt lgkmcnt(6)
    v_exp_f32 v52, v108
    v_mfma_f32_16x16x32_bf16 v[76:79], a[196:199], a[132:135], v[76:79]
    s_waitcnt lgkmcnt(5)
    ds_read_b64_tr_b16 a[224:225], v42 offset:32768
    ds_read_b64_tr_b16 a[226:227], v42 offset:36864
    ds_read_b64_tr_b16 a[254:255], v45 offset:45056
    v_mfma_f32_16x16x32_bf16 v[76:79], a[200:203], a[136:139], v[76:79]
    s_waitcnt lgkmcnt(7)
    v_exp_f32 v53, v109
    v_mfma_f32_16x16x32_bf16 v[76:79], a[204:207], a[140:143], v[76:79]
    ds_read_b64_tr_b16 a[228:229], v42 offset:40960
    v_add_f32 v48, v48, v52
    v_mfma_f32_16x16x32_bf16 v[80:83], a[192:195], a[144:147], v[144:147]
    v_exp_f32 v54, v110
    v_mfma_f32_16x16x32_bf16 v[80:83], a[196:199], a[148:151], v[80:83]
    buffer_load_dwordx4 v46, s[24:27], s46 offen offset:2048 lds
    v_mfma_f32_16x16x32_bf16 v[80:83], a[200:203], a[152:155], v[80:83]
    v_exp_f32 v55, v111
    v_mfma_f32_16x16x32_bf16 v[80:83], a[204:207], a[156:159], v[80:83]
    v_add_f32 v48, v48, v53
    v_cvt_pk_bf16_f32 v172, v52, v53
    v_mfma_f32_16x16x32_bf16 v[84:87], a[192:195], a[160:163], v[148:151]
    v_exp_f32 v56, v124
    v_mfma_f32_16x16x32_bf16 v[84:87], a[196:199], a[164:167], v[84:87]
    v_add_f32 v48, v48, v54
    v_add_f32 v48, v48, v55
    v_mfma_f32_16x16x32_bf16 v[84:87], a[200:203], a[168:171], v[84:87]
    v_exp_f32 v57, v125
    v_mfma_f32_16x16x32_bf16 v[84:87], a[204:207], a[172:175], v[84:87]
    v_cvt_pk_bf16_f32 v173, v54, v55
    v_add_f32 v48, v48, v56
    v_mfma_f32_16x16x32_bf16 v[88:91], a[192:195], a[176:179], v[152:155]
    v_exp_f32 v58, v126
    v_mfma_f32_16x16x32_bf16 v[88:91], a[196:199], a[180:183], v[88:91]
    v_add_f32 v48, v48, v57
    v_cvt_pk_bf16_f32 v174, v56, v57
    v_mfma_f32_16x16x32_bf16 v[88:91], a[200:203], a[184:187], v[88:91]
    v_exp_f32 v59, v127
    v_mfma_f32_16x16x32_bf16 v[88:91], a[204:207], a[188:191], v[88:91]
    s_waitcnt lgkmcnt(7)
    buffer_load_dwordx4 v47, s[24:27], s46 offen offset:3072 lds
    v_mfma_f32_16x16x32_bf16 v[92:95], a[208:211], a[128:131], v[140:143]
    s_waitcnt lgkmcnt(6)
    v_exp_f32 v52, v112
    v_mfma_f32_16x16x32_bf16 v[92:95], a[212:215], a[132:135], v[92:95]
    s_waitcnt lgkmcnt(5)
    ds_read_b64_tr_b16 a[230:231], v42 offset:45056
    v_add_f32 v48, v48, v58
    v_mfma_f32_16x16x32_bf16 v[92:95], a[216:219], a[136:139], v[92:95]
    s_waitcnt lgkmcnt(5)
    v_exp_f32 v53, v113
    v_mfma_f32_16x16x32_bf16 v[92:95], a[220:223], a[140:143], v[92:95]
    v_add_f32 v48, v48, v59
    v_cvt_pk_bf16_f32 v175, v58, v59
    v_mfma_f32_16x16x32_bf16 v[96:99], a[208:211], a[144:147], v[144:147]
    v_exp_f32 v54, v114
    v_mfma_f32_16x16x32_bf16 v[96:99], a[212:215], a[148:151], v[96:99]
    v_add_f32 v49, v49, v52
    v_add_f32 v49, v49, v53
    v_mfma_f32_16x16x32_bf16 v[96:99], a[216:219], a[152:155], v[96:99]
    v_exp_f32 v55, v115
    v_mfma_f32_16x16x32_bf16 v[96:99], a[220:223], a[156:159], v[96:99]
    ds_read_b64_tr_b16 a[232:233], v43 offset:32768
    v_cvt_pk_bf16_f32 v176, v52, v53
    v_mfma_f32_16x16x32_bf16 v[100:103], a[208:211], a[160:163], v[148:151]
    s_mov_b32 m0, s50
    v_exp_f32 v56, v128
    v_mfma_f32_16x16x32_bf16 v[100:103], a[212:215], a[164:167], v[100:103]
    buffer_load_dwordx4 v46, s[28:31], s47 offen offset:0 lds
    v_mfma_f32_16x16x32_bf16 v[100:103], a[216:219], a[168:171], v[100:103]
    v_exp_f32 v57, v129
    v_mfma_f32_16x16x32_bf16 v[100:103], a[220:223], a[172:175], v[100:103]
    ds_read_b64_tr_b16 a[234:235], v43 offset:36864
    v_add_f32 v49, v49, v54
    v_mfma_f32_16x16x32_bf16 v[104:107], a[208:211], a[176:179], v[152:155]
    v_exp_f32 v58, v130
    v_mfma_f32_16x16x32_bf16 v[104:107], a[212:215], a[180:183], v[104:107]
    ds_read_b64_tr_b16 a[236:237], v43 offset:40960
    ds_read_b64_tr_b16 a[238:239], v43 offset:45056
    v_mfma_f32_16x16x32_bf16 v[104:107], a[216:219], a[184:187], v[104:107]
    v_exp_f32 v59, v131
    v_mfma_f32_16x16x32_bf16 v[104:107], a[220:223], a[188:191], v[104:107]
    s_waitcnt lgkmcnt(7)
    v_add_f32 v49, v49, v55
    v_cvt_pk_bf16_f32 v177, v54, v55
    v_mfma_f32_16x16x32_bf16 a[64:67], a[224:227], v[188:191], a[64:67]
    s_waitcnt lgkmcnt(4)
    v_exp_f32 v52, v116
    v_mfma_f32_16x16x32_bf16 a[64:67], a[228:231], v[204:207], a[64:67]
    v_add_f32 v49, v49, v56
    v_add_f32 v49, v49, v57
    v_mfma_f32_16x16x32_bf16 a[68:71], a[224:227], v[192:195], a[68:71]
    v_exp_f32 v53, v117
    v_mfma_f32_16x16x32_bf16 a[68:71], a[228:231], v[208:211], a[68:71]
    buffer_load_dwordx4 v47, s[28:31], s47 offen offset:1024 lds
    v_mfma_f32_16x16x32_bf16 a[72:75], a[224:227], v[196:199], a[72:75]
    v_exp_f32 v54, v118
    v_mfma_f32_16x16x32_bf16 a[72:75], a[228:231], v[212:215], a[72:75]
    ds_read_b64_tr_b16 a[240:241], v44 offset:32768
    v_cvt_pk_bf16_f32 v178, v56, v57
    v_mfma_f32_16x16x32_bf16 a[76:79], a[224:227], v[200:203], a[76:79]
    v_exp_f32 v55, v119
    v_mfma_f32_16x16x32_bf16 a[76:79], a[228:231], v[216:219], a[76:79]
    s_waitcnt lgkmcnt(3)
    ds_read_b64_tr_b16 a[242:243], v44 offset:36864
    v_add_f32 v49, v49, v58
    v_mfma_f32_16x16x32_bf16 a[80:83], a[232:235], v[188:191], a[80:83]
    s_waitcnt lgkmcnt(2)
    v_exp_f32 v56, v132
    v_mfma_f32_16x16x32_bf16 a[80:83], a[236:239], v[204:207], a[80:83]
    ds_read_b64_tr_b16 a[244:245], v44 offset:40960
    ds_read_b64_tr_b16 a[246:247], v44 offset:45056
    v_mfma_f32_16x16x32_bf16 a[84:87], a[232:235], v[192:195], a[84:87]
    v_exp_f32 v57, v133
    v_mfma_f32_16x16x32_bf16 a[84:87], a[236:239], v[208:211], a[84:87]
    v_add_f32 v49, v49, v59
    v_cvt_pk_bf16_f32 v179, v58, v59
    v_mfma_f32_16x16x32_bf16 a[88:91], a[232:235], v[196:199], a[88:91]
    v_exp_f32 v58, v134
    v_mfma_f32_16x16x32_bf16 a[88:91], a[236:239], v[212:215], a[88:91]
    buffer_load_dwordx4 v46, s[28:31], s47 offen offset:2048 lds
    v_mfma_f32_16x16x32_bf16 a[92:95], a[232:235], v[200:203], a[92:95]
    v_exp_f32 v59, v135
    v_mfma_f32_16x16x32_bf16 a[92:95], a[236:239], v[216:219], a[92:95]
    s_waitcnt lgkmcnt(2)
    ds_read_b64_tr_b16 a[248:249], v45 offset:32768
    v_cvt_pk_bf16_f32 v180, v52, v53
    v_mfma_f32_16x16x32_bf16 a[96:99], a[240:243], v[188:191], a[96:99]
    s_waitcnt lgkmcnt(1)
    v_exp_f32 v52, v120
    v_mfma_f32_16x16x32_bf16 a[96:99], a[244:247], v[204:207], a[96:99]
    ds_read_b64_tr_b16 a[250:251], v45 offset:36864
    ds_read_b64_tr_b16 a[252:253], v45 offset:40960
    v_mfma_f32_16x16x32_bf16 a[100:103], a[240:243], v[192:195], a[100:103]
    v_exp_f32 v53, v121
    v_mfma_f32_16x16x32_bf16 a[100:103], a[244:247], v[208:211], a[100:103]
    v_cvt_pk_bf16_f32 v181, v54, v55
    v_cvt_pk_bf16_f32 v182, v56, v57
    v_mfma_f32_16x16x32_bf16 a[104:107], a[240:243], v[196:199], a[104:107]
    v_exp_f32 v54, v122
    v_mfma_f32_16x16x32_bf16 a[104:107], a[244:247], v[212:215], a[104:107]
    v_cvt_pk_bf16_f32 v183, v58, v59
    v_cvt_pk_bf16_f32 v184, v52, v53
    v_mfma_f32_16x16x32_bf16 a[108:111], a[240:243], v[200:203], a[108:111]
    v_exp_f32 v55, v123
    v_mfma_f32_16x16x32_bf16 a[108:111], a[244:247], v[216:219], a[108:111]
    s_waitcnt lgkmcnt(1)
    ds_read_b128 a[192:195], v34 offset:40960
    ds_read_b128 a[196:199], v35 offset:40960
    v_mfma_f32_16x16x32_bf16 a[112:115], a[248:251], v[188:191], a[112:115]
    s_waitcnt lgkmcnt(2)
    v_exp_f32 v56, v136
    v_mfma_f32_16x16x32_bf16 a[112:115], a[252:255], v[204:207], a[112:115]
    ds_read_b128 a[200:203], v36 offset:40960
    ds_read_b128 a[204:207], v37 offset:40960
    v_mfma_f32_16x16x32_bf16 a[116:119], a[248:251], v[192:195], a[116:119]
    v_exp_f32 v57, v137
    v_mfma_f32_16x16x32_bf16 a[116:119], a[252:255], v[208:211], a[116:119]
    ds_read_b128 a[208:211], v34 offset:45056
    ds_read_b128 a[212:215], v35 offset:45056
    v_mfma_f32_16x16x32_bf16 a[120:123], a[248:251], v[196:199], a[120:123]
    v_exp_f32 v58, v138
    v_mfma_f32_16x16x32_bf16 a[120:123], a[252:255], v[212:215], a[120:123]
    ds_read_b128 a[216:219], v36 offset:45056
    ds_read_b128 a[220:223], v37 offset:45056
    v_mfma_f32_16x16x32_bf16 a[124:127], a[248:251], v[200:203], a[124:127]
    v_exp_f32 v59, v139
    v_mfma_f32_16x16x32_bf16 a[124:127], a[252:255], v[216:219], a[124:127]
    v_cvt_pk_bf16_f32 v185, v54, v55
    v_cvt_pk_bf16_f32 v186, v56, v57
    v_mfma_f32_16x16x32_bf16 v[232:235], v[236:239], v[200:203], v[232:235]
    v_mfma_f32_16x16x32_bf16 v[232:235], v[236:239], v[216:219], v[232:235]
    s_waitcnt lgkmcnt(7)
    v_cvt_pk_bf16_f32 v187, v58, v59
    v_mfma_f32_16x16x32_bf16 v[108:111], a[192:195], a[128:131], v[140:143]
    s_waitcnt lgkmcnt(6)
    v_exp_f32 v52, v76
    v_mfma_f32_16x16x32_bf16 v[108:111], a[196:199], a[132:135], v[108:111]
    s_waitcnt lgkmcnt(5)
    ds_read_b64_tr_b16 a[224:225], v38 offset:49152
    ds_read_b64_tr_b16 a[226:227], v38 offset:53248
    ds_read_b64_tr_b16 a[254:255], v41 offset:61440
    v_mfma_f32_16x16x32_bf16 v[108:111], a[200:203], a[136:139], v[108:111]
    s_waitcnt lgkmcnt(7)
    v_exp_f32 v53, v77
    v_mfma_f32_16x16x32_bf16 v[108:111], a[204:207], a[140:143], v[108:111]
    ds_read_b64_tr_b16 a[228:229], v38 offset:57344
    v_add_f32 v48, v48, v52
    v_mfma_f32_16x16x32_bf16 v[112:115], a[192:195], a[144:147], v[144:147]
    v_exp_f32 v54, v78
    v_mfma_f32_16x16x32_bf16 v[112:115], a[196:199], a[148:151], v[112:115]
    buffer_load_dwordx4 v47, s[28:31], s47 offen offset:3072 lds
    v_mfma_f32_16x16x32_bf16 v[112:115], a[200:203], a[152:155], v[112:115]
    v_exp_f32 v55, v79
    v_mfma_f32_16x16x32_bf16 v[112:115], a[204:207], a[156:159], v[112:115]
    v_add_f32 v48, v48, v53
    v_cvt_pk_bf16_f32 v188, v52, v53
    v_mfma_f32_16x16x32_bf16 v[116:119], a[192:195], a[160:163], v[148:151]
    v_exp_f32 v56, v92
    v_mfma_f32_16x16x32_bf16 v[116:119], a[196:199], a[164:167], v[116:119]
    v_add_f32 v48, v48, v54
    v_add_f32 v48, v48, v55
    v_mfma_f32_16x16x32_bf16 v[116:119], a[200:203], a[168:171], v[116:119]
    v_exp_f32 v57, v93
    v_mfma_f32_16x16x32_bf16 v[116:119], a[204:207], a[172:175], v[116:119]
    v_cvt_pk_bf16_f32 v189, v54, v55
    v_add_f32 v48, v48, v56
    v_mfma_f32_16x16x32_bf16 v[120:123], a[192:195], a[176:179], v[152:155]
    v_exp_f32 v58, v94
    v_mfma_f32_16x16x32_bf16 v[120:123], a[196:199], a[180:183], v[120:123]
    v_add_f32 v48, v48, v57
    v_cvt_pk_bf16_f32 v190, v56, v57
    v_mfma_f32_16x16x32_bf16 v[120:123], a[200:203], a[184:187], v[120:123]
    s_add_u32 m0, s50, 4096
    v_exp_f32 v59, v95
    v_mfma_f32_16x16x32_bf16 v[120:123], a[204:207], a[188:191], v[120:123]
    s_waitcnt lgkmcnt(7)
    buffer_load_dwordx4 v46, s[28:31], s48 offen offset:0 lds
    v_mfma_f32_16x16x32_bf16 v[124:127], a[208:211], a[128:131], v[140:143]
    s_waitcnt lgkmcnt(6)
    v_exp_f32 v52, v80
    v_mfma_f32_16x16x32_bf16 v[124:127], a[212:215], a[132:135], v[124:127]
    s_waitcnt lgkmcnt(5)
    ds_read_b64_tr_b16 a[230:231], v38 offset:61440
    v_add_f32 v48, v48, v58
    v_mfma_f32_16x16x32_bf16 v[124:127], a[216:219], a[136:139], v[124:127]
    s_waitcnt lgkmcnt(5)
    v_exp_f32 v53, v81
    v_mfma_f32_16x16x32_bf16 v[124:127], a[220:223], a[140:143], v[124:127]
    v_add_f32 v48, v48, v59
    v_cvt_pk_bf16_f32 v191, v58, v59
    v_mfma_f32_16x16x32_bf16 v[128:131], a[208:211], a[144:147], v[144:147]
    v_exp_f32 v54, v82
    v_mfma_f32_16x16x32_bf16 v[128:131], a[212:215], a[148:151], v[128:131]
    v_add_f32 v49, v49, v52
    v_add_f32 v49, v49, v53
    v_mfma_f32_16x16x32_bf16 v[128:131], a[216:219], a[152:155], v[128:131]
    v_exp_f32 v55, v83
    v_mfma_f32_16x16x32_bf16 v[128:131], a[220:223], a[156:159], v[128:131]
    ds_read_b64_tr_b16 a[232:233], v39 offset:49152
    v_cvt_pk_bf16_f32 v192, v52, v53
    v_mfma_f32_16x16x32_bf16 v[132:135], a[208:211], a[160:163], v[148:151]
    v_exp_f32 v56, v96
    v_mfma_f32_16x16x32_bf16 v[132:135], a[212:215], a[164:167], v[132:135]
    buffer_load_dwordx4 v47, s[28:31], s48 offen offset:1024 lds
    v_mfma_f32_16x16x32_bf16 v[132:135], a[216:219], a[168:171], v[132:135]
    v_exp_f32 v57, v97
    v_mfma_f32_16x16x32_bf16 v[132:135], a[220:223], a[172:175], v[132:135]
    ds_read_b64_tr_b16 a[234:235], v39 offset:53248
    v_add_f32 v49, v49, v54
    v_mfma_f32_16x16x32_bf16 v[136:139], a[208:211], a[176:179], v[152:155]
    v_exp_f32 v58, v98
    v_mfma_f32_16x16x32_bf16 v[136:139], a[212:215], a[180:183], v[136:139]
    ds_read_b64_tr_b16 a[236:237], v39 offset:57344
    ds_read_b64_tr_b16 a[238:239], v39 offset:61440
    v_mfma_f32_16x16x32_bf16 v[136:139], a[216:219], a[184:187], v[136:139]
    v_exp_f32 v59, v99
    v_mfma_f32_16x16x32_bf16 v[136:139], a[220:223], a[188:191], v[136:139]
    s_waitcnt lgkmcnt(7)
    v_add_f32 v49, v49, v55
    v_cvt_pk_bf16_f32 v193, v54, v55
    v_mfma_f32_16x16x32_bf16 a[0:3], a[224:227], v[156:159], a[0:3]
    s_waitcnt lgkmcnt(4)
    v_exp_f32 v52, v84
    v_mfma_f32_16x16x32_bf16 a[0:3], a[228:231], v[172:175], a[0:3]
    v_add_f32 v49, v49, v56
    v_add_f32 v49, v49, v57
    v_mfma_f32_16x16x32_bf16 a[4:7], a[224:227], v[160:163], a[4:7]
    v_exp_f32 v53, v85
    v_mfma_f32_16x16x32_bf16 a[4:7], a[228:231], v[176:179], a[4:7]
    buffer_load_dwordx4 v46, s[28:31], s48 offen offset:2048 lds
    v_mfma_f32_16x16x32_bf16 a[8:11], a[224:227], v[164:167], a[8:11]
    v_exp_f32 v54, v86
    v_mfma_f32_16x16x32_bf16 a[8:11], a[228:231], v[180:183], a[8:11]
    ds_read_b64_tr_b16 a[240:241], v40 offset:49152
    v_cvt_pk_bf16_f32 v194, v56, v57
    v_mfma_f32_16x16x32_bf16 a[12:15], a[224:227], v[168:171], a[12:15]
    v_exp_f32 v55, v87
    v_mfma_f32_16x16x32_bf16 a[12:15], a[228:231], v[184:187], a[12:15]
    s_waitcnt lgkmcnt(3)
    ds_read_b64_tr_b16 a[242:243], v40 offset:53248
    v_add_f32 v49, v49, v58
    v_mfma_f32_16x16x32_bf16 a[16:19], a[232:235], v[156:159], a[16:19]
    s_waitcnt lgkmcnt(2)
    v_exp_f32 v56, v100
    v_mfma_f32_16x16x32_bf16 a[16:19], a[236:239], v[172:175], a[16:19]
    ds_read_b64_tr_b16 a[244:245], v40 offset:57344
    ds_read_b64_tr_b16 a[246:247], v40 offset:61440
    v_mfma_f32_16x16x32_bf16 a[20:23], a[232:235], v[160:163], a[20:23]
    v_exp_f32 v57, v101
    v_mfma_f32_16x16x32_bf16 a[20:23], a[236:239], v[176:179], a[20:23]
    v_add_f32 v49, v49, v59
    v_cvt_pk_bf16_f32 v195, v58, v59
    v_mfma_f32_16x16x32_bf16 a[24:27], a[232:235], v[164:167], a[24:27]
    v_exp_f32 v58, v102
    v_mfma_f32_16x16x32_bf16 a[24:27], a[236:239], v[180:183], a[24:27]
    buffer_load_dwordx4 v47, s[28:31], s48 offen offset:3072 lds
    v_mfma_f32_16x16x32_bf16 a[28:31], a[232:235], v[168:171], a[28:31]
    v_exp_f32 v59, v103
    v_mfma_f32_16x16x32_bf16 a[28:31], a[236:239], v[184:187], a[28:31]
    s_waitcnt lgkmcnt(2)
    ds_read_b64_tr_b16 a[248:249], v41 offset:49152
    v_cvt_pk_bf16_f32 v196, v52, v53
    v_mfma_f32_16x16x32_bf16 a[32:35], a[240:243], v[156:159], a[32:35]
    s_waitcnt lgkmcnt(1)
    v_exp_f32 v52, v88
    v_mfma_f32_16x16x32_bf16 a[32:35], a[244:247], v[172:175], a[32:35]
    ds_read_b64_tr_b16 a[250:251], v41 offset:53248
    ds_read_b64_tr_b16 a[252:253], v41 offset:57344
    v_mfma_f32_16x16x32_bf16 a[36:39], a[240:243], v[160:163], a[36:39]
    v_exp_f32 v53, v89
    v_mfma_f32_16x16x32_bf16 a[36:39], a[244:247], v[176:179], a[36:39]
    v_cvt_pk_bf16_f32 v197, v54, v55
    v_cvt_pk_bf16_f32 v198, v56, v57
    v_mfma_f32_16x16x32_bf16 a[40:43], a[240:243], v[164:167], a[40:43]
    v_exp_f32 v54, v90
    v_mfma_f32_16x16x32_bf16 a[40:43], a[244:247], v[180:183], a[40:43]
    v_cvt_pk_bf16_f32 v199, v58, v59
    v_cvt_pk_bf16_f32 v200, v52, v53
    v_mfma_f32_16x16x32_bf16 a[44:47], a[240:243], v[168:171], a[44:47]
    v_exp_f32 v55, v91
    v_mfma_f32_16x16x32_bf16 a[44:47], a[244:247], v[184:187], a[44:47]
    s_waitcnt lgkmcnt(1)
    ds_read_b128 a[192:195], v34 offset:49152
    ds_read_b128 a[196:199], v35 offset:49152
    v_mfma_f32_16x16x32_bf16 a[48:51], a[248:251], v[156:159], a[48:51]
    s_waitcnt lgkmcnt(2)
    v_exp_f32 v56, v104
    v_mfma_f32_16x16x32_bf16 a[48:51], a[252:255], v[172:175], a[48:51]
    ds_read_b128 a[200:203], v36 offset:49152
    ds_read_b128 a[204:207], v37 offset:49152
    v_mfma_f32_16x16x32_bf16 a[52:55], a[248:251], v[160:163], a[52:55]
    v_exp_f32 v57, v105
    v_mfma_f32_16x16x32_bf16 a[52:55], a[252:255], v[176:179], a[52:55]
    ds_read_b128 a[208:211], v34 offset:53248
    ds_read_b128 a[212:215], v35 offset:53248
    v_mfma_f32_16x16x32_bf16 a[56:59], a[248:251], v[164:167], a[56:59]
    v_exp_f32 v58, v106
    v_mfma_f32_16x16x32_bf16 a[56:59], a[252:255], v[180:183], a[56:59]
    ds_read_b128 a[216:219], v36 offset:53248
    ds_read_b128 a[220:223], v37 offset:53248
    v_mfma_f32_16x16x32_bf16 a[60:63], a[248:251], v[168:171], a[60:63]
    v_exp_f32 v59, v107
    v_mfma_f32_16x16x32_bf16 a[60:63], a[252:255], v[184:187], a[60:63]
    v_cvt_pk_bf16_f32 v201, v54, v55
    v_cvt_pk_bf16_f32 v202, v56, v57
    v_mfma_f32_16x16x32_bf16 v[228:231], v[236:239], v[164:167], v[228:231]
    v_mfma_f32_16x16x32_bf16 v[228:231], v[236:239], v[180:183], v[228:231]
    s_waitcnt lgkmcnt(7)
    v_cvt_pk_bf16_f32 v203, v58, v59
    v_mfma_f32_16x16x32_bf16 v[76:79], a[192:195], a[128:131], v[140:143]
    s_waitcnt lgkmcnt(6)
    v_exp_f32 v52, v108
    v_mfma_f32_16x16x32_bf16 v[76:79], a[196:199], a[132:135], v[76:79]
    s_waitcnt lgkmcnt(5)
    ds_read_b64_tr_b16 a[224:225], v42 offset:49152
    ds_read_b64_tr_b16 a[226:227], v42 offset:53248
    v_mfma_f32_16x16x32_bf16 v[76:79], a[200:203], a[136:139], v[76:79]
    s_waitcnt lgkmcnt(6)
    v_exp_f32 v53, v109
    v_mfma_f32_16x16x32_bf16 v[76:79], a[204:207], a[140:143], v[76:79]
    ds_read_b64_tr_b16 a[228:229], v42 offset:57344
    v_add_f32 v48, v48, v52
    v_mfma_f32_16x16x32_bf16 v[80:83], a[192:195], a[144:147], v[144:147]
    v_exp_f32 v54, v110
    v_mfma_f32_16x16x32_bf16 v[80:83], a[196:199], a[148:151], v[80:83]
    v_add_f32 v48, v48, v53
    v_cvt_pk_bf16_f32 v204, v52, v53
    v_mfma_f32_16x16x32_bf16 v[80:83], a[200:203], a[152:155], v[80:83]
    v_exp_f32 v55, v111
    v_mfma_f32_16x16x32_bf16 v[80:83], a[204:207], a[156:159], v[80:83]
    ds_read_b64_tr_b16 a[230:231], v42 offset:61440
    v_add_f32 v48, v48, v54
    v_mfma_f32_16x16x32_bf16 v[84:87], a[192:195], a[160:163], v[148:151]
    v_exp_f32 v56, v124
    v_mfma_f32_16x16x32_bf16 v[84:87], a[196:199], a[164:167], v[84:87]
    v_add_f32 v48, v48, v55
    v_cvt_pk_bf16_f32 v205, v54, v55
    v_mfma_f32_16x16x32_bf16 v[84:87], a[200:203], a[168:171], v[84:87]
    v_exp_f32 v57, v125
    v_mfma_f32_16x16x32_bf16 v[84:87], a[204:207], a[172:175], v[84:87]
    ds_read_b64_tr_b16 a[232:233], v43 offset:49152
    v_add_f32 v48, v48, v56
    v_mfma_f32_16x16x32_bf16 v[88:91], a[192:195], a[176:179], v[152:155]
    v_exp_f32 v58, v126
    v_mfma_f32_16x16x32_bf16 v[88:91], a[196:199], a[180:183], v[88:91]
    v_add_f32 v48, v48, v57
    v_cvt_pk_bf16_f32 v206, v56, v57
    v_mfma_f32_16x16x32_bf16 v[88:91], a[200:203], a[184:187], v[88:91]
    v_exp_f32 v59, v127
    v_mfma_f32_16x16x32_bf16 v[88:91], a[204:207], a[188:191], v[88:91]
    s_waitcnt lgkmcnt(8)
    ds_read_b64_tr_b16 a[234:235], v43 offset:53248
    v_add_f32 v48, v48, v58
    v_mfma_f32_16x16x32_bf16 v[92:95], a[208:211], a[128:131], v[140:143]
    s_waitcnt lgkmcnt(8)
    v_exp_f32 v52, v112
    v_mfma_f32_16x16x32_bf16 v[92:95], a[212:215], a[132:135], v[92:95]
    s_waitcnt lgkmcnt(7)
    v_add_f32 v48, v48, v59
    v_cvt_pk_bf16_f32 v207, v58, v59
    v_mfma_f32_16x16x32_bf16 v[92:95], a[216:219], a[136:139], v[92:95]
    s_waitcnt lgkmcnt(6)
    v_exp_f32 v53, v113
    v_mfma_f32_16x16x32_bf16 v[92:95], a[220:223], a[140:143], v[92:95]
    ds_read_b64_tr_b16 a[236:237], v43 offset:57344
    v_add_f32 v49, v49, v52
    v_mfma_f32_16x16x32_bf16 v[96:99], a[208:211], a[144:147], v[144:147]
    v_exp_f32 v54, v114
    v_mfma_f32_16x16x32_bf16 v[96:99], a[212:215], a[148:151], v[96:99]
    v_add_f32 v49, v49, v53
    v_cvt_pk_bf16_f32 v208, v52, v53
    v_mfma_f32_16x16x32_bf16 v[96:99], a[216:219], a[152:155], v[96:99]
    v_exp_f32 v55, v115
    v_mfma_f32_16x16x32_bf16 v[96:99], a[220:223], a[156:159], v[96:99]
    ds_read_b64_tr_b16 a[238:239], v43 offset:61440
    v_add_f32 v49, v49, v54
    v_mfma_f32_16x16x32_bf16 v[100:103], a[208:211], a[160:163], v[148:151]
    v_exp_f32 v56, v128
    v_mfma_f32_16x16x32_bf16 v[100:103], a[212:215], a[164:167], v[100:103]
    v_add_f32 v49, v49, v55
    v_cvt_pk_bf16_f32 v209, v54, v55
    v_mfma_f32_16x16x32_bf16 v[100:103], a[216:219], a[168:171], v[100:103]
    v_exp_f32 v57, v129
    v_mfma_f32_16x16x32_bf16 v[100:103], a[220:223], a[172:175], v[100:103]
    ds_read_b64_tr_b16 a[240:241], v44 offset:49152
    v_add_f32 v49, v49, v56
    v_mfma_f32_16x16x32_bf16 v[104:107], a[208:211], a[176:179], v[152:155]
    v_exp_f32 v58, v130
    v_mfma_f32_16x16x32_bf16 v[104:107], a[212:215], a[180:183], v[104:107]
    v_add_f32 v49, v49, v57
    v_cvt_pk_bf16_f32 v210, v56, v57
    v_mfma_f32_16x16x32_bf16 v[104:107], a[216:219], a[184:187], v[104:107]
    v_exp_f32 v59, v131
    v_mfma_f32_16x16x32_bf16 v[104:107], a[220:223], a[188:191], v[104:107]
    s_waitcnt lgkmcnt(7)
    ds_read_b64_tr_b16 a[242:243], v44 offset:53248
    v_add_f32 v49, v49, v58
    v_mfma_f32_16x16x32_bf16 a[64:67], a[224:227], v[156:159], a[64:67]
    s_waitcnt lgkmcnt(6)
    v_exp_f32 v52, v116
    v_mfma_f32_16x16x32_bf16 a[64:67], a[228:231], v[172:175], a[64:67]
    ds_read_b64_tr_b16 a[244:245], v44 offset:57344
    ds_read_b64_tr_b16 a[246:247], v44 offset:61440
    v_mfma_f32_16x16x32_bf16 a[68:71], a[224:227], v[160:163], a[68:71]
    v_exp_f32 v53, v117
    v_mfma_f32_16x16x32_bf16 a[68:71], a[228:231], v[176:179], a[68:71]
    v_add_f32 v49, v49, v59
    v_cvt_pk_bf16_f32 v211, v58, v59
    v_mfma_f32_16x16x32_bf16 a[72:75], a[224:227], v[164:167], a[72:75]
    v_exp_f32 v54, v118
    v_mfma_f32_16x16x32_bf16 a[72:75], a[228:231], v[180:183], a[72:75]
    ds_read_b64_tr_b16 a[248:249], v45 offset:49152
    v_cvt_pk_bf16_f32 v212, v52, v53
    v_mfma_f32_16x16x32_bf16 a[76:79], a[224:227], v[168:171], a[76:79]
    v_exp_f32 v55, v119
    v_mfma_f32_16x16x32_bf16 a[76:79], a[228:231], v[184:187], a[76:79]
    s_waitcnt lgkmcnt(7)
    ds_read_b64_tr_b16 a[250:251], v45 offset:53248
    ds_read_b64_tr_b16 a[252:253], v45 offset:57344
    v_mfma_f32_16x16x32_bf16 a[80:83], a[232:235], v[156:159], a[80:83]
    s_waitcnt lgkmcnt(7)
    v_exp_f32 v56, v132
    v_mfma_f32_16x16x32_bf16 a[80:83], a[236:239], v[172:175], a[80:83]
    ds_read_b64_tr_b16 a[254:255], v45 offset:61440
    v_cvt_pk_bf16_f32 v213, v54, v55
    v_mfma_f32_16x16x32_bf16 a[84:87], a[232:235], v[160:163], a[84:87]
    v_exp_f32 v57, v133
    v_mfma_f32_16x16x32_bf16 a[84:87], a[236:239], v[176:179], a[84:87]
    ds_read_b128 a[192:195], v34 offset:57344
    ds_read_b128 a[196:199], v35 offset:57344
    v_mfma_f32_16x16x32_bf16 a[88:91], a[232:235], v[164:167], a[88:91]
    v_exp_f32 v58, v134
    v_mfma_f32_16x16x32_bf16 a[88:91], a[236:239], v[180:183], a[88:91]
    ds_read_b128 a[200:203], v36 offset:57344
    v_cvt_pk_bf16_f32 v214, v56, v57
    v_mfma_f32_16x16x32_bf16 a[92:95], a[232:235], v[168:171], a[92:95]
    v_exp_f32 v59, v135
    v_mfma_f32_16x16x32_bf16 a[92:95], a[236:239], v[184:187], a[92:95]
    s_waitcnt lgkmcnt(9)
    ds_read_b128 a[204:207], v37 offset:57344
    ds_read_b128 a[208:211], v34 offset:61440
    v_mfma_f32_16x16x32_bf16 a[96:99], a[240:243], v[156:159], a[96:99]
    s_waitcnt lgkmcnt(9)
    v_exp_f32 v52, v120
    v_mfma_f32_16x16x32_bf16 a[96:99], a[244:247], v[172:175], a[96:99]
    ds_read_b128 a[212:215], v35 offset:61440
    v_cvt_pk_bf16_f32 v215, v58, v59
    v_mfma_f32_16x16x32_bf16 a[100:103], a[240:243], v[160:163], a[100:103]
    v_exp_f32 v53, v121
    v_mfma_f32_16x16x32_bf16 a[100:103], a[244:247], v[176:179], a[100:103]
    ds_read_b128 a[216:219], v36 offset:61440
    ds_read_b128 a[220:223], v37 offset:61440
    v_mfma_f32_16x16x32_bf16 a[104:107], a[240:243], v[164:167], a[104:107]
    v_exp_f32 v54, v122
    v_mfma_f32_16x16x32_bf16 a[104:107], a[244:247], v[180:183], a[104:107]
    v_cvt_pk_bf16_f32 v216, v52, v53
    v_mfma_f32_16x16x32_bf16 a[108:111], a[240:243], v[168:171], a[108:111]
    v_exp_f32 v55, v123
    v_mfma_f32_16x16x32_bf16 a[108:111], a[244:247], v[184:187], a[108:111]
    s_waitcnt lgkmcnt(10)
    v_mfma_f32_16x16x32_bf16 a[112:115], a[248:251], v[156:159], a[112:115]
    s_waitcnt lgkmcnt(8)
    v_exp_f32 v56, v136
    v_mfma_f32_16x16x32_bf16 a[112:115], a[252:255], v[172:175], a[112:115]
    v_cvt_pk_bf16_f32 v217, v54, v55
    v_mfma_f32_16x16x32_bf16 a[116:119], a[248:251], v[160:163], a[116:119]
    v_exp_f32 v57, v137
    v_mfma_f32_16x16x32_bf16 a[116:119], a[252:255], v[176:179], a[116:119]
    v_mfma_f32_16x16x32_bf16 a[120:123], a[248:251], v[164:167], a[120:123]
    v_exp_f32 v58, v138
    v_mfma_f32_16x16x32_bf16 a[120:123], a[252:255], v[180:183], a[120:123]
    v_cvt_pk_bf16_f32 v218, v56, v57
    v_mfma_f32_16x16x32_bf16 a[124:127], a[248:251], v[168:171], a[124:127]
    v_exp_f32 v59, v139
    v_mfma_f32_16x16x32_bf16 a[124:127], a[252:255], v[184:187], a[124:127]
    v_mfma_f32_16x16x32_bf16 v[232:235], v[236:239], v[168:171], v[232:235]
    v_mfma_f32_16x16x32_bf16 v[232:235], v[236:239], v[184:187], v[232:235]
    s_waitcnt lgkmcnt(7)
    v_cvt_pk_bf16_f32 v219, v58, v59
    s_add_u32 s45, s45, 0x8000
    s_add_u32 s46, s46, 0x8000
    s_add_u32 s47, s47, 0x8000
    s_add_u32 s48, s48, 0x8000
    s_xor_b32 s49, s49, 0x8000
    s_xor_b32 s50, s50, 0x8000
    s_add_u32 s51, s51, 1
    s_waitcnt vmcnt(0)
    s_barrier
    s_cmp_eq_u32 s51, 12
    s_cbranch_scc0 KF_nopf
    s_getpc_b64 s[96:97]
KF_pc_t:
    s_add_u32 s96, s96, KF_tailcode-KF_pc_t
    s_addc_u32 s97, s97, 0
    s_lshr_b32 s98, s2, 3
    s_lshl_b32 s98, s98, 12
    v_lshlrev_b32 v2, 4, v0
    v_add_u32 v2, s98, v2
    v_min_u32 v2, KF_codeend-KF_tailcode-16, v2
    global_load_dwordx4 v[240:243], v2, s[96:97]
    s_lshr_b32 s54, s71, 1
    s_lshl_b32 s54, s54, 2
    s_add_u32 s54, s54, 32
    v_mov_b32 v244, s54
    buffer_load_dword v245, v244, s[72:75], 0 offen sc1
    v_subrev_u32 v246, 32, v244
    buffer_load_dword v247, v246, s[72:75], 0 offen sc1
KF_nopf:
    v_mfma_f32_16x16x32_bf16 v[108:111], a[192:195], a[128:131], v[140:143]
    s_waitcnt lgkmcnt(6)
    v_exp_f32 v52, v76
    v_mfma_f32_16x16x32_bf16 v[108:111], a[196:199], a[132:135], v[108:111]
    s_waitcnt lgkmcnt(5)
    ds_read_b64_tr_b16 a[224:225], v38 offset:0
    ds_read_b64_tr_b16 a[226:227], v38 offset:4096
    ds_read_b64_tr_b16 a[254:255], v41 offset:12288
    v_mfma_f32_16x16x32_bf16 v[108:111], a[200:203], a[136:139], v[108:111]
    s_waitcnt lgkmcnt(7)
    v_exp_f32 v53, v77
    v_mfma_f32_16x16x32_bf16 v[108:111], a[204:207], a[140:143], v[108:111]
    ds_read_b64_tr_b16 a[228:229], v38 offset:8192
    v_add_f32 v48, v48, v52
    v_mfma_f32_16x16x32_bf16 v[112:115], a[192:195], a[144:147], v[144:147]
    s_mov_b32 m0, s49
    v_exp_f32 v54, v78
    v_mfma_f32_16x16x32_bf16 v[112:115], a[196:199], a[148:151], v[112:115]
    buffer_load_dwordx4 v46, s[24:27], s45 offen offset:0 lds
    v_mfma_f32_16x16x32_bf16 v[112:115], a[200:203], a[152:155], v[112:115]
    v_exp_f32 v55, v79
    v_mfma_f32_16x16x32_bf16 v[112:115], a[204:207], a[156:159], v[112:115]
    v_add_f32 v48, v48, v53
    v_cvt_pk_bf16_f32 v156, v52, v53
    v_mfma_f32_16x16x32_bf16 v[116:119], a[192:195], a[160:163], v[148:151]
    v_exp_f32 v56, v92
    v_mfma_f32_16x16x32_bf16 v[116:119], a[196:199], a[164:167], v[116:119]
    v_add_f32 v48, v48, v54
    v_add_f32 v48, v48, v55
    v_mfma_f32_16x16x32_bf16 v[116:119], a[200:203], a[168:171], v[116:119]
    v_exp_f32 v57, v93
    v_mfma_f32_16x16x32_bf16 v[116:119], a[204:207], a[172:175], v[116:119]
    v_cvt_pk_bf16_f32 v157, v54, v55
    v_add_f32 v48, v48, v56
    v_mfma_f32_16x16x32_bf16 v[120:123], a[192:195], a[176:179], v[152:155]
    v_exp_f32 v58, v94
    v_mfma_f32_16x16x32_bf16 v[120:123], a[196:199], a[180:183], v[120:123]
    v_add_f32 v48, v48, v57
    v_cvt_pk_bf16_f32 v158, v56, v57
    v_mfma_f32_16x16x32_bf16 v[120:123], a[200:203], a[184:187], v[120:123]
    v_exp_f32 v59, v95
    v_mfma_f32_16x16x32_bf16 v[120:123], a[204:207], a[188:191], v[120:123]
    s_waitcnt lgkmcnt(7)
    buffer_load_dwordx4 v47, s[24:27], s45 offen offset:1024 lds
    v_mfma_f32_16x16x32_bf16 v[124:127], a[208:211], a[128:131], v[140:143]
    s_waitcnt lgkmcnt(6)
    v_exp_f32 v52, v80
    v_mfma_f32_16x16x32_bf16 v[124:127], a[212:215], a[132:135], v[124:127]
    s_waitcnt lgkmcnt(5)
    ds_read_b64_tr_b16 a[230:231], v38 offset:12288
    v_add_f32 v48, v48, v58
    v_mfma_f32_16x16x32_bf16 v[124:127], a[216:219], a[136:139], v[124:127]
    s_waitcnt lgkmcnt(5)
    v_exp_f32 v53, v81
    v_mfma_f32_16x16x32_bf16 v[124:127], a[220:223], a[140:143], v[124:127]
    v_add_f32 v48, v48, v59
    v_cvt_pk_bf16_f32 v159, v58, v59
    v_mfma_f32_16x16x32_bf16 v[128:131], a[208:211], a[144:147], v[144:147]
    v_exp_f32 v54, v82
    v_mfma_f32_16x16x32_bf16 v[128:131], a[212:215], a[148:151], v[128:131]
    v_add_f32 v49, v49, v52
    v_add_f32 v49, v49, v53
    v_mfma_f32_16x16x32_bf16 v[128:131], a[216:219], a[152:155], v[128:131]
    v_exp_f32 v55, v83
    v_mfma_f32_16x16x32_bf16 v[128:131], a[220:223], a[156:159], v[128:131]
    ds_read_b64_tr_b16 a[232:233], v39 offset:0
    v_cvt_pk_bf16_f32 v160, v52, v53
    v_mfma_f32_16x16x32_bf16 v[132:135], a[208:211], a[160:163], v[148:151]
    v_exp_f32 v56, v96
    v_mfma_f32_16x16x32_bf16 v[132:135], a[212:215], a[164:167], v[132:135]
    buffer_load_dwordx4 v46, s[24:27], s45 offen offset:2048 lds
    v_mfma_f32_16x16x32_bf16 v[132:135], a[216:219], a[168:171], v[132:135]
    v_exp_f32 v57, v97
    v_mfma_f32_16x16x32_bf16 v[132:135], a[220:223], a[172:175], v[132:135]
    ds_read_b64_tr_b16 a[234:235], v39 offset:4096
    v_add_f32 v49, v49, v54
    v_mfma_f32_16x16x32_bf16 v[136:139], a[208:211], a[176:179], v[152:155]
    v_exp_f32 v58, v98
    v_mfma_f32_16x16x32_bf16 v[136:139], a[212:215], a[180:183], v[136:139]
    ds_read_b64_tr_b16 a[236:237], v39 offset:8192
    ds_read_b64_tr_b16 a[238:239], v39 offset:12288
    v_mfma_f32_16x16x32_bf16 v[136:139], a[216:219], a[184:187], v[136:139]
    v_exp_f32 v59, v99
    v_mfma_f32_16x16x32_bf16 v[136:139], a[220:223], a[188:191], v[136:139]
    s_waitcnt lgkmcnt(7)
    v_add_f32 v49, v49, v55
    v_cvt_pk_bf16_f32 v161, v54, v55
    v_mfma_f32_16x16x32_bf16 a[0:3], a[224:227], v[188:191], a[0:3]
    s_waitcnt lgkmcnt(4)
    v_exp_f32 v52, v84
    v_mfma_f32_16x16x32_bf16 a[0:3], a[228:231], v[204:207], a[0:3]
    v_add_f32 v49, v49, v56
    v_add_f32 v49, v49, v57
    v_mfma_f32_16x16x32_bf16 a[4:7], a[224:227], v[192:195], a[4:7]
    v_exp_f32 v53, v85
    v_mfma_f32_16x16x32_bf16 a[4:7], a[228:231], v[208:211], a[4:7]
    buffer_load_dwordx4 v47, s[24:27], s45 offen offset:3072 lds
    v_mfma_f32_16x16x32_bf16 a[8:11], a[224:227], v[196:199], a[8:11]
    v_exp_f32 v54, v86
    v_mfma_f32_16x16x32_bf16 a[8:11], a[228:231], v[212:215], a[8:11]
    ds_read_b64_tr_b16 a[240:241], v40 offset:0
    v_cvt_pk_bf16_f32 v162, v56, v57
    v_mfma_f32_16x16x32_bf16 a[12:15], a[224:227], v[200:203], a[12:15]
    v_exp_f32 v55, v87
    v_mfma_f32_16x16x32_bf16 a[12:15], a[228:231], v[216:219], a[12:15]
    s_waitcnt lgkmcnt(3)
    ds_read_b64_tr_b16 a[242:243], v40 offset:4096
    v_add_f32 v49, v49, v58
    v_mfma_f32_16x16x32_bf16 a[16:19], a[232:235], v[188:191], a[16:19]
    s_waitcnt lgkmcnt(2)
    v_exp_f32 v56, v100
    v_mfma_f32_16x16x32_bf16 a[16:19], a[236:239], v[204:207], a[16:19]
    ds_read_b64_tr_b16 a[244:245], v40 offset:8192
    ds_read_b64_tr_b16 a[246:247], v40 offset:12288
    v_mfma_f32_16x16x32_bf16 a[20:23], a[232:235], v[192:195], a[20:23]
    v_exp_f32 v57, v101
    v_mfma_f32_16x16x32_bf16 a[20:23], a[236:239], v[208:211], a[20:23]
    v_add_f32 v49, v49, v59
    v_cvt_pk_bf16_f32 v163, v58, v59
    v_mfma_f32_16x16x32_bf16 a[24:27], a[232:235], v[196:199], a[24:27]
    s_add_u32 m0, s49, 4096
    v_exp_f32 v58, v102
    v_mfma_f32_16x16x32_bf16 a[24:27], a[236:239], v[212:215], a[24:27]
    buffer_load_dwordx4 v46, s[24:27], s46 offen offset:0 lds
    v_mfma_f32_16x16x32_bf16 a[28:31], a[232:235], v[200:203], a[28:31]
    v_exp_f32 v59, v103
    v_mfma_f32_16x16x32_bf16 a[28:31], a[236:239], v[216:219], a[28:31]
    s_waitcnt lgkmcnt(2)
    ds_read_b64_tr_b16 a[248:249], v41 offset:0
    v_cvt_pk_bf16_f32 v164, v52, v53
    v_mfma_f32_16x16x32_bf16 a[32:35], a[240:243], v[188:191], a[32:35]
    s_waitcnt lgkmcnt(1)
    v_exp_f32 v52, v88
    v_mfma_f32_16x16x32_bf16 a[32:35], a[244:247], v[204:207], a[32:35]
    ds_read_b64_tr_b16 a[250:251], v41 offset:4096
    ds_read_b64_tr_b16 a[252:253], v41 offset:8192
    v_mfma_f32_16x16x32_bf16 a[36:39], a[240:243], v[192:195], a[36:39]
    v_exp_f32 v53, v89
    v_mfma_f32_16x16x32_bf16 a[36:39], a[244:247], v[208:211], a[36:39]
    v_cvt_pk_bf16_f32 v165, v54, v55
    v_cvt_pk_bf16_f32 v166, v56, v57
    v_mfma_f32_16x16x32_bf16 a[40:43], a[240:243], v[196:199], a[40:43]
    v_exp_f32 v54, v90
    v_mfma_f32_16x16x32_bf16 a[40:43], a[244:247], v[212:215], a[40:43]
    v_cvt_pk_bf16_f32 v167, v58, v59
    v_cvt_pk_bf16_f32 v168, v52, v53
    v_mfma_f32_16x16x32_bf16 a[44:47], a[240:243], v[200:203], a[44:47]
    v_exp_f32 v55, v91
    v_mfma_f32_16x16x32_bf16 a[44:47], a[244:247], v[216:219], a[44:47]
    s_waitcnt lgkmcnt(1)
    buffer_load_dwordx4 v47, s[24:27], s46 offen offset:1024 lds
    v_mfma_f32_16x16x32_bf16 a[48:51], a[248:251], v[188:191], a[48:51]
    s_waitcnt lgkmcnt(0)
    v_exp_f32 v56, v104
    v_mfma_f32_16x16x32_bf16 a[48:51], a[252:255], v[204:207], a[48:51]
    ds_read_b128 a[192:195], v34 offset:0
    ds_read_b128 a[196:199], v35 offset:0
    v_mfma_f32_16x16x32_bf16 a[52:55], a[248:251], v[192:195], a[52:55]
    v_exp_f32 v57, v105
    v_mfma_f32_16x16x32_bf16 a[52:55], a[252:255], v[208:211], a[52:55]
    ds_read_b128 a[200:203], v36 offset:0
    ds_read_b128 a[204:207], v37 offset:0
    v_mfma_f32_16x16x32_bf16 a[56:59], a[248:251], v[196:199], a[56:59]
    v_exp_f32 v58, v106
    v_mfma_f32_16x16x32_bf16 a[56:59], a[252:255], v[212:215], a[56:59]
    ds_read_b128 a[208:211], v34 offset:4096
    ds_read_b128 a[212:215], v35 offset:4096
    v_mfma_f32_16x16x32_bf16 a[60:63], a[248:251], v[200:203], a[60:63]
    v_exp_f32 v59, v107
    v_mfma_f32_16x16x32_bf16 a[60:63], a[252:255], v[216:219], a[60:63]
    ds_read_b128 a[216:219], v36 offset:4096
    ds_read_b128 a[220:223], v37 offset:4096
    v_mfma_f32_16x16x32_bf16 v[228:231], v[236:239], v[196:199], v[228:231]
    v_cvt_pk_bf16_f32 v169, v54, v55
    v_cvt_pk_bf16_f32 v170, v56, v57
    v_mfma_f32_16x16x32_bf16 v[228:231], v[236:239], v[212:215], v[228:231]
    s_waitcnt lgkmcnt(7)
    v_cvt_pk_bf16_f32 v171, v58, v59
    v_mfma_f32_16x16x32_bf16 v[76:79], a[192:195], a[128:131], v[140:143]
    s_waitcnt lgkmcnt(6)
    v_exp_f32 v52, v108
    v_mfma_f32_16x16x32_bf16 v[76:79], a[196:199], a[132:135], v[76:79]
    s_waitcnt lgkmcnt(5)
    ds_read_b64_tr_b16 a[224:225], v42 offset:0
    ds_read_b64_tr_b16 a[226:227], v42 offset:4096
    ds_read_b64_tr_b16 a[254:255], v45 offset:12288
    v_mfma_f32_16x16x32_bf16 v[76:79], a[200:203], a[136:139], v[76:79]
    s_waitcnt lgkmcnt(7)
    v_exp_f32 v53, v109
    v_mfma_f32_16x16x32_bf16 v[76:79], a[204:207], a[140:143], v[76:79]
    ds_read_b64_tr_b16 a[228:229], v42 offset:8192
    v_add_f32 v48, v48, v52
    v_mfma_f32_16x16x32_bf16 v[80:83], a[192:195], a[144:147], v[144:147]
    v_exp_f32 v54, v110
    v_mfma_f32_16x16x32_bf16 v[80:83], a[196:199], a[148:151], v[80:83]
    buffer_load_dwordx4 v46, s[24:27], s46 offen offset:2048 lds
    v_mfma_f32_16x16x32_bf16 v[80:83], a[200:203], a[152:155], v[80:83]
    v_exp_f32 v55, v111
    v_mfma_f32_16x16x32_bf16 v[80:83], a[204:207], a[156:159], v[80:83]
    v_add_f32 v48, v48, v53
    v_cvt_pk_bf16_f32 v172, v52, v53
    v_mfma_f32_16x16x32_bf16 v[84:87], a[192:195], a[160:163], v[148:151]
    v_exp_f32 v56, v124
    v_mfma_f32_16x16x32_bf16 v[84:87], a[196:199], a[164:167], v[84:87]
    v_add_f32 v48, v48, v54
    v_add_f32 v48, v48, v55
    v_mfma_f32_16x16x32_bf16 v[84:87], a[200:203], a[168:171], v[84:87]
    v_exp_f32 v57, v125
    v_mfma_f32_16x16x32_bf16 v[84:87], a[204:207], a[172:175], v[84:87]
    v_cvt_pk_bf16_f32 v173, v54, v55
    v_add_f32 v48, v48, v56
    v_mfma_f32_16x16x32_bf16 v[88:91], a[192:195], a[176:179], v[152:155]
    v_exp_f32 v58, v126
    v_mfma_f32_16x16x32_bf16 v[88:91], a[196:199], a[180:183], v[88:91]
    v_add_f32 v48, v48, v57
    v_cvt_pk_bf16_f32 v174, v56, v57
    v_mfma_f32_16x16x32_bf16 v[88:91], a[200:203], a[184:187], v[88:91]
    v_exp_f32 v59, v127
    v_mfma_f32_16x16x32_bf16 v[88:91], a[204:207], a[188:191], v[88:91]
    s_waitcnt lgkmcnt(7)
    buffer_load_dwordx4 v47, s[24:27], s46 offen offset:3072 lds
    v_mfma_f32_16x16x32_bf16 v[92:95], a[208:211], a[128:131], v[140:143]
    s_waitcnt lgkmcnt(6)
    v_exp_f32 v52, v112
    v_mfma_f32_16x16x32_bf16 v[92:95], a[212:215], a[132:135], v[92:95]
    s_waitcnt lgkmcnt(5)
    ds_read_b64_tr_b16 a[230:231], v42 offset:12288
    v_add_f32 v48, v48, v58
    v_mfma_f32_16x16x32_bf16 v[92:95], a[216:219], a[136:139], v[92:95]
    s_waitcnt lgkmcnt(5)
    v_exp_f32 v53, v113
    v_mfma_f32_16x16x32_bf16 v[92:95], a[220:223], a[140:143], v[92:95]
    v_add_f32 v48, v48, v59
    v_cvt_pk_bf16_f32 v175, v58, v59
    v_mfma_f32_16x16x32_bf16 v[96:99], a[208:211], a[144:147], v[144:147]
    v_exp_f32 v54, v114
    v_mfma_f32_16x16x32_bf16 v[96:99], a[212:215], a[148:151], v[96:99]
    v_add_f32 v49, v49, v52
    v_add_f32 v49, v49, v53
    v_mfma_f32_16x16x32_bf16 v[96:99], a[216:219], a[152:155], v[96:99]
    v_exp_f32 v55, v115
    v_mfma_f32_16x16x32_bf16 v[96:99], a[220:223], a[156:159], v[96:99]
    ds_read_b64_tr_b16 a[232:233], v43 offset:0
    v_cvt_pk_bf16_f32 v176, v52, v53
    v_mfma_f32_16x16x32_bf16 v[100:103], a[208:211], a[160:163], v[148:151]
    s_mov_b32 m0, s50
    v_exp_f32 v56, v128
    v_mfma_f32_16x16x32_bf16 v[100:103], a[212:215], a[164:167], v[100:103]
    buffer_load_dwordx4 v46, s[28:31], s47 offen offset:0 lds
    v_mfma_f32_16x16x32_bf16 v[100:103], a[216:219], a[168:171], v[100:103]
    v_exp_f32 v57, v129
    v_mfma_f32_16x16x32_bf16 v[100:103], a[220:223], a[172:175], v[100:103]
    ds_read_b64_tr_b16 a[234:235], v43 offset:4096
    v_add_f32 v49, v49, v54
    v_mfma_f32_16x16x32_bf16 v[104:107], a[208:211], a[176:179], v[152:155]
    v_exp_f32 v58, v130
    v_mfma_f32_16x16x32_bf16 v[104:107], a[212:215], a[180:183], v[104:107]
    ds_read_b64_tr_b16 a[236:237], v43 offset:8192
    ds_read_b64_tr_b16 a[238:239], v43 offset:12288
    v_mfma_f32_16x16x32_bf16 v[104:107], a[216:219], a[184:187], v[104:107]
    v_exp_f32 v59, v131
    v_mfma_f32_16x16x32_bf16 v[104:107], a[220:223], a[188:191], v[104:107]
    s_waitcnt lgkmcnt(7)
    v_add_f32 v49, v49, v55
    v_cvt_pk_bf16_f32 v177, v54, v55
    v_mfma_f32_16x16x32_bf16 a[64:67], a[224:227], v[188:191], a[64:67]
    s_waitcnt lgkmcnt(4)
    v_exp_f32 v52, v116
    v_mfma_f32_16x16x32_bf16 a[64:67], a[228:231], v[204:207], a[64:67]
    v_add_f32 v49, v49, v56
    v_add_f32 v49, v49, v57
    v_mfma_f32_16x16x32_bf16 a[68:71], a[224:227], v[192:195], a[68:71]
    v_exp_f32 v53, v117
    v_mfma_f32_16x16x32_bf16 a[68:71], a[228:231], v[208:211], a[68:71]
    buffer_load_dwordx4 v47, s[28:31], s47 offen offset:1024 lds
    v_mfma_f32_16x16x32_bf16 a[72:75], a[224:227], v[196:199], a[72:75]
    v_exp_f32 v54, v118
    v_mfma_f32_16x16x32_bf16 a[72:75], a[228:231], v[212:215], a[72:75]
    ds_read_b64_tr_b16 a[240:241], v44 offset:0
    v_cvt_pk_bf16_f32 v178, v56, v57
    v_mfma_f32_16x16x32_bf16 a[76:79], a[224:227], v[200:203], a[76:79]
    v_exp_f32 v55, v119
    v_mfma_f32_16x16x32_bf16 a[76:79], a[228:231], v[216:219], a[76:79]
    s_waitcnt lgkmcnt(3)
    ds_read_b64_tr_b16 a[242:243], v44 offset:4096
    v_add_f32 v49, v49, v58
    v_mfma_f32_16x16x32_bf16 a[80:83], a[232:235], v[188:191], a[80:83]
    s_waitcnt lgkmcnt(2)
    v_exp_f32 v56, v132
    v_mfma_f32_16x16x32_bf16 a[80:83], a[236:239], v[204:207], a[80:83]
    ds_read_b64_tr_b16 a[244:245], v44 offset:8192
    ds_read_b64_tr_b16 a[246:247], v44 offset:12288
    v_mfma_f32_16x16x32_bf16 a[84:87], a[232:235], v[192:195], a[84:87]
    v_exp_f32 v57, v133
    v_mfma_f32_16x16x32_bf16 a[84:87], a[236:239], v[208:211], a[84:87]
    v_add_f32 v49, v49, v59
    v_cvt_pk_bf16_f32 v179, v58, v59
    v_mfma_f32_16x16x32_bf16 a[88:91], a[232:235], v[196:199], a[88:91]
    v_exp_f32 v58, v134
    v_mfma_f32_16x16x32_bf16 a[88:91], a[236:239], v[212:215], a[88:91]
    buffer_load_dwordx4 v46, s[28:31], s47 offen offset:2048 lds
    v_mfma_f32_16x16x32_bf16 a[92:95], a[232:235], v[200:203], a[92:95]
    v_exp_f32 v59, v135
    v_mfma_f32_16x16x32_bf16 a[92:95], a[236:239], v[216:219], a[92:95]
    s_waitcnt lgkmcnt(2)
    ds_read_b64_tr_b16 a[248:249], v45 offset:0
    v_cvt_pk_bf16_f32 v180, v52, v53
    v_mfma_f32_16x16x32_bf16 a[96:99], a[240:243], v[188:191], a[96:99]
    s_waitcnt lgkmcnt(1)
    v_exp_f32 v52, v120
    v_mfma_f32_16x16x32_bf16 a[96:99], a[244:247], v[204:207], a[96:99]
    ds_read_b64_tr_b16 a[250:251], v45 offset:4096
    ds_read_b64_tr_b16 a[252:253], v45 offset:8192
    v_mfma_f32_16x16x32_bf16 a[100:103], a[240:243], v[192:195], a[100:103]
    v_exp_f32 v53, v121
    v_mfma_f32_16x16x32_bf16 a[100:103], a[244:247], v[208:211], a[100:103]
    v_cvt_pk_bf16_f32 v181, v54, v55
    v_cvt_pk_bf16_f32 v182, v56, v57
    v_mfma_f32_16x16x32_bf16 a[104:107], a[240:243], v[196:199], a[104:107]
    v_exp_f32 v54, v122
    v_mfma_f32_16x16x32_bf16 a[104:107], a[244:247], v[212:215], a[104:107]
    v_cvt_pk_bf16_f32 v183, v58, v59
    v_cvt_pk_bf16_f32 v184, v52, v53
    v_mfma_f32_16x16x32_bf16 a[108:111], a[240:243], v[200:203], a[108:111]
    v_exp_f32 v55, v123
    v_mfma_f32_16x16x32_bf16 a[108:111], a[244:247], v[216:219], a[108:111]
    s_waitcnt lgkmcnt(1)
    ds_read_b128 a[192:195], v34 offset:8192
    ds_read_b128 a[196:199], v35 offset:8192
    v_mfma_f32_16x16x32_bf16 a[112:115], a[248:251], v[188:191], a[112:115]
    s_waitcnt lgkmcnt(2)
    v_exp_f32 v56, v136
    v_mfma_f32_16x16x32_bf16 a[112:115], a[252:255], v[204:207], a[112:115]
    ds_read_b128 a[200:203], v36 offset:8192
    ds_read_b128 a[204:207], v37 offset:8192
    v_mfma_f32_16x16x32_bf16 a[116:119], a[248:251], v[192:195], a[116:119]
    v_exp_f32 v57, v137
    v_mfma_f32_16x16x32_bf16 a[116:119], a[252:255], v[208:211], a[116:119]
    ds_read_b128 a[208:211], v34 offset:12288
    ds_read_b128 a[212:215], v35 offset:12288
    v_mfma_f32_16x16x32_bf16 a[120:123], a[248:251], v[196:199], a[120:123]
    v_exp_f32 v58, v138
    v_mfma_f32_16x16x32_bf16 a[120:123], a[252:255], v[212:215], a[120:123]
    ds_read_b128 a[216:219], v36 offset:12288
    ds_read_b128 a[220:223], v37 offset:12288
    v_mfma_f32_16x16x32_bf16 a[124:127], a[248:251], v[200:203], a[124:127]
    v_exp_f32 v59, v139
    v_mfma_f32_16x16x32_bf16 a[124:127], a[252:255], v[216:219], a[124:127]
    v_cvt_pk_bf16_f32 v185, v54, v55
    v_cvt_pk_bf16_f32 v186, v56, v57
    v_mfma_f32_16x16x32_bf16 v[232:235], v[236:239], v[200:203], v[232:235]
    v_mfma_f32_16x16x32_bf16 v[232:235], v[236:239], v[216:219], v[232:235]
    s_waitcnt lgkmcnt(7)
    v_cvt_pk_bf16_f32 v187, v58, v59
    v_mfma_f32_16x16x32_bf16 v[108:111], a[192:195], a[128:131], v[140:143]
    s_waitcnt lgkmcnt(6)
    v_exp_f32 v52, v76
    v_mfma_f32_16x16x32_bf16 v[108:111], a[196:199], a[132:135], v[108:111]
    s_waitcnt lgkmcnt(5)
    ds_read_b64_tr_b16 a[224:225], v38 offset:16384
    ds_read_b64_tr_b16 a[226:227], v38 offset:20480
    ds_read_b64_tr_b16 a[254:255], v41 offset:28672
    v_mfma_f32_16x16x32_bf16 v[108:111], a[200:203], a[136:139], v[108:111]
    s_waitcnt lgkmcnt(7)
    v_exp_f32 v53, v77
    v_mfma_f32_16x16x32_bf16 v[108:111], a[204:207], a[140:143], v[108:111]
    ds_read_b64_tr_b16 a[228:229], v38 offset:24576
    v_add_f32 v48, v48, v52
    v_mfma_f32_16x16x32_bf16 v[112:115], a[192:195], a[144:147], v[144:147]
    v_exp_f32 v54, v78
    v_mfma_f32_16x16x32_bf16 v[112:115], a[196:199], a[148:151], v[112:115]
    buffer_load_dwordx4 v47, s[28:31], s47 offen offset:3072 lds
    v_mfma_f32_16x16x32_bf16 v[112:115], a[200:203], a[152:155], v[112:115]
    v_exp_f32 v55, v79
    v_mfma_f32_16x16x32_bf16 v[112:115], a[204:207], a[156:159], v[112:115]
    v_add_f32 v48, v48, v53
    v_cvt_pk_bf16_f32 v188, v52, v53
    v_mfma_f32_16x16x32_bf16 v[116:119], a[192:195], a[160:163], v[148:151]
    v_exp_f32 v56, v92
    v_mfma_f32_16x16x32_bf16 v[116:119], a[196:199], a[164:167], v[116:119]
    v_add_f32 v48, v48, v54
    v_add_f32 v48, v48, v55
    v_mfma_f32_16x16x32_bf16 v[116:119], a[200:203], a[168:171], v[116:119]
    v_exp_f32 v57, v93
    v_mfma_f32_16x16x32_bf16 v[116:119], a[204:207], a[172:175], v[116:119]
    v_cvt_pk_bf16_f32 v189, v54, v55
    v_add_f32 v48, v48, v56
    v_mfma_f32_16x16x32_bf16 v[120:123], a[192:195], a[176:179], v[152:155]
    v_exp_f32 v58, v94
    v_mfma_f32_16x16x32_bf16 v[120:123], a[196:199], a[180:183], v[120:123]
    v_add_f32 v48, v48, v57
    v_cvt_pk_bf16_f32 v190, v56, v57
    v_mfma_f32_16x16x32_bf16 v[120:123], a[200:203], a[184:187], v[120:123]
    s_add_u32 m0, s50, 4096
    v_exp_f32 v59, v95
    v_mfma_f32_16x16x32_bf16 v[120:123], a[204:207], a[188:191], v[120:123]
    s_waitcnt lgkmcnt(7)
    buffer_load_dwordx4 v46, s[28:31], s48 offen offset:0 lds
    v_mfma_f32_16x16x32_bf16 v[124:127], a[208:211], a[128:131], v[140:143]
    s_waitcnt lgkmcnt(6)
    v_exp_f32 v52, v80
    v_mfma_f32_16x16x32_bf16 v[124:127], a[212:215], a[132:135], v[124:127]
    s_waitcnt lgkmcnt(5)
    ds_read_b64_tr_b16 a[230:231], v38 offset:28672
    v_add_f32 v48, v48, v58
    v_mfma_f32_16x16x32_bf16 v[124:127], a[216:219], a[136:139], v[124:127]
    s_waitcnt lgkmcnt(5)
    v_exp_f32 v53, v81
    v_mfma_f32_16x16x32_bf16 v[124:127], a[220:223], a[140:143], v[124:127]
    v_add_f32 v48, v48, v59
    v_cvt_pk_bf16_f32 v191, v58, v59
    v_mfma_f32_16x16x32_bf16 v[128:131], a[208:211], a[144:147], v[144:147]
    v_exp_f32 v54, v82
    v_mfma_f32_16x16x32_bf16 v[128:131], a[212:215], a[148:151], v[128:131]
    v_add_f32 v49, v49, v52
    v_add_f32 v49, v49, v53
    v_mfma_f32_16x16x32_bf16 v[128:131], a[216:219], a[152:155], v[128:131]
    v_exp_f32 v55, v83
    v_mfma_f32_16x16x32_bf16 v[128:131], a[220:223], a[156:159], v[128:131]
    ds_read_b64_tr_b16 a[232:233], v39 offset:16384
    v_cvt_pk_bf16_f32 v192, v52, v53
    v_mfma_f32_16x16x32_bf16 v[132:135], a[208:211], a[160:163], v[148:151]
    v_exp_f32 v56, v96
    v_mfma_f32_16x16x32_bf16 v[132:135], a[212:215], a[164:167], v[132:135]
    buffer_load_dwordx4 v47, s[28:31], s48 offen offset:1024 lds
    v_mfma_f32_16x16x32_bf16 v[132:135], a[216:219], a[168:171], v[132:135]
    v_exp_f32 v57, v97
    v_mfma_f32_16x16x32_bf16 v[132:135], a[220:223], a[172:175], v[132:135]
    ds_read_b64_tr_b16 a[234:235], v39 offset:20480
    v_add_f32 v49, v49, v54
    v_mfma_f32_16x16x32_bf16 v[136:139], a[208:211], a[176:179], v[152:155]
    v_exp_f32 v58, v98
    v_mfma_f32_16x16x32_bf16 v[136:139], a[212:215], a[180:183], v[136:139]
    ds_read_b64_tr_b16 a[236:237], v39 offset:24576
    ds_read_b64_tr_b16 a[238:239], v39 offset:28672
    v_mfma_f32_16x16x32_bf16 v[136:139], a[216:219], a[184:187], v[136:139]
    v_exp_f32 v59, v99
    v_mfma_f32_16x16x32_bf16 v[136:139], a[220:223], a[188:191], v[136:139]
    s_waitcnt lgkmcnt(7)
    v_add_f32 v49, v49, v55
    v_cvt_pk_bf16_f32 v193, v54, v55
    v_mfma_f32_16x16x32_bf16 a[0:3], a[224:227], v[156:159], a[0:3]
    s_waitcnt lgkmcnt(4)
    v_exp_f32 v52, v84
    v_mfma_f32_16x16x32_bf16 a[0:3], a[228:231], v[172:175], a[0:3]
    v_add_f32 v49, v49, v56
    v_add_f32 v49, v49, v57
    v_mfma_f32_16x16x32_bf16 a[4:7], a[224:227], v[160:163], a[4:7]
    v_exp_f32 v53, v85
    v_mfma_f32_16x16x32_bf16 a[4:7], a[228:231], v[176:179], a[4:7]
    buffer_load_dwordx4 v46, s[28:31], s48 offen offset:2048 lds
    v_mfma_f32_16x16x32_bf16 a[8:11], a[224:227], v[164:167], a[8:11]
    v_exp_f32 v54, v86
    v_mfma_f32_16x16x32_bf16 a[8:11], a[228:231], v[180:183], a[8:11]
    ds_read_b64_tr_b16 a[240:241], v40 offset:16384
    v_cvt_pk_bf16_f32 v194, v56, v57
    v_mfma_f32_16x16x32_bf16 a[12:15], a[224:227], v[168:171], a[12:15]
    v_exp_f32 v55, v87
    v_mfma_f32_16x16x32_bf16 a[12:15], a[228:231], v[184:187], a[12:15]
    s_waitcnt lgkmcnt(3)
    ds_read_b64_tr_b16 a[242:243], v40 offset:20480
    v_add_f32 v49, v49, v58
    v_mfma_f32_16x16x32_bf16 a[16:19], a[232:235], v[156:159], a[16:19]
    s_waitcnt lgkmcnt(2)
    v_exp_f32 v56, v100
    v_mfma_f32_16x16x32_bf16 a[16:19], a[236:239], v[172:175], a[16:19]
    ds_read_b64_tr_b16 a[244:245], v40 offset:24576
    ds_read_b64_tr_b16 a[246:247], v40 offset:28672
    v_mfma_f32_16x16x32_bf16 a[20:23], a[232:235], v[160:163], a[20:23]
    v_exp_f32 v57, v101
    v_mfma_f32_16x16x32_bf16 a[20:23], a[236:239], v[176:179], a[20:23]
    v_add_f32 v49, v49, v59
    v_cvt_pk_bf16_f32 v195, v58, v59
    v_mfma_f32_16x16x32_bf16 a[24:27], a[232:235], v[164:167], a[24:27]
    v_exp_f32 v58, v102
    v_mfma_f32_16x16x32_bf16 a[24:27], a[236:239], v[180:183], a[24:27]
    buffer_load_dwordx4 v47, s[28:31], s48 offen offset:3072 lds
    v_mfma_f32_16x16x32_bf16 a[28:31], a[232:235], v[168:171], a[28:31]
    v_exp_f32 v59, v103
    v_mfma_f32_16x16x32_bf16 a[28:31], a[236:239], v[184:187], a[28:31]
    s_waitcnt lgkmcnt(2)
    ds_read_b64_tr_b16 a[248:249], v41 offset:16384
    v_cvt_pk_bf16_f32 v196, v52, v53
    v_mfma_f32_16x16x32_bf16 a[32:35], a[240:243], v[156:159], a[32:35]
    s_waitcnt lgkmcnt(1)
    v_exp_f32 v52, v88
    v_mfma_f32_16x16x32_bf16 a[32:35], a[244:247], v[172:175], a[32:35]
    ds_read_b64_tr_b16 a[250:251], v41 offset:20480
    ds_read_b64_tr_b16 a[252:253], v41 offset:24576
    v_mfma_f32_16x16x32_bf16 a[36:39], a[240:243], v[160:163], a[36:39]
    v_exp_f32 v53, v89
    v_mfma_f32_16x16x32_bf16 a[36:39], a[244:247], v[176:179], a[36:39]
    v_cvt_pk_bf16_f32 v197, v54, v55
    v_cvt_pk_bf16_f32 v198, v56, v57
    v_mfma_f32_16x16x32_bf16 a[40:43], a[240:243], v[164:167], a[40:43]
    v_exp_f32 v54, v90
    v_mfma_f32_16x16x32_bf16 a[40:43], a[244:247], v[180:183], a[40:43]
    v_cvt_pk_bf16_f32 v199, v58, v59
    v_cvt_pk_bf16_f32 v200, v52, v53
    v_mfma_f32_16x16x32_bf16 a[44:47], a[240:243], v[168:171], a[44:47]
    v_exp_f32 v55, v91
    v_mfma_f32_16x16x32_bf16 a[44:47], a[244:247], v[184:187], a[44:47]
    s_waitcnt lgkmcnt(1)
    ds_read_b128 a[192:195], v34 offset:16384
    ds_read_b128 a[196:199], v35 offset:16384
    v_mfma_f32_16x16x32_bf16 a[48:51], a[248:251], v[156:159], a[48:51]
    s_waitcnt lgkmcnt(2)
    v_exp_f32 v56, v104
    v_mfma_f32_16x16x32_bf16 a[48:51], a[252:255], v[172:175], a[48:51]
    ds_read_b128 a[200:203], v36 offset:16384
    ds_read_b128 a[204:207], v37 offset:16384
    v_mfma_f32_16x16x32_bf16 a[52:55], a[248:251], v[160:163], a[52:55]
    v_exp_f32 v57, v105
    v_mfma_f32_16x16x32_bf16 a[52:55], a[252:255], v[176:179], a[52:55]
    ds_read_b128 a[208:211], v34 offset:20480
    ds_read_b128 a[212:215], v35 offset:20480
    v_mfma_f32_16x16x32_bf16 a[56:59], a[248:251], v[164:167], a[56:59]
    v_exp_f32 v58, v106
    v_mfma_f32_16x16x32_bf16 a[56:59], a[252:255], v[180:183], a[56:59]
    ds_read_b128 a[216:219], v36 offset:20480
    ds_read_b128 a[220:223], v37 offset:20480
    v_mfma_f32_16x16x32_bf16 a[60:63], a[248:251], v[168:171], a[60:63]
    v_exp_f32 v59, v107
    v_mfma_f32_16x16x32_bf16 a[60:63], a[252:255], v[184:187], a[60:63]
    v_cvt_pk_bf16_f32 v201, v54, v55
    v_cvt_pk_bf16_f32 v202, v56, v57
    v_mfma_f32_16x16x32_bf16 v[228:231], v[236:239], v[164:167], v[228:231]
    v_mfma_f32_16x16x32_bf16 v[228:231], v[236:239], v[180:183], v[228:231]
    s_waitcnt lgkmcnt(7)
    v_cvt_pk_bf16_f32 v203, v58, v59
    v_mfma_f32_16x16x32_bf16 v[76:79], a[192:195], a[128:131], v[140:143]
    s_waitcnt lgkmcnt(6)
    v_exp_f32 v52, v108
    v_mfma_f32_16x16x32_bf16 v[76:79], a[196:199], a[132:135], v[76:79]
    s_waitcnt lgkmcnt(5)
    ds_read_b64_tr_b16 a[224:225], v42 offset:16384
    ds_read_b64_tr_b16 a[226:227], v42 offset:20480
    v_mfma_f32_16x16x32_bf16 v[76:79], a[200:203], a[136:139], v[76:79]
    s_waitcnt lgkmcnt(6)
    v_exp_f32 v53, v109
    v_mfma_f32_16x16x32_bf16 v[76:79], a[204:207], a[140:143], v[76:79]
    ds_read_b64_tr_b16 a[228:229], v42 offset:24576
    v_add_f32 v48, v48, v52
    v_mfma_f32_16x16x32_bf16 v[80:83], a[192:195], a[144:147], v[144:147]
    v_exp_f32 v54, v110
    v_mfma_f32_16x16x32_bf16 v[80:83], a[196:199], a[148:151], v[80:83]
    v_add_f32 v48, v48, v53
    v_cvt_pk_bf16_f32 v204, v52, v53
    v_mfma_f32_16x16x32_bf16 v[80:83], a[200:203], a[152:155], v[80:83]
    v_exp_f32 v55, v111
    v_mfma_f32_16x16x32_bf16 v[80:83], a[204:207], a[156:159], v[80:83]
    ds_read_b64_tr_b16 a[230:231], v42 offset:28672
    v_add_f32 v48, v48, v54
    v_mfma_f32_16x16x32_bf16 v[84:87], a[192:195], a[160:163], v[148:151]
    v_exp_f32 v56, v124
    v_mfma_f32_16x16x32_bf16 v[84:87], a[196:199], a[164:167], v[84:87]
    v_add_f32 v48, v48, v55
    v_cvt_pk_bf16_f32 v205, v54, v55
    v_mfma_f32_16x16x32_bf16 v[84:87], a[200:203], a[168:171], v[84:87]
    v_exp_f32 v57, v125
    v_mfma_f32_16x16x32_bf16 v[84:87], a[204:207], a[172:175], v[84:87]
    ds_read_b64_tr_b16 a[232:233], v43 offset:16384
    v_add_f32 v48, v48, v56
    v_mfma_f32_16x16x32_bf16 v[88:91], a[192:195], a[176:179], v[152:155]
    v_exp_f32 v58, v126
    v_mfma_f32_16x16x32_bf16 v[88:91], a[196:199], a[180:183], v[88:91]
    v_add_f32 v48, v48, v57
    v_cvt_pk_bf16_f32 v206, v56, v57
    v_mfma_f32_16x16x32_bf16 v[88:91], a[200:203], a[184:187], v[88:91]
    v_exp_f32 v59, v127
    v_mfma_f32_16x16x32_bf16 v[88:91], a[204:207], a[188:191], v[88:91]
    s_waitcnt lgkmcnt(8)
    ds_read_b64_tr_b16 a[234:235], v43 offset:20480
    v_add_f32 v48, v48, v58
    v_mfma_f32_16x16x32_bf16 v[92:95], a[208:211], a[128:131], v[140:143]
    s_waitcnt lgkmcnt(8)
    v_exp_f32 v52, v112
    v_mfma_f32_16x16x32_bf16 v[92:95], a[212:215], a[132:135], v[92:95]
    s_waitcnt lgkmcnt(7)
    v_add_f32 v48, v48, v59
    v_cvt_pk_bf16_f32 v207, v58, v59
    v_mfma_f32_16x16x32_bf16 v[92:95], a[216:219], a[136:139], v[92:95]
    s_waitcnt lgkmcnt(6)
    v_exp_f32 v53, v113
    v_mfma_f32_16x16x32_bf16 v[92:95], a[220:223], a[140:143], v[92:95]
    ds_read_b64_tr_b16 a[236:237], v43 offset:24576
    v_add_f32 v49, v49, v52
    v_mfma_f32_16x16x32_bf16 v[96:99], a[208:211], a[144:147], v[144:147]
    v_exp_f32 v54, v114
    v_mfma_f32_16x16x32_bf16 v[96:99], a[212:215], a[148:151], v[96:99]
    v_add_f32 v49, v49, v53
    v_cvt_pk_bf16_f32 v208, v52, v53
    v_mfma_f32_16x16x32_bf16 v[96:99], a[216:219], a[152:155], v[96:99]
    v_exp_f32 v55, v115
    v_mfma_f32_16x16x32_bf16 v[96:99], a[220:223], a[156:159], v[96:99]
    ds_read_b64_tr_b16 a[238:239], v43 offset:28672
    v_add_f32 v49, v49, v54
    v_mfma_f32_16x16x32_bf16 v[100:103], a[208:211], a[160:163], v[148:151]
    v_exp_f32 v56, v128
    v_mfma_f32_16x16x32_bf16 v[100:103], a[212:215], a[164:167], v[100:103]
    v_add_f32 v49, v49, v55
    v_cvt_pk_bf16_f32 v209, v54, v55
    v_mfma_f32_16x16x32_bf16 v[100:103], a[216:219], a[168:171], v[100:103]
    v_exp_f32 v57, v129
    v_mfma_f32_16x16x32_bf16 v[100:103], a[220:223], a[172:175], v[100:103]
    ds_read_b64_tr_b16 a[240:241], v44 offset:16384
    v_add_f32 v49, v49, v56
    v_mfma_f32_16x16x32_bf16 v[104:107], a[208:211], a[176:179], v[152:155]
    v_exp_f32 v58, v130
    v_mfma_f32_16x16x32_bf16 v[104:107], a[212:215], a[180:183], v[104:107]
    v_add_f32 v49, v49, v57
    v_cvt_pk_bf16_f32 v210, v56, v57
    v_mfma_f32_16x16x32_bf16 v[104:107], a[216:219], a[184:187], v[104:107]
    v_exp_f32 v59, v131
    v_mfma_f32_16x16x32_bf16 v[104:107], a[220:223], a[188:191], v[104:107]
    s_waitcnt lgkmcnt(7)
    ds_read_b64_tr_b16 a[242:243], v44 offset:20480
    v_add_f32 v49, v49, v58
    v_mfma_f32_16x16x32_bf16 a[64:67], a[224:227], v[156:159], a[64:67]
    s_waitcnt lgkmcnt(6)
    v_exp_f32 v52, v116
    v_mfma_f32_16x16x32_bf16 a[64:67], a[228:231], v[172:175], a[64:67]
    ds_read_b64_tr_b16 a[244:245], v44 offset:24576
    ds_read_b64_tr_b16 a[246:247], v44 offset:28672
    v_mfma_f32_16x16x32_bf16 a[68:71], a[224:227], v[160:163], a[68:71]
    v_exp_f32 v53, v117
    v_mfma_f32_16x16x32_bf16 a[68:71], a[228:231], v[176:179], a[68:71]
    v_add_f32 v49, v49, v59
    v_cvt_pk_bf16_f32 v211, v58, v59
    v_mfma_f32_16x16x32_bf16 a[72:75], a[224:227], v[164:167], a[72:75]
    v_exp_f32 v54, v118
    v_mfma_f32_16x16x32_bf16 a[72:75], a[228:231], v[180:183], a[72:75]
    ds_read_b64_tr_b16 a[248:249], v45 offset:16384
    v_cvt_pk_bf16_f32 v212, v52, v53
    v_mfma_f32_16x16x32_bf16 a[76:79], a[224:227], v[168:171], a[76:79]
    v_exp_f32 v55, v119
    v_mfma_f32_16x16x32_bf16 a[76:79], a[228:231], v[184:187], a[76:79]
    s_waitcnt lgkmcnt(7)
    ds_read_b64_tr_b16 a[250:251], v45 offset:20480
    ds_read_b64_tr_b16 a[252:253], v45 offset:24576
    v_mfma_f32_16x16x32_bf16 a[80:83], a[232:235], v[156:159], a[80:83]
    s_waitcnt lgkmcnt(7)
    v_exp_f32 v56, v132
    v_mfma_f32_16x16x32_bf16 a[80:83], a[236:239], v[172:175], a[80:83]
    ds_read_b64_tr_b16 a[254:255], v45 offset:28672
    v_cvt_pk_bf16_f32 v213, v54, v55
    v_mfma_f32_16x16x32_bf16 a[84:87], a[232:235], v[160:163], a[84:87]
    v_exp_f32 v57, v133
    v_mfma_f32_16x16x32_bf16 a[84:87], a[236:239], v[176:179], a[84:87]
    ds_read_b128 a[192:195], v34 offset:24576
    ds_read_b128 a[196:199], v35 offset:24576
    v_mfma_f32_16x16x32_bf16 a[88:91], a[232:235], v[164:167], a[88:91]
    v_exp_f32 v58, v134
    v_mfma_f32_16x16x32_bf16 a[88:91], a[236:239], v[180:183], a[88:91]
    ds_read_b128 a[200:203], v36 offset:24576
    v_cvt_pk_bf16_f32 v214, v56, v57
    v_mfma_f32_16x16x32_bf16 a[92:95], a[232:235], v[168:171], a[92:95]
    v_exp_f32 v59, v135
    v_mfma_f32_16x16x32_bf16 a[92:95], a[236:239], v[184:187], a[92:95]
    s_waitcnt lgkmcnt(9)
    ds_read_b128 a[204:207], v37 offset:24576
    ds_read_b128 a[208:211], v34 offset:28672
    v_mfma_f32_16x16x32_bf16 a[96:99], a[240:243], v[156:159], a[96:99]
    s_waitcnt lgkmcnt(9)
    v_exp_f32 v52, v120
    v_mfma_f32_16x16x32_bf16 a[96:99], a[244:247], v[172:175], a[96:99]
    ds_read_b128 a[212:215], v35 offset:28672
    v_cvt_pk_bf16_f32 v215, v58, v59
    v_mfma_f32_16x16x32_bf16 a[100:103], a[240:243], v[160:163], a[100:103]
    v_exp_f32 v53, v121
    v_mfma_f32_16x16x32_bf16 a[100:103], a[244:247], v[176:179], a[100:103]
    ds_read_b128 a[216:219], v36 offset:28672
    ds_read_b128 a[220:223], v37 offset:28672
    v_mfma_f32_16x16x32_bf16 a[104:107], a[240:243], v[164:167], a[104:107]
    v_exp_f32 v54, v122
    v_mfma_f32_16x16x32_bf16 a[104:107], a[244:247], v[180:183], a[104:107]
    v_cvt_pk_bf16_f32 v216, v52, v53
    v_mfma_f32_16x16x32_bf16 a[108:111], a[240:243], v[168:171], a[108:111]
    v_exp_f32 v55, v123
    v_mfma_f32_16x16x32_bf16 a[108:111], a[244:247], v[184:187], a[108:111]
    s_waitcnt lgkmcnt(10)
    v_mfma_f32_16x16x32_bf16 a[112:115], a[248:251], v[156:159], a[112:115]
    s_waitcnt lgkmcnt(8)
    v_exp_f32 v56, v136
    v_mfma_f32_16x16x32_bf16 a[112:115], a[252:255], v[172:175], a[112:115]
    v_cvt_pk_bf16_f32 v217, v54, v55
    v_mfma_f32_16x16x32_bf16 a[116:119], a[248:251], v[160:163], a[116:119]
    v_exp_f32 v57, v137
    v_mfma_f32_16x16x32_bf16 a[116:119], a[252:255], v[176:179], a[116:119]
    v_mfma_f32_16x16x32_bf16 a[120:123], a[248:251], v[164:167], a[120:123]
    v_exp_f32 v58, v138
    v_mfma_f32_16x16x32_bf16 a[120:123], a[252:255], v[180:183], a[120:123]
    v_cvt_pk_bf16_f32 v218, v56, v57
    v_mfma_f32_16x16x32_bf16 a[124:127], a[248:251], v[168:171], a[124:127]
    v_exp_f32 v59, v139
    v_mfma_f32_16x16x32_bf16 a[124:127], a[252:255], v[184:187], a[124:127]
    v_mfma_f32_16x16x32_bf16 v[232:235], v[236:239], v[168:171], v[232:235]
    v_mfma_f32_16x16x32_bf16 v[232:235], v[236:239], v[184:187], v[232:235]
    s_waitcnt lgkmcnt(7)
    v_cvt_pk_bf16_f32 v219, v58, v59
    s_add_u32 s45, s45, 0x8000
    s_add_u32 s46, s46, 0x8000
    s_add_u32 s47, s47, 0x8000
    s_add_u32 s48, s48, 0x8000
    s_xor_b32 s49, s49, 0x8000
    s_xor_b32 s50, s50, 0x8000
    s_add_u32 s51, s51, 1
    s_waitcnt vmcnt(0)
    s_barrier
    s_cmp_lt_u32 s51, 15
    s_cbranch_scc1 KF_loop
KF_tailcode:
    s_waitcnt lgkmcnt(7)
    v_mfma_f32_16x16x32_bf16 v[108:111], a[192:195], a[128:131], v[140:143]
    s_waitcnt lgkmcnt(6)
    v_exp_f32 v52, v76
    v_mfma_f32_16x16x32_bf16 v[108:111], a[196:199], a[132:135], v[108:111]
    s_waitcnt lgkmcnt(5)
    ds_read_b64_tr_b16 a[224:225], v38 offset:32768
    ds_read_b64_tr_b16 a[226:227], v38 offset:36864
    ds_read_b64_tr_b16 a[254:255], v41 offset:45056
    v_mfma_f32_16x16x32_bf16 v[108:111], a[200:203], a[136:139], v[108:111]
    s_waitcnt lgkmcnt(7)
    v_exp_f32 v53, v77
    v_mfma_f32_16x16x32_bf16 v[108:111], a[204:207], a[140:143], v[108:111]
    ds_read_b64_tr_b16 a[228:229], v38 offset:40960
    v_add_f32 v48, v48, v52
    v_mfma_f32_16x16x32_bf16 v[112:115], a[192:195], a[144:147], v[144:147]
    s_mov_b32 m0, s50
    v_exp_f32 v54, v78
    v_mfma_f32_16x16x32_bf16 v[112:115], a[196:199], a[148:151], v[112:115]
    buffer_load_dwordx4 v46, s[28:31], s47 offen offset:0 lds
    v_mfma_f32_16x16x32_bf16 v[112:115], a[200:203], a[152:155], v[112:115]
    v_exp_f32 v55, v79
    v_mfma_f32_16x16x32_bf16 v[112:115], a[204:207], a[156:159], v[112:115]
    v_add_f32 v48, v48, v53
    v_cvt_pk_bf16_f32 v156, v52, v53
    v_mfma_f32_16x16x32_bf16 v[116:119], a[192:195], a[160:163], v[148:151]
    v_exp_f32 v56, v92
    v_mfma_f32_16x16x32_bf16 v[116:119], a[196:199], a[164:167], v[116:119]
    v_add_f32 v48, v48, v54
    v_add_f32 v48, v48, v55
    v_mfma_f32_16x16x32_bf16 v[116:119], a[200:203], a[168:171], v[116:119]
    v_exp_f32 v57, v93
    v_mfma_f32_16x16x32_bf16 v[116:119], a[204:207], a[172:175], v[116:119]
    v_cvt_pk_bf16_f32 v157, v54, v55
    v_add_f32 v48, v48, v56
    v_mfma_f32_16x16x32_bf16 v[120:123], a[192:195], a[176:179], v[152:155]
    v_exp_f32 v58, v94
    v_mfma_f32_16x16x32_bf16 v[120:123], a[196:199], a[180:183], v[120:123]
    v_add_f32 v48, v48, v57
    v_cvt_pk_bf16_f32 v158, v56, v57
    v_mfma_f32_16x16x32_bf16 v[120:123], a[200:203], a[184:187], v[120:123]
    v_exp_f32 v59, v95
    v_mfma_f32_16x16x32_bf16 v[120:123], a[204:207], a[188:191], v[120:123]
    s_waitcnt lgkmcnt(7)
    buffer_load_dwordx4 v47, s[28:31], s47 offen offset:1024 lds
    v_mfma_f32_16x16x32_bf16 v[124:127], a[208:211], a[128:131], v[140:143]
    s_waitcnt lgkmcnt(6)
    v_exp_f32 v52, v80
    v_mfma_f32_16x16x32_bf16 v[124:127], a[212:215], a[132:135], v[124:127]
    s_waitcnt lgkmcnt(5)
    ds_read_b64_tr_b16 a[230:231], v38 offset:45056
    v_add_f32 v48, v48, v58
    v_mfma_f32_16x16x32_bf16 v[124:127], a[216:219], a[136:139], v[124:127]
    s_waitcnt lgkmcnt(5)
    v_exp_f32 v53, v81
    v_mfma_f32_16x16x32_bf16 v[124:127], a[220:223], a[140:143], v[124:127]
    v_add_f32 v48, v48, v59
    v_cvt_pk_bf16_f32 v159, v58, v59
    v_mfma_f32_16x16x32_bf16 v[128:131], a[208:211], a[144:147], v[144:147]
    v_exp_f32 v54, v82
    v_mfma_f32_16x16x32_bf16 v[128:131], a[212:215], a[148:151], v[128:131]
    v_add_f32 v49, v49, v52
    v_add_f32 v49, v49, v53
    v_mfma_f32_16x16x32_bf16 v[128:131], a[216:219], a[152:155], v[128:131]
    v_exp_f32 v55, v83
    v_mfma_f32_16x16x32_bf16 v[128:131], a[220:223], a[156:159], v[128:131]
    ds_read_b64_tr_b16 a[232:233], v39 offset:32768
    v_cvt_pk_bf16_f32 v160, v52, v53
    v_mfma_f32_16x16x32_bf16 v[132:135], a[208:211], a[160:163], v[148:151]
    v_exp_f32 v56, v96
    v_mfma_f32_16x16x32_bf16 v[132:135], a[212:215], a[164:167], v[132:135]
    buffer_load_dwordx4 v46, s[28:31], s47 offen offset:2048 lds
    v_mfma_f32_16x16x32_bf16 v[132:135], a[216:219], a[168:171], v[132:135]
    v_exp_f32 v57, v97
    v_mfma_f32_16x16x32_bf16 v[132:135], a[220:223], a[172:175], v[132:135]
    ds_read_b64_tr_b16 a[234:235], v39 offset:36864
    v_add_f32 v49, v49, v54
    v_mfma_f32_16x16x32_bf16 v[136:139], a[208:211], a[176:179], v[152:155]
    v_exp_f32 v58, v98
    v_mfma_f32_16x16x32_bf16 v[136:139], a[212:215], a[180:183], v[136:139]
    ds_read_b64_tr_b16 a[236:237], v39 offset:40960
    ds_read_b64_tr_b16 a[238:239], v39 offset:45056
    v_mfma_f32_16x16x32_bf16 v[136:139], a[216:219], a[184:187], v[136:139]
    v_exp_f32 v59, v99
    v_mfma_f32_16x16x32_bf16 v[136:139], a[220:223], a[188:191], v[136:139]
    s_waitcnt lgkmcnt(7)
    v_add_f32 v49, v49, v55
    v_cvt_pk_bf16_f32 v161, v54, v55
    v_mfma_f32_16x16x32_bf16 a[0:3], a[224:227], v[188:191], a[0:3]
    s_waitcnt lgkmcnt(4)
    v_exp_f32 v52, v84
    v_mfma_f32_16x16x32_bf16 a[0:3], a[228:231], v[204:207], a[0:3]
    v_add_f32 v49, v49, v56
    v_add_f32 v49, v49, v57
    v_mfma_f32_16x16x32_bf16 a[4:7], a[224:227], v[192:195], a[4:7]
    v_exp_f32 v53, v85
    v_mfma_f32_16x16x32_bf16 a[4:7], a[228:231], v[208:211], a[4:7]
    buffer_load_dwordx4 v47, s[28:31], s47 offen offset:3072 lds
    v_mfma_f32_16x16x32_bf16 a[8:11], a[224:227], v[196:199], a[8:11]
    v_exp_f32 v54, v86
    v_mfma_f32_16x16x32_bf16 a[8:11], a[228:231], v[212:215], a[8:11]
    ds_read_b64_tr_b16 a[240:241], v40 offset:32768
    v_cvt_pk_bf16_f32 v162, v56, v57
    v_mfma_f32_16x16x32_bf16 a[12:15], a[224:227], v[200:203], a[12:15]
    v_exp_f32 v55, v87
    v_mfma_f32_16x16x32_bf16 a[12:15], a[228:231], v[216:219], a[12:15]
    s_waitcnt lgkmcnt(3)
    ds_read_b64_tr_b16 a[242:243], v40 offset:36864
    v_add_f32 v49, v49, v58
    v_mfma_f32_16x16x32_bf16 a[16:19], a[232:235], v[188:191], a[16:19]
    s_waitcnt lgkmcnt(2)
    v_exp_f32 v56, v100
    v_mfma_f32_16x16x32_bf16 a[16:19], a[236:239], v[204:207], a[16:19]
    ds_read_b64_tr_b16 a[244:245], v40 offset:40960
    ds_read_b64_tr_b16 a[246:247], v40 offset:45056
    v_mfma_f32_16x16x32_bf16 a[20:23], a[232:235], v[192:195], a[20:23]
    v_exp_f32 v57, v101
    v_mfma_f32_16x16x32_bf16 a[20:23], a[236:239], v[208:211], a[20:23]
    v_add_f32 v49, v49, v59
    v_cvt_pk_bf16_f32 v163, v58, v59
    v_mfma_f32_16x16x32_bf16 a[24:27], a[232:235], v[196:199], a[24:27]
    s_add_u32 m0, s50, 4096
    v_exp_f32 v58, v102
    v_mfma_f32_16x16x32_bf16 a[24:27], a[236:239], v[212:215], a[24:27]
    buffer_load_dwordx4 v46, s[28:31], s48 offen offset:0 lds
    v_mfma_f32_16x16x32_bf16 a[28:31], a[232:235], v[200:203], a[28:31]
    v_exp_f32 v59, v103
    v_mfma_f32_16x16x32_bf16 a[28:31], a[236:239], v[216:219], a[28:31]
    s_waitcnt lgkmcnt(2)
    ds_read_b64_tr_b16 a[248:249], v41 offset:32768
    v_cvt_pk_bf16_f32 v164, v52, v53
    v_mfma_f32_16x16x32_bf16 a[32:35], a[240:243], v[188:191], a[32:35]
    s_waitcnt lgkmcnt(1)
    v_exp_f32 v52, v88
    v_mfma_f32_16x16x32_bf16 a[32:35], a[244:247], v[204:207], a[32:35]
    ds_read_b64_tr_b16 a[250:251], v41 offset:36864
    ds_read_b64_tr_b16 a[252:253], v41 offset:40960
    v_mfma_f32_16x16x32_bf16 a[36:39], a[240:243], v[192:195], a[36:39]
    v_exp_f32 v53, v89
    v_mfma_f32_16x16x32_bf16 a[36:39], a[244:247], v[208:211], a[36:39]
    v_cvt_pk_bf16_f32 v165, v54, v55
    v_cvt_pk_bf16_f32 v166, v56, v57
    v_mfma_f32_16x16x32_bf16 a[40:43], a[240:243], v[196:199], a[40:43]
    v_exp_f32 v54, v90
    v_mfma_f32_16x16x32_bf16 a[40:43], a[244:247], v[212:215], a[40:43]
    v_cvt_pk_bf16_f32 v167, v58, v59
    v_cvt_pk_bf16_f32 v168, v52, v53
    v_mfma_f32_16x16x32_bf16 a[44:47], a[240:243], v[200:203], a[44:47]
    v_exp_f32 v55, v91
    v_mfma_f32_16x16x32_bf16 a[44:47], a[244:247], v[216:219], a[44:47]
    s_waitcnt lgkmcnt(1)
    buffer_load_dwordx4 v47, s[28:31], s48 offen offset:1024 lds
    v_mfma_f32_16x16x32_bf16 a[48:51], a[248:251], v[188:191], a[48:51]
    s_waitcnt lgkmcnt(0)
    v_exp_f32 v56, v104
    v_mfma_f32_16x16x32_bf16 a[48:51], a[252:255], v[204:207], a[48:51]
    ds_read_b128 a[192:195], v34 offset:32768
    ds_read_b128 a[196:199], v35 offset:32768
    v_mfma_f32_16x16x32_bf16 a[52:55], a[248:251], v[192:195], a[52:55]
    v_exp_f32 v57, v105
    v_mfma_f32_16x16x32_bf16 a[52:55], a[252:255], v[208:211], a[52:55]
    ds_read_b128 a[200:203], v36 offset:32768
    ds_read_b128 a[204:207], v37 offset:32768
    v_mfma_f32_16x16x32_bf16 a[56:59], a[248:251], v[196:199], a[56:59]
    v_exp_f32 v58, v106
    v_mfma_f32_16x16x32_bf16 a[56:59], a[252:255], v[212:215], a[56:59]
    ds_read_b128 a[208:211], v34 offset:36864
    ds_read_b128 a[212:215], v35 offset:36864
    v_mfma_f32_16x16x32_bf16 a[60:63], a[248:251], v[200:203], a[60:63]
    v_exp_f32 v59, v107
    v_mfma_f32_16x16x32_bf16 a[60:63], a[252:255], v[216:219], a[60:63]
    ds_read_b128 a[216:219], v36 offset:36864
    ds_read_b128 a[220:223], v37 offset:36864
    v_mfma_f32_16x16x32_bf16 v[228:231], v[236:239], v[196:199], v[228:231]
    v_cvt_pk_bf16_f32 v169, v54, v55
    v_cvt_pk_bf16_f32 v170, v56, v57
    v_mfma_f32_16x16x32_bf16 v[228:231], v[236:239], v[212:215], v[228:231]
    s_waitcnt lgkmcnt(7)
    v_cvt_pk_bf16_f32 v171, v58, v59
    v_mfma_f32_16x16x32_bf16 v[76:79], a[192:195], a[128:131], v[140:143]
    s_waitcnt lgkmcnt(6)
    v_exp_f32 v52, v108
    v_mfma_f32_16x16x32_bf16 v[76:79], a[196:199], a[132:135], v[76:79]
    s_waitcnt lgkmcnt(5)
    ds_read_b64_tr_b16 a[224:225], v42 offset:32768
    ds_read_b64_tr_b16 a[226:227], v42 offset:36864
    v_mfma_f32_16x16x32_bf16 v[76:79], a[200:203], a[136:139], v[76:79]
    s_waitcnt lgkmcnt(6)
    v_exp_f32 v53, v109
    v_mfma_f32_16x16x32_bf16 v[76:79], a[204:207], a[140:143], v[76:79]
    ds_read_b64_tr_b16 a[228:229], v42 offset:40960
    v_add_f32 v48, v48, v52
    v_mfma_f32_16x16x32_bf16 v[80:83], a[192:195], a[144:147], v[144:147]
    v_exp_f32 v54, v110
    v_mfma_f32_16x16x32_bf16 v[80:83], a[196:199], a[148:151], v[80:83]
    buffer_load_dwordx4 v46, s[28:31], s48 offen offset:2048 lds
    v_mfma_f32_16x16x32_bf16 v[80:83], a[200:203], a[152:155], v[80:83]
    v_exp_f32 v55, v111
    v_mfma_f32_16x16x32_bf16 v[80:83], a[204:207], a[156:159], v[80:83]
    v_add_f32 v48, v48, v53
    v_cvt_pk_bf16_f32 v172, v52, v53
    v_mfma_f32_16x16x32_bf16 v[84:87], a[192:195], a[160:163], v[148:151]
    v_exp_f32 v56, v124
    v_mfma_f32_16x16x32_bf16 v[84:87], a[196:199], a[164:167], v[84:87]
    v_add_f32 v48, v48, v54
    v_add_f32 v48, v48, v55
    v_mfma_f32_16x16x32_bf16 v[84:87], a[200:203], a[168:171], v[84:87]
    v_exp_f32 v57, v125
    v_mfma_f32_16x16x32_bf16 v[84:87], a[204:207], a[172:175], v[84:87]
    v_cvt_pk_bf16_f32 v173, v54, v55
    v_add_f32 v48, v48, v56
    v_mfma_f32_16x16x32_bf16 v[88:91], a[192:195], a[176:179], v[152:155]
    v_exp_f32 v58, v126
    v_mfma_f32_16x16x32_bf16 v[88:91], a[196:199], a[180:183], v[88:91]
    v_add_f32 v48, v48, v57
    v_cvt_pk_bf16_f32 v174, v56, v57
    v_mfma_f32_16x16x32_bf16 v[88:91], a[200:203], a[184:187], v[88:91]
    v_exp_f32 v59, v127
    v_mfma_f32_16x16x32_bf16 v[88:91], a[204:207], a[188:191], v[88:91]
    s_waitcnt lgkmcnt(6)
    buffer_load_dwordx4 v47, s[28:31], s48 offen offset:3072 lds
    v_mfma_f32_16x16x32_bf16 v[92:95], a[208:211], a[128:131], v[140:143]
    s_waitcnt lgkmcnt(5)
    v_exp_f32 v52, v112
    v_mfma_f32_16x16x32_bf16 v[92:95], a[212:215], a[132:135], v[92:95]
    s_waitcnt lgkmcnt(4)
    ds_read_b64_tr_b16 a[230:231], v42 offset:45056
    v_add_f32 v48, v48, v58
    v_mfma_f32_16x16x32_bf16 v[92:95], a[216:219], a[136:139], v[92:95]
    s_waitcnt lgkmcnt(4)
    v_exp_f32 v53, v113
    v_mfma_f32_16x16x32_bf16 v[92:95], a[220:223], a[140:143], v[92:95]
    v_add_f32 v48, v48, v59
    v_cvt_pk_bf16_f32 v175, v58, v59
    v_mfma_f32_16x16x32_bf16 v[96:99], a[208:211], a[144:147], v[144:147]
    v_exp_f32 v54, v114
    v_mfma_f32_16x16x32_bf16 v[96:99], a[212:215], a[148:151], v[96:99]
    v_add_f32 v49, v49, v52
    v_add_f32 v49, v49, v53
    v_mfma_f32_16x16x32_bf16 v[96:99], a[216:219], a[152:155], v[96:99]
    v_exp_f32 v55, v115
    v_mfma_f32_16x16x32_bf16 v[96:99], a[220:223], a[156:159], v[96:99]
    ds_read_b64_tr_b16 a[232:233], v43 offset:32768
    v_cvt_pk_bf16_f32 v176, v52, v53
    v_mfma_f32_16x16x32_bf16 v[100:103], a[208:211], a[160:163], v[148:151]
    v_exp_f32 v56, v128
    v_mfma_f32_16x16x32_bf16 v[100:103], a[212:215], a[164:167], v[100:103]
    ds_read_b64_tr_b16 a[234:235], v43 offset:36864
    v_add_f32 v49, v49, v54
    v_mfma_f32_16x16x32_bf16 v[100:103], a[216:219], a[168:171], v[100:103]
    v_exp_f32 v57, v129
    v_mfma_f32_16x16x32_bf16 v[100:103], a[220:223], a[172:175], v[100:103]
    ds_read_b64_tr_b16 a[236:237], v43 offset:40960
    ds_read_b64_tr_b16 a[238:239], v43 offset:45056
    v_mfma_f32_16x16x32_bf16 v[104:107], a[208:211], a[176:179], v[152:155]
    v_exp_f32 v58, v130
    v_mfma_f32_16x16x32_bf16 v[104:107], a[212:215], a[180:183], v[104:107]
    v_add_f32 v49, v49, v55
    v_cvt_pk_bf16_f32 v177, v54, v55
    v_mfma_f32_16x16x32_bf16 v[104:107], a[216:219], a[184:187], v[104:107]
    v_exp_f32 v59, v131
    v_mfma_f32_16x16x32_bf16 v[104:107], a[220:223], a[188:191], v[104:107]
    s_waitcnt lgkmcnt(6)
    v_add_f32 v49, v49, v56
    v_add_f32 v49, v49, v57
    v_mfma_f32_16x16x32_bf16 a[64:67], a[224:227], v[188:191], a[64:67]
    s_waitcnt lgkmcnt(4)
    v_exp_f32 v52, v116
    v_mfma_f32_16x16x32_bf16 a[64:67], a[228:231], v[204:207], a[64:67]
    ds_read_b64_tr_b16 a[240:241], v44 offset:32768
    v_cvt_pk_bf16_f32 v178, v56, v57
    v_mfma_f32_16x16x32_bf16 a[68:71], a[224:227], v[192:195], a[68:71]
    v_exp_f32 v53, v117
    v_mfma_f32_16x16x32_bf16 a[68:71], a[228:231], v[208:211], a[68:71]
    ds_read_b64_tr_b16 a[242:243], v44 offset:36864
    v_add_f32 v49, v49, v58
    v_mfma_f32_16x16x32_bf16 a[72:75], a[224:227], v[196:199], a[72:75]
    v_exp_f32 v54, v118
    v_mfma_f32_16x16x32_bf16 a[72:75], a[228:231], v[212:215], a[72:75]
    ds_read_b64_tr_b16 a[244:245], v44 offset:40960
    ds_read_b64_tr_b16 a[246:247], v44 offset:45056
    v_mfma_f32_16x16x32_bf16 a[76:79], a[224:227], v[200:203], a[76:79]
    v_exp_f32 v55, v119
    v_mfma_f32_16x16x32_bf16 a[76:79], a[228:231], v[216:219], a[76:79]
    s_waitcnt lgkmcnt(6)
    v_add_f32 v49, v49, v59
    v_cvt_pk_bf16_f32 v179, v58, v59
    v_mfma_f32_16x16x32_bf16 a[80:83], a[232:235], v[188:191], a[80:83]
    s_waitcnt lgkmcnt(4)
    v_exp_f32 v56, v132
    v_mfma_f32_16x16x32_bf16 a[80:83], a[236:239], v[204:207], a[80:83]
    ds_read_b64_tr_b16 a[248:249], v45 offset:32768
    v_cvt_pk_bf16_f32 v180, v52, v53
    v_mfma_f32_16x16x32_bf16 a[84:87], a[232:235], v[192:195], a[84:87]
    v_exp_f32 v57, v133
    v_mfma_f32_16x16x32_bf16 a[84:87], a[236:239], v[208:211], a[84:87]
    ds_read_b64_tr_b16 a[250:251], v45 offset:36864
    ds_read_b64_tr_b16 a[252:253], v45 offset:40960
    v_mfma_f32_16x16x32_bf16 a[88:91], a[232:235], v[196:199], a[88:91]
    v_exp_f32 v58, v134
    v_mfma_f32_16x16x32_bf16 a[88:91], a[236:239], v[212:215], a[88:91]
    ds_read_b64_tr_b16 a[254:255], v45 offset:45056
    v_cvt_pk_bf16_f32 v181, v54, v55
    v_mfma_f32_16x16x32_bf16 a[92:95], a[232:235], v[200:203], a[92:95]
    v_exp_f32 v59, v135
    v_mfma_f32_16x16x32_bf16 a[92:95], a[236:239], v[216:219], a[92:95]
    s_waitcnt lgkmcnt(6)
    ds_read_b128 a[192:195], v34 offset:40960
    v_cvt_pk_bf16_f32 v182, v56, v57
    v_mfma_f32_16x16x32_bf16 a[96:99], a[240:243], v[188:191], a[96:99]
    s_waitcnt lgkmcnt(5)
    v_exp_f32 v52, v120
    v_mfma_f32_16x16x32_bf16 a[96:99], a[244:247], v[204:207], a[96:99]
    ds_read_b128 a[196:199], v35 offset:40960
    v_cvt_pk_bf16_f32 v183, v58, v59
    v_mfma_f32_16x16x32_bf16 a[100:103], a[240:243], v[192:195], a[100:103]
    v_exp_f32 v53, v121
    v_mfma_f32_16x16x32_bf16 a[100:103], a[244:247], v[208:211], a[100:103]
    ds_read_b128 a[200:203], v36 offset:40960
    ds_read_b128 a[204:207], v37 offset:40960
    v_mfma_f32_16x16x32_bf16 a[104:107], a[240:243], v[196:199], a[104:107]
    v_exp_f32 v54, v122
    v_mfma_f32_16x16x32_bf16 a[104:107], a[244:247], v[212:215], a[104:107]
    ds_read_b128 a[208:211], v34 offset:45056
    v_cvt_pk_bf16_f32 v184, v52, v53
    v_mfma_f32_16x16x32_bf16 a[108:111], a[240:243], v[200:203], a[108:111]
    v_exp_f32 v55, v123
    v_mfma_f32_16x16x32_bf16 a[108:111], a[244:247], v[216:219], a[108:111]
    s_waitcnt lgkmcnt(7)
    ds_read_b128 a[212:215], v35 offset:45056
    ds_read_b128 a[216:219], v36 offset:45056
    v_mfma_f32_16x16x32_bf16 a[112:115], a[248:251], v[188:191], a[112:115]
    s_waitcnt lgkmcnt(7)
    v_exp_f32 v56, v136
    v_mfma_f32_16x16x32_bf16 a[112:115], a[252:255], v[204:207], a[112:115]
    ds_read_b128 a[220:223], v37 offset:45056
    v_cvt_pk_bf16_f32 v185, v54, v55
    v_mfma_f32_16x16x32_bf16 a[116:119], a[248:251], v[192:195], a[116:119]
    v_exp_f32 v57, v137
    v_mfma_f32_16x16x32_bf16 a[116:119], a[252:255], v[208:211], a[116:119]
    v_mfma_f32_16x16x32_bf16 a[120:123], a[248:251], v[196:199], a[120:123]
    v_exp_f32 v58, v138
    v_mfma_f32_16x16x32_bf16 a[120:123], a[252:255], v[212:215], a[120:123]
    v_cvt_pk_bf16_f32 v186, v56, v57
    v_mfma_f32_16x16x32_bf16 a[124:127], a[248:251], v[200:203], a[124:127]
    v_exp_f32 v59, v139
    v_mfma_f32_16x16x32_bf16 a[124:127], a[252:255], v[216:219], a[124:127]
    v_mfma_f32_16x16x32_bf16 v[232:235], v[236:239], v[200:203], v[232:235]
    v_mfma_f32_16x16x32_bf16 v[232:235], v[236:239], v[216:219], v[232:235]
    s_waitcnt lgkmcnt(7)
    v_cvt_pk_bf16_f32 v187, v58, v59
    v_mfma_f32_16x16x32_bf16 v[108:111], a[192:195], a[128:131], v[140:143]
    s_waitcnt lgkmcnt(6)
    v_exp_f32 v52, v76
    v_mfma_f32_16x16x32_bf16 v[108:111], a[196:199], a[132:135], v[108:111]
    s_waitcnt lgkmcnt(5)
    ds_read_b64_tr_b16 a[224:225], v38 offset:49152
    ds_read_b64_tr_b16 a[226:227], v38 offset:53248
    v_mfma_f32_16x16x32_bf16 v[108:111], a[200:203], a[136:139], v[108:111]
    s_waitcnt lgkmcnt(6)
    v_exp_f32 v53, v77
    v_mfma_f32_16x16x32_bf16 v[108:111], a[204:207], a[140:143], v[108:111]
    ds_read_b64_tr_b16 a[228:229], v38 offset:57344
    v_add_f32 v48, v48, v52
    v_mfma_f32_16x16x32_bf16 v[112:115], a[192:195], a[144:147], v[144:147]
    v_exp_f32 v54, v78
    v_mfma_f32_16x16x32_bf16 v[112:115], a[196:199], a[148:151], v[112:115]
    v_add_f32 v48, v48, v53
    v_cvt_pk_bf16_f32 v188, v52, v53
    v_mfma_f32_16x16x32_bf16 v[112:115], a[200:203], a[152:155], v[112:115]
    v_exp_f32 v55, v79
    v_mfma_f32_16x16x32_bf16 v[112:115], a[204:207], a[156:159], v[112:115]
    ds_read_b64_tr_b16 a[230:231], v38 offset:61440
    v_add_f32 v48, v48, v54
    v_mfma_f32_16x16x32_bf16 v[116:119], a[192:195], a[160:163], v[148:151]
    v_exp_f32 v56, v92
    v_mfma_f32_16x16x32_bf16 v[116:119], a[196:199], a[164:167], v[116:119]
    v_add_f32 v48, v48, v55
    v_cvt_pk_bf16_f32 v189, v54, v55
    v_mfma_f32_16x16x32_bf16 v[116:119], a[200:203], a[168:171], v[116:119]
    v_exp_f32 v57, v93
    v_mfma_f32_16x16x32_bf16 v[116:119], a[204:207], a[172:175], v[116:119]
    ds_read_b64_tr_b16 a[232:233], v39 offset:49152
    v_add_f32 v48, v48, v56
    v_mfma_f32_16x16x32_bf16 v[120:123], a[192:195], a[176:179], v[152:155]
    v_exp_f32 v58, v94
    v_mfma_f32_16x16x32_bf16 v[120:123], a[196:199], a[180:183], v[120:123]
    v_add_f32 v48, v48, v57
    v_cvt_pk_bf16_f32 v190, v56, v57
    v_mfma_f32_16x16x32_bf16 v[120:123], a[200:203], a[184:187], v[120:123]
    v_exp_f32 v59, v95
    v_mfma_f32_16x16x32_bf16 v[120:123], a[204:207], a[188:191], v[120:123]
    s_waitcnt lgkmcnt(8)
    ds_read_b64_tr_b16 a[234:235], v39 offset:53248
    v_add_f32 v48, v48, v58
    v_mfma_f32_16x16x32_bf16 v[124:127], a[208:211], a[128:131], v[140:143]
    s_waitcnt lgkmcnt(8)
    v_exp_f32 v52, v80
    v_mfma_f32_16x16x32_bf16 v[124:127], a[212:215], a[132:135], v[124:127]
    s_waitcnt lgkmcnt(7)
    v_add_f32 v48, v48, v59
    v_cvt_pk_bf16_f32 v191, v58, v59
    v_mfma_f32_16x16x32_bf16 v[124:127], a[216:219], a[136:139], v[124:127]
    s_waitcnt lgkmcnt(6)
    v_exp_f32 v53, v81
    v_mfma_f32_16x16x32_bf16 v[124:127], a[220:223], a[140:143], v[124:127]
    ds_read_b64_tr_b16 a[236:237], v39 offset:57344
    v_add_f32 v49, v49, v52
    v_mfma_f32_16x16x32_bf16 v[128:131], a[208:211], a[144:147], v[144:147]
    v_exp_f32 v54, v82
    v_mfma_f32_16x16x32_bf16 v[128:131], a[212:215], a[148:151], v[128:131]
    v_add_f32 v49, v49, v53
    v_cvt_pk_bf16_f32 v192, v52, v53
    v_mfma_f32_16x16x32_bf16 v[128:131], a[216:219], a[152:155], v[128:131]
    v_exp_f32 v55, v83
    v_mfma_f32_16x16x32_bf16 v[128:131], a[220:223], a[156:159], v[128:131]
    ds_read_b64_tr_b16 a[238:239], v39 offset:61440
    v_add_f32 v49, v49, v54
    v_mfma_f32_16x16x32_bf16 v[132:135], a[208:211], a[160:163], v[148:151]
    v_exp_f32 v56, v96
    v_mfma_f32_16x16x32_bf16 v[132:135], a[212:215], a[164:167], v[132:135]
    v_add_f32 v49, v49, v55
    v_cvt_pk_bf16_f32 v193, v54, v55
    v_mfma_f32_16x16x32_bf16 v[132:135], a[216:219], a[168:171], v[132:135]
    v_exp_f32 v57, v97
    v_mfma_f32_16x16x32_bf16 v[132:135], a[220:223], a[172:175], v[132:135]
    ds_read_b64_tr_b16 a[240:241], v40 offset:49152
    v_add_f32 v49, v49, v56
    v_mfma_f32_16x16x32_bf16 v[136:139], a[208:211], a[176:179], v[152:155]
    v_exp_f32 v58, v98
    v_mfma_f32_16x16x32_bf16 v[136:139], a[212:215], a[180:183], v[136:139]
    v_add_f32 v49, v49, v57
    v_cvt_pk_bf16_f32 v194, v56, v57
    v_mfma_f32_16x16x32_bf16 v[136:139], a[216:219], a[184:187], v[136:139]
    v_exp_f32 v59, v99
    v_mfma_f32_16x16x32_bf16 v[136:139], a[220:223], a[188:191], v[136:139]
    s_waitcnt lgkmcnt(7)
    ds_read_b64_tr_b16 a[242:243], v40 offset:53248
    v_add_f32 v49, v49, v58
    v_mfma_f32_16x16x32_bf16 a[0:3], a[224:227], v[156:159], a[0:3]
    s_waitcnt lgkmcnt(6)
    v_exp_f32 v52, v84
    v_mfma_f32_16x16x32_bf16 a[0:3], a[228:231], v[172:175], a[0:3]
    ds_read_b64_tr_b16 a[244:245], v40 offset:57344
    ds_read_b64_tr_b16 a[246:247], v40 offset:61440
    v_mfma_f32_16x16x32_bf16 a[4:7], a[224:227], v[160:163], a[4:7]
    v_exp_f32 v53, v85
    v_mfma_f32_16x16x32_bf16 a[4:7], a[228:231], v[176:179], a[4:7]
    v_add_f32 v49, v49, v59
    v_cvt_pk_bf16_f32 v195, v58, v59
    v_mfma_f32_16x16x32_bf16 a[8:11], a[224:227], v[164:167], a[8:11]
    v_exp_f32 v54, v86
    v_mfma_f32_16x16x32_bf16 a[8:11], a[228:231], v[180:183], a[8:11]
    ds_read_b64_tr_b16 a[248:249], v41 offset:49152
    v_cvt_pk_bf16_f32 v196, v52, v53
    v_mfma_f32_16x16x32_bf16 a[12:15], a[224:227], v[168:171], a[12:15]
    v_exp_f32 v55, v87
    v_mfma_f32_16x16x32_bf16 a[12:15], a[228:231], v[184:187], a[12:15]
    s_waitcnt lgkmcnt(7)
    ds_read_b64_tr_b16 a[250:251], v41 offset:53248
    ds_read_b64_tr_b16 a[252:253], v41 offset:57344
    v_mfma_f32_16x16x32_bf16 a[16:19], a[232:235], v[156:159], a[16:19]
    s_waitcnt lgkmcnt(7)
    v_exp_f32 v56, v100
    v_mfma_f32_16x16x32_bf16 a[16:19], a[236:239], v[172:175], a[16:19]
    ds_read_b64_tr_b16 a[254:255], v41 offset:61440
    v_cvt_pk_bf16_f32 v197, v54, v55
    v_mfma_f32_16x16x32_bf16 a[20:23], a[232:235], v[160:163], a[20:23]
    v_exp_f32 v57, v101
    v_mfma_f32_16x16x32_bf16 a[20:23], a[236:239], v[176:179], a[20:23]
    v_mfma_f32_16x16x32_bf16 a[24:27], a[232:235], v[164:167], a[24:27]
    v_exp_f32 v58, v102
    v_mfma_f32_16x16x32_bf16 a[24:27], a[236:239], v[180:183], a[24:27]
    v_cvt_pk_bf16_f32 v198, v56, v57
    v_mfma_f32_16x16x32_bf16 a[28:31], a[232:235], v[168:171], a[28:31]
    v_exp_f32 v59, v103
    v_mfma_f32_16x16x32_bf16 a[28:31], a[236:239], v[184:187], a[28:31]
    s_waitcnt lgkmcnt(6)
    v_mfma_f32_16x16x32_bf16 a[32:35], a[240:243], v[156:159], a[32:35]
    s_waitcnt lgkmcnt(4)
    v_exp_f32 v52, v88
    v_mfma_f32_16x16x32_bf16 a[32:35], a[244:247], v[172:175], a[32:35]
    v_cvt_pk_bf16_f32 v199, v58, v59
    v_mfma_f32_16x16x32_bf16 a[36:39], a[240:243], v[160:163], a[36:39]
    v_exp_f32 v53, v89
    v_mfma_f32_16x16x32_bf16 a[36:39], a[244:247], v[176:179], a[36:39]
    v_mfma_f32_16x16x32_bf16 a[40:43], a[240:243], v[164:167], a[40:43]
    v_exp_f32 v54, v90
    v_mfma_f32_16x16x32_bf16 a[40:43], a[244:247], v[180:183], a[40:43]
    v_cvt_pk_bf16_f32 v200, v52, v53
    v_mfma_f32_16x16x32_bf16 a[44:47], a[240:243], v[168:171], a[44:47]
    v_exp_f32 v55, v91
    v_mfma_f32_16x16x32_bf16 a[44:47], a[244:247], v[184:187], a[44:47]
    s_waitcnt lgkmcnt(2)
    v_mfma_f32_16x16x32_bf16 a[48:51], a[248:251], v[156:159], a[48:51]
    s_waitcnt lgkmcnt(0)
    v_exp_f32 v56, v104
    v_mfma_f32_16x16x32_bf16 a[48:51], a[252:255], v[172:175], a[48:51]
    v_cvt_pk_bf16_f32 v201, v54, v55
    v_mfma_f32_16x16x32_bf16 a[52:55], a[248:251], v[160:163], a[52:55]
    v_exp_f32 v57, v105
    v_mfma_f32_16x16x32_bf16 a[52:55], a[252:255], v[176:179], a[52:55]
    v_mfma_f32_16x16x32_bf16 a[56:59], a[248:251], v[164:167], a[56:59]
    v_exp_f32 v58, v106
    v_mfma_f32_16x16x32_bf16 a[56:59], a[252:255], v[180:183], a[56:59]
    v_cvt_pk_bf16_f32 v202, v56, v57
    v_mfma_f32_16x16x32_bf16 a[60:63], a[248:251], v[168:171], a[60:63]
    v_exp_f32 v59, v107
    v_mfma_f32_16x16x32_bf16 a[60:63], a[252:255], v[184:187], a[60:63]
    v_mfma_f32_16x16x32_bf16 v[228:231], v[236:239], v[164:167], v[228:231]
    v_mfma_f32_16x16x32_bf16 v[228:231], v[236:239], v[180:183], v[228:231]
    v_cvt_pk_bf16_f32 v203, v58, v59
    ds_read_b64_tr_b16 a[224:225], v42 offset:49152
    ds_read_b64_tr_b16 a[226:227], v42 offset:53248
    ds_read_b64_tr_b16 a[228:229], v42 offset:57344
    ds_read_b64_tr_b16 a[230:231], v42 offset:61440
    ds_read_b64_tr_b16 a[232:233], v43 offset:49152
    ds_read_b64_tr_b16 a[234:235], v43 offset:53248
    ds_read_b64_tr_b16 a[236:237], v43 offset:57344
    ds_read_b64_tr_b16 a[238:239], v43 offset:61440
    ds_read_b64_tr_b16 a[240:241], v44 offset:49152
    ds_read_b64_tr_b16 a[242:243], v44 offset:53248
    ds_read_b64_tr_b16 a[244:245], v44 offset:57344
    ds_read_b64_tr_b16 a[246:247], v44 offset:61440
    ds_read_b64_tr_b16 a[248:249], v45 offset:49152
    ds_read_b64_tr_b16 a[250:251], v45 offset:53248
    ds_read_b64_tr_b16 a[252:253], v45 offset:57344
    ds_read_b64_tr_b16 a[254:255], v45 offset:61440
    v_exp_f32 v52, v108
    v_exp_f32 v53, v109
    v_exp_f32 v54, v110
    v_add_f32 v48, v48, v52
    v_exp_f32 v55, v111
    v_add_f32 v48, v48, v53
    v_cvt_pk_bf16_f32 v204, v52, v53
    v_exp_f32 v56, v124
    v_add_f32 v48, v48, v54
    v_exp_f32 v57, v125
    v_add_f32 v48, v48, v55
    v_cvt_pk_bf16_f32 v205, v54, v55
    v_exp_f32 v58, v126
    v_add_f32 v48, v48, v56
    s_waitcnt lgkmcnt(0)
    v_mfma_f32_16x16x32_bf16 a[64:67], a[224:227], v[156:159], a[64:67]
    v_exp_f32 v59, v127
    v_mfma_f32_16x16x32_bf16 a[64:67], a[228:231], v[172:175], a[64:67]
    v_add_f32 v48, v48, v57
    v_cvt_pk_bf16_f32 v206, v56, v57
    v_mfma_f32_16x16x32_bf16 a[68:71], a[224:227], v[160:163], a[68:71]
    v_exp_f32 v52, v112
    v_mfma_f32_16x16x32_bf16 a[68:71], a[228:231], v[176:179], a[68:71]
    v_add_f32 v48, v48, v58
    v_exp_f32 v53, v113
    v_mfma_f32_16x16x32_bf16 a[72:75], a[224:227], v[164:167], a[72:75]
    v_add_f32 v48, v48, v59
    v_mfma_f32_16x16x32_bf16 a[72:75], a[228:231], v[180:183], a[72:75]
    v_cvt_pk_bf16_f32 v207, v58, v59
    v_exp_f32 v54, v114
    v_mfma_f32_16x16x32_bf16 a[76:79], a[224:227], v[168:171], a[76:79]
    v_add_f32 v49, v49, v52
    v_mfma_f32_16x16x32_bf16 a[76:79], a[228:231], v[184:187], a[76:79]
    v_exp_f32 v55, v115
    v_add_f32 v49, v49, v53
    v_mfma_f32_16x16x32_bf16 a[80:83], a[232:235], v[156:159], a[80:83]
    v_cvt_pk_bf16_f32 v208, v52, v53
    v_mfma_f32_16x16x32_bf16 a[80:83], a[236:239], v[172:175], a[80:83]
    v_exp_f32 v56, v128
    v_add_f32 v49, v49, v54
    v_mfma_f32_16x16x32_bf16 a[84:87], a[232:235], v[160:163], a[84:87]
    v_exp_f32 v57, v129
    v_mfma_f32_16x16x32_bf16 a[84:87], a[236:239], v[176:179], a[84:87]
    v_add_f32 v49, v49, v55
    v_cvt_pk_bf16_f32 v209, v54, v55
    v_mfma_f32_16x16x32_bf16 a[88:91], a[232:235], v[164:167], a[88:91]
    v_exp_f32 v58, v130
    v_mfma_f32_16x16x32_bf16 a[88:91], a[236:239], v[180:183], a[88:91]
    v_add_f32 v49, v49, v56
    v_exp_f32 v59, v131
    v_mfma_f32_16x16x32_bf16 a[92:95], a[232:235], v[168:171], a[92:95]
    v_add_f32 v49, v49, v57
    v_mfma_f32_16x16x32_bf16 a[92:95], a[236:239], v[184:187], a[92:95]
    v_cvt_pk_bf16_f32 v210, v56, v57
    v_exp_f32 v52, v116
    v_mfma_f32_16x16x32_bf16 a[96:99], a[240:243], v[156:159], a[96:99]
    v_add_f32 v49, v49, v58
    v_mfma_f32_16x16x32_bf16 a[96:99], a[244:247], v[172:175], a[96:99]
    v_exp_f32 v53, v117
    v_add_f32 v49, v49, v59
    v_mfma_f32_16x16x32_bf16 a[100:103], a[240:243], v[160:163], a[100:103]
    v_cvt_pk_bf16_f32 v211, v58, v59
    v_mfma_f32_16x16x32_bf16 a[100:103], a[244:247], v[176:179], a[100:103]
    v_exp_f32 v54, v118
    v_exp_f32 v55, v119
    v_mfma_f32_16x16x32_bf16 a[104:107], a[240:243], v[164:167], a[104:107]
    v_cvt_pk_bf16_f32 v212, v52, v53
    v_mfma_f32_16x16x32_bf16 a[104:107], a[244:247], v[180:183], a[104:107]
    v_exp_f32 v56, v132
    v_exp_f32 v57, v133
    v_mfma_f32_16x16x32_bf16 a[108:111], a[240:243], v[168:171], a[108:111]
    v_cvt_pk_bf16_f32 v213, v54, v55
    v_mfma_f32_16x16x32_bf16 a[108:111], a[244:247], v[184:187], a[108:111]
    v_exp_f32 v58, v134
    v_exp_f32 v59, v135
    v_mfma_f32_16x16x32_bf16 a[112:115], a[248:251], v[156:159], a[112:115]
    v_cvt_pk_bf16_f32 v214, v56, v57
    v_mfma_f32_16x16x32_bf16 a[112:115], a[252:255], v[172:175], a[112:115]
    v_exp_f32 v52, v120
    v_exp_f32 v53, v121
    v_mfma_f32_16x16x32_bf16 a[116:119], a[248:251], v[160:163], a[116:119]
    v_cvt_pk_bf16_f32 v215, v58, v59
    v_mfma_f32_16x16x32_bf16 a[116:119], a[252:255], v[176:179], a[116:119]
    v_exp_f32 v54, v122
    v_exp_f32 v55, v123
    v_mfma_f32_16x16x32_bf16 a[120:123], a[248:251], v[164:167], a[120:123]
    v_cvt_pk_bf16_f32 v216, v52, v53
    v_mfma_f32_16x16x32_bf16 a[120:123], a[252:255], v[180:183], a[120:123]
    v_exp_f32 v56, v136
    v_exp_f32 v57, v137
    v_mfma_f32_16x16x32_bf16 a[124:127], a[248:251], v[168:171], a[124:127]
    v_cvt_pk_bf16_f32 v217, v54, v55
    v_mfma_f32_16x16x32_bf16 a[124:127], a[252:255], v[184:187], a[124:127]
    v_exp_f32 v58, v138
    v_exp_f32 v59, v139
    v_mfma_f32_16x16x32_bf16 v[232:235], v[236:239], v[168:171], v[232:235]
    v_cvt_pk_bf16_f32 v218, v56, v57
    v_mfma_f32_16x16x32_bf16 v[232:235], v[236:239], v[184:187], v[232:235]
    s_nop 0
    v_cvt_pk_bf16_f32 v219, v58, v59
    s_waitcnt vmcnt(0)
    s_barrier
    ds_read_b64_tr_b16 a[224:225], v38 offset:0
    ds_read_b64_tr_b16 a[226:227], v38 offset:4096
    ds_read_b64_tr_b16 a[228:229], v38 offset:8192
    ds_read_b64_tr_b16 a[230:231], v38 offset:12288
    ds_read_b64_tr_b16 a[232:233], v39 offset:0
    ds_read_b64_tr_b16 a[234:235], v39 offset:4096
    ds_read_b64_tr_b16 a[236:237], v39 offset:8192
    ds_read_b64_tr_b16 a[238:239], v39 offset:12288
    ds_read_b64_tr_b16 a[240:241], v40 offset:0
    ds_read_b64_tr_b16 a[242:243], v40 offset:4096
    ds_read_b64_tr_b16 a[244:245], v40 offset:8192
    ds_read_b64_tr_b16 a[246:247], v40 offset:12288
    ds_read_b64_tr_b16 a[248:249], v41 offset:0
    ds_read_b64_tr_b16 a[250:251], v41 offset:4096
    ds_read_b64_tr_b16 a[252:253], v41 offset:8192
    ds_read_b64_tr_b16 a[254:255], v41 offset:12288
    s_waitcnt lgkmcnt(0)
    s_nop 1
    v_mfma_f32_16x16x32_bf16 a[0:3], a[224:227], v[188:191], a[0:3]
    v_mfma_f32_16x16x32_bf16 a[0:3], a[228:231], v[204:207], a[0:3]
    v_mfma_f32_16x16x32_bf16 a[4:7], a[224:227], v[192:195], a[4:7]
    v_mfma_f32_16x16x32_bf16 a[4:7], a[228:231], v[208:211], a[4:7]
    v_mfma_f32_16x16x32_bf16 a[8:11], a[224:227], v[196:199], a[8:11]
    v_mfma_f32_16x16x32_bf16 a[8:11], a[228:231], v[212:215], a[8:11]
    v_mfma_f32_16x16x32_bf16 a[12:15], a[224:227], v[200:203], a[12:15]
    v_mfma_f32_16x16x32_bf16 a[12:15], a[228:231], v[216:219], a[12:15]
    ds_read_b64_tr_b16 a[224:225], v42 offset:0
    ds_read_b64_tr_b16 a[226:227], v42 offset:4096
    ds_read_b64_tr_b16 a[228:229], v42 offset:8192
    ds_read_b64_tr_b16 a[230:231], v42 offset:12288
    v_mfma_f32_16x16x32_bf16 a[16:19], a[232:235], v[188:191], a[16:19]
    v_mfma_f32_16x16x32_bf16 a[16:19], a[236:239], v[204:207], a[16:19]
    v_mfma_f32_16x16x32_bf16 a[20:23], a[232:235], v[192:195], a[20:23]
    v_mfma_f32_16x16x32_bf16 a[20:23], a[236:239], v[208:211], a[20:23]
    v_mfma_f32_16x16x32_bf16 a[24:27], a[232:235], v[196:199], a[24:27]
    v_mfma_f32_16x16x32_bf16 a[24:27], a[236:239], v[212:215], a[24:27]
    v_mfma_f32_16x16x32_bf16 a[28:31], a[232:235], v[200:203], a[28:31]
    v_mfma_f32_16x16x32_bf16 a[28:31], a[236:239], v[216:219], a[28:31]
    ds_read_b64_tr_b16 a[232:233], v43 offset:0
    ds_read_b64_tr_b16 a[234:235], v43 offset:4096
    ds_read_b64_tr_b16 a[236:237], v43 offset:8192
    ds_read_b64_tr_b16 a[238:239], v43 offset:12288
    v_mfma_f32_16x16x32_bf16 a[32:35], a[240:243], v[188:191], a[32:35]
    v_mfma_f32_16x16x32_bf16 a[32:35], a[244:247], v[204:207], a[32:35]
    v_mfma_f32_16x16x32_bf16 a[36:39], a[240:243], v[192:195], a[36:39]
    v_mfma_f32_16x16x32_bf16 a[36:39], a[244:247], v[208:211], a[36:39]
    v_mfma_f32_16x16x32_bf16 a[40:43], a[240:243], v[196:199], a[40:43]
    v_mfma_f32_16x16x32_bf16 a[40:43], a[244:247], v[212:215], a[40:43]
    v_mfma_f32_16x16x32_bf16 a[44:47], a[240:243], v[200:203], a[44:47]
    v_mfma_f32_16x16x32_bf16 a[44:47], a[244:247], v[216:219], a[44:47]
    ds_read_b64_tr_b16 a[240:241], v44 offset:0
    ds_read_b64_tr_b16 a[242:243], v44 offset:4096
    ds_read_b64_tr_b16 a[244:245], v44 offset:8192
    ds_read_b64_tr_b16 a[246:247], v44 offset:12288
    v_mfma_f32_16x16x32_bf16 a[48:51], a[248:251], v[188:191], a[48:51]
    v_mfma_f32_16x16x32_bf16 a[48:51], a[252:255], v[204:207], a[48:51]
    v_mfma_f32_16x16x32_bf16 a[52:55], a[248:251], v[192:195], a[52:55]
    v_mfma_f32_16x16x32_bf16 a[52:55], a[252:255], v[208:211], a[52:55]
    v_mfma_f32_16x16x32_bf16 a[56:59], a[248:251], v[196:199], a[56:59]
    v_mfma_f32_16x16x32_bf16 a[56:59], a[252:255], v[212:215], a[56:59]
    v_mfma_f32_16x16x32_bf16 a[60:63], a[248:251], v[200:203], a[60:63]
    v_mfma_f32_16x16x32_bf16 a[60:63], a[252:255], v[216:219], a[60:63]
    ds_read_b64_tr_b16 a[248:249], v45 offset:0
    ds_read_b64_tr_b16 a[250:251], v45 offset:4096
    ds_read_b64_tr_b16 a[252:253], v45 offset:8192
    ds_read_b64_tr_b16 a[254:255], v45 offset:12288
    s_waitcnt lgkmcnt(0)
    v_mfma_f32_16x16x32_bf16 a[64:67], a[224:227], v[188:191], a[64:67]
    v_mfma_f32_16x16x32_bf16 a[64:67], a[228:231], v[204:207], a[64:67]
    v_mfma_f32_16x16x32_bf16 a[68:71], a[224:227], v[192:195], a[68:71]
    v_mfma_f32_16x16x32_bf16 a[68:71], a[228:231], v[208:211], a[68:71]
    v_mfma_f32_16x16x32_bf16 a[72:75], a[224:227], v[196:199], a[72:75]
    v_mfma_f32_16x16x32_bf16 a[72:75], a[228:231], v[212:215], a[72:75]
    v_mfma_f32_16x16x32_bf16 a[76:79], a[224:227], v[200:203], a[76:79]
    v_mfma_f32_16x16x32_bf16 a[76:79], a[228:231], v[216:219], a[76:79]
    v_mfma_f32_16x16x32_bf16 a[80:83], a[232:235], v[188:191], a[80:83]
    v_mfma_f32_16x16x32_bf16 a[80:83], a[236:239], v[204:207], a[80:83]
    v_mfma_f32_16x16x32_bf16 a[84:87], a[232:235], v[192:195], a[84:87]
    v_mfma_f32_16x16x32_bf16 a[84:87], a[236:239], v[208:211], a[84:87]
    v_mfma_f32_16x16x32_bf16 a[88:91], a[232:235], v[196:199], a[88:91]
    v_mfma_f32_16x16x32_bf16 a[88:91], a[236:239], v[212:215], a[88:91]
    v_mfma_f32_16x16x32_bf16 a[92:95], a[232:235], v[200:203], a[92:95]
    v_mfma_f32_16x16x32_bf16 a[92:95], a[236:239], v[216:219], a[92:95]
    v_mfma_f32_16x16x32_bf16 a[96:99], a[240:243], v[188:191], a[96:99]
    v_mfma_f32_16x16x32_bf16 a[96:99], a[244:247], v[204:207], a[96:99]
    v_mfma_f32_16x16x32_bf16 a[100:103], a[240:243], v[192:195], a[100:103]
    v_mfma_f32_16x16x32_bf16 a[100:103], a[244:247], v[208:211], a[100:103]
    v_mfma_f32_16x16x32_bf16 a[104:107], a[240:243], v[196:199], a[104:107]
    v_mfma_f32_16x16x32_bf16 a[104:107], a[244:247], v[212:215], a[104:107]
    v_mfma_f32_16x16x32_bf16 a[108:111], a[240:243], v[200:203], a[108:111]
    v_mfma_f32_16x16x32_bf16 a[108:111], a[244:247], v[216:219], a[108:111]
    v_mfma_f32_16x16x32_bf16 a[112:115], a[248:251], v[188:191], a[112:115]
    v_mfma_f32_16x16x32_bf16 a[112:115], a[252:255], v[204:207], a[112:115]
    v_mfma_f32_16x16x32_bf16 a[116:119], a[248:251], v[192:195], a[116:119]
    v_mfma_f32_16x16x32_bf16 a[116:119], a[252:255], v[208:211], a[116:119]
    v_mfma_f32_16x16x32_bf16 a[120:123], a[248:251], v[196:199], a[120:123]
    v_mfma_f32_16x16x32_bf16 a[120:123], a[252:255], v[212:215], a[120:123]
    v_mfma_f32_16x16x32_bf16 a[124:127], a[248:251], v[200:203], a[124:127]
    v_mfma_f32_16x16x32_bf16 a[124:127], a[252:255], v[216:219], a[124:127]
    v_mfma_f32_16x16x32_bf16 v[228:231], v[236:239], v[196:199], v[228:231]
    v_mfma_f32_16x16x32_bf16 v[228:231], v[236:239], v[212:215], v[228:231]
    v_mfma_f32_16x16x32_bf16 v[232:235], v[236:239], v[200:203], v[232:235]
    v_mfma_f32_16x16x32_bf16 v[232:235], v[236:239], v[216:219], v[232:235]
    s_nop 7
    v_mul_f32 v50, s70, v228
    v_mul_f32 v51, s70, v232
    v_readfirstlane_b32 s96, v245
    s_nop 3
    s_cmp_ge_u32 s96, 28
    s_cbranch_scc1 KF_phA
    v_mov_b32 v2, v244
    s_mov_b32 s97, 0
KF_ph:
    buffer_load_dword v3, v2, s[72:75], 0 offen sc1
    s_waitcnt vmcnt(0)
    v_readfirstlane_b32 s96, v3
    s_add_u32 s97, s97, 1
    s_nop 3
    s_cmp_ge_u32 s96, 28
    s_cbranch_scc1 KF_ph_ok
    s_cmp_ge_u32 s97, 20000
    s_cbranch_scc1 KF_ph_ok
    s_sleep 8
    s_branch KF_ph
KF_ph_ok:
KF_phA:
    v_readfirstlane_b32 s96, v247
    s_nop 3
    s_cmp_ge_u32 s96, 32
    s_cbranch_scc1 KF_pxB
    v_mov_b32 v2, v246
    s_mov_b32 s97, 0
KF_px2:
    buffer_load_dword v3, v2, s[72:75], 0 offen sc1
    s_waitcnt vmcnt(0)
    v_readfirstlane_b32 s96, v3
    s_add_u32 s97, s97, 1
    s_nop 3
    s_cmp_ge_u32 s96, 32
    s_cbranch_scc1 KF_px2_ok
    s_cmp_ge_u32 s97, 20000
    s_cbranch_scc1 KF_px2_ok
    s_sleep 8
    s_branch KF_px2
KF_px2_ok:
KF_pxB:
KF_fin:
    s_mul_i32 s90, s88, 57344
    s_and_b32 s52, s3, 1
    s_lshl_b32 s52, s52, 11
    s_add_u32 s90, s90, s52
    s_lshl_b32 s91, s88, 17
    s_add_u32 s91, s91, s52
    s_mul_i32 s92, s88, 458752
    s_lshl_b32 s61, s88, 20
    v_mov_b32 v60, v48
    v_mov_b32 v61, v49
    v_mov_b32 v62, v50
    v_mov_b32 v63, v51
    s_nop 1
    v_permlane16_swap_b32 v48, v60
    v_permlane16_swap_b32 v49, v61
    v_permlane16_swap_b32 v50, v62
    v_permlane16_swap_b32 v51, v63
    s_nop 1
    v_add_f32 v48, v48, v60
    v_add_f32 v49, v49, v61
    v_add_f32 v50, v50, v62
    v_add_f32 v51, v51, v63
    v_mov_b32 v60, v48
    v_mov_b32 v61, v49
    v_mov_b32 v62, v50
    v_mov_b32 v63, v51
    s_nop 1
    v_permlane32_swap_b32 v48, v60
    v_permlane32_swap_b32 v49, v61
    v_permlane32_swap_b32 v50, v62
    v_permlane32_swap_b32 v51, v63
    s_nop 1
    v_add_f32 v48, v48, v60
    v_add_f32 v49, v49, v61
    v_add_f32 v50, v50, v62
    v_add_f32 v51, v51, v63
    s_mov_b32 s52, 0x5f800000
    s_mov_b64 s[94:95], 0
    v_cmp_ngt_f32 vcc, s52, v48
    s_nop 0
    s_or_b64 s[94:95], s[94:95], vcc
    v_cmp_ngt_f32 vcc, s52, v49
    s_nop 0
    s_or_b64 s[94:95], s[94:95], vcc
    v_cmp_ngt_f32 vcc, s52, v50
    s_nop 0
    s_or_b64 s[94:95], s[94:95], vcc
    v_cmp_ngt_f32 vcc, s52, v51
    s_nop 0
    s_or_b64 s[94:95], s[94:95], vcc
    v_rcp_f32 v64, v48
    v_rcp_f32 v65, v49
    v_rcp_f32 v66, v50
    v_rcp_f32 v67, v51
    v_mov_b32 v68, 0x3f803f80
    v_mov_b32 v69, 0x3f803f80
    v_mov_b32 v70, 0x3f803f80
    v_mov_b32 v71, 0x3f803f80
    v_accvgpr_read_b32 v108, a0
    v_accvgpr_read_b32 v109, a1
    v_accvgpr_read_b32 v110, a2
    v_accvgpr_read_b32 v111, a3
    v_accvgpr_read_b32 v112, a16
    v_accvgpr_read_b32 v113, a17
    v_accvgpr_read_b32 v114, a18
    v_accvgpr_read_b32 v115, a19
    v_pk_mul_f32 v[108:109], v[108:109], v[64:65] op_sel_hi:[1,0]
    v_pk_mul_f32 v[110:111], v[110:111], v[64:65] op_sel_hi:[1,0]
    v_pk_mul_f32 v[112:113], v[112:113], v[64:65] op_sel_hi:[1,0]
    v_pk_mul_f32 v[114:115], v[114:115], v[64:65] op_sel_hi:[1,0]
    v_cvt_pk_bf16_f32 v52, v108, v109
    v_cvt_pk_bf16_f32 v53, v110, v111
    v_cvt_pk_bf16_f32 v54, v112, v113
    v_cvt_pk_bf16_f32 v55, v114, v115
    s_mov_b32 s53, 0
    buffer_store_dwordx4 v[52:55], v10, s[36:39], s53 offen offset:0 sc1
    v_mfma_f32_16x16x32_bf16 v[72:75], v[68:71], v[52:55], 0
    v_accvgpr_read_b32 v116, a4
    v_accvgpr_read_b32 v117, a5
    v_accvgpr_read_b32 v118, a6
    v_accvgpr_read_b32 v119, a7
    v_accvgpr_read_b32 v120, a20
    v_accvgpr_read_b32 v121, a21
    v_accvgpr_read_b32 v122, a22
    v_accvgpr_read_b32 v123, a23
    v_pk_mul_f32 v[116:117], v[116:117], v[64:65] op_sel:[0,1] op_sel_hi:[1,1]
    v_pk_mul_f32 v[118:119], v[118:119], v[64:65] op_sel:[0,1] op_sel_hi:[1,1]
    v_pk_mul_f32 v[120:121], v[120:121], v[64:65] op_sel:[0,1] op_sel_hi:[1,1]
    v_pk_mul_f32 v[122:123], v[122:123], v[64:65] op_sel:[0,1] op_sel_hi:[1,1]
    v_cvt_pk_bf16_f32 v56, v116, v117
    v_cvt_pk_bf16_f32 v57, v118, v119
    v_cvt_pk_bf16_f32 v58, v120, v121
    v_cvt_pk_bf16_f32 v59, v122, v123
    s_mov_b32 s53, 0
    buffer_store_dwordx4 v[56:59], v10, s[36:39], s53 offen offset:1024 sc1
    v_mfma_f32_16x16x32_bf16 v[72:75], v[68:71], v[56:59], v[72:75]
    v_accvgpr_read_b32 v108, a8
    v_accvgpr_read_b32 v109, a9
    v_accvgpr_read_b32 v110, a10
    v_accvgpr_read_b32 v111, a11
    v_accvgpr_read_b32 v112, a24
    v_accvgpr_read_b32 v113, a25
    v_accvgpr_read_b32 v114, a26
    v_accvgpr_read_b32 v115, a27
    v_pk_mul_f32 v[108:109], v[108:109], v[66:67] op_sel_hi:[1,0]
    v_pk_mul_f32 v[110:111], v[110:111], v[66:67] op_sel_hi:[1,0]
    v_pk_mul_f32 v[112:113], v[112:113], v[66:67] op_sel_hi:[1,0]
    v_pk_mul_f32 v[114:115], v[114:115], v[66:67] op_sel_hi:[1,0]
    v_cvt_pk_bf16_f32 v52, v108, v109
    v_cvt_pk_bf16_f32 v53, v110, v111
    v_cvt_pk_bf16_f32 v54, v112, v113
    v_cvt_pk_bf16_f32 v55, v114, v115
    s_mov_b32 s53, 0
    buffer_store_dwordx4 v[52:55], v10, s[36:39], s53 offen offset:2048 sc1
    v_mfma_f32_16x16x32_bf16 v[72:75], v[68:71], v[52:55], v[72:75]
    v_accvgpr_read_b32 v116, a12
    v_accvgpr_read_b32 v117, a13
    v_accvgpr_read_b32 v118, a14
    v_accvgpr_read_b32 v119, a15
    v_accvgpr_read_b32 v120, a28
    v_accvgpr_read_b32 v121, a29
    v_accvgpr_read_b32 v122, a30
    v_accvgpr_read_b32 v123, a31
    v_pk_mul_f32 v[116:117], v[116:117], v[66:67] op_sel:[0,1] op_sel_hi:[1,1]
    v_pk_mul_f32 v[118:119], v[118:119], v[66:67] op_sel:[0,1] op_sel_hi:[1,1]
    v_pk_mul_f32 v[120:121], v[120:121], v[66:67] op_sel:[0,1] op_sel_hi:[1,1]
    v_pk_mul_f32 v[122:123], v[122:123], v[66:67] op_sel:[0,1] op_sel_hi:[1,1]
    v_cvt_pk_bf16_f32 v56, v116, v117
    v_cvt_pk_bf16_f32 v57, v118, v119
    v_cvt_pk_bf16_f32 v58, v120, v121
    v_cvt_pk_bf16_f32 v59, v122, v123
    s_mov_b32 s53, 0
    buffer_store_dwordx4 v[56:59], v10, s[36:39], s53 offen offset:3072 sc1
    v_mfma_f32_16x16x32_bf16 v[72:75], v[68:71], v[56:59], v[72:75]
    v_accvgpr_read_b32 v108, a32
    v_accvgpr_read_b32 v109, a33
    v_accvgpr_read_b32 v110, a34
    v_accvgpr_read_b32 v111, a35
    v_accvgpr_read_b32 v112, a48
    v_accvgpr_read_b32 v113, a49
    v_accvgpr_read_b32 v114, a50
    v_accvgpr_read_b32 v115, a51
    v_pk_mul_f32 v[108:109], v[108:109], v[64:65] op_sel_hi:[1,0]
    v_pk_mul_f32 v[110:111], v[110:111], v[64:65] op_sel_hi:[1,0]
    v_pk_mul_f32 v[112:113], v[112:113], v[64:65] op_sel_hi:[1,0]
    v_pk_mul_f32 v[114:115], v[114:115], v[64:65] op_sel_hi:[1,0]
    v_cvt_pk_bf16_f32 v52, v108, v109
    v_cvt_pk_bf16_f32 v53, v110, v111
    v_cvt_pk_bf16_f32 v54, v112, v113
    v_cvt_pk_bf16_f32 v55, v114, v115
    s_mov_b32 s53, 4096
    buffer_store_dwordx4 v[52:55], v10, s[36:39], s53 offen offset:0 sc1
    v_mfma_f32_16x16x32_bf16 v[72:75], v[68:71], v[52:55], v[72:75]
    v_accvgpr_read_b32 v116, a36
    v_accvgpr_read_b32 v117, a37
    v_accvgpr_read_b32 v118, a38
    v_accvgpr_read_b32 v119, a39
    v_accvgpr_read_b32 v120, a52
    v_accvgpr_read_b32 v121, a53
    v_accvgpr_read_b32 v122, a54
    v_accvgpr_read_b32 v123, a55
    v_pk_mul_f32 v[116:117], v[116:117], v[64:65] op_sel:[0,1] op_sel_hi:[1,1]
    v_pk_mul_f32 v[118:119], v[118:119], v[64:65] op_sel:[0,1] op_sel_hi:[1,1]
    v_pk_mul_f32 v[120:121], v[120:121], v[64:65] op_sel:[0,1] op_sel_hi:[1,1]
    v_pk_mul_f32 v[122:123], v[122:123], v[64:65] op_sel:[0,1] op_sel_hi:[1,1]
    v_cvt_pk_bf16_f32 v56, v116, v117
    v_cvt_pk_bf16_f32 v57, v118, v119
    v_cvt_pk_bf16_f32 v58, v120, v121
    v_cvt_pk_bf16_f32 v59, v122, v123
    s_mov_b32 s53, 4096
    buffer_store_dwordx4 v[56:59], v10, s[36:39], s53 offen offset:1024 sc1
    v_mfma_f32_16x16x32_bf16 v[72:75], v[68:71], v[56:59], v[72:75]
    v_accvgpr_read_b32 v108, a40
    v_accvgpr_read_b32 v109, a41
    v_accvgpr_read_b32 v110, a42
    v_accvgpr_read_b32 v111, a43
    v_accvgpr_read_b32 v112, a56
    v_accvgpr_read_b32 v113, a57
    v_accvgpr_read_b32 v114, a58
    v_accvgpr_read_b32 v115, a59
    v_pk_mul_f32 v[108:109], v[108:109], v[66:67] op_sel_hi:[1,0]
    v_pk_mul_f32 v[110:111], v[110:111], v[66:67] op_sel_hi:[1,0]
    v_pk_mul_f32 v[112:113], v[112:113], v[66:67] op_sel_hi:[1,0]
    v_pk_mul_f32 v[114:115], v[114:115], v[66:67] op_sel_hi:[1,0]
    v_cvt_pk_bf16_f32 v52, v108, v109
    v_cvt_pk_bf16_f32 v53, v110, v111
    v_cvt_pk_bf16_f32 v54, v112, v113
    v_cvt_pk_bf16_f32 v55, v114, v115
    s_mov_b32 s53, 4096
    buffer_store_dwordx4 v[52:55], v10, s[36:39], s53 offen offset:2048 sc1
    v_mfma_f32_16x16x32_bf16 v[72:75], v[68:71], v[52:55], v[72:75]
    v_accvgpr_read_b32 v116, a44
    v_accvgpr_read_b32 v117, a45
    v_accvgpr_read_b32 v118, a46
    v_accvgpr_read_b32 v119, a47
    v_accvgpr_read_b32 v120, a60
    v_accvgpr_read_b32 v121, a61
    v_accvgpr_read_b32 v122, a62
    v_accvgpr_read_b32 v123, a63
    v_pk_mul_f32 v[116:117], v[116:117], v[66:67] op_sel:[0,1] op_sel_hi:[1,1]
    v_pk_mul_f32 v[118:119], v[118:119], v[66:67] op_sel:[0,1] op_sel_hi:[1,1]
    v_pk_mul_f32 v[120:121], v[120:121], v[66:67] op_sel:[0,1] op_sel_hi:[1,1]
    v_pk_mul_f32 v[122:123], v[122:123], v[66:67] op_sel:[0,1] op_sel_hi:[1,1]
    v_cvt_pk_bf16_f32 v56, v116, v117
    v_cvt_pk_bf16_f32 v57, v118, v119
    v_cvt_pk_bf16_f32 v58, v120, v121
    v_cvt_pk_bf16_f32 v59, v122, v123
    s_mov_b32 s53, 4096
    buffer_store_dwordx4 v[56:59], v10, s[36:39], s53 offen offset:3072 sc1
    v_mfma_f32_16x16x32_bf16 v[72:75], v[68:71], v[56:59], v[72:75]
    v_accvgpr_read_b32 v108, a64
    v_accvgpr_read_b32 v109, a65
    v_accvgpr_read_b32 v110, a66
    v_accvgpr_read_b32 v111, a67
    v_accvgpr_read_b32 v112, a80
    v_accvgpr_read_b32 v113, a81
    v_accvgpr_read_b32 v114, a82
    v_accvgpr_read_b32 v115, a83
    v_pk_mul_f32 v[108:109], v[108:109], v[64:65] op_sel_hi:[1,0]
    v_pk_mul_f32 v[110:111], v[110:111], v[64:65] op_sel_hi:[1,0]
    v_pk_mul_f32 v[112:113], v[112:113], v[64:65] op_sel_hi:[1,0]
    v_pk_mul_f32 v[114:115], v[114:115], v[64:65] op_sel_hi:[1,0]
    v_cvt_pk_bf16_f32 v52, v108, v109
    v_cvt_pk_bf16_f32 v53, v110, v111
    v_cvt_pk_bf16_f32 v54, v112, v113
    v_cvt_pk_bf16_f32 v55, v114, v115
    s_mov_b32 s53, 8192
    buffer_store_dwordx4 v[52:55], v10, s[36:39], s53 offen offset:0 sc1
    v_mfma_f32_16x16x32_bf16 v[72:75], v[68:71], v[52:55], v[72:75]
    s_add_u32 m0, s93, 0
    s_nop 0
    buffer_load_dwordx4 v11, s[20:23], s92 offen lds
    buffer_load_dwordx4 v12, s[20:23], s92 offen offset:1024 lds
    s_add_u32 s92, s92, 32768
    v_accvgpr_read_b32 v116, a68
    v_accvgpr_read_b32 v117, a69
    v_accvgpr_read_b32 v118, a70
    v_accvgpr_read_b32 v119, a71
    v_accvgpr_read_b32 v120, a84
    v_accvgpr_read_b32 v121, a85
    v_accvgpr_read_b32 v122, a86
    v_accvgpr_read_b32 v123, a87
    v_pk_mul_f32 v[116:117], v[116:117], v[64:65] op_sel:[0,1] op_sel_hi:[1,1]
    v_pk_mul_f32 v[118:119], v[118:119], v[64:65] op_sel:[0,1] op_sel_hi:[1,1]
    v_pk_mul_f32 v[120:121], v[120:121], v[64:65] op_sel:[0,1] op_sel_hi:[1,1]
    v_pk_mul_f32 v[122:123], v[122:123], v[64:65] op_sel:[0,1] op_sel_hi:[1,1]
    v_cvt_pk_bf16_f32 v56, v116, v117
    v_cvt_pk_bf16_f32 v57, v118, v119
    v_cvt_pk_bf16_f32 v58, v120, v121
    v_cvt_pk_bf16_f32 v59, v122, v123
    s_mov_b32 s53, 8192
    buffer_store_dwordx4 v[56:59], v10, s[36:39], s53 offen offset:1024 sc1
    v_mfma_f32_16x16x32_bf16 v[72:75], v[68:71], v[56:59], v[72:75]
    s_add_u32 m0, s93, 16384
    s_nop 0
    buffer_load_dwordx4 v11, s[20:23], s92 offen lds
    buffer_load_dwordx4 v12, s[20:23], s92 offen offset:1024 lds
    s_add_u32 s92, s92, 32768
    v_accvgpr_read_b32 v108, a72
    v_accvgpr_read_b32 v109, a73
    v_accvgpr_read_b32 v110, a74
    v_accvgpr_read_b32 v111, a75
    v_accvgpr_read_b32 v112, a88
    v_accvgpr_read_b32 v113, a89
    v_accvgpr_read_b32 v114, a90
    v_accvgpr_read_b32 v115, a91
    v_pk_mul_f32 v[108:109], v[108:109], v[66:67] op_sel_hi:[1,0]
    v_pk_mul_f32 v[110:111], v[110:111], v[66:67] op_sel_hi:[1,0]
    v_pk_mul_f32 v[112:113], v[112:113], v[66:67] op_sel_hi:[1,0]
    v_pk_mul_f32 v[114:115], v[114:115], v[66:67] op_sel_hi:[1,0]
    v_cvt_pk_bf16_f32 v52, v108, v109
    v_cvt_pk_bf16_f32 v53, v110, v111
    v_cvt_pk_bf16_f32 v54, v112, v113
    v_cvt_pk_bf16_f32 v55, v114, v115
    s_mov_b32 s53, 8192
    buffer_store_dwordx4 v[52:55], v10, s[36:39], s53 offen offset:2048 sc1
    v_mfma_f32_16x16x32_bf16 v[72:75], v[68:71], v[52:55], v[72:75]
    s_add_u32 m0, s93, 8192
    s_nop 0
    buffer_load_dwordx4 v10, s[12:15], s90 offen sc1 lds
    buffer_load_dwordx4 v10, s[12:15], s90 offen offset:1024 sc1 lds
    s_add_u32 s90, s90, 4096
    v_accvgpr_read_b32 v116, a76
    v_accvgpr_read_b32 v117, a77
    v_accvgpr_read_b32 v118, a78
    v_accvgpr_read_b32 v119, a79
    v_accvgpr_read_b32 v120, a92
    v_accvgpr_read_b32 v121, a93
    v_accvgpr_read_b32 v122, a94
    v_accvgpr_read_b32 v123, a95
    v_pk_mul_f32 v[116:117], v[116:117], v[66:67] op_sel:[0,1] op_sel_hi:[1,1]
    v_pk_mul_f32 v[118:119], v[118:119], v[66:67] op_sel:[0,1] op_sel_hi:[1,1]
    v_pk_mul_f32 v[120:121], v[120:121], v[66:67] op_sel:[0,1] op_sel_hi:[1,1]
    v_pk_mul_f32 v[122:123], v[122:123], v[66:67] op_sel:[0,1] op_sel_hi:[1,1]
    v_cvt_pk_bf16_f32 v56, v116, v117
    v_cvt_pk_bf16_f32 v57, v118, v119
    v_cvt_pk_bf16_f32 v58, v120, v121
    v_cvt_pk_bf16_f32 v59, v122, v123
    s_mov_b32 s53, 8192
    buffer_store_dwordx4 v[56:59], v10, s[36:39], s53 offen offset:3072 sc1
    v_mfma_f32_16x16x32_bf16 v[72:75], v[68:71], v[56:59], v[72:75]
    s_add_u32 m0, s93, 24576
    s_nop 0
    buffer_load_dwordx4 v10, s[12:15], s90 offen sc1 lds
    buffer_load_dwordx4 v10, s[12:15], s90 offen offset:1024 sc1 lds
    s_add_u32 s90, s90, 4096
    v_accvgpr_read_b32 v108, a96
    v_accvgpr_read_b32 v109, a97
    v_accvgpr_read_b32 v110, a98
    v_accvgpr_read_b32 v111, a99
    v_accvgpr_read_b32 v112, a112
    v_accvgpr_read_b32 v113, a113
    v_accvgpr_read_b32 v114, a114
    v_accvgpr_read_b32 v115, a115
    v_pk_mul_f32 v[108:109], v[108:109], v[64:65] op_sel_hi:[1,0]
    v_pk_mul_f32 v[110:111], v[110:111], v[64:65] op_sel_hi:[1,0]
    v_pk_mul_f32 v[112:113], v[112:113], v[64:65] op_sel_hi:[1,0]
    v_pk_mul_f32 v[114:115], v[114:115], v[64:65] op_sel_hi:[1,0]
    v_cvt_pk_bf16_f32 v52, v108, v109
    v_cvt_pk_bf16_f32 v53, v110, v111
    v_cvt_pk_bf16_f32 v54, v112, v113
    v_cvt_pk_bf16_f32 v55, v114, v115
    s_mov_b32 s53, 12288
    buffer_store_dwordx4 v[52:55], v10, s[36:39], s53 offen offset:0 sc1
    v_mfma_f32_16x16x32_bf16 v[72:75], v[68:71], v[52:55], v[72:75]
    s_add_u32 m0, s93, 32768
    s_nop 0
    buffer_load_dwordx4 v11, s[20:23], s92 offen lds
    buffer_load_dwordx4 v12, s[20:23], s92 offen offset:1024 lds
    s_add_u32 s92, s92, 32768
    v_accvgpr_read_b32 v116, a100
    v_accvgpr_read_b32 v117, a101
    v_accvgpr_read_b32 v118, a102
    v_accvgpr_read_b32 v119, a103
    v_accvgpr_read_b32 v120, a116
    v_accvgpr_read_b32 v121, a117
    v_accvgpr_read_b32 v122, a118
    v_accvgpr_read_b32 v123, a119
    v_pk_mul_f32 v[116:117], v[116:117], v[64:65] op_sel:[0,1] op_sel_hi:[1,1]
    v_pk_mul_f32 v[118:119], v[118:119], v[64:65] op_sel:[0,1] op_sel_hi:[1,1]
    v_pk_mul_f32 v[120:121], v[120:121], v[64:65] op_sel:[0,1] op_sel_hi:[1,1]
    v_pk_mul_f32 v[122:123], v[122:123], v[64:65] op_sel:[0,1] op_sel_hi:[1,1]
    v_cvt_pk_bf16_f32 v56, v116, v117
    v_cvt_pk_bf16_f32 v57, v118, v119
    v_cvt_pk_bf16_f32 v58, v120, v121
    v_cvt_pk_bf16_f32 v59, v122, v123
    s_mov_b32 s53, 12288
    buffer_store_dwordx4 v[56:59], v10, s[36:39], s53 offen offset:1024 sc1
    v_mfma_f32_16x16x32_bf16 v[72:75], v[68:71], v[56:59], v[72:75]
    s_add_u32 m0, s93, 49152
    s_nop 0
    buffer_load_dwordx4 v11, s[20:23], s92 offen lds
    buffer_load_dwordx4 v12, s[20:23], s92 offen offset:1024 lds
    s_add_u32 s92, s92, 32768
    v_accvgpr_read_b32 v108, a104
    v_accvgpr_read_b32 v109, a105
    v_accvgpr_read_b32 v110, a106
    v_accvgpr_read_b32 v111, a107
    v_accvgpr_read_b32 v112, a120
    v_accvgpr_read_b32 v113, a121
    v_accvgpr_read_b32 v114, a122
    v_accvgpr_read_b32 v115, a123
    v_pk_mul_f32 v[108:109], v[108:109], v[66:67] op_sel_hi:[1,0]
    v_pk_mul_f32 v[110:111], v[110:111], v[66:67] op_sel_hi:[1,0]
    v_pk_mul_f32 v[112:113], v[112:113], v[66:67] op_sel_hi:[1,0]
    v_pk_mul_f32 v[114:115], v[114:115], v[66:67] op_sel_hi:[1,0]
    v_cvt_pk_bf16_f32 v52, v108, v109
    v_cvt_pk_bf16_f32 v53, v110, v111
    v_cvt_pk_bf16_f32 v54, v112, v113
    v_cvt_pk_bf16_f32 v55, v114, v115
    s_mov_b32 s53, 12288
    buffer_store_dwordx4 v[52:55], v10, s[36:39], s53 offen offset:2048 sc1
    v_mfma_f32_16x16x32_bf16 v[72:75], v[68:71], v[52:55], v[72:75]
    s_add_u32 m0, s93, 40960
    s_nop 0
    buffer_load_dwordx4 v10, s[12:15], s90 offen sc1 lds
    buffer_load_dwordx4 v10, s[12:15], s90 offen offset:1024 sc1 lds
    s_add_u32 s90, s90, 4096
    v_accvgpr_read_b32 v116, a108
    v_accvgpr_read_b32 v117, a109
    v_accvgpr_read_b32 v118, a110
    v_accvgpr_read_b32 v119, a111
    v_accvgpr_read_b32 v120, a124
    v_accvgpr_read_b32 v121, a125
    v_accvgpr_read_b32 v122, a126
    v_accvgpr_read_b32 v123, a127
    v_pk_mul_f32 v[116:117], v[116:117], v[66:67] op_sel:[0,1] op_sel_hi:[1,1]
    v_pk_mul_f32 v[118:119], v[118:119], v[66:67] op_sel:[0,1] op_sel_hi:[1,1]
    v_pk_mul_f32 v[120:121], v[120:121], v[66:67] op_sel:[0,1] op_sel_hi:[1,1]
    v_pk_mul_f32 v[122:123], v[122:123], v[66:67] op_sel:[0,1] op_sel_hi:[1,1]
    v_cvt_pk_bf16_f32 v56, v116, v117
    v_cvt_pk_bf16_f32 v57, v118, v119
    v_cvt_pk_bf16_f32 v58, v120, v121
    v_cvt_pk_bf16_f32 v59, v122, v123
    s_mov_b32 s53, 12288
    buffer_store_dwordx4 v[56:59], v10, s[36:39], s53 offen offset:3072 sc1
    v_mfma_f32_16x16x32_bf16 v[72:75], v[68:71], v[56:59], v[72:75]
    s_add_u32 m0, s93, 57344
    s_nop 0
    buffer_load_dwordx4 v10, s[12:15], s90 offen sc1 lds
    buffer_load_dwordx4 v10, s[12:15], s90 offen offset:1024 sc1 lds
    s_add_u32 s90, s90, 4096
    s_nop 7
    s_mov_b32 s52, 0x7f800000
    v_cmp_nlt_f32_e64 vcc, abs(v72), s52
    s_nop 0
    s_or_b64 s[94:95], s[94:95], vcc
    s_cmp_eq_u64 s[94:95], 0
    s_cbranch_scc1 KF_nobad
    v_mov_b32 v2, 148480
    v_mov_b32 v3, 1
    ds_write_b32 v2, v3
KF_nobad:
    s_waitcnt lgkmcnt(0)
    s_barrier
    v_mov_b32 v2, 148480
    ds_read_b64 v[4:5], v2
    s_waitcnt lgkmcnt(0)
    v_readfirstlane_b32 s51, v4
    v_readfirstlane_b32 s54, v5
    s_nop 3
    s_cmp_eq_u32 s44, 0
    s_cbranch_scc0 KF_tail
    s_cmp_eq_u32 s51, 0
    s_cbranch_scc1 KF_tail
    s_mov_b32 s44, 1
    s_waitcnt vmcnt(0)
    s_barrier
    s_lshl_b32 s54, s3, 14
    v_and_b32 v108, 0xfff, v34
    v_add_u32 v108, s54, v108
    v_and_b32 v109, 0xfff, v35
    v_add_u32 v109, s54, v109
    v_and_b32 v110, 0xfff, v36
    v_add_u32 v110, s54, v110
    v_and_b32 v111, 0xfff, v37
    v_add_u32 v111, s54, v111
    v_and_b32 v112, 0xfff, v38
    v_add_u32 v112, s54, v112
    v_add_u32 v112, 0x2000, v112
    v_and_b32 v113, 0xfff, v39
    v_add_u32 v113, s54, v113
    v_add_u32 v113, 0x2000, v113
    v_and_b32 v114, 0xfff, v40
    v_add_u32 v114, s54, v114
    v_add_u32 v114, 0x2000, v114
    v_and_b32 v115, 0xfff, v41
    v_add_u32 v115, s54, v115
    v_add_u32 v115, 0x2000, v115
    v_and_b32 v116, 0xfff, v42
    v_add_u32 v116, s54, v116
    v_add_u32 v116, 0x2000, v116
    v_and_b32 v117, 0xfff, v43
    v_add_u32 v117, s54, v117
    v_add_u32 v117, 0x2000, v117
    v_and_b32 v118, 0xfff, v44
    v_add_u32 v118, s54, v118
    v_add_u32 v118, 0x2000, v118
    v_and_b32 v119, 0xfff, v45
    v_add_u32 v119, s54, v119
    v_add_u32 v119, 0x2000, v119
    v_accvgpr_write_b32 a0, 0
    v_accvgpr_write_b32 a1, 0
    v_accvgpr_write_b32 a2, 0
    v_accvgpr_write_b32 a3, 0
    v_accvgpr_write_b32 a4, 0
    v_accvgpr_write_b32 a5, 0
    v_accvgpr_write_b32 a6, 0
    v_accvgpr_write_b32 a7, 0
    v_accvgpr_write_b32 a8, 0
    v_accvgpr_write_b32 a9, 0
    v_accvgpr_write_b32 a10, 0
    v_accvgpr_write_b32 a11, 0
    v_accvgpr_write_b32 a12, 0
    v_accvgpr_write_b32 a13, 0
    v_accvgpr_write_b32 a14, 0
    v_accvgpr_write_b32 a15, 0
    v_accvgpr_write_b32 a16, 0
    v_accvgpr_write_b32 a17, 0
    v_accvgpr_write_b32 a18, 0
    v_accvgpr_write_b32 a19, 0
    v_accvgpr_write_b32 a20, 0
    v_accvgpr_write_b32 a21, 0
    v_accvgpr_write_b32 a22, 0
    v_accvgpr_write_b32 a23, 0
    v_accvgpr_write_b32 a24, 0
    v_accvgpr_write_b32 a25, 0
    v_accvgpr_write_b32 a26, 0
    v_accvgpr_write_b32 a27, 0
    v_accvgpr_write_b32 a28, 0
    v_accvgpr_write_b32 a29, 0
    v_accvgpr_write_b32 a30, 0
    v_accvgpr_write_b32 a31, 0
    v_accvgpr_write_b32 a32, 0
    v_accvgpr_write_b32 a33, 0
    v_accvgpr_write_b32 a34, 0
    v_accvgpr_write_b32 a35, 0
    v_accvgpr_write_b32 a36, 0
    v_accvgpr_write_b32 a37, 0
    v_accvgpr_write_b32 a38, 0
    v_accvgpr_write_b32 a39, 0
    v_accvgpr_write_b32 a40, 0
    v_accvgpr_write_b32 a41, 0
    v_accvgpr_write_b32 a42, 0
    v_accvgpr_write_b32 a43, 0
    v_accvgpr_write_b32 a44, 0
    v_accvgpr_write_b32 a45, 0
    v_accvgpr_write_b32 a46, 0
    v_accvgpr_write_b32 a47, 0
    v_accvgpr_write_b32 a48, 0
    v_accvgpr_write_b32 a49, 0
    v_accvgpr_write_b32 a50, 0
    v_accvgpr_write_b32 a51, 0
    v_accvgpr_write_b32 a52, 0
    v_accvgpr_write_b32 a53, 0
    v_accvgpr_write_b32 a54, 0
    v_accvgpr_write_b32 a55, 0
    v_accvgpr_write_b32 a56, 0
    v_accvgpr_write_b32 a57, 0
    v_accvgpr_write_b32 a58, 0
    v_accvgpr_write_b32 a59, 0
    v_accvgpr_write_b32 a60, 0
    v_accvgpr_write_b32 a61, 0
    v_accvgpr_write_b32 a62, 0
    v_accvgpr_write_b32 a63, 0
    v_accvgpr_write_b32 a64, 0
    v_accvgpr_write_b32 a65, 0
    v_accvgpr_write_b32 a66, 0
    v_accvgpr_write_b32 a67, 0
    v_accvgpr_write_b32 a68, 0
    v_accvgpr_write_b32 a69, 0
    v_accvgpr_write_b32 a70, 0
    v_accvgpr_write_b32 a71, 0
    v_accvgpr_write_b32 a72, 0
    v_accvgpr_write_b32 a73, 0
    v_accvgpr_write_b32 a74, 0
    v_accvgpr_write_b32 a75, 0
    v_accvgpr_write_b32 a76, 0
    v_accvgpr_write_b32 a77, 0
    v_accvgpr_write_b32 a78, 0
    v_accvgpr_write_b32 a79, 0
    v_accvgpr_write_b32 a80, 0
    v_accvgpr_write_b32 a81, 0
    v_accvgpr_write_b32 a82, 0
    v_accvgpr_write_b32 a83, 0
    v_accvgpr_write_b32 a84, 0
    v_accvgpr_write_b32 a85, 0
    v_accvgpr_write_b32 a86, 0
    v_accvgpr_write_b32 a87, 0
    v_accvgpr_write_b32 a88, 0
    v_accvgpr_write_b32 a89, 0
    v_accvgpr_write_b32 a90, 0
    v_accvgpr_write_b32 a91, 0
    v_accvgpr_write_b32 a92, 0
    v_accvgpr_write_b32 a93, 0
    v_accvgpr_write_b32 a94, 0
    v_accvgpr_write_b32 a95, 0
    v_accvgpr_write_b32 a96, 0
    v_accvgpr_write_b32 a97, 0
    v_accvgpr_write_b32 a98, 0
    v_accvgpr_write_b32 a99, 0
    v_accvgpr_write_b32 a100, 0
    v_accvgpr_write_b32 a101, 0
    v_accvgpr_write_b32 a102, 0
    v_accvgpr_write_b32 a103, 0
    v_accvgpr_write_b32 a104, 0
    v_accvgpr_write_b32 a105, 0
    v_accvgpr_write_b32 a106, 0
    v_accvgpr_write_b32 a107, 0
    v_accvgpr_write_b32 a108, 0
    v_accvgpr_write_b32 a109, 0
    v_accvgpr_write_b32 a110, 0
    v_accvgpr_write_b32 a111, 0
    v_accvgpr_write_b32 a112, 0
    v_accvgpr_write_b32 a113, 0
    v_accvgpr_write_b32 a114, 0
    v_accvgpr_write_b32 a115, 0
    v_accvgpr_write_b32 a116, 0
    v_accvgpr_write_b32 a117, 0
    v_accvgpr_write_b32 a118, 0
    v_accvgpr_write_b32 a119, 0
    v_accvgpr_write_b32 a120, 0
    v_accvgpr_write_b32 a121, 0
    v_accvgpr_write_b32 a122, 0
    v_accvgpr_write_b32 a123, 0
    v_accvgpr_write_b32 a124, 0
    v_accvgpr_write_b32 a125, 0
    v_accvgpr_write_b32 a126, 0
    v_accvgpr_write_b32 a127, 0
    v_mov_b32 v48, 0
    v_mov_b32 v49, 0
    v_mov_b32 v50, 0
    v_mov_b32 v51, 0
    v_mov_b32 v140, 0xff800000
    v_mov_b32 v141, 0xff800000
    v_mov_b32 v142, 0xff800000
    v_mov_b32 v143, 0xff800000
    s_mov_b32 s45, 0
    s_mov_b32 s46, 4096
    s_mov_b32 s51, 0
    s_mov_b32 s49, s54
    s_add_u32 s50, s54, 0x2000
KF_slow:
    s_mov_b32 m0, s49
    s_nop 0
    buffer_load_dwordx4 v46, s[24:27], s45 offen offset:0 lds
    buffer_load_dwordx4 v47, s[24:27], s45 offen offset:1024 lds
    buffer_load_dwordx4 v46, s[24:27], s45 offen offset:2048 lds
    buffer_load_dwordx4 v47, s[24:27], s45 offen offset:3072 lds
    s_add_u32 m0, s49, 4096
    s_nop 0
    buffer_load_dwordx4 v46, s[24:27], s46 offen offset:0 lds
    buffer_load_dwordx4 v47, s[24:27], s46 offen offset:1024 lds
    buffer_load_dwordx4 v46, s[24:27], s46 offen offset:2048 lds
    buffer_load_dwordx4 v47, s[24:27], s46 offen offset:3072 lds
    s_mov_b32 m0, s50
    s_nop 0
    buffer_load_dwordx4 v46, s[28:31], s45 offen offset:0 lds
    buffer_load_dwordx4 v47, s[28:31], s45 offen offset:1024 lds
    buffer_load_dwordx4 v46, s[28:31], s45 offen offset:2048 lds
    buffer_load_dwordx4 v47, s[28:31], s45 offen offset:3072 lds
    s_add_u32 m0, s50, 4096
    s_nop 0
    buffer_load_dwordx4 v46, s[28:31], s46 offen offset:0 lds
    buffer_load_dwordx4 v47, s[28:31], s46 offen offset:1024 lds
    buffer_load_dwordx4 v46, s[28:31], s46 offen offset:2048 lds
    buffer_load_dwordx4 v47, s[28:31], s46 offen offset:3072 lds
    s_waitcnt vmcnt(0)
    ds_read_b128 a[192:195], v108 offset:0
    ds_read_b128 a[196:199], v109 offset:0
    ds_read_b128 a[200:203], v110 offset:0
    ds_read_b128 a[204:207], v111 offset:0
    ds_read_b128 a[208:211], v108 offset:4096
    ds_read_b128 a[212:215], v109 offset:4096
    ds_read_b128 a[216:219], v110 offset:4096
    ds_read_b128 a[220:223], v111 offset:4096
    s_waitcnt lgkmcnt(0)
    ds_read_b64_tr_b16 a[224:225], v112 offset:0
    ds_read_b64_tr_b16 a[226:227], v112 offset:4096
    ds_read_b64_tr_b16 a[228:229], v113 offset:0
    ds_read_b64_tr_b16 a[230:231], v113 offset:4096
    ds_read_b64_tr_b16 a[232:233], v114 offset:0
    ds_read_b64_tr_b16 a[234:235], v114 offset:4096
    ds_read_b64_tr_b16 a[236:237], v115 offset:0
    ds_read_b64_tr_b16 a[238:239], v115 offset:4096
    ds_read_b64_tr_b16 a[240:241], v116 offset:0
    ds_read_b64_tr_b16 a[242:243], v116 offset:4096
    ds_read_b64_tr_b16 a[244:245], v117 offset:0
    ds_read_b64_tr_b16 a[246:247], v117 offset:4096
    ds_read_b64_tr_b16 a[248:249], v118 offset:0
    ds_read_b64_tr_b16 a[250:251], v118 offset:4096
    ds_read_b64_tr_b16 a[252:253], v119 offset:0
    ds_read_b64_tr_b16 a[254:255], v119 offset:4096
    v_mfma_f32_16x16x32_bf16 v[76:79], a[192:195], a[128:131], 0
    v_mfma_f32_16x16x32_bf16 v[80:83], a[192:195], a[144:147], 0
    v_mfma_f32_16x16x32_bf16 v[84:87], a[192:195], a[160:163], 0
    v_mfma_f32_16x16x32_bf16 v[88:91], a[192:195], a[176:179], 0
    v_mfma_f32_16x16x32_bf16 v[76:79], a[196:199], a[132:135], v[76:79]
    v_mfma_f32_16x16x32_bf16 v[80:83], a[196:199], a[148:151], v[80:83]
    v_mfma_f32_16x16x32_bf16 v[84:87], a[196:199], a[164:167], v[84:87]
    v_mfma_f32_16x16x32_bf16 v[88:91], a[196:199], a[180:183], v[88:91]
    v_mfma_f32_16x16x32_bf16 v[76:79], a[200:203], a[136:139], v[76:79]
    v_mfma_f32_16x16x32_bf16 v[80:83], a[200:203], a[152:155], v[80:83]
    v_mfma_f32_16x16x32_bf16 v[84:87], a[200:203], a[168:171], v[84:87]
    v_mfma_f32_16x16x32_bf16 v[88:91], a[200:203], a[184:187], v[88:91]
    v_mfma_f32_16x16x32_bf16 v[76:79], a[204:207], a[140:143], v[76:79]
    v_mfma_f32_16x16x32_bf16 v[80:83], a[204:207], a[156:159], v[80:83]
    v_mfma_f32_16x16x32_bf16 v[84:87], a[204:207], a[172:175], v[84:87]
    v_mfma_f32_16x16x32_bf16 v[88:91], a[204:207], a[188:191], v[88:91]
    v_mfma_f32_16x16x32_bf16 v[92:95], a[208:211], a[128:131], 0
    v_mfma_f32_16x16x32_bf16 v[96:99], a[208:211], a[144:147], 0
    v_mfma_f32_16x16x32_bf16 v[100:103], a[208:211], a[160:163], 0
    v_mfma_f32_16x16x32_bf16 v[104:107], a[208:211], a[176:179], 0
    v_mfma_f32_16x16x32_bf16 v[92:95], a[212:215], a[132:135], v[92:95]
    v_mfma_f32_16x16x32_bf16 v[96:99], a[212:215], a[148:151], v[96:99]
    v_mfma_f32_16x16x32_bf16 v[100:103], a[212:215], a[164:167], v[100:103]
    v_mfma_f32_16x16x32_bf16 v[104:107], a[212:215], a[180:183], v[104:107]
    v_mfma_f32_16x16x32_bf16 v[92:95], a[216:219], a[136:139], v[92:95]
    v_mfma_f32_16x16x32_bf16 v[96:99], a[216:219], a[152:155], v[96:99]
    v_mfma_f32_16x16x32_bf16 v[100:103], a[216:219], a[168:171], v[100:103]
    v_mfma_f32_16x16x32_bf16 v[104:107], a[216:219], a[184:187], v[104:107]
    v_mfma_f32_16x16x32_bf16 v[92:95], a[220:223], a[140:143], v[92:95]
    v_mfma_f32_16x16x32_bf16 v[96:99], a[220:223], a[156:159], v[96:99]
    v_mfma_f32_16x16x32_bf16 v[100:103], a[220:223], a[172:175], v[100:103]
    v_mfma_f32_16x16x32_bf16 v[104:107], a[220:223], a[188:191], v[104:107]
    s_nop 7
    v_max3_f32 v68, v76, v77, v78
    v_max3_f32 v68, v68, v79, v92
    v_max3_f32 v68, v68, v93, v94
    v_max3_f32 v68, v68, v95, v140
    v_max3_f32 v69, v80, v81, v82
    v_max3_f32 v69, v69, v83, v96
    v_max3_f32 v69, v69, v97, v98
    v_max3_f32 v69, v69, v99, v141
    v_max3_f32 v70, v84, v85, v86
    v_max3_f32 v70, v70, v87, v100
    v_max3_f32 v70, v70, v101, v102
    v_max3_f32 v70, v70, v103, v142
    v_max3_f32 v71, v88, v89, v90
    v_max3_f32 v71, v71, v91, v104
    v_max3_f32 v71, v71, v105, v106
    v_max3_f32 v71, v71, v107, v143
    v_mov_b32 v72, v68
    v_mov_b32 v73, v69
    v_mov_b32 v74, v70
    v_mov_b32 v75, v71
    s_nop 1
    v_permlane16_swap_b32 v68, v72
    v_permlane16_swap_b32 v69, v73
    v_permlane16_swap_b32 v70, v74
    v_permlane16_swap_b32 v71, v75
    s_nop 1
    v_max_f32 v68, v68, v72
    v_max_f32 v69, v69, v73
    v_max_f32 v70, v70, v74
    v_max_f32 v71, v71, v75
    v_mov_b32 v72, v68
    v_mov_b32 v73, v69
    v_mov_b32 v74, v70
    v_mov_b32 v75, v71
    s_nop 1
    v_permlane32_swap_b32 v68, v72
    v_permlane32_swap_b32 v69, v73
    v_permlane32_swap_b32 v70, v74
    v_permlane32_swap_b32 v71, v75
    s_nop 1
    v_max_f32 v68, v68, v72
    v_max_f32 v69, v69, v73
    v_max_f32 v70, v70, v74
    v_max_f32 v71, v71, v75
    v_sub_f32 v64, v140, v68
    v_sub_f32 v65, v141, v69
    v_sub_f32 v66, v142, v70
    v_sub_f32 v67, v143, v71
    v_exp_f32 v64, v64
    v_exp_f32 v65, v65
    v_exp_f32 v66, v66
    v_exp_f32 v67, v67
    v_mov_b32 v140, v68
    v_mov_b32 v141, v69
    v_mov_b32 v142, v70
    v_mov_b32 v143, v71
    v_mul_f32 v48, v48, v64
    v_mul_f32 v49, v49, v65
    v_mul_f32 v50, v50, v66
    v_mul_f32 v51, v51, v67
    v_sub_f32 v76, v76, v68
    v_sub_f32 v77, v77, v68
    v_sub_f32 v78, v78, v68
    v_sub_f32 v79, v79, v68
    v_exp_f32 v76, v76
    v_exp_f32 v77, v77
    v_exp_f32 v78, v78
    v_exp_f32 v79, v79
    s_nop 0
    v_add_f32 v48, v48, v76
    v_add_f32 v48, v48, v77
    v_add_f32 v48, v48, v78
    v_add_f32 v48, v48, v79
    v_cvt_pk_bf16_f32 v156, v76, v77
    v_cvt_pk_bf16_f32 v157, v78, v79
    v_sub_f32 v92, v92, v68
    v_sub_f32 v93, v93, v68
    v_sub_f32 v94, v94, v68
    v_sub_f32 v95, v95, v68
    v_exp_f32 v92, v92
    v_exp_f32 v93, v93
    v_exp_f32 v94, v94
    v_exp_f32 v95, v95
    s_nop 0
    v_add_f32 v48, v48, v92
    v_add_f32 v48, v48, v93
    v_add_f32 v48, v48, v94
    v_add_f32 v48, v48, v95
    v_cvt_pk_bf16_f32 v158, v92, v93
    v_cvt_pk_bf16_f32 v159, v94, v95
    v_sub_f32 v80, v80, v69
    v_sub_f32 v81, v81, v69
    v_sub_f32 v82, v82, v69
    v_sub_f32 v83, v83, v69
    v_exp_f32 v80, v80
    v_exp_f32 v81, v81
    v_exp_f32 v82, v82
    v_exp_f32 v83, v83
    s_nop 0
    v_add_f32 v49, v49, v80
    v_add_f32 v49, v49, v81
    v_add_f32 v49, v49, v82
    v_add_f32 v49, v49, v83
    v_cvt_pk_bf16_f32 v160, v80, v81
    v_cvt_pk_bf16_f32 v161, v82, v83
    v_sub_f32 v96, v96, v69
    v_sub_f32 v97, v97, v69
    v_sub_f32 v98, v98, v69
    v_sub_f32 v99, v99, v69
    v_exp_f32 v96, v96
    v_exp_f32 v97, v97
    v_exp_f32 v98, v98
    v_exp_f32 v99, v99
    s_nop 0
    v_add_f32 v49, v49, v96
    v_add_f32 v49, v49, v97
    v_add_f32 v49, v49, v98
    v_add_f32 v49, v49, v99
    v_cvt_pk_bf16_f32 v162, v96, v97
    v_cvt_pk_bf16_f32 v163, v98, v99
    v_sub_f32 v84, v84, v70
    v_sub_f32 v85, v85, v70
    v_sub_f32 v86, v86, v70
    v_sub_f32 v87, v87, v70
    v_exp_f32 v84, v84
    v_exp_f32 v85, v85
    v_exp_f32 v86, v86
    v_exp_f32 v87, v87
    s_nop 0
    v_add_f32 v50, v50, v84
    v_add_f32 v50, v50, v85
    v_add_f32 v50, v50, v86
    v_add_f32 v50, v50, v87
    v_cvt_pk_bf16_f32 v164, v84, v85
    v_cvt_pk_bf16_f32 v165, v86, v87
    v_sub_f32 v100, v100, v70
    v_sub_f32 v101, v101, v70
    v_sub_f32 v102, v102, v70
    v_sub_f32 v103, v103, v70
    v_exp_f32 v100, v100
    v_exp_f32 v101, v101
    v_exp_f32 v102, v102
    v_exp_f32 v103, v103
    s_nop 0
    v_add_f32 v50, v50, v100
    v_add_f32 v50, v50, v101
    v_add_f32 v50, v50, v102
    v_add_f32 v50, v50, v103
    v_cvt_pk_bf16_f32 v166, v100, v101
    v_cvt_pk_bf16_f32 v167, v102, v103
    v_sub_f32 v88, v88, v71
    v_sub_f32 v89, v89, v71
    v_sub_f32 v90, v90, v71
    v_sub_f32 v91, v91, v71
    v_exp_f32 v88, v88
    v_exp_f32 v89, v89
    v_exp_f32 v90, v90
    v_exp_f32 v91, v91
    s_nop 0
    v_add_f32 v51, v51, v88
    v_add_f32 v51, v51, v89
    v_add_f32 v51, v51, v90
    v_add_f32 v51, v51, v91
    v_cvt_pk_bf16_f32 v168, v88, v89
    v_cvt_pk_bf16_f32 v169, v90, v91
    v_sub_f32 v104, v104, v71
    v_sub_f32 v105, v105, v71
    v_sub_f32 v106, v106, v71
    v_sub_f32 v107, v107, v71
    v_exp_f32 v104, v104
    v_exp_f32 v105, v105
    v_exp_f32 v106, v106
    v_exp_f32 v107, v107
    s_nop 0
    v_add_f32 v51, v51, v104
    v_add_f32 v51, v51, v105
    v_add_f32 v51, v51, v106
    v_add_f32 v51, v51, v107
    v_cvt_pk_bf16_f32 v170, v104, v105
    v_cvt_pk_bf16_f32 v171, v106, v107
    v_accvgpr_read_b32 v52, a0
    v_accvgpr_read_b32 v53, a1
    v_accvgpr_read_b32 v54, a2
    v_accvgpr_read_b32 v55, a3
    v_mul_f32 v52, v52, v64
    v_mul_f32 v53, v53, v64
    v_mul_f32 v54, v54, v64
    v_mul_f32 v55, v55, v64
    v_accvgpr_write_b32 a0, v52
    v_accvgpr_write_b32 a1, v53
    v_accvgpr_write_b32 a2, v54
    v_accvgpr_write_b32 a3, v55
    v_accvgpr_read_b32 v52, a4
    v_accvgpr_read_b32 v53, a5
    v_accvgpr_read_b32 v54, a6
    v_accvgpr_read_b32 v55, a7
    v_mul_f32 v52, v52, v65
    v_mul_f32 v53, v53, v65
    v_mul_f32 v54, v54, v65
    v_mul_f32 v55, v55, v65
    v_accvgpr_write_b32 a4, v52
    v_accvgpr_write_b32 a5, v53
    v_accvgpr_write_b32 a6, v54
    v_accvgpr_write_b32 a7, v55
    v_accvgpr_read_b32 v52, a8
    v_accvgpr_read_b32 v53, a9
    v_accvgpr_read_b32 v54, a10
    v_accvgpr_read_b32 v55, a11
    v_mul_f32 v52, v52, v66
    v_mul_f32 v53, v53, v66
    v_mul_f32 v54, v54, v66
    v_mul_f32 v55, v55, v66
    v_accvgpr_write_b32 a8, v52
    v_accvgpr_write_b32 a9, v53
    v_accvgpr_write_b32 a10, v54
    v_accvgpr_write_b32 a11, v55
    v_accvgpr_read_b32 v52, a12
    v_accvgpr_read_b32 v53, a13
    v_accvgpr_read_b32 v54, a14
    v_accvgpr_read_b32 v55, a15
    v_mul_f32 v52, v52, v67
    v_mul_f32 v53, v53, v67
    v_mul_f32 v54, v54, v67
    v_mul_f32 v55, v55, v67
    v_accvgpr_write_b32 a12, v52
    v_accvgpr_write_b32 a13, v53
    v_accvgpr_write_b32 a14, v54
    v_accvgpr_write_b32 a15, v55
    v_accvgpr_read_b32 v52, a16
    v_accvgpr_read_b32 v53, a17
    v_accvgpr_read_b32 v54, a18
    v_accvgpr_read_b32 v55, a19
    v_mul_f32 v52, v52, v64
    v_mul_f32 v53, v53, v64
    v_mul_f32 v54, v54, v64
    v_mul_f32 v55, v55, v64
    v_accvgpr_write_b32 a16, v52
    v_accvgpr_write_b32 a17, v53
    v_accvgpr_write_b32 a18, v54
    v_accvgpr_write_b32 a19, v55
    v_accvgpr_read_b32 v52, a20
    v_accvgpr_read_b32 v53, a21
    v_accvgpr_read_b32 v54, a22
    v_accvgpr_read_b32 v55, a23
    v_mul_f32 v52, v52, v65
    v_mul_f32 v53, v53, v65
    v_mul_f32 v54, v54, v65
    v_mul_f32 v55, v55, v65
    v_accvgpr_write_b32 a20, v52
    v_accvgpr_write_b32 a21, v53
    v_accvgpr_write_b32 a22, v54
    v_accvgpr_write_b32 a23, v55
    v_accvgpr_read_b32 v52, a24
    v_accvgpr_read_b32 v53, a25
    v_accvgpr_read_b32 v54, a26
    v_accvgpr_read_b32 v55, a27
    v_mul_f32 v52, v52, v66
    v_mul_f32 v53, v53, v66
    v_mul_f32 v54, v54, v66
    v_mul_f32 v55, v55, v66
    v_accvgpr_write_b32 a24, v52
    v_accvgpr_write_b32 a25, v53
    v_accvgpr_write_b32 a26, v54
    v_accvgpr_write_b32 a27, v55
    v_accvgpr_read_b32 v52, a28
    v_accvgpr_read_b32 v53, a29
    v_accvgpr_read_b32 v54, a30
    v_accvgpr_read_b32 v55, a31
    v_mul_f32 v52, v52, v67
    v_mul_f32 v53, v53, v67
    v_mul_f32 v54, v54, v67
    v_mul_f32 v55, v55, v67
    v_accvgpr_write_b32 a28, v52
    v_accvgpr_write_b32 a29, v53
    v_accvgpr_write_b32 a30, v54
    v_accvgpr_write_b32 a31, v55
    v_accvgpr_read_b32 v52, a32
    v_accvgpr_read_b32 v53, a33
    v_accvgpr_read_b32 v54, a34
    v_accvgpr_read_b32 v55, a35
    v_mul_f32 v52, v52, v64
    v_mul_f32 v53, v53, v64
    v_mul_f32 v54, v54, v64
    v_mul_f32 v55, v55, v64
    v_accvgpr_write_b32 a32, v52
    v_accvgpr_write_b32 a33, v53
    v_accvgpr_write_b32 a34, v54
    v_accvgpr_write_b32 a35, v55
    v_accvgpr_read_b32 v52, a36
    v_accvgpr_read_b32 v53, a37
    v_accvgpr_read_b32 v54, a38
    v_accvgpr_read_b32 v55, a39
    v_mul_f32 v52, v52, v65
    v_mul_f32 v53, v53, v65
    v_mul_f32 v54, v54, v65
    v_mul_f32 v55, v55, v65
    v_accvgpr_write_b32 a36, v52
    v_accvgpr_write_b32 a37, v53
    v_accvgpr_write_b32 a38, v54
    v_accvgpr_write_b32 a39, v55
    v_accvgpr_read_b32 v52, a40
    v_accvgpr_read_b32 v53, a41
    v_accvgpr_read_b32 v54, a42
    v_accvgpr_read_b32 v55, a43
    v_mul_f32 v52, v52, v66
    v_mul_f32 v53, v53, v66
    v_mul_f32 v54, v54, v66
    v_mul_f32 v55, v55, v66
    v_accvgpr_write_b32 a40, v52
    v_accvgpr_write_b32 a41, v53
    v_accvgpr_write_b32 a42, v54
    v_accvgpr_write_b32 a43, v55
    v_accvgpr_read_b32 v52, a44
    v_accvgpr_read_b32 v53, a45
    v_accvgpr_read_b32 v54, a46
    v_accvgpr_read_b32 v55, a47
    v_mul_f32 v52, v52, v67
    v_mul_f32 v53, v53, v67
    v_mul_f32 v54, v54, v67
    v_mul_f32 v55, v55, v67
    v_accvgpr_write_b32 a44, v52
    v_accvgpr_write_b32 a45, v53
    v_accvgpr_write_b32 a46, v54
    v_accvgpr_write_b32 a47, v55
    v_accvgpr_read_b32 v52, a48
    v_accvgpr_read_b32 v53, a49
    v_accvgpr_read_b32 v54, a50
    v_accvgpr_read_b32 v55, a51
    v_mul_f32 v52, v52, v64
    v_mul_f32 v53, v53, v64
    v_mul_f32 v54, v54, v64
    v_mul_f32 v55, v55, v64
    v_accvgpr_write_b32 a48, v52
    v_accvgpr_write_b32 a49, v53
    v_accvgpr_write_b32 a50, v54
    v_accvgpr_write_b32 a51, v55
    v_accvgpr_read_b32 v52, a52
    v_accvgpr_read_b32 v53, a53
    v_accvgpr_read_b32 v54, a54
    v_accvgpr_read_b32 v55, a55
    v_mul_f32 v52, v52, v65
    v_mul_f32 v53, v53, v65
    v_mul_f32 v54, v54, v65
    v_mul_f32 v55, v55, v65
    v_accvgpr_write_b32 a52, v52
    v_accvgpr_write_b32 a53, v53
    v_accvgpr_write_b32 a54, v54
    v_accvgpr_write_b32 a55, v55
    v_accvgpr_read_b32 v52, a56
    v_accvgpr_read_b32 v53, a57
    v_accvgpr_read_b32 v54, a58
    v_accvgpr_read_b32 v55, a59
    v_mul_f32 v52, v52, v66
    v_mul_f32 v53, v53, v66
    v_mul_f32 v54, v54, v66
    v_mul_f32 v55, v55, v66
    v_accvgpr_write_b32 a56, v52
    v_accvgpr_write_b32 a57, v53
    v_accvgpr_write_b32 a58, v54
    v_accvgpr_write_b32 a59, v55
    v_accvgpr_read_b32 v52, a60
    v_accvgpr_read_b32 v53, a61
    v_accvgpr_read_b32 v54, a62
    v_accvgpr_read_b32 v55, a63
    v_mul_f32 v52, v52, v67
    v_mul_f32 v53, v53, v67
    v_mul_f32 v54, v54, v67
    v_mul_f32 v55, v55, v67
    v_accvgpr_write_b32 a60, v52
    v_accvgpr_write_b32 a61, v53
    v_accvgpr_write_b32 a62, v54
    v_accvgpr_write_b32 a63, v55
    v_accvgpr_read_b32 v52, a64
    v_accvgpr_read_b32 v53, a65
    v_accvgpr_read_b32 v54, a66
    v_accvgpr_read_b32 v55, a67
    v_mul_f32 v52, v52, v64
    v_mul_f32 v53, v53, v64
    v_mul_f32 v54, v54, v64
    v_mul_f32 v55, v55, v64
    v_accvgpr_write_b32 a64, v52
    v_accvgpr_write_b32 a65, v53
    v_accvgpr_write_b32 a66, v54
    v_accvgpr_write_b32 a67, v55
    v_accvgpr_read_b32 v52, a68
    v_accvgpr_read_b32 v53, a69
    v_accvgpr_read_b32 v54, a70
    v_accvgpr_read_b32 v55, a71
    v_mul_f32 v52, v52, v65
    v_mul_f32 v53, v53, v65
    v_mul_f32 v54, v54, v65
    v_mul_f32 v55, v55, v65
    v_accvgpr_write_b32 a68, v52
    v_accvgpr_write_b32 a69, v53
    v_accvgpr_write_b32 a70, v54
    v_accvgpr_write_b32 a71, v55
    v_accvgpr_read_b32 v52, a72
    v_accvgpr_read_b32 v53, a73
    v_accvgpr_read_b32 v54, a74
    v_accvgpr_read_b32 v55, a75
    v_mul_f32 v52, v52, v66
    v_mul_f32 v53, v53, v66
    v_mul_f32 v54, v54, v66
    v_mul_f32 v55, v55, v66
    v_accvgpr_write_b32 a72, v52
    v_accvgpr_write_b32 a73, v53
    v_accvgpr_write_b32 a74, v54
    v_accvgpr_write_b32 a75, v55
    v_accvgpr_read_b32 v52, a76
    v_accvgpr_read_b32 v53, a77
    v_accvgpr_read_b32 v54, a78
    v_accvgpr_read_b32 v55, a79
    v_mul_f32 v52, v52, v67
    v_mul_f32 v53, v53, v67
    v_mul_f32 v54, v54, v67
    v_mul_f32 v55, v55, v67
    v_accvgpr_write_b32 a76, v52
    v_accvgpr_write_b32 a77, v53
    v_accvgpr_write_b32 a78, v54
    v_accvgpr_write_b32 a79, v55
    v_accvgpr_read_b32 v52, a80
    v_accvgpr_read_b32 v53, a81
    v_accvgpr_read_b32 v54, a82
    v_accvgpr_read_b32 v55, a83
    v_mul_f32 v52, v52, v64
    v_mul_f32 v53, v53, v64
    v_mul_f32 v54, v54, v64
    v_mul_f32 v55, v55, v64
    v_accvgpr_write_b32 a80, v52
    v_accvgpr_write_b32 a81, v53
    v_accvgpr_write_b32 a82, v54
    v_accvgpr_write_b32 a83, v55
    v_accvgpr_read_b32 v52, a84
    v_accvgpr_read_b32 v53, a85
    v_accvgpr_read_b32 v54, a86
    v_accvgpr_read_b32 v55, a87
    v_mul_f32 v52, v52, v65
    v_mul_f32 v53, v53, v65
    v_mul_f32 v54, v54, v65
    v_mul_f32 v55, v55, v65
    v_accvgpr_write_b32 a84, v52
    v_accvgpr_write_b32 a85, v53
    v_accvgpr_write_b32 a86, v54
    v_accvgpr_write_b32 a87, v55
    v_accvgpr_read_b32 v52, a88
    v_accvgpr_read_b32 v53, a89
    v_accvgpr_read_b32 v54, a90
    v_accvgpr_read_b32 v55, a91
    v_mul_f32 v52, v52, v66
    v_mul_f32 v53, v53, v66
    v_mul_f32 v54, v54, v66
    v_mul_f32 v55, v55, v66
    v_accvgpr_write_b32 a88, v52
    v_accvgpr_write_b32 a89, v53
    v_accvgpr_write_b32 a90, v54
    v_accvgpr_write_b32 a91, v55
    v_accvgpr_read_b32 v52, a92
    v_accvgpr_read_b32 v53, a93
    v_accvgpr_read_b32 v54, a94
    v_accvgpr_read_b32 v55, a95
    v_mul_f32 v52, v52, v67
    v_mul_f32 v53, v53, v67
    v_mul_f32 v54, v54, v67
    v_mul_f32 v55, v55, v67
    v_accvgpr_write_b32 a92, v52
    v_accvgpr_write_b32 a93, v53
    v_accvgpr_write_b32 a94, v54
    v_accvgpr_write_b32 a95, v55
    v_accvgpr_read_b32 v52, a96
    v_accvgpr_read_b32 v53, a97
    v_accvgpr_read_b32 v54, a98
    v_accvgpr_read_b32 v55, a99
    v_mul_f32 v52, v52, v64
    v_mul_f32 v53, v53, v64
    v_mul_f32 v54, v54, v64
    v_mul_f32 v55, v55, v64
    v_accvgpr_write_b32 a96, v52
    v_accvgpr_write_b32 a97, v53
    v_accvgpr_write_b32 a98, v54
    v_accvgpr_write_b32 a99, v55
    v_accvgpr_read_b32 v52, a100
    v_accvgpr_read_b32 v53, a101
    v_accvgpr_read_b32 v54, a102
    v_accvgpr_read_b32 v55, a103
    v_mul_f32 v52, v52, v65
    v_mul_f32 v53, v53, v65
    v_mul_f32 v54, v54, v65
    v_mul_f32 v55, v55, v65
    v_accvgpr_write_b32 a100, v52
    v_accvgpr_write_b32 a101, v53
    v_accvgpr_write_b32 a102, v54
    v_accvgpr_write_b32 a103, v55
    v_accvgpr_read_b32 v52, a104
    v_accvgpr_read_b32 v53, a105
    v_accvgpr_read_b32 v54, a106
    v_accvgpr_read_b32 v55, a107
    v_mul_f32 v52, v52, v66
    v_mul_f32 v53, v53, v66
    v_mul_f32 v54, v54, v66
    v_mul_f32 v55, v55, v66
    v_accvgpr_write_b32 a104, v52
    v_accvgpr_write_b32 a105, v53
    v_accvgpr_write_b32 a106, v54
    v_accvgpr_write_b32 a107, v55
    v_accvgpr_read_b32 v52, a108
    v_accvgpr_read_b32 v53, a109
    v_accvgpr_read_b32 v54, a110
    v_accvgpr_read_b32 v55, a111
    v_mul_f32 v52, v52, v67
    v_mul_f32 v53, v53, v67
    v_mul_f32 v54, v54, v67
    v_mul_f32 v55, v55, v67
    v_accvgpr_write_b32 a108, v52
    v_accvgpr_write_b32 a109, v53
    v_accvgpr_write_b32 a110, v54
    v_accvgpr_write_b32 a111, v55
    v_accvgpr_read_b32 v52, a112
    v_accvgpr_read_b32 v53, a113
    v_accvgpr_read_b32 v54, a114
    v_accvgpr_read_b32 v55, a115
    v_mul_f32 v52, v52, v64
    v_mul_f32 v53, v53, v64
    v_mul_f32 v54, v54, v64
    v_mul_f32 v55, v55, v64
    v_accvgpr_write_b32 a112, v52
    v_accvgpr_write_b32 a113, v53
    v_accvgpr_write_b32 a114, v54
    v_accvgpr_write_b32 a115, v55
    v_accvgpr_read_b32 v52, a116
    v_accvgpr_read_b32 v53, a117
    v_accvgpr_read_b32 v54, a118
    v_accvgpr_read_b32 v55, a119
    v_mul_f32 v52, v52, v65
    v_mul_f32 v53, v53, v65
    v_mul_f32 v54, v54, v65
    v_mul_f32 v55, v55, v65
    v_accvgpr_write_b32 a116, v52
    v_accvgpr_write_b32 a117, v53
    v_accvgpr_write_b32 a118, v54
    v_accvgpr_write_b32 a119, v55
    v_accvgpr_read_b32 v52, a120
    v_accvgpr_read_b32 v53, a121
    v_accvgpr_read_b32 v54, a122
    v_accvgpr_read_b32 v55, a123
    v_mul_f32 v52, v52, v66
    v_mul_f32 v53, v53, v66
    v_mul_f32 v54, v54, v66
    v_mul_f32 v55, v55, v66
    v_accvgpr_write_b32 a120, v52
    v_accvgpr_write_b32 a121, v53
    v_accvgpr_write_b32 a122, v54
    v_accvgpr_write_b32 a123, v55
    v_accvgpr_read_b32 v52, a124
    v_accvgpr_read_b32 v53, a125
    v_accvgpr_read_b32 v54, a126
    v_accvgpr_read_b32 v55, a127
    v_mul_f32 v52, v52, v67
    v_mul_f32 v53, v53, v67
    v_mul_f32 v54, v54, v67
    v_mul_f32 v55, v55, v67
    v_accvgpr_write_b32 a124, v52
    v_accvgpr_write_b32 a125, v53
    v_accvgpr_write_b32 a126, v54
    v_accvgpr_write_b32 a127, v55
    s_waitcnt lgkmcnt(0)
    s_nop 1
    v_mfma_f32_16x16x32_bf16 a[0:3], a[224:227], v[156:159], a[0:3]
    v_mfma_f32_16x16x32_bf16 a[4:7], a[224:227], v[160:163], a[4:7]
    v_mfma_f32_16x16x32_bf16 a[8:11], a[224:227], v[164:167], a[8:11]
    v_mfma_f32_16x16x32_bf16 a[12:15], a[224:227], v[168:171], a[12:15]
    v_mfma_f32_16x16x32_bf16 a[16:19], a[228:231], v[156:159], a[16:19]
    v_mfma_f32_16x16x32_bf16 a[20:23], a[228:231], v[160:163], a[20:23]
    v_mfma_f32_16x16x32_bf16 a[24:27], a[228:231], v[164:167], a[24:27]
    v_mfma_f32_16x16x32_bf16 a[28:31], a[228:231], v[168:171], a[28:31]
    v_mfma_f32_16x16x32_bf16 a[32:35], a[232:235], v[156:159], a[32:35]
    v_mfma_f32_16x16x32_bf16 a[36:39], a[232:235], v[160:163], a[36:39]
    v_mfma_f32_16x16x32_bf16 a[40:43], a[232:235], v[164:167], a[40:43]
    v_mfma_f32_16x16x32_bf16 a[44:47], a[232:235], v[168:171], a[44:47]
    v_mfma_f32_16x16x32_bf16 a[48:51], a[236:239], v[156:159], a[48:51]
    v_mfma_f32_16x16x32_bf16 a[52:55], a[236:239], v[160:163], a[52:55]
    v_mfma_f32_16x16x32_bf16 a[56:59], a[236:239], v[164:167], a[56:59]
    v_mfma_f32_16x16x32_bf16 a[60:63], a[236:239], v[168:171], a[60:63]
    v_mfma_f32_16x16x32_bf16 a[64:67], a[240:243], v[156:159], a[64:67]
    v_mfma_f32_16x16x32_bf16 a[68:71], a[240:243], v[160:163], a[68:71]
    v_mfma_f32_16x16x32_bf16 a[72:75], a[240:243], v[164:167], a[72:75]
    v_mfma_f32_16x16x32_bf16 a[76:79], a[240:243], v[168:171], a[76:79]
    v_mfma_f32_16x16x32_bf16 a[80:83], a[244:247], v[156:159], a[80:83]
    v_mfma_f32_16x16x32_bf16 a[84:87], a[244:247], v[160:163], a[84:87]
    v_mfma_f32_16x16x32_bf16 a[88:91], a[244:247], v[164:167], a[88:91]
    v_mfma_f32_16x16x32_bf16 a[92:95], a[244:247], v[168:171], a[92:95]
    v_mfma_f32_16x16x32_bf16 a[96:99], a[248:251], v[156:159], a[96:99]
    v_mfma_f32_16x16x32_bf16 a[100:103], a[248:251], v[160:163], a[100:103]
    v_mfma_f32_16x16x32_bf16 a[104:107], a[248:251], v[164:167], a[104:107]
    v_mfma_f32_16x16x32_bf16 a[108:111], a[248:251], v[168:171], a[108:111]
    v_mfma_f32_16x16x32_bf16 a[112:115], a[252:255], v[156:159], a[112:115]
    v_mfma_f32_16x16x32_bf16 a[116:119], a[252:255], v[160:163], a[116:119]
    v_mfma_f32_16x16x32_bf16 a[120:123], a[252:255], v[164:167], a[120:123]
    v_mfma_f32_16x16x32_bf16 a[124:127], a[252:255], v[168:171], a[124:127]
    s_add_u32 s45, s45, 8192
    s_add_u32 s46, s46, 8192
    s_add_u32 s51, s51, 1
    s_cmp_lt_u32 s51, 64
    s_cbranch_scc1 KF_slow
    s_nop 7
    s_barrier
    s_branch KF_fin
KF_tail:
    s_lshl_b32 s68, s88, 16
    s_lshl_b32 s52, s3, 13
    s_add_u32 s68, s68, s52
    s_waitcnt vmcnt(12)
    s_barrier
    s_add_u32 m0, s93, 81920
    s_nop 0
    buffer_load_dwordx4 v11, s[20:23], s92 offen lds
    buffer_load_dwordx4 v12, s[20:23], s92 offen offset:1024 lds
    s_add_u32 s92, s92, 32768
    s_add_u32 m0, s93, 98304
    s_nop 0
    buffer_load_dwordx4 v11, s[20:23], s92 offen lds
    buffer_load_dwordx4 v12, s[20:23], s92 offen offset:1024 lds
    s_add_u32 s92, s92, 32768
    s_add_u32 m0, s93, 90112
    s_nop 0
    buffer_load_dwordx4 v10, s[12:15], s90 offen sc1 lds
    buffer_load_dwordx4 v10, s[12:15], s90 offen offset:1024 sc1 lds
    s_add_u32 s90, s90, 4096
    s_add_u32 m0, s93, 106496
    s_nop 0
    buffer_load_dwordx4 v10, s[12:15], s90 offen sc1 lds
    buffer_load_dwordx4 v10, s[12:15], s90 offen offset:1024 sc1 lds
    s_add_u32 s90, s90, 4096
    s_add_u32 m0, s93, 114688
    s_nop 0
    buffer_load_dwordx4 v11, s[20:23], s92 offen lds
    buffer_load_dwordx4 v12, s[20:23], s92 offen offset:1024 lds
    s_add_u32 s92, s92, 32768
    s_add_u32 m0, s93, 131072
    s_nop 0
    buffer_load_dwordx4 v11, s[20:23], s92 offen lds
    buffer_load_dwordx4 v12, s[20:23], s92 offen offset:1024 lds
    s_add_u32 s92, s92, 32768
    s_add_u32 m0, s93, 122880
    s_nop 0
    buffer_load_dwordx4 v10, s[12:15], s90 offen sc1 lds
    buffer_load_dwordx4 v10, s[12:15], s90 offen offset:1024 sc1 lds
    s_add_u32 s90, s90, 4096
    s_add_u32 m0, s93, 139264
    s_nop 0
    buffer_load_dwordx4 v10, s[12:15], s90 offen sc1 lds
    buffer_load_dwordx4 v10, s[12:15], s90 offen offset:1024 sc1 lds
    s_add_u32 s90, s90, 4096
    ds_read_b64_tr_b16 v[76:77], v13 offset:0
    ds_read_b64_tr_b16 v[78:79], v13 offset:4096
    ds_read_b64_tr_b16 v[80:81], v14 offset:0
    ds_read_b64_tr_b16 v[82:83], v14 offset:4096
    ds_read_b64_tr_b16 v[84:85], v15 offset:0
    ds_read_b64_tr_b16 v[86:87], v15 offset:4096
    ds_read_b64_tr_b16 v[88:89], v16 offset:0
    ds_read_b64_tr_b16 v[90:91], v16 offset:4096
    ds_read_b128 v[140:143], v21 offset:0
    ds_read_b128 v[144:147], v21 offset:1024
    ds_read_b128 v[148:151], v21 offset:2048
    ds_read_b128 v[152:155], v21 offset:3072
    ds_read_b64_tr_b16 v[92:93], v13 offset:16384
    ds_read_b64_tr_b16 v[94:95], v13 offset:20480
    ds_read_b64_tr_b16 v[96:97], v14 offset:16384
    ds_read_b64_tr_b16 v[98:99], v14 offset:20480
    ds_read_b64_tr_b16 v[100:101], v15 offset:16384
    ds_read_b64_tr_b16 v[102:103], v15 offset:20480
    ds_read_b64_tr_b16 v[104:105], v16 offset:16384
    ds_read_b64_tr_b16 v[106:107], v16 offset:20480
    ds_read_b128 v[156:159], v21 offset:16384
    ds_read_b128 v[160:163], v21 offset:17408
    ds_read_b128 v[164:167], v21 offset:18432
    ds_read_b128 v[168:171], v21 offset:19456
    s_waitcnt vmcnt(16) lgkmcnt(0)
    s_barrier
    v_mfma_f32_16x16x32_bf16 a[192:195], v[76:79], v[140:143], 0
    ds_read_b64_tr_b16 v[108:109], v13 offset:32768
    ds_read_b64_tr_b16 v[110:111], v13 offset:36864
    v_mfma_f32_16x16x32_bf16 a[192:195], v[92:95], v[156:159], a[192:195]
    s_add_u32 m0, s93, 0
    ds_read_b64_tr_b16 v[112:113], v14 offset:32768
    ds_read_b64_tr_b16 v[114:115], v14 offset:36864
    v_mfma_f32_16x16x32_bf16 a[196:199], v[80:83], v[140:143], 0
    buffer_load_dwordx4 v11, s[20:23], s92 offen lds
    v_mfma_f32_16x16x32_bf16 a[196:199], v[96:99], v[156:159], a[196:199]
    ds_read_b64_tr_b16 v[116:117], v15 offset:32768
    ds_read_b64_tr_b16 v[118:119], v15 offset:36864
    v_mfma_f32_16x16x32_bf16 a[200:203], v[84:87], v[140:143], 0
    ds_read_b64_tr_b16 v[120:121], v16 offset:32768
    ds_read_b64_tr_b16 v[122:123], v16 offset:36864
    v_mfma_f32_16x16x32_bf16 a[200:203], v[100:103], v[156:159], a[200:203]
    buffer_load_dwordx4 v12, s[20:23], s92 offen offset:1024 lds
    s_add_u32 s92, s92, 32768
    v_mfma_f32_16x16x32_bf16 a[204:207], v[88:91], v[140:143], 0
    ds_read_b128 v[172:175], v21 offset:32768
    ds_read_b128 v[176:179], v21 offset:33792
    v_mfma_f32_16x16x32_bf16 a[204:207], v[104:107], v[156:159], a[204:207]
    s_add_u32 m0, s93, 16384
    ds_read_b128 v[180:183], v21 offset:34816
    ds_read_b128 v[184:187], v21 offset:35840
    v_mfma_f32_16x16x32_bf16 a[208:211], v[76:79], v[144:147], 0
    buffer_load_dwordx4 v11, s[20:23], s92 offen lds
    v_mfma_f32_16x16x32_bf16 a[208:211], v[92:95], v[160:163], a[208:211]
    ds_read_b64_tr_b16 v[124:125], v13 offset:49152
    ds_read_b64_tr_b16 v[126:127], v13 offset:53248
    v_mfma_f32_16x16x32_bf16 a[212:215], v[80:83], v[144:147], 0
    ds_read_b64_tr_b16 v[128:129], v14 offset:49152
    ds_read_b64_tr_b16 v[130:131], v14 offset:53248
    v_mfma_f32_16x16x32_bf16 a[212:215], v[96:99], v[160:163], a[212:215]
    buffer_load_dwordx4 v12, s[20:23], s92 offen offset:1024 lds
    s_add_u32 s92, s92, 32768
    v_mfma_f32_16x16x32_bf16 a[216:219], v[84:87], v[144:147], 0
    ds_read_b64_tr_b16 v[132:133], v15 offset:49152
    ds_read_b64_tr_b16 v[134:135], v15 offset:53248
    v_mfma_f32_16x16x32_bf16 a[216:219], v[100:103], v[160:163], a[216:219]
    s_add_u32 m0, s93, 8192
    ds_read_b64_tr_b16 v[136:137], v16 offset:49152
    ds_read_b64_tr_b16 v[138:139], v16 offset:53248
    v_mfma_f32_16x16x32_bf16 a[220:223], v[88:91], v[144:147], 0
    buffer_load_dwordx4 v10, s[12:15], s90 offen sc1 lds
    v_mfma_f32_16x16x32_bf16 a[220:223], v[104:107], v[160:163], a[220:223]
    ds_read_b128 v[188:191], v21 offset:49152
    ds_read_b128 v[192:195], v21 offset:50176
    v_mfma_f32_16x16x32_bf16 a[224:227], v[76:79], v[148:151], 0
    ds_read_b128 v[196:199], v21 offset:51200
    ds_read_b128 v[200:203], v21 offset:52224
    v_mfma_f32_16x16x32_bf16 a[224:227], v[92:95], v[164:167], a[224:227]
    buffer_load_dwordx4 v10, s[12:15], s90 offen offset:1024 sc1 lds
    s_add_u32 s90, s90, 4096
    s_add_u32 m0, s93, 24576
    v_mfma_f32_16x16x32_bf16 a[228:231], v[80:83], v[148:151], 0
    buffer_load_dwordx4 v10, s[12:15], s90 offen sc1 lds
    v_mfma_f32_16x16x32_bf16 a[228:231], v[96:99], v[164:167], a[228:231]
    buffer_load_dwordx4 v10, s[12:15], s90 offen offset:1024 sc1 lds
    s_add_u32 s90, s90, 4096
    v_mfma_f32_16x16x32_bf16 a[232:235], v[84:87], v[148:151], 0
    v_mfma_f32_16x16x32_bf16 a[232:235], v[100:103], v[164:167], a[232:235]
    v_mfma_f32_16x16x32_bf16 a[236:239], v[88:91], v[148:151], 0
    v_mfma_f32_16x16x32_bf16 a[236:239], v[104:107], v[164:167], a[236:239]
    v_mfma_f32_16x16x32_bf16 a[240:243], v[76:79], v[152:155], 0
    v_mfma_f32_16x16x32_bf16 a[240:243], v[92:95], v[168:171], a[240:243]
    v_mfma_f32_16x16x32_bf16 a[244:247], v[80:83], v[152:155], 0
    v_mfma_f32_16x16x32_bf16 a[244:247], v[96:99], v[168:171], a[244:247]
    v_mfma_f32_16x16x32_bf16 a[248:251], v[84:87], v[152:155], 0
    v_mfma_f32_16x16x32_bf16 a[248:251], v[100:103], v[168:171], a[248:251]
    v_mfma_f32_16x16x32_bf16 a[252:255], v[88:91], v[152:155], 0
    v_mfma_f32_16x16x32_bf16 a[252:255], v[104:107], v[168:171], a[252:255]
    s_waitcnt vmcnt(16) lgkmcnt(0)
    s_barrier
    v_mfma_f32_16x16x32_bf16 a[192:195], v[108:111], v[172:175], a[192:195]
    ds_read_b64_tr_b16 v[76:77], v17 offset:0
    ds_read_b64_tr_b16 v[78:79], v17 offset:4096
    v_mfma_f32_16x16x32_bf16 a[192:195], v[124:127], v[188:191], a[192:195]
    s_add_u32 m0, s93, 32768
    ds_read_b64_tr_b16 v[80:81], v18 offset:0
    ds_read_b64_tr_b16 v[82:83], v18 offset:4096
    v_mfma_f32_16x16x32_bf16 a[196:199], v[112:115], v[172:175], a[196:199]
    buffer_load_dwordx4 v11, s[20:23], s92 offen lds
    v_mfma_f32_16x16x32_bf16 a[196:199], v[128:131], v[188:191], a[196:199]
    ds_read_b64_tr_b16 v[84:85], v19 offset:0
    ds_read_b64_tr_b16 v[86:87], v19 offset:4096
    v_mfma_f32_16x16x32_bf16 a[200:203], v[116:119], v[172:175], a[200:203]
    ds_read_b64_tr_b16 v[88:89], v20 offset:0
    ds_read_b64_tr_b16 v[90:91], v20 offset:4096
    v_mfma_f32_16x16x32_bf16 a[200:203], v[132:135], v[188:191], a[200:203]
    buffer_load_dwordx4 v12, s[20:23], s92 offen offset:1024 lds
    s_add_u32 s92, s92, 32768
    v_mfma_f32_16x16x32_bf16 a[204:207], v[120:123], v[172:175], a[204:207]
    ds_read_b128 v[140:143], v22 offset:0
    ds_read_b128 v[144:147], v22 offset:1024
    v_mfma_f32_16x16x32_bf16 a[204:207], v[136:139], v[188:191], a[204:207]
    s_add_u32 m0, s93, 49152
    ds_read_b128 v[148:151], v22 offset:2048
    ds_read_b128 v[152:155], v22 offset:3072
    v_mfma_f32_16x16x32_bf16 a[208:211], v[108:111], v[176:179], a[208:211]
    buffer_load_dwordx4 v11, s[20:23], s92 offen lds
    v_mfma_f32_16x16x32_bf16 a[208:211], v[124:127], v[192:195], a[208:211]
    ds_read_b64_tr_b16 v[92:93], v17 offset:16384
    ds_read_b64_tr_b16 v[94:95], v17 offset:20480
    v_mfma_f32_16x16x32_bf16 a[212:215], v[112:115], v[176:179], a[212:215]
    ds_read_b64_tr_b16 v[96:97], v18 offset:16384
    ds_read_b64_tr_b16 v[98:99], v18 offset:20480
    v_mfma_f32_16x16x32_bf16 a[212:215], v[128:131], v[192:195], a[212:215]
    buffer_load_dwordx4 v12, s[20:23], s92 offen offset:1024 lds
    s_add_u32 s92, s92, 32768
    v_mfma_f32_16x16x32_bf16 a[216:219], v[116:119], v[176:179], a[216:219]
    ds_read_b64_tr_b16 v[100:101], v19 offset:16384
    ds_read_b64_tr_b16 v[102:103], v19 offset:20480
    v_mfma_f32_16x16x32_bf16 a[216:219], v[132:135], v[192:195], a[216:219]
    s_add_u32 m0, s93, 40960
    ds_read_b64_tr_b16 v[104:105], v20 offset:16384
    ds_read_b64_tr_b16 v[106:107], v20 offset:20480
    v_mfma_f32_16x16x32_bf16 a[220:223], v[120:123], v[176:179], a[220:223]
    buffer_load_dwordx4 v10, s[12:15], s90 offen sc1 lds
    v_mfma_f32_16x16x32_bf16 a[220:223], v[136:139], v[192:195], a[220:223]
    ds_read_b128 v[156:159], v22 offset:16384
    ds_read_b128 v[160:163], v22 offset:17408
    v_mfma_f32_16x16x32_bf16 a[224:227], v[108:111], v[180:183], a[224:227]
    ds_read_b128 v[164:167], v22 offset:18432
    ds_read_b128 v[168:171], v22 offset:19456
    v_mfma_f32_16x16x32_bf16 a[224:227], v[124:127], v[196:199], a[224:227]
    buffer_load_dwordx4 v10, s[12:15], s90 offen offset:1024 sc1 lds
    s_add_u32 s90, s90, 4096
    s_add_u32 m0, s93, 57344
    v_mfma_f32_16x16x32_bf16 a[228:231], v[112:115], v[180:183], a[228:231]
    buffer_load_dwordx4 v10, s[12:15], s90 offen sc1 lds
    v_mfma_f32_16x16x32_bf16 a[228:231], v[128:131], v[196:199], a[228:231]
    buffer_load_dwordx4 v10, s[12:15], s90 offen offset:1024 sc1 lds
    s_add_u32 s90, s90, 4096
    v_mfma_f32_16x16x32_bf16 a[232:235], v[116:119], v[180:183], a[232:235]
    v_mfma_f32_16x16x32_bf16 a[232:235], v[132:135], v[196:199], a[232:235]
    v_mfma_f32_16x16x32_bf16 a[236:239], v[120:123], v[180:183], a[236:239]
    v_mfma_f32_16x16x32_bf16 a[236:239], v[136:139], v[196:199], a[236:239]
    v_mfma_f32_16x16x32_bf16 a[240:243], v[108:111], v[184:187], a[240:243]
    v_mfma_f32_16x16x32_bf16 a[240:243], v[124:127], v[200:203], a[240:243]
    v_mfma_f32_16x16x32_bf16 a[244:247], v[112:115], v[184:187], a[244:247]
    v_mfma_f32_16x16x32_bf16 a[244:247], v[128:131], v[200:203], a[244:247]
    v_mfma_f32_16x16x32_bf16 a[248:251], v[116:119], v[184:187], a[248:251]
    v_mfma_f32_16x16x32_bf16 a[248:251], v[132:135], v[200:203], a[248:251]
    v_mfma_f32_16x16x32_bf16 a[252:255], v[120:123], v[184:187], a[252:255]
    v_mfma_f32_16x16x32_bf16 a[252:255], v[136:139], v[200:203], a[252:255]
    s_waitcnt vmcnt(16) lgkmcnt(0)
    s_barrier
    s_cmp_eq_u32 s3, 0
    s_cbranch_scc0 KF_sigo
    s_mov_b64 s[96:97], exec
    s_mov_b64 exec, 1
    v_mov_b32 v3, 1
    v_mov_b32 v2, 0
    buffer_store_dword v3, v2, s[76:79], s63 offen offset:0 sc1
    s_mov_b64 exec, s[96:97]
KF_sigo:
    v_mfma_f32_16x16x32_bf16 a[192:195], v[76:79], v[140:143], a[192:195]
    ds_read_b64_tr_b16 v[108:109], v17 offset:32768
    ds_read_b64_tr_b16 v[110:111], v17 offset:36864
    v_mfma_f32_16x16x32_bf16 a[192:195], v[92:95], v[156:159], a[192:195]
    s_add_u32 m0, s93, 81920
    ds_read_b64_tr_b16 v[112:113], v18 offset:32768
    ds_read_b64_tr_b16 v[114:115], v18 offset:36864
    v_mfma_f32_16x16x32_bf16 a[196:199], v[80:83], v[140:143], a[196:199]
    buffer_load_dwordx4 v11, s[20:23], s92 offen lds
    v_mfma_f32_16x16x32_bf16 a[196:199], v[96:99], v[156:159], a[196:199]
    ds_read_b64_tr_b16 v[116:117], v19 offset:32768
    ds_read_b64_tr_b16 v[118:119], v19 offset:36864
    v_mfma_f32_16x16x32_bf16 a[200:203], v[84:87], v[140:143], a[200:203]
    ds_read_b64_tr_b16 v[120:121], v20 offset:32768
    ds_read_b64_tr_b16 v[122:123], v20 offset:36864
    v_mfma_f32_16x16x32_bf16 a[200:203], v[100:103], v[156:159], a[200:203]
    buffer_load_dwordx4 v12, s[20:23], s92 offen offset:1024 lds
    s_add_u32 s92, s92, 32768
    v_mfma_f32_16x16x32_bf16 a[204:207], v[88:91], v[140:143], a[204:207]
    ds_read_b128 v[172:175], v22 offset:32768
    ds_read_b128 v[176:179], v22 offset:33792
    v_mfma_f32_16x16x32_bf16 a[204:207], v[104:107], v[156:159], a[204:207]
    s_add_u32 m0, s93, 98304
    ds_read_b128 v[180:183], v22 offset:34816
    ds_read_b128 v[184:187], v22 offset:35840
    v_mfma_f32_16x16x32_bf16 a[208:211], v[76:79], v[144:147], a[208:211]
    buffer_load_dwordx4 v11, s[20:23], s92 offen lds
    v_mfma_f32_16x16x32_bf16 a[208:211], v[92:95], v[160:163], a[208:211]
    ds_read_b64_tr_b16 v[124:125], v17 offset:49152
    ds_read_b64_tr_b16 v[126:127], v17 offset:53248
    v_mfma_f32_16x16x32_bf16 a[212:215], v[80:83], v[144:147], a[212:215]
    ds_read_b64_tr_b16 v[128:129], v18 offset:49152
    ds_read_b64_tr_b16 v[130:131], v18 offset:53248
    v_mfma_f32_16x16x32_bf16 a[212:215], v[96:99], v[160:163], a[212:215]
    buffer_load_dwordx4 v12, s[20:23], s92 offen offset:1024 lds
    s_add_u32 s92, s92, 32768
    v_mfma_f32_16x16x32_bf16 a[216:219], v[84:87], v[144:147], a[216:219]
    ds_read_b64_tr_b16 v[132:133], v19 offset:49152
    ds_read_b64_tr_b16 v[134:135], v19 offset:53248
    v_mfma_f32_16x16x32_bf16 a[216:219], v[100:103], v[160:163], a[216:219]
    s_add_u32 m0, s93, 90112
    ds_read_b64_tr_b16 v[136:137], v20 offset:49152
    ds_read_b64_tr_b16 v[138:139], v20 offset:53248
    v_mfma_f32_16x16x32_bf16 a[220:223], v[88:91], v[144:147], a[220:223]
    buffer_load_dwordx4 v10, s[12:15], s90 offen sc1 lds
    v_mfma_f32_16x16x32_bf16 a[220:223], v[104:107], v[160:163], a[220:223]
    ds_read_b128 v[188:191], v22 offset:49152
    ds_read_b128 v[192:195], v22 offset:50176
    v_mfma_f32_16x16x32_bf16 a[224:227], v[76:79], v[148:151], a[224:227]
    ds_read_b128 v[196:199], v22 offset:51200
    ds_read_b128 v[200:203], v22 offset:52224
    v_mfma_f32_16x16x32_bf16 a[224:227], v[92:95], v[164:167], a[224:227]
    buffer_load_dwordx4 v10, s[12:15], s90 offen offset:1024 sc1 lds
    s_add_u32 s90, s90, 4096
    s_add_u32 m0, s93, 106496
    v_mfma_f32_16x16x32_bf16 a[228:231], v[80:83], v[148:151], a[228:231]
    buffer_load_dwordx4 v10, s[12:15], s90 offen sc1 lds
    v_mfma_f32_16x16x32_bf16 a[228:231], v[96:99], v[164:167], a[228:231]
    buffer_load_dwordx4 v10, s[12:15], s90 offen offset:1024 sc1 lds
    s_add_u32 s90, s90, 4096
    v_mfma_f32_16x16x32_bf16 a[232:235], v[84:87], v[148:151], a[232:235]
    v_mfma_f32_16x16x32_bf16 a[232:235], v[100:103], v[164:167], a[232:235]
    v_mfma_f32_16x16x32_bf16 a[236:239], v[88:91], v[148:151], a[236:239]
    v_mfma_f32_16x16x32_bf16 a[236:239], v[104:107], v[164:167], a[236:239]
    v_mfma_f32_16x16x32_bf16 a[240:243], v[76:79], v[152:155], a[240:243]
    v_mfma_f32_16x16x32_bf16 a[240:243], v[92:95], v[168:171], a[240:243]
    v_mfma_f32_16x16x32_bf16 a[244:247], v[80:83], v[152:155], a[244:247]
    v_mfma_f32_16x16x32_bf16 a[244:247], v[96:99], v[168:171], a[244:247]
    v_mfma_f32_16x16x32_bf16 a[248:251], v[84:87], v[152:155], a[248:251]
    v_mfma_f32_16x16x32_bf16 a[248:251], v[100:103], v[168:171], a[248:251]
    v_mfma_f32_16x16x32_bf16 a[252:255], v[88:91], v[152:155], a[252:255]
    v_mfma_f32_16x16x32_bf16 a[252:255], v[104:107], v[168:171], a[252:255]
    s_waitcnt vmcnt(16) lgkmcnt(0)
    s_barrier
    s_lshr_b32 s54, s71, 1
    s_lshl_b32 s54, s54, 2
    s_add_u32 s54, s54, s88
    s_lshl_b32 s60, s54, 7
    s_add_u32 s60, s60, 0x10000
    v_and_b32 v4, 7, v1
    v_lshlrev_b32 v4, 2, v4
    buffer_load_dword v5, v4, s[76:79], s60 offen sc1
    v_mfma_f32_16x16x32_bf16 a[192:195], v[108:111], v[172:175], a[192:195]
    ds_read_b64_tr_b16 v[76:77], v13 offset:0
    ds_read_b64_tr_b16 v[78:79], v13 offset:4096
    v_mfma_f32_16x16x32_bf16 a[192:195], v[124:127], v[188:191], a[192:195]
    s_add_u32 m0, s93, 114688
    ds_read_b64_tr_b16 v[80:81], v14 offset:0
    ds_read_b64_tr_b16 v[82:83], v14 offset:4096
    v_mfma_f32_16x16x32_bf16 a[196:199], v[112:115], v[172:175], a[196:199]
    buffer_load_dwordx4 v11, s[16:19], s61 offen lds
    v_mfma_f32_16x16x32_bf16 a[196:199], v[128:131], v[188:191], a[196:199]
    ds_read_b64_tr_b16 v[84:85], v15 offset:0
    ds_read_b64_tr_b16 v[86:87], v15 offset:4096
    v_mfma_f32_16x16x32_bf16 a[200:203], v[116:119], v[172:175], a[200:203]
    ds_read_b64_tr_b16 v[88:89], v16 offset:0
    ds_read_b64_tr_b16 v[90:91], v16 offset:4096
    v_mfma_f32_16x16x32_bf16 a[200:203], v[132:135], v[188:191], a[200:203]
    buffer_load_dwordx4 v12, s[16:19], s61 offen offset:1024 lds
    s_add_u32 s61, s61, 32768
    v_mfma_f32_16x16x32_bf16 a[204:207], v[120:123], v[172:175], a[204:207]
    ds_read_b128 v[140:143], v21 offset:0
    ds_read_b128 v[144:147], v21 offset:1024
    v_mfma_f32_16x16x32_bf16 a[204:207], v[136:139], v[188:191], a[204:207]
    s_add_u32 m0, s93, 131072
    ds_read_b128 v[148:151], v21 offset:2048
    ds_read_b128 v[152:155], v21 offset:3072
    v_mfma_f32_16x16x32_bf16 a[208:211], v[108:111], v[176:179], a[208:211]
    buffer_load_dwordx4 v11, s[16:19], s61 offen lds
    v_mfma_f32_16x16x32_bf16 a[208:211], v[124:127], v[192:195], a[208:211]
    ds_read_b64_tr_b16 v[92:93], v13 offset:16384
    ds_read_b64_tr_b16 v[94:95], v13 offset:20480
    v_mfma_f32_16x16x32_bf16 a[212:215], v[112:115], v[176:179], a[212:215]
    ds_read_b64_tr_b16 v[96:97], v14 offset:16384
    ds_read_b64_tr_b16 v[98:99], v14 offset:20480
    v_mfma_f32_16x16x32_bf16 a[212:215], v[128:131], v[192:195], a[212:215]
    buffer_load_dwordx4 v12, s[16:19], s61 offen offset:1024 lds
    s_add_u32 s61, s61, 32768
    v_mfma_f32_16x16x32_bf16 a[216:219], v[116:119], v[176:179], a[216:219]
    ds_read_b64_tr_b16 v[100:101], v15 offset:16384
    ds_read_b64_tr_b16 v[102:103], v15 offset:20480
    v_mfma_f32_16x16x32_bf16 a[216:219], v[132:135], v[192:195], a[216:219]
    ds_read_b64_tr_b16 v[104:105], v16 offset:16384
    ds_read_b64_tr_b16 v[106:107], v16 offset:20480
    v_mfma_f32_16x16x32_bf16 a[220:223], v[120:123], v[176:179], a[220:223]
    ds_read_b128 v[156:159], v21 offset:16384
    ds_read_b128 v[160:163], v21 offset:17408
    v_mfma_f32_16x16x32_bf16 a[220:223], v[136:139], v[192:195], a[220:223]
    ds_read_b128 v[164:167], v21 offset:18432
    ds_read_b128 v[168:171], v21 offset:19456
    v_mfma_f32_16x16x32_bf16 a[224:227], v[108:111], v[180:183], a[224:227]
    v_mfma_f32_16x16x32_bf16 a[224:227], v[124:127], v[196:199], a[224:227]
    v_mfma_f32_16x16x32_bf16 a[228:231], v[112:115], v[180:183], a[228:231]
    v_mfma_f32_16x16x32_bf16 a[228:231], v[128:131], v[196:199], a[228:231]
    v_mfma_f32_16x16x32_bf16 a[232:235], v[116:119], v[180:183], a[232:235]
    v_mfma_f32_16x16x32_bf16 a[232:235], v[132:135], v[196:199], a[232:235]
    v_mfma_f32_16x16x32_bf16 a[236:239], v[120:123], v[180:183], a[236:239]
    v_mfma_f32_16x16x32_bf16 a[236:239], v[136:139], v[196:199], a[236:239]
    v_mfma_f32_16x16x32_bf16 a[240:243], v[108:111], v[184:187], a[240:243]
    v_mfma_f32_16x16x32_bf16 a[240:243], v[124:127], v[200:203], a[240:243]
    v_mfma_f32_16x16x32_bf16 a[244:247], v[112:115], v[184:187], a[244:247]
    v_mfma_f32_16x16x32_bf16 a[244:247], v[128:131], v[200:203], a[244:247]
    v_mfma_f32_16x16x32_bf16 a[248:251], v[116:119], v[184:187], a[248:251]
    v_mfma_f32_16x16x32_bf16 a[248:251], v[132:135], v[200:203], a[248:251]
    v_mfma_f32_16x16x32_bf16 a[252:255], v[120:123], v[184:187], a[252:255]
    v_mfma_f32_16x16x32_bf16 a[252:255], v[136:139], v[200:203], a[252:255]
    s_cmp_eq_u32 s3, 0
    s_cbranch_scc0 KF_poA
    s_waitcnt vmcnt(4)
    v_and_b32 v2, 7, v1
    v_lshlrev_b32 v2, 2, v2
    s_mov_b32 s97, 0
    v_cmp_ne_u32 vcc, 1, v5
    s_nop 1
    s_cbranch_vccz KF_po_ok
KF_po:
    buffer_load_dword v3, v2, s[76:79], s60 offen sc1
    s_waitcnt vmcnt(0)
    s_add_u32 s97, s97, 1
    v_cmp_ne_u32 vcc, 1, v3
    s_nop 4
    s_cbranch_vccz KF_po_ok
    s_cmp_ge_u32 s97, 20000
    s_cbranch_scc1 KF_po_ok
    s_sleep 2
    s_branch KF_po
KF_po_ok:
KF_poA:
    s_waitcnt vmcnt(13) lgkmcnt(0)
    s_barrier
    v_mfma_f32_16x16x32_bf16 a[192:195], v[76:79], v[140:143], a[192:195]
    ds_read_b64_tr_b16 v[108:109], v13 offset:32768
    ds_read_b64_tr_b16 v[110:111], v13 offset:36864
    v_mfma_f32_16x16x32_bf16 a[192:195], v[92:95], v[156:159], a[192:195]
    s_add_u32 m0, s93, 0
    ds_read_b64_tr_b16 v[112:113], v14 offset:32768
    ds_read_b64_tr_b16 v[114:115], v14 offset:36864
    v_mfma_f32_16x16x32_bf16 a[196:199], v[80:83], v[140:143], a[196:199]
    buffer_load_dwordx4 v11, s[16:19], s61 offen lds
    v_mfma_f32_16x16x32_bf16 a[196:199], v[96:99], v[156:159], a[196:199]
    ds_read_b64_tr_b16 v[116:117], v15 offset:32768
    ds_read_b64_tr_b16 v[118:119], v15 offset:36864
    v_mfma_f32_16x16x32_bf16 a[200:203], v[84:87], v[140:143], a[200:203]
    ds_read_b64_tr_b16 v[120:121], v16 offset:32768
    ds_read_b64_tr_b16 v[122:123], v16 offset:36864
    v_mfma_f32_16x16x32_bf16 a[200:203], v[100:103], v[156:159], a[200:203]
    buffer_load_dwordx4 v12, s[16:19], s61 offen offset:1024 lds
    s_add_u32 s61, s61, 32768
    v_mfma_f32_16x16x32_bf16 a[204:207], v[88:91], v[140:143], a[204:207]
    ds_read_b128 v[172:175], v21 offset:32768
    ds_read_b128 v[176:179], v21 offset:33792
    v_mfma_f32_16x16x32_bf16 a[204:207], v[104:107], v[156:159], a[204:207]
    s_add_u32 m0, s93, 16384
    ds_read_b128 v[180:183], v21 offset:34816
    ds_read_b128 v[184:187], v21 offset:35840
    v_mfma_f32_16x16x32_bf16 a[208:211], v[76:79], v[144:147], a[208:211]
    buffer_load_dwordx4 v11, s[16:19], s61 offen lds
    v_mfma_f32_16x16x32_bf16 a[208:211], v[92:95], v[160:163], a[208:211]
    ds_read_b64_tr_b16 v[124:125], v13 offset:49152
    ds_read_b64_tr_b16 v[126:127], v13 offset:53248
    v_mfma_f32_16x16x32_bf16 a[212:215], v[80:83], v[144:147], a[212:215]
    ds_read_b64_tr_b16 v[128:129], v14 offset:49152
    ds_read_b64_tr_b16 v[130:131], v14 offset:53248
    v_mfma_f32_16x16x32_bf16 a[212:215], v[96:99], v[160:163], a[212:215]
    buffer_load_dwordx4 v12, s[16:19], s61 offen offset:1024 lds
    s_add_u32 s61, s61, 32768
    v_mfma_f32_16x16x32_bf16 a[216:219], v[84:87], v[144:147], a[216:219]
    ds_read_b64_tr_b16 v[132:133], v15 offset:49152
    ds_read_b64_tr_b16 v[134:135], v15 offset:53248
    v_mfma_f32_16x16x32_bf16 a[216:219], v[100:103], v[160:163], a[216:219]
    s_add_u32 m0, s93, 122880
    ds_read_b64_tr_b16 v[136:137], v16 offset:49152
    ds_read_b64_tr_b16 v[138:139], v16 offset:53248
    v_mfma_f32_16x16x32_bf16 a[220:223], v[88:91], v[144:147], a[220:223]
    buffer_load_dwordx4 v10, s[8:11], s91 offen sc1 lds
    v_mfma_f32_16x16x32_bf16 a[220:223], v[104:107], v[160:163], a[220:223]
    ds_read_b128 v[188:191], v21 offset:49152
    ds_read_b128 v[192:195], v21 offset:50176
    v_mfma_f32_16x16x32_bf16 a[224:227], v[76:79], v[148:151], a[224:227]
    ds_read_b128 v[196:199], v21 offset:51200
    ds_read_b128 v[200:203], v21 offset:52224
    v_mfma_f32_16x16x32_bf16 a[224:227], v[92:95], v[164:167], a[224:227]
    buffer_load_dwordx4 v10, s[8:11], s91 offen offset:1024 sc1 lds
    s_add_u32 s91, s91, 4096
    s_add_u32 m0, s93, 139264
    v_mfma_f32_16x16x32_bf16 a[228:231], v[80:83], v[148:151], a[228:231]
    buffer_load_dwordx4 v10, s[8:11], s91 offen sc1 lds
    v_mfma_f32_16x16x32_bf16 a[228:231], v[96:99], v[164:167], a[228:231]
    buffer_load_dwordx4 v10, s[8:11], s91 offen offset:1024 sc1 lds
    s_add_u32 s91, s91, 4096
    s_add_u32 m0, s93, 8192
    v_mfma_f32_16x16x32_bf16 a[232:235], v[84:87], v[148:151], a[232:235]
    buffer_load_dwordx4 v10, s[8:11], s91 offen sc1 lds
    v_mfma_f32_16x16x32_bf16 a[232:235], v[100:103], v[164:167], a[232:235]
    buffer_load_dwordx4 v10, s[8:11], s91 offen offset:1024 sc1 lds
    s_add_u32 s91, s91, 4096
    s_add_u32 m0, s93, 24576
    v_mfma_f32_16x16x32_bf16 a[236:239], v[88:91], v[148:151], a[236:239]
    buffer_load_dwordx4 v10, s[8:11], s91 offen sc1 lds
    v_mfma_f32_16x16x32_bf16 a[236:239], v[104:107], v[164:167], a[236:239]
    buffer_load_dwordx4 v10, s[8:11], s91 offen offset:1024 sc1 lds
    s_add_u32 s91, s91, 4096
    v_mfma_f32_16x16x32_bf16 a[240:243], v[76:79], v[152:155], a[240:243]
    v_mfma_f32_16x16x32_bf16 a[240:243], v[92:95], v[168:171], a[240:243]
    v_mfma_f32_16x16x32_bf16 a[244:247], v[80:83], v[152:155], a[244:247]
    v_mfma_f32_16x16x32_bf16 a[244:247], v[96:99], v[168:171], a[244:247]
    v_mfma_f32_16x16x32_bf16 a[248:251], v[84:87], v[152:155], a[248:251]
    v_mfma_f32_16x16x32_bf16 a[248:251], v[100:103], v[168:171], a[248:251]
    v_mfma_f32_16x16x32_bf16 a[252:255], v[88:91], v[152:155], a[252:255]
    v_mfma_f32_16x16x32_bf16 a[252:255], v[104:107], v[168:171], a[252:255]
    s_waitcnt vmcnt(17) lgkmcnt(0)
    s_barrier
    v_mfma_f32_16x16x32_bf16 a[192:195], v[108:111], v[172:175], a[192:195]
    ds_read_b64_tr_b16 v[76:77], v17 offset:0
    ds_read_b64_tr_b16 v[78:79], v17 offset:4096
    v_mfma_f32_16x16x32_bf16 a[192:195], v[124:127], v[188:191], a[192:195]
    s_add_u32 m0, s93, 32768
    ds_read_b64_tr_b16 v[80:81], v18 offset:0
    ds_read_b64_tr_b16 v[82:83], v18 offset:4096
    v_mfma_f32_16x16x32_bf16 a[196:199], v[112:115], v[172:175], a[196:199]
    buffer_load_dwordx4 v11, s[16:19], s61 offen lds
    v_mfma_f32_16x16x32_bf16 a[196:199], v[128:131], v[188:191], a[196:199]
    ds_read_b64_tr_b16 v[84:85], v19 offset:0
    ds_read_b64_tr_b16 v[86:87], v19 offset:4096
    v_mfma_f32_16x16x32_bf16 a[200:203], v[116:119], v[172:175], a[200:203]
    ds_read_b64_tr_b16 v[88:89], v20 offset:0
    ds_read_b64_tr_b16 v[90:91], v20 offset:4096
    v_mfma_f32_16x16x32_bf16 a[200:203], v[132:135], v[188:191], a[200:203]
    buffer_load_dwordx4 v12, s[16:19], s61 offen offset:1024 lds
    s_add_u32 s61, s61, 32768
    v_mfma_f32_16x16x32_bf16 a[204:207], v[120:123], v[172:175], a[204:207]
    ds_read_b128 v[140:143], v22 offset:0
    ds_read_b128 v[144:147], v22 offset:1024
    v_mfma_f32_16x16x32_bf16 a[204:207], v[136:139], v[188:191], a[204:207]
    s_add_u32 m0, s93, 49152
    ds_read_b128 v[148:151], v22 offset:2048
    ds_read_b128 v[152:155], v22 offset:3072
    v_mfma_f32_16x16x32_bf16 a[208:211], v[108:111], v[176:179], a[208:211]
    buffer_load_dwordx4 v11, s[16:19], s61 offen lds
    v_mfma_f32_16x16x32_bf16 a[208:211], v[124:127], v[192:195], a[208:211]
    ds_read_b64_tr_b16 v[92:93], v17 offset:16384
    ds_read_b64_tr_b16 v[94:95], v17 offset:20480
    v_mfma_f32_16x16x32_bf16 a[212:215], v[112:115], v[176:179], a[212:215]
    ds_read_b64_tr_b16 v[96:97], v18 offset:16384
    ds_read_b64_tr_b16 v[98:99], v18 offset:20480
    v_mfma_f32_16x16x32_bf16 a[212:215], v[128:131], v[192:195], a[212:215]
    buffer_load_dwordx4 v12, s[16:19], s61 offen offset:1024 lds
    s_add_u32 s61, s61, 32768
    v_mfma_f32_16x16x32_bf16 a[216:219], v[116:119], v[176:179], a[216:219]
    ds_read_b64_tr_b16 v[100:101], v19 offset:16384
    ds_read_b64_tr_b16 v[102:103], v19 offset:20480
    v_mfma_f32_16x16x32_bf16 a[216:219], v[132:135], v[192:195], a[216:219]
    s_add_u32 m0, s93, 40960
    ds_read_b64_tr_b16 v[104:105], v20 offset:16384
    ds_read_b64_tr_b16 v[106:107], v20 offset:20480
    v_mfma_f32_16x16x32_bf16 a[220:223], v[120:123], v[176:179], a[220:223]
    buffer_load_dwordx4 v10, s[8:11], s91 offen sc1 lds
    v_mfma_f32_16x16x32_bf16 a[220:223], v[136:139], v[192:195], a[220:223]
    ds_read_b128 v[156:159], v22 offset:16384
    ds_read_b128 v[160:163], v22 offset:17408
    v_mfma_f32_16x16x32_bf16 a[224:227], v[108:111], v[180:183], a[224:227]
    ds_read_b128 v[164:167], v22 offset:18432
    ds_read_b128 v[168:171], v22 offset:19456
    v_mfma_f32_16x16x32_bf16 a[224:227], v[124:127], v[196:199], a[224:227]
    buffer_load_dwordx4 v10, s[8:11], s91 offen offset:1024 sc1 lds
    s_add_u32 s91, s91, 4096
    s_add_u32 m0, s93, 57344
    v_mfma_f32_16x16x32_bf16 a[228:231], v[112:115], v[180:183], a[228:231]
    buffer_load_dwordx4 v10, s[8:11], s91 offen sc1 lds
    v_mfma_f32_16x16x32_bf16 a[228:231], v[128:131], v[196:199], a[228:231]
    buffer_load_dwordx4 v10, s[8:11], s91 offen offset:1024 sc1 lds
    s_add_u32 s91, s91, 4096
    v_mfma_f32_16x16x32_bf16 a[232:235], v[116:119], v[180:183], a[232:235]
    v_mfma_f32_16x16x32_bf16 a[232:235], v[132:135], v[196:199], a[232:235]
    v_mfma_f32_16x16x32_bf16 a[236:239], v[120:123], v[180:183], a[236:239]
    v_mfma_f32_16x16x32_bf16 a[236:239], v[136:139], v[196:199], a[236:239]
    v_mfma_f32_16x16x32_bf16 a[240:243], v[108:111], v[184:187], a[240:243]
    v_mfma_f32_16x16x32_bf16 a[240:243], v[124:127], v[200:203], a[240:243]
    v_mfma_f32_16x16x32_bf16 a[244:247], v[112:115], v[184:187], a[244:247]
    v_mfma_f32_16x16x32_bf16 a[244:247], v[128:131], v[200:203], a[244:247]
    v_mfma_f32_16x16x32_bf16 a[248:251], v[116:119], v[184:187], a[248:251]
    v_mfma_f32_16x16x32_bf16 a[248:251], v[132:135], v[200:203], a[248:251]
    v_mfma_f32_16x16x32_bf16 a[252:255], v[120:123], v[184:187], a[252:255]
    v_mfma_f32_16x16x32_bf16 a[252:255], v[136:139], v[200:203], a[252:255]
    s_waitcnt vmcnt(12) lgkmcnt(0)
    s_barrier
    v_mfma_f32_16x16x32_bf16 a[192:195], v[76:79], v[140:143], a[192:195]
    ds_read_b64_tr_b16 v[108:109], v17 offset:32768
    ds_read_b64_tr_b16 v[110:111], v17 offset:36864
    v_mfma_f32_16x16x32_bf16 a[192:195], v[92:95], v[156:159], a[192:195]
    s_add_u32 m0, s93, 81920
    ds_read_b64_tr_b16 v[112:113], v18 offset:32768
    ds_read_b64_tr_b16 v[114:115], v18 offset:36864
    v_mfma_f32_16x16x32_bf16 a[196:199], v[80:83], v[140:143], a[196:199]
    buffer_load_dwordx4 v11, s[16:19], s61 offen lds
    v_mfma_f32_16x16x32_bf16 a[196:199], v[96:99], v[156:159], a[196:199]
    ds_read_b64_tr_b16 v[116:117], v19 offset:32768
    ds_read_b64_tr_b16 v[118:119], v19 offset:36864
    v_mfma_f32_16x16x32_bf16 a[200:203], v[84:87], v[140:143], a[200:203]
    ds_read_b64_tr_b16 v[120:121], v20 offset:32768
    ds_read_b64_tr_b16 v[122:123], v20 offset:36864
    v_mfma_f32_16x16x32_bf16 a[200:203], v[100:103], v[156:159], a[200:203]
    buffer_load_dwordx4 v12, s[16:19], s61 offen offset:1024 lds
    s_add_u32 s61, s61, 32768
    v_mfma_f32_16x16x32_bf16 a[204:207], v[88:91], v[140:143], a[204:207]
    ds_read_b128 v[172:175], v22 offset:32768
    ds_read_b128 v[176:179], v22 offset:33792
    v_mfma_f32_16x16x32_bf16 a[204:207], v[104:107], v[156:159], a[204:207]
    s_add_u32 m0, s93, 98304
    ds_read_b128 v[180:183], v22 offset:34816
    ds_read_b128 v[184:187], v22 offset:35840
    v_mfma_f32_16x16x32_bf16 a[208:211], v[76:79], v[144:147], a[208:211]
    buffer_load_dwordx4 v11, s[16:19], s61 offen lds
    v_mfma_f32_16x16x32_bf16 a[208:211], v[92:95], v[160:163], a[208:211]
    ds_read_b64_tr_b16 v[124:125], v17 offset:49152
    ds_read_b64_tr_b16 v[126:127], v17 offset:53248
    v_mfma_f32_16x16x32_bf16 a[212:215], v[80:83], v[144:147], a[212:215]
    ds_read_b64_tr_b16 v[128:129], v18 offset:49152
    ds_read_b64_tr_b16 v[130:131], v18 offset:53248
    v_mfma_f32_16x16x32_bf16 a[212:215], v[96:99], v[160:163], a[212:215]
    buffer_load_dwordx4 v12, s[16:19], s61 offen offset:1024 lds
    s_add_u32 s61, s61, 32768
    v_mfma_f32_16x16x32_bf16 a[216:219], v[84:87], v[144:147], a[216:219]
    ds_read_b64_tr_b16 v[132:133], v19 offset:49152
    ds_read_b64_tr_b16 v[134:135], v19 offset:53248
    v_mfma_f32_16x16x32_bf16 a[216:219], v[100:103], v[160:163], a[216:219]
    s_add_u32 m0, s93, 90112
    ds_read_b64_tr_b16 v[136:137], v20 offset:49152
    ds_read_b64_tr_b16 v[138:139], v20 offset:53248
    v_mfma_f32_16x16x32_bf16 a[220:223], v[88:91], v[144:147], a[220:223]
    buffer_load_dwordx4 v10, s[8:11], s91 offen sc1 lds
    v_mfma_f32_16x16x32_bf16 a[220:223], v[104:107], v[160:163], a[220:223]
    ds_read_b128 v[188:191], v22 offset:49152
    ds_read_b128 v[192:195], v22 offset:50176
    v_mfma_f32_16x16x32_bf16 a[224:227], v[76:79], v[148:151], a[224:227]
    ds_read_b128 v[196:199], v22 offset:51200
    ds_read_b128 v[200:203], v22 offset:52224
    v_mfma_f32_16x16x32_bf16 a[224:227], v[92:95], v[164:167], a[224:227]
    buffer_load_dwordx4 v10, s[8:11], s91 offen offset:1024 sc1 lds
    s_add_u32 s91, s91, 4096
    s_add_u32 m0, s93, 106496
    v_mfma_f32_16x16x32_bf16 a[228:231], v[80:83], v[148:151], a[228:231]
    buffer_load_dwordx4 v10, s[8:11], s91 offen sc1 lds
    v_mfma_f32_16x16x32_bf16 a[228:231], v[96:99], v[164:167], a[228:231]
    buffer_load_dwordx4 v10, s[8:11], s91 offen offset:1024 sc1 lds
    s_add_u32 s91, s91, 4096
    v_mfma_f32_16x16x32_bf16 a[232:235], v[84:87], v[148:151], a[232:235]
    v_mfma_f32_16x16x32_bf16 a[232:235], v[100:103], v[164:167], a[232:235]
    v_mfma_f32_16x16x32_bf16 a[236:239], v[88:91], v[148:151], a[236:239]
    v_mfma_f32_16x16x32_bf16 a[236:239], v[104:107], v[164:167], a[236:239]
    v_mfma_f32_16x16x32_bf16 a[240:243], v[76:79], v[152:155], a[240:243]
    v_mfma_f32_16x16x32_bf16 a[240:243], v[92:95], v[168:171], a[240:243]
    v_mfma_f32_16x16x32_bf16 a[244:247], v[80:83], v[152:155], a[244:247]
    v_mfma_f32_16x16x32_bf16 a[244:247], v[96:99], v[168:171], a[244:247]
    v_mfma_f32_16x16x32_bf16 a[248:251], v[84:87], v[152:155], a[248:251]
    v_mfma_f32_16x16x32_bf16 a[248:251], v[100:103], v[168:171], a[248:251]
    v_mfma_f32_16x16x32_bf16 a[252:255], v[88:91], v[152:155], a[252:255]
    v_mfma_f32_16x16x32_bf16 a[252:255], v[104:107], v[168:171], a[252:255]
    s_waitcnt vmcnt(16) lgkmcnt(0)
    s_barrier
    v_mfma_f32_16x16x32_bf16 a[128:131], v[108:111], v[172:175], 0
    ds_read_b64_tr_b16 v[76:77], v13 offset:0
    ds_read_b64_tr_b16 v[78:79], v13 offset:4096
    v_mfma_f32_16x16x32_bf16 a[128:131], v[124:127], v[188:191], a[128:131]
    s_add_u32 m0, s93, 114688
    ds_read_b64_tr_b16 v[80:81], v14 offset:0
    ds_read_b64_tr_b16 v[82:83], v14 offset:4096
    v_mfma_f32_16x16x32_bf16 a[132:135], v[112:115], v[172:175], 0
    buffer_load_dwordx4 v11, s[16:19], s61 offen lds
    v_mfma_f32_16x16x32_bf16 a[132:135], v[128:131], v[188:191], a[132:135]
    ds_read_b64_tr_b16 v[84:85], v15 offset:0
    ds_read_b64_tr_b16 v[86:87], v15 offset:4096
    v_mfma_f32_16x16x32_bf16 a[136:139], v[116:119], v[172:175], 0
    ds_read_b64_tr_b16 v[88:89], v16 offset:0
    ds_read_b64_tr_b16 v[90:91], v16 offset:4096
    v_mfma_f32_16x16x32_bf16 a[136:139], v[132:135], v[188:191], a[136:139]
    buffer_load_dwordx4 v12, s[16:19], s61 offen offset:1024 lds
    s_add_u32 s61, s61, 32768
    v_mfma_f32_16x16x32_bf16 a[140:143], v[120:123], v[172:175], 0
    ds_read_b128 v[140:143], v21 offset:0
    ds_read_b128 v[144:147], v21 offset:1024
    v_mfma_f32_16x16x32_bf16 a[140:143], v[136:139], v[188:191], a[140:143]
    s_add_u32 m0, s93, 131072
    ds_read_b128 v[148:151], v21 offset:2048
    ds_read_b128 v[152:155], v21 offset:3072
    v_mfma_f32_16x16x32_bf16 a[144:147], v[108:111], v[176:179], 0
    buffer_load_dwordx4 v11, s[16:19], s61 offen lds
    v_mfma_f32_16x16x32_bf16 a[144:147], v[124:127], v[192:195], a[144:147]
    ds_read_b64_tr_b16 v[92:93], v13 offset:16384
    ds_read_b64_tr_b16 v[94:95], v13 offset:20480
    v_mfma_f32_16x16x32_bf16 a[148:151], v[112:115], v[176:179], 0
    ds_read_b64_tr_b16 v[96:97], v14 offset:16384
    ds_read_b64_tr_b16 v[98:99], v14 offset:20480
    v_mfma_f32_16x16x32_bf16 a[148:151], v[128:131], v[192:195], a[148:151]
    buffer_load_dwordx4 v12, s[16:19], s61 offen offset:1024 lds
    s_add_u32 s61, s61, 32768
    v_mfma_f32_16x16x32_bf16 a[152:155], v[116:119], v[176:179], 0
    ds_read_b64_tr_b16 v[100:101], v15 offset:16384
    ds_read_b64_tr_b16 v[102:103], v15 offset:20480
    v_mfma_f32_16x16x32_bf16 a[152:155], v[132:135], v[192:195], a[152:155]
    s_add_u32 m0, s93, 122880
    ds_read_b64_tr_b16 v[104:105], v16 offset:16384
    ds_read_b64_tr_b16 v[106:107], v16 offset:20480
    v_mfma_f32_16x16x32_bf16 a[156:159], v[120:123], v[176:179], 0
    buffer_load_dwordx4 v10, s[8:11], s91 offen sc1 lds
    v_mfma_f32_16x16x32_bf16 a[156:159], v[136:139], v[192:195], a[156:159]
    ds_read_b128 v[156:159], v21 offset:16384
    ds_read_b128 v[160:163], v21 offset:17408
    v_mfma_f32_16x16x32_bf16 a[160:163], v[108:111], v[180:183], 0
    ds_read_b128 v[164:167], v21 offset:18432
    ds_read_b128 v[168:171], v21 offset:19456
    v_mfma_f32_16x16x32_bf16 a[160:163], v[124:127], v[196:199], a[160:163]
    buffer_load_dwordx4 v10, s[8:11], s91 offen offset:1024 sc1 lds
    s_add_u32 s91, s91, 4096
    s_add_u32 m0, s93, 139264
    v_mfma_f32_16x16x32_bf16 a[164:167], v[112:115], v[180:183], 0
    buffer_load_dwordx4 v10, s[8:11], s91 offen sc1 lds
    v_mfma_f32_16x16x32_bf16 a[164:167], v[128:131], v[196:199], a[164:167]
    buffer_load_dwordx4 v10, s[8:11], s91 offen offset:1024 sc1 lds
    s_add_u32 s91, s91, 4096
    v_mfma_f32_16x16x32_bf16 a[168:171], v[116:119], v[180:183], 0
    v_mfma_f32_16x16x32_bf16 a[168:171], v[132:135], v[196:199], a[168:171]
    v_mfma_f32_16x16x32_bf16 a[172:175], v[120:123], v[180:183], 0
    v_mfma_f32_16x16x32_bf16 a[172:175], v[136:139], v[196:199], a[172:175]
    v_mfma_f32_16x16x32_bf16 a[176:179], v[108:111], v[184:187], 0
    v_mfma_f32_16x16x32_bf16 a[176:179], v[124:127], v[200:203], a[176:179]
    v_mfma_f32_16x16x32_bf16 a[180:183], v[112:115], v[184:187], 0
    v_mfma_f32_16x16x32_bf16 a[180:183], v[128:131], v[200:203], a[180:183]
    v_mfma_f32_16x16x32_bf16 a[184:187], v[116:119], v[184:187], 0
    v_mfma_f32_16x16x32_bf16 a[184:187], v[132:135], v[200:203], a[184:187]
    v_mfma_f32_16x16x32_bf16 a[188:191], v[120:123], v[184:187], 0
    v_mfma_f32_16x16x32_bf16 a[188:191], v[136:139], v[200:203], a[188:191]
    s_waitcnt vmcnt(16) lgkmcnt(0)
    s_barrier
    v_mfma_f32_16x16x32_bf16 a[128:131], v[76:79], v[140:143], a[128:131]
    ds_read_b64_tr_b16 v[108:109], v13 offset:32768
    ds_read_b64_tr_b16 v[110:111], v13 offset:36864
    v_accvgpr_read_b32 v208, a192
    v_accvgpr_read_b32 v209, a193
    v_accvgpr_read_b32 v210, a194
    v_accvgpr_read_b32 v211, a195
    v_mfma_f32_16x16x32_bf16 a[128:131], v[92:95], v[156:159], a[128:131]
    s_add_u32 m0, s93, 0
    ds_read_b64_tr_b16 v[112:113], v14 offset:32768
    ds_read_b64_tr_b16 v[114:115], v14 offset:36864
    v_accvgpr_read_b32 v212, a196
    v_accvgpr_read_b32 v213, a197
    v_accvgpr_read_b32 v214, a198
    v_accvgpr_read_b32 v215, a199
    v_mfma_f32_16x16x32_bf16 a[132:135], v[80:83], v[140:143], a[132:135]
    buffer_load_dwordx4 v11, s[16:19], s61 offen lds
    v_cvt_pk_bf16_f32 v216, v208, v209
    v_cvt_pk_bf16_f32 v217, v210, v211
    v_cvt_pk_bf16_f32 v218, v212, v213
    v_cvt_pk_bf16_f32 v219, v214, v215
    v_mfma_f32_16x16x32_bf16 a[132:135], v[96:99], v[156:159], a[132:135]
    ds_read_b64_tr_b16 v[116:117], v15 offset:32768
    ds_read_b64_tr_b16 v[118:119], v15 offset:36864
    s_add_u32 s69, s68, 32768
    buffer_store_dwordx4 v[216:219], v10, s[64:67], s69 offen offset:0 sc1
    v_accvgpr_read_b32 v220, a200
    v_accvgpr_read_b32 v221, a201
    v_mfma_f32_16x16x32_bf16 a[136:139], v[84:87], v[140:143], a[136:139]
    ds_read_b64_tr_b16 v[120:121], v16 offset:32768
    ds_read_b64_tr_b16 v[122:123], v16 offset:36864
    v_accvgpr_read_b32 v222, a202
    v_accvgpr_read_b32 v223, a203
    v_accvgpr_read_b32 v224, a204
    v_accvgpr_read_b32 v225, a205
    v_mfma_f32_16x16x32_bf16 a[136:139], v[100:103], v[156:159], a[136:139]
    buffer_load_dwordx4 v12, s[16:19], s61 offen offset:1024 lds
    s_add_u32 s61, s61, 32768
    v_accvgpr_read_b32 v226, a206
    v_accvgpr_read_b32 v227, a207
    v_cvt_pk_bf16_f32 v228, v220, v221
    v_cvt_pk_bf16_f32 v229, v222, v223
    v_mfma_f32_16x16x32_bf16 a[140:143], v[88:91], v[140:143], a[140:143]
    ds_read_b128 v[172:175], v21 offset:32768
    ds_read_b128 v[176:179], v21 offset:33792
    v_cvt_pk_bf16_f32 v230, v224, v225
    v_cvt_pk_bf16_f32 v231, v226, v227
    buffer_store_dwordx4 v[228:231], v10, s[64:67], s69 offen offset:1024 sc1
    v_accvgpr_read_b32 v208, a208
    v_mfma_f32_16x16x32_bf16 a[140:143], v[104:107], v[156:159], a[140:143]
    s_add_u32 m0, s93, 16384
    ds_read_b128 v[180:183], v21 offset:34816
    ds_read_b128 v[184:187], v21 offset:35840
    v_accvgpr_read_b32 v209, a209
    v_accvgpr_read_b32 v210, a210
    v_accvgpr_read_b32 v211, a211
    v_accvgpr_read_b32 v212, a212
    v_mfma_f32_16x16x32_bf16 a[144:147], v[76:79], v[144:147], a[144:147]
    buffer_load_dwordx4 v11, s[16:19], s61 offen lds
    v_accvgpr_read_b32 v213, a213
    v_accvgpr_read_b32 v214, a214
    v_accvgpr_read_b32 v215, a215
    v_cvt_pk_bf16_f32 v216, v208, v209
    v_mfma_f32_16x16x32_bf16 a[144:147], v[92:95], v[160:163], a[144:147]
    ds_read_b64_tr_b16 v[124:125], v13 offset:49152
    ds_read_b64_tr_b16 v[126:127], v13 offset:53248
    v_cvt_pk_bf16_f32 v217, v210, v211
    v_cvt_pk_bf16_f32 v218, v212, v213
    v_cvt_pk_bf16_f32 v219, v214, v215
    buffer_store_dwordx4 v[216:219], v10, s[64:67], s69 offen offset:2048 sc1
    v_mfma_f32_16x16x32_bf16 a[148:151], v[80:83], v[144:147], a[148:151]
    ds_read_b64_tr_b16 v[128:129], v14 offset:49152
    ds_read_b64_tr_b16 v[130:131], v14 offset:53248
    v_accvgpr_read_b32 v220, a216
    v_accvgpr_read_b32 v221, a217
    v_accvgpr_read_b32 v222, a218
    v_accvgpr_read_b32 v223, a219
    v_mfma_f32_16x16x32_bf16 a[148:151], v[96:99], v[160:163], a[148:151]
    buffer_load_dwordx4 v12, s[16:19], s61 offen offset:1024 lds
    s_add_u32 s61, s61, 32768
    v_accvgpr_read_b32 v224, a220
    v_accvgpr_read_b32 v225, a221
    v_accvgpr_read_b32 v226, a222
    v_accvgpr_read_b32 v227, a223
    v_mfma_f32_16x16x32_bf16 a[152:155], v[84:87], v[144:147], a[152:155]
    ds_read_b64_tr_b16 v[132:133], v15 offset:49152
    ds_read_b64_tr_b16 v[134:135], v15 offset:53248
    v_cvt_pk_bf16_f32 v228, v220, v221
    v_cvt_pk_bf16_f32 v229, v222, v223
    v_cvt_pk_bf16_f32 v230, v224, v225
    v_cvt_pk_bf16_f32 v231, v226, v227
    v_mfma_f32_16x16x32_bf16 a[152:155], v[100:103], v[160:163], a[152:155]
    s_add_u32 m0, s93, 8192
    ds_read_b64_tr_b16 v[136:137], v16 offset:49152
    ds_read_b64_tr_b16 v[138:139], v16 offset:53248
    buffer_store_dwordx4 v[228:231], v10, s[64:67], s69 offen offset:3072 sc1
    v_accvgpr_read_b32 v208, a224
    v_accvgpr_read_b32 v209, a225
    v_accvgpr_read_b32 v210, a226
    v_mfma_f32_16x16x32_bf16 a[156:159], v[88:91], v[144:147], a[156:159]
    buffer_load_dwordx4 v10, s[8:11], s91 offen sc1 lds
    v_accvgpr_read_b32 v211, a227
    v_accvgpr_read_b32 v212, a228
    v_accvgpr_read_b32 v213, a229
    v_accvgpr_read_b32 v214, a230
    v_mfma_f32_16x16x32_bf16 a[156:159], v[104:107], v[160:163], a[156:159]
    ds_read_b128 v[188:191], v21 offset:49152
    ds_read_b128 v[192:195], v21 offset:50176
    v_accvgpr_read_b32 v215, a231
    v_cvt_pk_bf16_f32 v216, v208, v209
    v_cvt_pk_bf16_f32 v217, v210, v211
    v_cvt_pk_bf16_f32 v218, v212, v213
    v_mfma_f32_16x16x32_bf16 a[160:163], v[76:79], v[148:151], a[160:163]
    ds_read_b128 v[196:199], v21 offset:51200
    ds_read_b128 v[200:203], v21 offset:52224
    v_cvt_pk_bf16_f32 v219, v214, v215
    s_add_u32 s69, s68, 36864
    buffer_store_dwordx4 v[216:219], v10, s[64:67], s69 offen offset:0 sc1
    v_accvgpr_read_b32 v220, a232
    v_mfma_f32_16x16x32_bf16 a[160:163], v[92:95], v[164:167], a[160:163]
    buffer_load_dwordx4 v10, s[8:11], s91 offen offset:1024 sc1 lds
    s_add_u32 s91, s91, 4096
    s_add_u32 m0, s93, 24576
    v_accvgpr_read_b32 v221, a233
    v_accvgpr_read_b32 v222, a234
    v_accvgpr_read_b32 v223, a235
    v_accvgpr_read_b32 v224, a236
    v_mfma_f32_16x16x32_bf16 a[164:167], v[80:83], v[148:151], a[164:167]
    buffer_load_dwordx4 v10, s[8:11], s91 offen sc1 lds
    v_accvgpr_read_b32 v225, a237
    v_accvgpr_read_b32 v226, a238
    v_accvgpr_read_b32 v227, a239
    v_cvt_pk_bf16_f32 v228, v220, v221
    v_mfma_f32_16x16x32_bf16 a[164:167], v[96:99], v[164:167], a[164:167]
    buffer_load_dwordx4 v10, s[8:11], s91 offen offset:1024 sc1 lds
    s_add_u32 s91, s91, 4096
    v_cvt_pk_bf16_f32 v229, v222, v223
    v_cvt_pk_bf16_f32 v230, v224, v225
    v_cvt_pk_bf16_f32 v231, v226, v227
    buffer_store_dwordx4 v[228:231], v10, s[64:67], s69 offen offset:1024 sc1
    v_mfma_f32_16x16x32_bf16 a[168:171], v[84:87], v[148:151], a[168:171]
    v_accvgpr_read_b32 v208, a240
    v_accvgpr_read_b32 v209, a241
    v_accvgpr_read_b32 v210, a242
    v_accvgpr_read_b32 v211, a243
    v_mfma_f32_16x16x32_bf16 a[168:171], v[100:103], v[164:167], a[168:171]
    v_accvgpr_read_b32 v212, a244
    v_accvgpr_read_b32 v213, a245
    v_accvgpr_read_b32 v214, a246
    v_accvgpr_read_b32 v215, a247
    v_mfma_f32_16x16x32_bf16 a[172:175], v[88:91], v[148:151], a[172:175]
    v_cvt_pk_bf16_f32 v216, v208, v209
    v_cvt_pk_bf16_f32 v217, v210, v211
    v_cvt_pk_bf16_f32 v218, v212, v213
    v_cvt_pk_bf16_f32 v219, v214, v215
    v_mfma_f32_16x16x32_bf16 a[172:175], v[104:107], v[164:167], a[172:175]
    buffer_store_dwordx4 v[216:219], v10, s[64:67], s69 offen offset:2048 sc1
    v_accvgpr_read_b32 v220, a248
    v_accvgpr_read_b32 v221, a249
    v_accvgpr_read_b32 v222, a250
    v_mfma_f32_16x16x32_bf16 a[176:179], v[76:79], v[152:155], a[176:179]
    v_accvgpr_read_b32 v223, a251
    v_accvgpr_read_b32 v224, a252
    v_accvgpr_read_b32 v225, a253
    v_accvgpr_read_b32 v226, a254
    v_mfma_f32_16x16x32_bf16 a[176:179], v[92:95], v[168:171], a[176:179]
    v_accvgpr_read_b32 v227, a255
    v_cvt_pk_bf16_f32 v228, v220, v221
    v_cvt_pk_bf16_f32 v229, v222, v223
    v_cvt_pk_bf16_f32 v230, v224, v225
    v_mfma_f32_16x16x32_bf16 a[180:183], v[80:83], v[152:155], a[180:183]
    v_cvt_pk_bf16_f32 v231, v226, v227
    buffer_store_dwordx4 v[228:231], v10, s[64:67], s69 offen offset:3072 sc1
    v_mfma_f32_16x16x32_bf16 a[180:183], v[96:99], v[168:171], a[180:183]
    v_mfma_f32_16x16x32_bf16 a[184:187], v[84:87], v[152:155], a[184:187]
    v_mfma_f32_16x16x32_bf16 a[184:187], v[100:103], v[168:171], a[184:187]
    v_mfma_f32_16x16x32_bf16 a[188:191], v[88:91], v[152:155], a[188:191]
    v_mfma_f32_16x16x32_bf16 a[188:191], v[104:107], v[168:171], a[188:191]
    s_waitcnt vmcnt(24) lgkmcnt(0)
    s_barrier
    v_mfma_f32_16x16x32_bf16 a[128:131], v[108:111], v[172:175], a[128:131]
    ds_read_b64_tr_b16 v[76:77], v17 offset:0
    ds_read_b64_tr_b16 v[78:79], v17 offset:4096
    v_mfma_f32_16x16x32_bf16 a[128:131], v[124:127], v[188:191], a[128:131]
    s_add_u32 m0, s93, 32768
    ds_read_b64_tr_b16 v[80:81], v18 offset:0
    ds_read_b64_tr_b16 v[82:83], v18 offset:4096
    v_mfma_f32_16x16x32_bf16 a[132:135], v[112:115], v[172:175], a[132:135]
    buffer_load_dwordx4 v11, s[16:19], s61 offen lds
    v_mfma_f32_16x16x32_bf16 a[132:135], v[128:131], v[188:191], a[132:135]
    ds_read_b64_tr_b16 v[84:85], v19 offset:0
    ds_read_b64_tr_b16 v[86:87], v19 offset:4096
    v_mfma_f32_16x16x32_bf16 a[136:139], v[116:119], v[172:175], a[136:139]
    ds_read_b64_tr_b16 v[88:89], v20 offset:0
    ds_read_b64_tr_b16 v[90:91], v20 offset:4096
    v_mfma_f32_16x16x32_bf16 a[136:139], v[132:135], v[188:191], a[136:139]
    buffer_load_dwordx4 v12, s[16:19], s61 offen offset:1024 lds
    s_add_u32 s61, s61, 32768
    v_mfma_f32_16x16x32_bf16 a[140:143], v[120:123], v[172:175], a[140:143]
    ds_read_b128 v[140:143], v22 offset:0
    ds_read_b128 v[144:147], v22 offset:1024
    v_mfma_f32_16x16x32_bf16 a[140:143], v[136:139], v[188:191], a[140:143]
    s_add_u32 m0, s93, 49152
    ds_read_b128 v[148:151], v22 offset:2048
    ds_read_b128 v[152:155], v22 offset:3072
    v_mfma_f32_16x16x32_bf16 a[144:147], v[108:111], v[176:179], a[144:147]
    buffer_load_dwordx4 v11, s[16:19], s61 offen lds
    v_mfma_f32_16x16x32_bf16 a[144:147], v[124:127], v[192:195], a[144:147]
    ds_read_b64_tr_b16 v[92:93], v17 offset:16384
    ds_read_b64_tr_b16 v[94:95], v17 offset:20480
    v_mfma_f32_16x16x32_bf16 a[148:151], v[112:115], v[176:179], a[148:151]
    ds_read_b64_tr_b16 v[96:97], v18 offset:16384
    ds_read_b64_tr_b16 v[98:99], v18 offset:20480
    v_mfma_f32_16x16x32_bf16 a[148:151], v[128:131], v[192:195], a[148:151]
    buffer_load_dwordx4 v12, s[16:19], s61 offen offset:1024 lds
    s_add_u32 s61, s61, 32768
    v_mfma_f32_16x16x32_bf16 a[152:155], v[116:119], v[176:179], a[152:155]
    ds_read_b64_tr_b16 v[100:101], v19 offset:16384
    ds_read_b64_tr_b16 v[102:103], v19 offset:20480
    v_mfma_f32_16x16x32_bf16 a[152:155], v[132:135], v[192:195], a[152:155]
    s_add_u32 m0, s93, 40960
    ds_read_b64_tr_b16 v[104:105], v20 offset:16384
    ds_read_b64_tr_b16 v[106:107], v20 offset:20480
    v_mfma_f32_16x16x32_bf16 a[156:159], v[120:123], v[176:179], a[156:159]
    buffer_load_dwordx4 v10, s[8:11], s91 offen sc1 lds
    v_mfma_f32_16x16x32_bf16 a[156:159], v[136:139], v[192:195], a[156:159]
    ds_read_b128 v[156:159], v22 offset:16384
    ds_read_b128 v[160:163], v22 offset:17408
    v_mfma_f32_16x16x32_bf16 a[160:163], v[108:111], v[180:183], a[160:163]
    ds_read_b128 v[164:167], v22 offset:18432
    ds_read_b128 v[168:171], v22 offset:19456
    v_mfma_f32_16x16x32_bf16 a[160:163], v[124:127], v[196:199], a[160:163]
    buffer_load_dwordx4 v10, s[8:11], s91 offen offset:1024 sc1 lds
    s_add_u32 s91, s91, 4096
    s_add_u32 m0, s93, 57344
    v_mfma_f32_16x16x32_bf16 a[164:167], v[112:115], v[180:183], a[164:167]
    buffer_load_dwordx4 v10, s[8:11], s91 offen sc1 lds
    v_mfma_f32_16x16x32_bf16 a[164:167], v[128:131], v[196:199], a[164:167]
    buffer_load_dwordx4 v10, s[8:11], s91 offen offset:1024 sc1 lds
    s_add_u32 s91, s91, 4096
    v_mfma_f32_16x16x32_bf16 a[168:171], v[116:119], v[180:183], a[168:171]
    v_mfma_f32_16x16x32_bf16 a[168:171], v[132:135], v[196:199], a[168:171]
    v_mfma_f32_16x16x32_bf16 a[172:175], v[120:123], v[180:183], a[172:175]
    v_mfma_f32_16x16x32_bf16 a[172:175], v[136:139], v[196:199], a[172:175]
    v_mfma_f32_16x16x32_bf16 a[176:179], v[108:111], v[184:187], a[176:179]
    v_mfma_f32_16x16x32_bf16 a[176:179], v[124:127], v[200:203], a[176:179]
    v_mfma_f32_16x16x32_bf16 a[180:183], v[112:115], v[184:187], a[180:183]
    v_mfma_f32_16x16x32_bf16 a[180:183], v[128:131], v[200:203], a[180:183]
    v_mfma_f32_16x16x32_bf16 a[184:187], v[116:119], v[184:187], a[184:187]
    v_mfma_f32_16x16x32_bf16 a[184:187], v[132:135], v[200:203], a[184:187]
    v_mfma_f32_16x16x32_bf16 a[188:191], v[120:123], v[184:187], a[188:191]
    v_mfma_f32_16x16x32_bf16 a[188:191], v[136:139], v[200:203], a[188:191]
    s_waitcnt vmcnt(24) lgkmcnt(0)
    s_barrier
    v_mfma_f32_16x16x32_bf16 a[128:131], v[76:79], v[140:143], a[128:131]
    ds_read_b64_tr_b16 v[108:109], v17 offset:32768
    ds_read_b64_tr_b16 v[110:111], v17 offset:36864
    v_mfma_f32_16x16x32_bf16 a[128:131], v[92:95], v[156:159], a[128:131]
    s_add_u32 m0, s93, 81920
    ds_read_b64_tr_b16 v[112:113], v18 offset:32768
    ds_read_b64_tr_b16 v[114:115], v18 offset:36864
    v_mfma_f32_16x16x32_bf16 a[132:135], v[80:83], v[140:143], a[132:135]
    buffer_load_dwordx4 v11, s[16:19], s61 offen lds
    v_mfma_f32_16x16x32_bf16 a[132:135], v[96:99], v[156:159], a[132:135]
    ds_read_b64_tr_b16 v[116:117], v19 offset:32768
    ds_read_b64_tr_b16 v[118:119], v19 offset:36864
    v_mfma_f32_16x16x32_bf16 a[136:139], v[84:87], v[140:143], a[136:139]
    ds_read_b64_tr_b16 v[120:121], v20 offset:32768
    ds_read_b64_tr_b16 v[122:123], v20 offset:36864
    v_mfma_f32_16x16x32_bf16 a[136:139], v[100:103], v[156:159], a[136:139]
    buffer_load_dwordx4 v12, s[16:19], s61 offen offset:1024 lds
    s_add_u32 s61, s61, 32768
    v_mfma_f32_16x16x32_bf16 a[140:143], v[88:91], v[140:143], a[140:143]
    ds_read_b128 v[172:175], v22 offset:32768
    ds_read_b128 v[176:179], v22 offset:33792
    v_mfma_f32_16x16x32_bf16 a[140:143], v[104:107], v[156:159], a[140:143]
    s_add_u32 m0, s93, 98304
    ds_read_b128 v[180:183], v22 offset:34816
    ds_read_b128 v[184:187], v22 offset:35840
    v_mfma_f32_16x16x32_bf16 a[144:147], v[76:79], v[144:147], a[144:147]
    buffer_load_dwordx4 v11, s[16:19], s61 offen lds
    v_mfma_f32_16x16x32_bf16 a[144:147], v[92:95], v[160:163], a[144:147]
    ds_read_b64_tr_b16 v[124:125], v17 offset:49152
    ds_read_b64_tr_b16 v[126:127], v17 offset:53248
    v_mfma_f32_16x16x32_bf16 a[148:151], v[80:83], v[144:147], a[148:151]
    ds_read_b64_tr_b16 v[128:129], v18 offset:49152
    ds_read_b64_tr_b16 v[130:131], v18 offset:53248
    v_mfma_f32_16x16x32_bf16 a[148:151], v[96:99], v[160:163], a[148:151]
    buffer_load_dwordx4 v12, s[16:19], s61 offen offset:1024 lds
    s_add_u32 s61, s61, 32768
    v_mfma_f32_16x16x32_bf16 a[152:155], v[84:87], v[144:147], a[152:155]
    ds_read_b64_tr_b16 v[132:133], v19 offset:49152
    ds_read_b64_tr_b16 v[134:135], v19 offset:53248
    v_mfma_f32_16x16x32_bf16 a[152:155], v[100:103], v[160:163], a[152:155]
    s_add_u32 m0, s93, 90112
    ds_read_b64_tr_b16 v[136:137], v20 offset:49152
    ds_read_b64_tr_b16 v[138:139], v20 offset:53248
    v_mfma_f32_16x16x32_bf16 a[156:159], v[88:91], v[144:147], a[156:159]
    buffer_load_dwordx4 v10, s[8:11], s91 offen sc1 lds
    v_mfma_f32_16x16x32_bf16 a[156:159], v[104:107], v[160:163], a[156:159]
    ds_read_b128 v[188:191], v22 offset:49152
    ds_read_b128 v[192:195], v22 offset:50176
    v_mfma_f32_16x16x32_bf16 a[160:163], v[76:79], v[148:151], a[160:163]
    ds_read_b128 v[196:199], v22 offset:51200
    ds_read_b128 v[200:203], v22 offset:52224
    v_mfma_f32_16x16x32_bf16 a[160:163], v[92:95], v[164:167], a[160:163]
    buffer_load_dwordx4 v10, s[8:11], s91 offen offset:1024 sc1 lds
    s_add_u32 s91, s91, 4096
    s_add_u32 m0, s93, 106496
    v_mfma_f32_16x16x32_bf16 a[164:167], v[80:83], v[148:151], a[164:167]
    buffer_load_dwordx4 v10, s[8:11], s91 offen sc1 lds
    v_mfma_f32_16x16x32_bf16 a[164:167], v[96:99], v[164:167], a[164:167]
    buffer_load_dwordx4 v10, s[8:11], s91 offen offset:1024 sc1 lds
    s_add_u32 s91, s91, 4096
    v_mfma_f32_16x16x32_bf16 a[168:171], v[84:87], v[148:151], a[168:171]
    v_mfma_f32_16x16x32_bf16 a[168:171], v[100:103], v[164:167], a[168:171]
    v_mfma_f32_16x16x32_bf16 a[172:175], v[88:91], v[148:151], a[172:175]
    v_mfma_f32_16x16x32_bf16 a[172:175], v[104:107], v[164:167], a[172:175]
    v_mfma_f32_16x16x32_bf16 a[176:179], v[76:79], v[152:155], a[176:179]
    v_mfma_f32_16x16x32_bf16 a[176:179], v[92:95], v[168:171], a[176:179]
    v_mfma_f32_16x16x32_bf16 a[180:183], v[80:83], v[152:155], a[180:183]
    v_mfma_f32_16x16x32_bf16 a[180:183], v[96:99], v[168:171], a[180:183]
    v_mfma_f32_16x16x32_bf16 a[184:187], v[84:87], v[152:155], a[184:187]
    v_mfma_f32_16x16x32_bf16 a[184:187], v[100:103], v[168:171], a[184:187]
    v_mfma_f32_16x16x32_bf16 a[188:191], v[88:91], v[152:155], a[188:191]
    v_mfma_f32_16x16x32_bf16 a[188:191], v[104:107], v[168:171], a[188:191]
    s_waitcnt vmcnt(16) lgkmcnt(0)
    s_barrier
    s_cmp_eq_u32 s3, 0
    s_cbranch_scc0 KF_sigd
    s_mov_b64 s[96:97], exec
    s_mov_b64 exec, 1
    v_mov_b32 v3, 1
    v_mov_b32 v2, 0
    buffer_store_dword v3, v2, s[76:79], s62 offen offset:16 sc1
    s_mov_b64 exec, s[96:97]
KF_sigd:
    v_mfma_f32_16x16x32_bf16 a[128:131], v[108:111], v[172:175], a[128:131]
    ds_read_b64_tr_b16 v[76:77], v13 offset:0
    ds_read_b64_tr_b16 v[78:79], v13 offset:4096
    v_mfma_f32_16x16x32_bf16 a[128:131], v[124:127], v[188:191], a[128:131]
    s_add_u32 m0, s93, 114688
    ds_read_b64_tr_b16 v[80:81], v14 offset:0
    ds_read_b64_tr_b16 v[82:83], v14 offset:4096
    v_mfma_f32_16x16x32_bf16 a[132:135], v[112:115], v[172:175], a[132:135]
    buffer_load_dwordx4 v11, s[16:19], s61 offen lds
    v_mfma_f32_16x16x32_bf16 a[132:135], v[128:131], v[188:191], a[132:135]
    ds_read_b64_tr_b16 v[84:85], v15 offset:0
    ds_read_b64_tr_b16 v[86:87], v15 offset:4096
    v_mfma_f32_16x16x32_bf16 a[136:139], v[116:119], v[172:175], a[136:139]
    ds_read_b64_tr_b16 v[88:89], v16 offset:0
    ds_read_b64_tr_b16 v[90:91], v16 offset:4096
    v_mfma_f32_16x16x32_bf16 a[136:139], v[132:135], v[188:191], a[136:139]
    buffer_load_dwordx4 v12, s[16:19], s61 offen offset:1024 lds
    s_add_u32 s61, s61, 32768
    v_mfma_f32_16x16x32_bf16 a[140:143], v[120:123], v[172:175], a[140:143]
    ds_read_b128 v[140:143], v21 offset:0
    ds_read_b128 v[144:147], v21 offset:1024
    v_mfma_f32_16x16x32_bf16 a[140:143], v[136:139], v[188:191], a[140:143]
    s_add_u32 m0, s93, 131072
    ds_read_b128 v[148:151], v21 offset:2048
    ds_read_b128 v[152:155], v21 offset:3072
    v_mfma_f32_16x16x32_bf16 a[144:147], v[108:111], v[176:179], a[144:147]
    buffer_load_dwordx4 v11, s[16:19], s61 offen lds
    v_mfma_f32_16x16x32_bf16 a[144:147], v[124:127], v[192:195], a[144:147]
    ds_read_b64_tr_b16 v[92:93], v13 offset:16384
    ds_read_b64_tr_b16 v[94:95], v13 offset:20480
    v_mfma_f32_16x16x32_bf16 a[148:151], v[112:115], v[176:179], a[148:151]
    ds_read_b64_tr_b16 v[96:97], v14 offset:16384
    ds_read_b64_tr_b16 v[98:99], v14 offset:20480
    v_mfma_f32_16x16x32_bf16 a[148:151], v[128:131], v[192:195], a[148:151]
    buffer_load_dwordx4 v12, s[16:19], s61 offen offset:1024 lds
    s_add_u32 s61, s61, 32768
    v_mfma_f32_16x16x32_bf16 a[152:155], v[116:119], v[176:179], a[152:155]
    ds_read_b64_tr_b16 v[100:101], v15 offset:16384
    ds_read_b64_tr_b16 v[102:103], v15 offset:20480
    v_mfma_f32_16x16x32_bf16 a[152:155], v[132:135], v[192:195], a[152:155]
    s_add_u32 m0, s93, 122880
    ds_read_b64_tr_b16 v[104:105], v16 offset:16384
    ds_read_b64_tr_b16 v[106:107], v16 offset:20480
    v_mfma_f32_16x16x32_bf16 a[156:159], v[120:123], v[176:179], a[156:159]
    buffer_load_dwordx4 v10, s[8:11], s91 offen sc1 lds
    v_mfma_f32_16x16x32_bf16 a[156:159], v[136:139], v[192:195], a[156:159]
    ds_read_b128 v[156:159], v21 offset:16384
    ds_read_b128 v[160:163], v21 offset:17408
    v_mfma_f32_16x16x32_bf16 a[160:163], v[108:111], v[180:183], a[160:163]
    ds_read_b128 v[164:167], v21 offset:18432
    ds_read_b128 v[168:171], v21 offset:19456
    v_mfma_f32_16x16x32_bf16 a[160:163], v[124:127], v[196:199], a[160:163]
    buffer_load_dwordx4 v10, s[8:11], s91 offen offset:1024 sc1 lds
    s_add_u32 s91, s91, 4096
    s_add_u32 m0, s93, 139264
    v_mfma_f32_16x16x32_bf16 a[164:167], v[112:115], v[180:183], a[164:167]
    buffer_load_dwordx4 v10, s[8:11], s91 offen sc1 lds
    v_mfma_f32_16x16x32_bf16 a[164:167], v[128:131], v[196:199], a[164:167]
    buffer_load_dwordx4 v10, s[8:11], s91 offen offset:1024 sc1 lds
    s_add_u32 s91, s91, 4096
    v_mfma_f32_16x16x32_bf16 a[168:171], v[116:119], v[180:183], a[168:171]
    v_mfma_f32_16x16x32_bf16 a[168:171], v[132:135], v[196:199], a[168:171]
    v_mfma_f32_16x16x32_bf16 a[172:175], v[120:123], v[180:183], a[172:175]
    v_mfma_f32_16x16x32_bf16 a[172:175], v[136:139], v[196:199], a[172:175]
    v_mfma_f32_16x16x32_bf16 a[176:179], v[108:111], v[184:187], a[176:179]
    v_mfma_f32_16x16x32_bf16 a[176:179], v[124:127], v[200:203], a[176:179]
    v_mfma_f32_16x16x32_bf16 a[180:183], v[112:115], v[184:187], a[180:183]
    v_mfma_f32_16x16x32_bf16 a[180:183], v[128:131], v[200:203], a[180:183]
    v_mfma_f32_16x16x32_bf16 a[184:187], v[116:119], v[184:187], a[184:187]
    v_mfma_f32_16x16x32_bf16 a[184:187], v[132:135], v[200:203], a[184:187]
    v_mfma_f32_16x16x32_bf16 a[188:191], v[120:123], v[184:187], a[188:191]
    v_mfma_f32_16x16x32_bf16 a[188:191], v[136:139], v[200:203], a[188:191]
    s_waitcnt vmcnt(16) lgkmcnt(0)
    s_barrier
    v_mfma_f32_16x16x32_bf16 a[128:131], v[76:79], v[140:143], a[128:131]
    ds_read_b64_tr_b16 v[108:109], v13 offset:32768
    ds_read_b64_tr_b16 v[110:111], v13 offset:36864
    v_mfma_f32_16x16x32_bf16 a[128:131], v[92:95], v[156:159], a[128:131]
    s_add_u32 m0, s93, 0
    ds_read_b64_tr_b16 v[112:113], v14 offset:32768
    ds_read_b64_tr_b16 v[114:115], v14 offset:36864
    v_mfma_f32_16x16x32_bf16 a[132:135], v[80:83], v[140:143], a[132:135]
    buffer_load_dwordx4 v11, s[16:19], s61 offen lds
    v_mfma_f32_16x16x32_bf16 a[132:135], v[96:99], v[156:159], a[132:135]
    ds_read_b64_tr_b16 v[116:117], v15 offset:32768
    ds_read_b64_tr_b16 v[118:119], v15 offset:36864
    v_mfma_f32_16x16x32_bf16 a[136:139], v[84:87], v[140:143], a[136:139]
    ds_read_b64_tr_b16 v[120:121], v16 offset:32768
    ds_read_b64_tr_b16 v[122:123], v16 offset:36864
    v_mfma_f32_16x16x32_bf16 a[136:139], v[100:103], v[156:159], a[136:139]
    buffer_load_dwordx4 v12, s[16:19], s61 offen offset:1024 lds
    s_add_u32 s61, s61, 32768
    v_mfma_f32_16x16x32_bf16 a[140:143], v[88:91], v[140:143], a[140:143]
    ds_read_b128 v[172:175], v21 offset:32768
    ds_read_b128 v[176:179], v21 offset:33792
    v_mfma_f32_16x16x32_bf16 a[140:143], v[104:107], v[156:159], a[140:143]
    s_add_u32 m0, s93, 16384
    ds_read_b128 v[180:183], v21 offset:34816
    ds_read_b128 v[184:187], v21 offset:35840
    v_mfma_f32_16x16x32_bf16 a[144:147], v[76:79], v[144:147], a[144:147]
    buffer_load_dwordx4 v11, s[16:19], s61 offen lds
    v_mfma_f32_16x16x32_bf16 a[144:147], v[92:95], v[160:163], a[144:147]
    ds_read_b64_tr_b16 v[124:125], v13 offset:49152
    ds_read_b64_tr_b16 v[126:127], v13 offset:53248
    v_mfma_f32_16x16x32_bf16 a[148:151], v[80:83], v[144:147], a[148:151]
    ds_read_b64_tr_b16 v[128:129], v14 offset:49152
    ds_read_b64_tr_b16 v[130:131], v14 offset:53248
    v_mfma_f32_16x16x32_bf16 a[148:151], v[96:99], v[160:163], a[148:151]
    buffer_load_dwordx4 v12, s[16:19], s61 offen offset:1024 lds
    s_add_u32 s61, s61, 32768
    v_mfma_f32_16x16x32_bf16 a[152:155], v[84:87], v[144:147], a[152:155]
    ds_read_b64_tr_b16 v[132:133], v15 offset:49152
    ds_read_b64_tr_b16 v[134:135], v15 offset:53248
    v_mfma_f32_16x16x32_bf16 a[152:155], v[100:103], v[160:163], a[152:155]
    s_add_u32 m0, s93, 8192
    ds_read_b64_tr_b16 v[136:137], v16 offset:49152
    ds_read_b64_tr_b16 v[138:139], v16 offset:53248
    v_mfma_f32_16x16x32_bf16 a[156:159], v[88:91], v[144:147], a[156:159]
    buffer_load_dwordx4 v10, s[8:11], s91 offen sc1 lds
    v_mfma_f32_16x16x32_bf16 a[156:159], v[104:107], v[160:163], a[156:159]
    ds_read_b128 v[188:191], v21 offset:49152
    ds_read_b128 v[192:195], v21 offset:50176
    v_mfma_f32_16x16x32_bf16 a[160:163], v[76:79], v[148:151], a[160:163]
    ds_read_b128 v[196:199], v21 offset:51200
    ds_read_b128 v[200:203], v21 offset:52224
    v_mfma_f32_16x16x32_bf16 a[160:163], v[92:95], v[164:167], a[160:163]
    buffer_load_dwordx4 v10, s[8:11], s91 offen offset:1024 sc1 lds
    s_add_u32 s91, s91, 4096
    s_add_u32 m0, s93, 24576
    v_mfma_f32_16x16x32_bf16 a[164:167], v[80:83], v[148:151], a[164:167]
    buffer_load_dwordx4 v10, s[8:11], s91 offen sc1 lds
    v_mfma_f32_16x16x32_bf16 a[164:167], v[96:99], v[164:167], a[164:167]
    buffer_load_dwordx4 v10, s[8:11], s91 offen offset:1024 sc1 lds
    s_add_u32 s91, s91, 4096
    v_mfma_f32_16x16x32_bf16 a[168:171], v[84:87], v[148:151], a[168:171]
    v_mfma_f32_16x16x32_bf16 a[168:171], v[100:103], v[164:167], a[168:171]
    v_mfma_f32_16x16x32_bf16 a[172:175], v[88:91], v[148:151], a[172:175]
    v_mfma_f32_16x16x32_bf16 a[172:175], v[104:107], v[164:167], a[172:175]
    v_mfma_f32_16x16x32_bf16 a[176:179], v[76:79], v[152:155], a[176:179]
    v_mfma_f32_16x16x32_bf16 a[176:179], v[92:95], v[168:171], a[176:179]
    v_mfma_f32_16x16x32_bf16 a[180:183], v[80:83], v[152:155], a[180:183]
    v_mfma_f32_16x16x32_bf16 a[180:183], v[96:99], v[168:171], a[180:183]
    v_mfma_f32_16x16x32_bf16 a[184:187], v[84:87], v[152:155], a[184:187]
    v_mfma_f32_16x16x32_bf16 a[184:187], v[100:103], v[168:171], a[184:187]
    v_mfma_f32_16x16x32_bf16 a[188:191], v[88:91], v[152:155], a[188:191]
    v_mfma_f32_16x16x32_bf16 a[188:191], v[104:107], v[168:171], a[188:191]
    s_waitcnt vmcnt(16) lgkmcnt(0)
    s_barrier
    v_mfma_f32_16x16x32_bf16 a[128:131], v[108:111], v[172:175], a[128:131]
    ds_read_b64_tr_b16 v[76:77], v17 offset:0
    ds_read_b64_tr_b16 v[78:79], v17 offset:4096
    v_mfma_f32_16x16x32_bf16 a[128:131], v[124:127], v[188:191], a[128:131]
    s_add_u32 m0, s93, 32768
    ds_read_b64_tr_b16 v[80:81], v18 offset:0
    ds_read_b64_tr_b16 v[82:83], v18 offset:4096
    v_mfma_f32_16x16x32_bf16 a[132:135], v[112:115], v[172:175], a[132:135]
    buffer_load_dwordx4 v11, s[16:19], s61 offen lds
    v_mfma_f32_16x16x32_bf16 a[132:135], v[128:131], v[188:191], a[132:135]
    ds_read_b64_tr_b16 v[84:85], v19 offset:0
    ds_read_b64_tr_b16 v[86:87], v19 offset:4096
    v_mfma_f32_16x16x32_bf16 a[136:139], v[116:119], v[172:175], a[136:139]
    ds_read_b64_tr_b16 v[88:89], v20 offset:0
    ds_read_b64_tr_b16 v[90:91], v20 offset:4096
    v_mfma_f32_16x16x32_bf16 a[136:139], v[132:135], v[188:191], a[136:139]
    buffer_load_dwordx4 v12, s[16:19], s61 offen offset:1024 lds
    s_add_u32 s61, s61, 32768
    v_mfma_f32_16x16x32_bf16 a[140:143], v[120:123], v[172:175], a[140:143]
    ds_read_b128 v[140:143], v22 offset:0
    ds_read_b128 v[144:147], v22 offset:1024
    v_mfma_f32_16x16x32_bf16 a[140:143], v[136:139], v[188:191], a[140:143]
    s_add_u32 m0, s93, 49152
    ds_read_b128 v[148:151], v22 offset:2048
    ds_read_b128 v[152:155], v22 offset:3072
    v_mfma_f32_16x16x32_bf16 a[144:147], v[108:111], v[176:179], a[144:147]
    buffer_load_dwordx4 v11, s[16:19], s61 offen lds
    v_mfma_f32_16x16x32_bf16 a[144:147], v[124:127], v[192:195], a[144:147]
    ds_read_b64_tr_b16 v[92:93], v17 offset:16384
    ds_read_b64_tr_b16 v[94:95], v17 offset:20480
    v_mfma_f32_16x16x32_bf16 a[148:151], v[112:115], v[176:179], a[148:151]
    ds_read_b64_tr_b16 v[96:97], v18 offset:16384
    ds_read_b64_tr_b16 v[98:99], v18 offset:20480
    v_mfma_f32_16x16x32_bf16 a[148:151], v[128:131], v[192:195], a[148:151]
    buffer_load_dwordx4 v12, s[16:19], s61 offen offset:1024 lds
    s_add_u32 s61, s61, 32768
    v_mfma_f32_16x16x32_bf16 a[152:155], v[116:119], v[176:179], a[152:155]
    ds_read_b64_tr_b16 v[100:101], v19 offset:16384
    ds_read_b64_tr_b16 v[102:103], v19 offset:20480
    v_mfma_f32_16x16x32_bf16 a[152:155], v[132:135], v[192:195], a[152:155]
    s_add_u32 m0, s93, 40960
    ds_read_b64_tr_b16 v[104:105], v20 offset:16384
    ds_read_b64_tr_b16 v[106:107], v20 offset:20480
    v_mfma_f32_16x16x32_bf16 a[156:159], v[120:123], v[176:179], a[156:159]
    buffer_load_dwordx4 v10, s[8:11], s91 offen sc1 lds
    v_mfma_f32_16x16x32_bf16 a[156:159], v[136:139], v[192:195], a[156:159]
    ds_read_b128 v[156:159], v22 offset:16384
    ds_read_b128 v[160:163], v22 offset:17408
    v_mfma_f32_16x16x32_bf16 a[160:163], v[108:111], v[180:183], a[160:163]
    ds_read_b128 v[164:167], v22 offset:18432
    ds_read_b128 v[168:171], v22 offset:19456
    v_mfma_f32_16x16x32_bf16 a[160:163], v[124:127], v[196:199], a[160:163]
    buffer_load_dwordx4 v10, s[8:11], s91 offen offset:1024 sc1 lds
    s_add_u32 s91, s91, 4096
    s_add_u32 m0, s93, 57344
    v_mfma_f32_16x16x32_bf16 a[164:167], v[112:115], v[180:183], a[164:167]
    buffer_load_dwordx4 v10, s[8:11], s91 offen sc1 lds
    v_mfma_f32_16x16x32_bf16 a[164:167], v[128:131], v[196:199], a[164:167]
    buffer_load_dwordx4 v10, s[8:11], s91 offen offset:1024 sc1 lds
    s_add_u32 s91, s91, 4096
    v_mfma_f32_16x16x32_bf16 a[168:171], v[116:119], v[180:183], a[168:171]
    v_mfma_f32_16x16x32_bf16 a[168:171], v[132:135], v[196:199], a[168:171]
    v_mfma_f32_16x16x32_bf16 a[172:175], v[120:123], v[180:183], a[172:175]
    v_mfma_f32_16x16x32_bf16 a[172:175], v[136:139], v[196:199], a[172:175]
    v_mfma_f32_16x16x32_bf16 a[176:179], v[108:111], v[184:187], a[176:179]
    v_mfma_f32_16x16x32_bf16 a[176:179], v[124:127], v[200:203], a[176:179]
    v_mfma_f32_16x16x32_bf16 a[180:183], v[112:115], v[184:187], a[180:183]
    v_mfma_f32_16x16x32_bf16 a[180:183], v[128:131], v[200:203], a[180:183]
    v_mfma_f32_16x16x32_bf16 a[184:187], v[116:119], v[184:187], a[184:187]
    v_mfma_f32_16x16x32_bf16 a[184:187], v[132:135], v[200:203], a[184:187]
    v_mfma_f32_16x16x32_bf16 a[188:191], v[120:123], v[184:187], a[188:191]
    v_mfma_f32_16x16x32_bf16 a[188:191], v[136:139], v[200:203], a[188:191]
    s_waitcnt vmcnt(16) lgkmcnt(0)
    s_barrier
    v_mfma_f32_16x16x32_bf16 a[128:131], v[76:79], v[140:143], a[128:131]
    ds_read_b64_tr_b16 v[108:109], v17 offset:32768
    ds_read_b64_tr_b16 v[110:111], v17 offset:36864
    v_mfma_f32_16x16x32_bf16 a[128:131], v[92:95], v[156:159], a[128:131]
    s_add_u32 m0, s93, 81920
    ds_read_b64_tr_b16 v[112:113], v18 offset:32768
    ds_read_b64_tr_b16 v[114:115], v18 offset:36864
    v_mfma_f32_16x16x32_bf16 a[132:135], v[80:83], v[140:143], a[132:135]
    buffer_load_dwordx4 v11, s[16:19], s61 offen lds
    v_mfma_f32_16x16x32_bf16 a[132:135], v[96:99], v[156:159], a[132:135]
    ds_read_b64_tr_b16 v[116:117], v19 offset:32768
    ds_read_b64_tr_b16 v[118:119], v19 offset:36864
    v_mfma_f32_16x16x32_bf16 a[136:139], v[84:87], v[140:143], a[136:139]
    ds_read_b64_tr_b16 v[120:121], v20 offset:32768
    ds_read_b64_tr_b16 v[122:123], v20 offset:36864
    v_mfma_f32_16x16x32_bf16 a[136:139], v[100:103], v[156:159], a[136:139]
    buffer_load_dwordx4 v12, s[16:19], s61 offen offset:1024 lds
    s_add_u32 s61, s61, 32768
    v_mfma_f32_16x16x32_bf16 a[140:143], v[88:91], v[140:143], a[140:143]
    ds_read_b128 v[172:175], v22 offset:32768
    ds_read_b128 v[176:179], v22 offset:33792
    v_mfma_f32_16x16x32_bf16 a[140:143], v[104:107], v[156:159], a[140:143]
    s_add_u32 m0, s93, 98304
    ds_read_b128 v[180:183], v22 offset:34816
    ds_read_b128 v[184:187], v22 offset:35840
    v_mfma_f32_16x16x32_bf16 a[144:147], v[76:79], v[144:147], a[144:147]
    buffer_load_dwordx4 v11, s[16:19], s61 offen lds
    v_mfma_f32_16x16x32_bf16 a[144:147], v[92:95], v[160:163], a[144:147]
    ds_read_b64_tr_b16 v[124:125], v17 offset:49152
    ds_read_b64_tr_b16 v[126:127], v17 offset:53248
    v_mfma_f32_16x16x32_bf16 a[148:151], v[80:83], v[144:147], a[148:151]
    ds_read_b64_tr_b16 v[128:129], v18 offset:49152
    ds_read_b64_tr_b16 v[130:131], v18 offset:53248
    v_mfma_f32_16x16x32_bf16 a[148:151], v[96:99], v[160:163], a[148:151]
    buffer_load_dwordx4 v12, s[16:19], s61 offen offset:1024 lds
    s_add_u32 s61, s61, 32768
    v_mfma_f32_16x16x32_bf16 a[152:155], v[84:87], v[144:147], a[152:155]
    ds_read_b64_tr_b16 v[132:133], v19 offset:49152
    ds_read_b64_tr_b16 v[134:135], v19 offset:53248
    v_mfma_f32_16x16x32_bf16 a[152:155], v[100:103], v[160:163], a[152:155]
    s_add_u32 m0, s93, 90112
    ds_read_b64_tr_b16 v[136:137], v20 offset:49152
    ds_read_b64_tr_b16 v[138:139], v20 offset:53248
    v_mfma_f32_16x16x32_bf16 a[156:159], v[88:91], v[144:147], a[156:159]
    buffer_load_dwordx4 v10, s[8:11], s91 offen sc1 lds
    v_mfma_f32_16x16x32_bf16 a[156:159], v[104:107], v[160:163], a[156:159]
    ds_read_b128 v[188:191], v22 offset:49152
    ds_read_b128 v[192:195], v22 offset:50176
    v_mfma_f32_16x16x32_bf16 a[160:163], v[76:79], v[148:151], a[160:163]
    ds_read_b128 v[196:199], v22 offset:51200
    ds_read_b128 v[200:203], v22 offset:52224
    v_mfma_f32_16x16x32_bf16 a[160:163], v[92:95], v[164:167], a[160:163]
    buffer_load_dwordx4 v10, s[8:11], s91 offen offset:1024 sc1 lds
    s_add_u32 s91, s91, 4096
    s_add_u32 m0, s93, 106496
    v_mfma_f32_16x16x32_bf16 a[164:167], v[80:83], v[148:151], a[164:167]
    buffer_load_dwordx4 v10, s[8:11], s91 offen sc1 lds
    v_mfma_f32_16x16x32_bf16 a[164:167], v[96:99], v[164:167], a[164:167]
    buffer_load_dwordx4 v10, s[8:11], s91 offen offset:1024 sc1 lds
    s_add_u32 s91, s91, 4096
    v_mfma_f32_16x16x32_bf16 a[168:171], v[84:87], v[148:151], a[168:171]
    v_mfma_f32_16x16x32_bf16 a[168:171], v[100:103], v[164:167], a[168:171]
    v_mfma_f32_16x16x32_bf16 a[172:175], v[88:91], v[148:151], a[172:175]
    v_mfma_f32_16x16x32_bf16 a[172:175], v[104:107], v[164:167], a[172:175]
    v_mfma_f32_16x16x32_bf16 a[176:179], v[76:79], v[152:155], a[176:179]
    v_mfma_f32_16x16x32_bf16 a[176:179], v[92:95], v[168:171], a[176:179]
    v_mfma_f32_16x16x32_bf16 a[180:183], v[80:83], v[152:155], a[180:183]
    v_mfma_f32_16x16x32_bf16 a[180:183], v[96:99], v[168:171], a[180:183]
    v_mfma_f32_16x16x32_bf16 a[184:187], v[84:87], v[152:155], a[184:187]
    v_mfma_f32_16x16x32_bf16 a[184:187], v[100:103], v[168:171], a[184:187]
    v_mfma_f32_16x16x32_bf16 a[188:191], v[88:91], v[152:155], a[188:191]
    v_mfma_f32_16x16x32_bf16 a[188:191], v[104:107], v[168:171], a[188:191]
    s_waitcnt vmcnt(16) lgkmcnt(0)
    s_barrier
    v_mfma_f32_16x16x32_bf16 a[128:131], v[108:111], v[172:175], a[128:131]
    ds_read_b64_tr_b16 v[76:77], v13 offset:0
    ds_read_b64_tr_b16 v[78:79], v13 offset:4096
    v_mfma_f32_16x16x32_bf16 a[128:131], v[124:127], v[188:191], a[128:131]
    s_add_u32 m0, s93, 114688
    ds_read_b64_tr_b16 v[80:81], v14 offset:0
    ds_read_b64_tr_b16 v[82:83], v14 offset:4096
    v_mfma_f32_16x16x32_bf16 a[132:135], v[112:115], v[172:175], a[132:135]
    buffer_load_dwordx4 v11, s[16:19], s61 offen lds
    v_mfma_f32_16x16x32_bf16 a[132:135], v[128:131], v[188:191], a[132:135]
    ds_read_b64_tr_b16 v[84:85], v15 offset:0
    ds_read_b64_tr_b16 v[86:87], v15 offset:4096
    v_mfma_f32_16x16x32_bf16 a[136:139], v[116:119], v[172:175], a[136:139]
    ds_read_b64_tr_b16 v[88:89], v16 offset:0
    ds_read_b64_tr_b16 v[90:91], v16 offset:4096
    v_mfma_f32_16x16x32_bf16 a[136:139], v[132:135], v[188:191], a[136:139]
    buffer_load_dwordx4 v12, s[16:19], s61 offen offset:1024 lds
    s_add_u32 s61, s61, 32768
    v_mfma_f32_16x16x32_bf16 a[140:143], v[120:123], v[172:175], a[140:143]
    ds_read_b128 v[140:143], v21 offset:0
    ds_read_b128 v[144:147], v21 offset:1024
    v_mfma_f32_16x16x32_bf16 a[140:143], v[136:139], v[188:191], a[140:143]
    s_add_u32 m0, s93, 131072
    ds_read_b128 v[148:151], v21 offset:2048
    ds_read_b128 v[152:155], v21 offset:3072
    v_mfma_f32_16x16x32_bf16 a[144:147], v[108:111], v[176:179], a[144:147]
    buffer_load_dwordx4 v11, s[16:19], s61 offen lds
    v_mfma_f32_16x16x32_bf16 a[144:147], v[124:127], v[192:195], a[144:147]
    ds_read_b64_tr_b16 v[92:93], v13 offset:16384
    ds_read_b64_tr_b16 v[94:95], v13 offset:20480
    v_mfma_f32_16x16x32_bf16 a[148:151], v[112:115], v[176:179], a[148:151]
    ds_read_b64_tr_b16 v[96:97], v14 offset:16384
    ds_read_b64_tr_b16 v[98:99], v14 offset:20480
    v_mfma_f32_16x16x32_bf16 a[148:151], v[128:131], v[192:195], a[148:151]
    buffer_load_dwordx4 v12, s[16:19], s61 offen offset:1024 lds
    s_add_u32 s61, s61, 32768
    v_mfma_f32_16x16x32_bf16 a[152:155], v[116:119], v[176:179], a[152:155]
    ds_read_b64_tr_b16 v[100:101], v15 offset:16384
    ds_read_b64_tr_b16 v[102:103], v15 offset:20480
    v_mfma_f32_16x16x32_bf16 a[152:155], v[132:135], v[192:195], a[152:155]
    s_add_u32 m0, s93, 122880
    ds_read_b64_tr_b16 v[104:105], v16 offset:16384
    ds_read_b64_tr_b16 v[106:107], v16 offset:20480
    v_mfma_f32_16x16x32_bf16 a[156:159], v[120:123], v[176:179], a[156:159]
    buffer_load_dwordx4 v10, s[8:11], s91 offen sc1 lds
    v_mfma_f32_16x16x32_bf16 a[156:159], v[136:139], v[192:195], a[156:159]
    ds_read_b128 v[156:159], v21 offset:16384
    ds_read_b128 v[160:163], v21 offset:17408
    v_mfma_f32_16x16x32_bf16 a[160:163], v[108:111], v[180:183], a[160:163]
    ds_read_b128 v[164:167], v21 offset:18432
    ds_read_b128 v[168:171], v21 offset:19456
    v_mfma_f32_16x16x32_bf16 a[160:163], v[124:127], v[196:199], a[160:163]
    buffer_load_dwordx4 v10, s[8:11], s91 offen offset:1024 sc1 lds
    s_add_u32 s91, s91, 4096
    s_add_u32 m0, s93, 139264
    v_mfma_f32_16x16x32_bf16 a[164:167], v[112:115], v[180:183], a[164:167]
    buffer_load_dwordx4 v10, s[8:11], s91 offen sc1 lds
    v_mfma_f32_16x16x32_bf16 a[164:167], v[128:131], v[196:199], a[164:167]
    buffer_load_dwordx4 v10, s[8:11], s91 offen offset:1024 sc1 lds
    s_add_u32 s91, s91, 4096
    v_mfma_f32_16x16x32_bf16 a[168:171], v[116:119], v[180:183], a[168:171]
    v_mfma_f32_16x16x32_bf16 a[168:171], v[132:135], v[196:199], a[168:171]
    v_mfma_f32_16x16x32_bf16 a[172:175], v[120:123], v[180:183], a[172:175]
    v_mfma_f32_16x16x32_bf16 a[172:175], v[136:139], v[196:199], a[172:175]
    v_mfma_f32_16x16x32_bf16 a[176:179], v[108:111], v[184:187], a[176:179]
    v_mfma_f32_16x16x32_bf16 a[176:179], v[124:127], v[200:203], a[176:179]
    v_mfma_f32_16x16x32_bf16 a[180:183], v[112:115], v[184:187], a[180:183]
    v_mfma_f32_16x16x32_bf16 a[180:183], v[128:131], v[200:203], a[180:183]
    v_mfma_f32_16x16x32_bf16 a[184:187], v[116:119], v[184:187], a[184:187]
    v_mfma_f32_16x16x32_bf16 a[184:187], v[132:135], v[200:203], a[184:187]
    v_mfma_f32_16x16x32_bf16 a[188:191], v[120:123], v[184:187], a[188:191]
    v_mfma_f32_16x16x32_bf16 a[188:191], v[136:139], v[200:203], a[188:191]
    s_waitcnt vmcnt(16) lgkmcnt(0)
    s_barrier
    v_mfma_f32_16x16x32_bf16 a[128:131], v[76:79], v[140:143], a[128:131]
    ds_read_b64_tr_b16 v[108:109], v13 offset:32768
    ds_read_b64_tr_b16 v[110:111], v13 offset:36864
    v_mfma_f32_16x16x32_bf16 a[128:131], v[92:95], v[156:159], a[128:131]
    s_add_u32 m0, s93, 0
    ds_read_b64_tr_b16 v[112:113], v14 offset:32768
    ds_read_b64_tr_b16 v[114:115], v14 offset:36864
    v_mfma_f32_16x16x32_bf16 a[132:135], v[80:83], v[140:143], a[132:135]
    buffer_load_dwordx4 v11, s[16:19], s61 offen lds
    v_mfma_f32_16x16x32_bf16 a[132:135], v[96:99], v[156:159], a[132:135]
    ds_read_b64_tr_b16 v[116:117], v15 offset:32768
    ds_read_b64_tr_b16 v[118:119], v15 offset:36864
    v_mfma_f32_16x16x32_bf16 a[136:139], v[84:87], v[140:143], a[136:139]
    ds_read_b64_tr_b16 v[120:121], v16 offset:32768
    ds_read_b64_tr_b16 v[122:123], v16 offset:36864
    v_mfma_f32_16x16x32_bf16 a[136:139], v[100:103], v[156:159], a[136:139]
    buffer_load_dwordx4 v12, s[16:19], s61 offen offset:1024 lds
    s_add_u32 s61, s61, 32768
    v_mfma_f32_16x16x32_bf16 a[140:143], v[88:91], v[140:143], a[140:143]
    ds_read_b128 v[172:175], v21 offset:32768
    ds_read_b128 v[176:179], v21 offset:33792
    v_mfma_f32_16x16x32_bf16 a[140:143], v[104:107], v[156:159], a[140:143]
    s_add_u32 m0, s93, 16384
    ds_read_b128 v[180:183], v21 offset:34816
    ds_read_b128 v[184:187], v21 offset:35840
    v_mfma_f32_16x16x32_bf16 a[144:147], v[76:79], v[144:147], a[144:147]
    buffer_load_dwordx4 v11, s[16:19], s61 offen lds
    v_mfma_f32_16x16x32_bf16 a[144:147], v[92:95], v[160:163], a[144:147]
    ds_read_b64_tr_b16 v[124:125], v13 offset:49152
    ds_read_b64_tr_b16 v[126:127], v13 offset:53248
    v_mfma_f32_16x16x32_bf16 a[148:151], v[80:83], v[144:147], a[148:151]
    ds_read_b64_tr_b16 v[128:129], v14 offset:49152
    ds_read_b64_tr_b16 v[130:131], v14 offset:53248
    v_mfma_f32_16x16x32_bf16 a[148:151], v[96:99], v[160:163], a[148:151]
    buffer_load_dwordx4 v12, s[16:19], s61 offen offset:1024 lds
    s_add_u32 s61, s61, 32768
    v_mfma_f32_16x16x32_bf16 a[152:155], v[84:87], v[144:147], a[152:155]
    ds_read_b64_tr_b16 v[132:133], v15 offset:49152
    ds_read_b64_tr_b16 v[134:135], v15 offset:53248
    v_mfma_f32_16x16x32_bf16 a[152:155], v[100:103], v[160:163], a[152:155]
    s_add_u32 m0, s93, 8192
    ds_read_b64_tr_b16 v[136:137], v16 offset:49152
    ds_read_b64_tr_b16 v[138:139], v16 offset:53248
    v_mfma_f32_16x16x32_bf16 a[156:159], v[88:91], v[144:147], a[156:159]
    buffer_load_dwordx4 v10, s[8:11], s91 offen sc1 lds
    v_mfma_f32_16x16x32_bf16 a[156:159], v[104:107], v[160:163], a[156:159]
    ds_read_b128 v[188:191], v21 offset:49152
    ds_read_b128 v[192:195], v21 offset:50176
    v_mfma_f32_16x16x32_bf16 a[160:163], v[76:79], v[148:151], a[160:163]
    ds_read_b128 v[196:199], v21 offset:51200
    ds_read_b128 v[200:203], v21 offset:52224
    v_mfma_f32_16x16x32_bf16 a[160:163], v[92:95], v[164:167], a[160:163]
    buffer_load_dwordx4 v10, s[8:11], s91 offen offset:1024 sc1 lds
    s_add_u32 s91, s91, 4096
    s_add_u32 m0, s93, 24576
    v_mfma_f32_16x16x32_bf16 a[164:167], v[80:83], v[148:151], a[164:167]
    buffer_load_dwordx4 v10, s[8:11], s91 offen sc1 lds
    v_mfma_f32_16x16x32_bf16 a[164:167], v[96:99], v[164:167], a[164:167]
    buffer_load_dwordx4 v10, s[8:11], s91 offen offset:1024 sc1 lds
    s_add_u32 s91, s91, 4096
    v_mfma_f32_16x16x32_bf16 a[168:171], v[84:87], v[148:151], a[168:171]
    v_mfma_f32_16x16x32_bf16 a[168:171], v[100:103], v[164:167], a[168:171]
    v_mfma_f32_16x16x32_bf16 a[172:175], v[88:91], v[148:151], a[172:175]
    v_mfma_f32_16x16x32_bf16 a[172:175], v[104:107], v[164:167], a[172:175]
    v_mfma_f32_16x16x32_bf16 a[176:179], v[76:79], v[152:155], a[176:179]
    v_mfma_f32_16x16x32_bf16 a[176:179], v[92:95], v[168:171], a[176:179]
    v_mfma_f32_16x16x32_bf16 a[180:183], v[80:83], v[152:155], a[180:183]
    v_mfma_f32_16x16x32_bf16 a[180:183], v[96:99], v[168:171], a[180:183]
    v_mfma_f32_16x16x32_bf16 a[184:187], v[84:87], v[152:155], a[184:187]
    v_mfma_f32_16x16x32_bf16 a[184:187], v[100:103], v[168:171], a[184:187]
    v_mfma_f32_16x16x32_bf16 a[188:191], v[88:91], v[152:155], a[188:191]
    v_mfma_f32_16x16x32_bf16 a[188:191], v[104:107], v[168:171], a[188:191]
    s_waitcnt vmcnt(16) lgkmcnt(0)
    s_barrier
    v_mfma_f32_16x16x32_bf16 a[128:131], v[108:111], v[172:175], a[128:131]
    ds_read_b64_tr_b16 v[76:77], v17 offset:0
    ds_read_b64_tr_b16 v[78:79], v17 offset:4096
    v_mfma_f32_16x16x32_bf16 a[128:131], v[124:127], v[188:191], a[128:131]
    s_add_u32 m0, s93, 32768
    ds_read_b64_tr_b16 v[80:81], v18 offset:0
    ds_read_b64_tr_b16 v[82:83], v18 offset:4096
    v_mfma_f32_16x16x32_bf16 a[132:135], v[112:115], v[172:175], a[132:135]
    buffer_load_dwordx4 v11, s[16:19], s61 offen lds
    v_mfma_f32_16x16x32_bf16 a[132:135], v[128:131], v[188:191], a[132:135]
    ds_read_b64_tr_b16 v[84:85], v19 offset:0
    ds_read_b64_tr_b16 v[86:87], v19 offset:4096
    v_mfma_f32_16x16x32_bf16 a[136:139], v[116:119], v[172:175], a[136:139]
    ds_read_b64_tr_b16 v[88:89], v20 offset:0
    ds_read_b64_tr_b16 v[90:91], v20 offset:4096
    v_mfma_f32_16x16x32_bf16 a[136:139], v[132:135], v[188:191], a[136:139]
    buffer_load_dwordx4 v12, s[16:19], s61 offen offset:1024 lds
    s_add_u32 s61, s61, 32768
    v_mfma_f32_16x16x32_bf16 a[140:143], v[120:123], v[172:175], a[140:143]
    ds_read_b128 v[140:143], v22 offset:0
    ds_read_b128 v[144:147], v22 offset:1024
    v_mfma_f32_16x16x32_bf16 a[140:143], v[136:139], v[188:191], a[140:143]
    s_add_u32 m0, s93, 49152
    ds_read_b128 v[148:151], v22 offset:2048
    ds_read_b128 v[152:155], v22 offset:3072
    v_mfma_f32_16x16x32_bf16 a[144:147], v[108:111], v[176:179], a[144:147]
    buffer_load_dwordx4 v11, s[16:19], s61 offen lds
    v_mfma_f32_16x16x32_bf16 a[144:147], v[124:127], v[192:195], a[144:147]
    ds_read_b64_tr_b16 v[92:93], v17 offset:16384
    ds_read_b64_tr_b16 v[94:95], v17 offset:20480
    v_mfma_f32_16x16x32_bf16 a[148:151], v[112:115], v[176:179], a[148:151]
    ds_read_b64_tr_b16 v[96:97], v18 offset:16384
    ds_read_b64_tr_b16 v[98:99], v18 offset:20480
    v_mfma_f32_16x16x32_bf16 a[148:151], v[128:131], v[192:195], a[148:151]
    buffer_load_dwordx4 v12, s[16:19], s61 offen offset:1024 lds
    s_add_u32 s61, s61, 32768
    v_mfma_f32_16x16x32_bf16 a[152:155], v[116:119], v[176:179], a[152:155]
    ds_read_b64_tr_b16 v[100:101], v19 offset:16384
    ds_read_b64_tr_b16 v[102:103], v19 offset:20480
    v_mfma_f32_16x16x32_bf16 a[152:155], v[132:135], v[192:195], a[152:155]
    s_add_u32 m0, s93, 40960
    ds_read_b64_tr_b16 v[104:105], v20 offset:16384
    ds_read_b64_tr_b16 v[106:107], v20 offset:20480
    v_mfma_f32_16x16x32_bf16 a[156:159], v[120:123], v[176:179], a[156:159]
    buffer_load_dwordx4 v10, s[8:11], s91 offen sc1 lds
    v_mfma_f32_16x16x32_bf16 a[156:159], v[136:139], v[192:195], a[156:159]
    ds_read_b128 v[156:159], v22 offset:16384
    ds_read_b128 v[160:163], v22 offset:17408
    v_mfma_f32_16x16x32_bf16 a[160:163], v[108:111], v[180:183], a[160:163]
    ds_read_b128 v[164:167], v22 offset:18432
    ds_read_b128 v[168:171], v22 offset:19456
    v_mfma_f32_16x16x32_bf16 a[160:163], v[124:127], v[196:199], a[160:163]
    buffer_load_dwordx4 v10, s[8:11], s91 offen offset:1024 sc1 lds
    s_add_u32 s91, s91, 4096
    s_add_u32 m0, s93, 57344
    v_mfma_f32_16x16x32_bf16 a[164:167], v[112:115], v[180:183], a[164:167]
    buffer_load_dwordx4 v10, s[8:11], s91 offen sc1 lds
    v_mfma_f32_16x16x32_bf16 a[164:167], v[128:131], v[196:199], a[164:167]
    buffer_load_dwordx4 v10, s[8:11], s91 offen offset:1024 sc1 lds
    s_add_u32 s91, s91, 4096
    v_mfma_f32_16x16x32_bf16 a[168:171], v[116:119], v[180:183], a[168:171]
    v_mfma_f32_16x16x32_bf16 a[168:171], v[132:135], v[196:199], a[168:171]
    v_mfma_f32_16x16x32_bf16 a[172:175], v[120:123], v[180:183], a[172:175]
    v_mfma_f32_16x16x32_bf16 a[172:175], v[136:139], v[196:199], a[172:175]
    v_mfma_f32_16x16x32_bf16 a[176:179], v[108:111], v[184:187], a[176:179]
    v_mfma_f32_16x16x32_bf16 a[176:179], v[124:127], v[200:203], a[176:179]
    v_mfma_f32_16x16x32_bf16 a[180:183], v[112:115], v[184:187], a[180:183]
    v_mfma_f32_16x16x32_bf16 a[180:183], v[128:131], v[200:203], a[180:183]
    v_mfma_f32_16x16x32_bf16 a[184:187], v[116:119], v[184:187], a[184:187]
    v_mfma_f32_16x16x32_bf16 a[184:187], v[132:135], v[200:203], a[184:187]
    v_mfma_f32_16x16x32_bf16 a[188:191], v[120:123], v[184:187], a[188:191]
    v_mfma_f32_16x16x32_bf16 a[188:191], v[136:139], v[200:203], a[188:191]
    s_waitcnt vmcnt(16) lgkmcnt(0)
    s_barrier
    v_mfma_f32_16x16x32_bf16 a[128:131], v[76:79], v[140:143], a[128:131]
    ds_read_b64_tr_b16 v[108:109], v17 offset:32768
    ds_read_b64_tr_b16 v[110:111], v17 offset:36864
    v_mfma_f32_16x16x32_bf16 a[128:131], v[92:95], v[156:159], a[128:131]
    s_add_u32 m0, s93, 81920
    ds_read_b64_tr_b16 v[112:113], v18 offset:32768
    ds_read_b64_tr_b16 v[114:115], v18 offset:36864
    v_mfma_f32_16x16x32_bf16 a[132:135], v[80:83], v[140:143], a[132:135]
    buffer_load_dwordx4 v11, s[16:19], s61 offen lds
    v_mfma_f32_16x16x32_bf16 a[132:135], v[96:99], v[156:159], a[132:135]
    ds_read_b64_tr_b16 v[116:117], v19 offset:32768
    ds_read_b64_tr_b16 v[118:119], v19 offset:36864
    v_mfma_f32_16x16x32_bf16 a[136:139], v[84:87], v[140:143], a[136:139]
    ds_read_b64_tr_b16 v[120:121], v20 offset:32768
    ds_read_b64_tr_b16 v[122:123], v20 offset:36864
    v_mfma_f32_16x16x32_bf16 a[136:139], v[100:103], v[156:159], a[136:139]
    buffer_load_dwordx4 v12, s[16:19], s61 offen offset:1024 lds
    s_add_u32 s61, s61, 32768
    v_mfma_f32_16x16x32_bf16 a[140:143], v[88:91], v[140:143], a[140:143]
    ds_read_b128 v[172:175], v22 offset:32768
    ds_read_b128 v[176:179], v22 offset:33792
    v_mfma_f32_16x16x32_bf16 a[140:143], v[104:107], v[156:159], a[140:143]
    s_add_u32 m0, s93, 98304
    ds_read_b128 v[180:183], v22 offset:34816
    ds_read_b128 v[184:187], v22 offset:35840
    v_mfma_f32_16x16x32_bf16 a[144:147], v[76:79], v[144:147], a[144:147]
    buffer_load_dwordx4 v11, s[16:19], s61 offen lds
    v_mfma_f32_16x16x32_bf16 a[144:147], v[92:95], v[160:163], a[144:147]
    ds_read_b64_tr_b16 v[124:125], v17 offset:49152
    ds_read_b64_tr_b16 v[126:127], v17 offset:53248
    v_mfma_f32_16x16x32_bf16 a[148:151], v[80:83], v[144:147], a[148:151]
    ds_read_b64_tr_b16 v[128:129], v18 offset:49152
    ds_read_b64_tr_b16 v[130:131], v18 offset:53248
    v_mfma_f32_16x16x32_bf16 a[148:151], v[96:99], v[160:163], a[148:151]
    buffer_load_dwordx4 v12, s[16:19], s61 offen offset:1024 lds
    s_add_u32 s61, s61, 32768
    v_mfma_f32_16x16x32_bf16 a[152:155], v[84:87], v[144:147], a[152:155]
    ds_read_b64_tr_b16 v[132:133], v19 offset:49152
    ds_read_b64_tr_b16 v[134:135], v19 offset:53248
    v_mfma_f32_16x16x32_bf16 a[152:155], v[100:103], v[160:163], a[152:155]
    s_add_u32 m0, s93, 90112
    ds_read_b64_tr_b16 v[136:137], v20 offset:49152
    ds_read_b64_tr_b16 v[138:139], v20 offset:53248
    v_mfma_f32_16x16x32_bf16 a[156:159], v[88:91], v[144:147], a[156:159]
    buffer_load_dwordx4 v10, s[8:11], s91 offen sc1 lds
    v_mfma_f32_16x16x32_bf16 a[156:159], v[104:107], v[160:163], a[156:159]
    ds_read_b128 v[188:191], v22 offset:49152
    ds_read_b128 v[192:195], v22 offset:50176
    v_mfma_f32_16x16x32_bf16 a[160:163], v[76:79], v[148:151], a[160:163]
    ds_read_b128 v[196:199], v22 offset:51200
    ds_read_b128 v[200:203], v22 offset:52224
    v_mfma_f32_16x16x32_bf16 a[160:163], v[92:95], v[164:167], a[160:163]
    buffer_load_dwordx4 v10, s[8:11], s91 offen offset:1024 sc1 lds
    s_add_u32 s91, s91, 4096
    s_add_u32 m0, s93, 106496
    v_mfma_f32_16x16x32_bf16 a[164:167], v[80:83], v[148:151], a[164:167]
    buffer_load_dwordx4 v10, s[8:11], s91 offen sc1 lds
    v_mfma_f32_16x16x32_bf16 a[164:167], v[96:99], v[164:167], a[164:167]
    buffer_load_dwordx4 v10, s[8:11], s91 offen offset:1024 sc1 lds
    s_add_u32 s91, s91, 4096
    v_mfma_f32_16x16x32_bf16 a[168:171], v[84:87], v[148:151], a[168:171]
    v_mfma_f32_16x16x32_bf16 a[168:171], v[100:103], v[164:167], a[168:171]
    v_mfma_f32_16x16x32_bf16 a[172:175], v[88:91], v[148:151], a[172:175]
    v_mfma_f32_16x16x32_bf16 a[172:175], v[104:107], v[164:167], a[172:175]
    v_mfma_f32_16x16x32_bf16 a[176:179], v[76:79], v[152:155], a[176:179]
    v_mfma_f32_16x16x32_bf16 a[176:179], v[92:95], v[168:171], a[176:179]
    v_mfma_f32_16x16x32_bf16 a[180:183], v[80:83], v[152:155], a[180:183]
    v_mfma_f32_16x16x32_bf16 a[180:183], v[96:99], v[168:171], a[180:183]
    v_mfma_f32_16x16x32_bf16 a[184:187], v[84:87], v[152:155], a[184:187]
    v_mfma_f32_16x16x32_bf16 a[184:187], v[100:103], v[168:171], a[184:187]
    v_mfma_f32_16x16x32_bf16 a[188:191], v[88:91], v[152:155], a[188:191]
    v_mfma_f32_16x16x32_bf16 a[188:191], v[104:107], v[168:171], a[188:191]
    s_waitcnt vmcnt(16) lgkmcnt(0)
    s_barrier
    v_mfma_f32_16x16x32_bf16 a[128:131], v[108:111], v[172:175], a[128:131]
    ds_read_b64_tr_b16 v[76:77], v13 offset:0
    ds_read_b64_tr_b16 v[78:79], v13 offset:4096
    v_mfma_f32_16x16x32_bf16 a[128:131], v[124:127], v[188:191], a[128:131]
    ds_read_b64_tr_b16 v[80:81], v14 offset:0
    ds_read_b64_tr_b16 v[82:83], v14 offset:4096
    v_mfma_f32_16x16x32_bf16 a[132:135], v[112:115], v[172:175], a[132:135]
    ds_read_b64_tr_b16 v[84:85], v15 offset:0
    ds_read_b64_tr_b16 v[86:87], v15 offset:4096
    v_mfma_f32_16x16x32_bf16 a[132:135], v[128:131], v[188:191], a[132:135]
    ds_read_b64_tr_b16 v[88:89], v16 offset:0
    ds_read_b64_tr_b16 v[90:91], v16 offset:4096
    v_mfma_f32_16x16x32_bf16 a[136:139], v[116:119], v[172:175], a[136:139]
    ds_read_b128 v[140:143], v21 offset:0
    ds_read_b128 v[144:147], v21 offset:1024
    v_mfma_f32_16x16x32_bf16 a[136:139], v[132:135], v[188:191], a[136:139]
    ds_read_b128 v[148:151], v21 offset:2048
    ds_read_b128 v[152:155], v21 offset:3072
    v_mfma_f32_16x16x32_bf16 a[140:143], v[120:123], v[172:175], a[140:143]
    ds_read_b64_tr_b16 v[92:93], v13 offset:16384
    ds_read_b64_tr_b16 v[94:95], v13 offset:20480
    v_mfma_f32_16x16x32_bf16 a[140:143], v[136:139], v[188:191], a[140:143]
    ds_read_b64_tr_b16 v[96:97], v14 offset:16384
    ds_read_b64_tr_b16 v[98:99], v14 offset:20480
    v_mfma_f32_16x16x32_bf16 a[144:147], v[108:111], v[176:179], a[144:147]
    ds_read_b64_tr_b16 v[100:101], v15 offset:16384
    ds_read_b64_tr_b16 v[102:103], v15 offset:20480
    v_mfma_f32_16x16x32_bf16 a[144:147], v[124:127], v[192:195], a[144:147]
    ds_read_b64_tr_b16 v[104:105], v16 offset:16384
    ds_read_b64_tr_b16 v[106:107], v16 offset:20480
    v_mfma_f32_16x16x32_bf16 a[148:151], v[112:115], v[176:179], a[148:151]
    ds_read_b128 v[156:159], v21 offset:16384
    ds_read_b128 v[160:163], v21 offset:17408
    v_mfma_f32_16x16x32_bf16 a[148:151], v[128:131], v[192:195], a[148:151]
    ds_read_b128 v[164:167], v21 offset:18432
    ds_read_b128 v[168:171], v21 offset:19456
    v_mfma_f32_16x16x32_bf16 a[152:155], v[116:119], v[176:179], a[152:155]
    v_mfma_f32_16x16x32_bf16 a[152:155], v[132:135], v[192:195], a[152:155]
    v_mfma_f32_16x16x32_bf16 a[156:159], v[120:123], v[176:179], a[156:159]
    v_mfma_f32_16x16x32_bf16 a[156:159], v[136:139], v[192:195], a[156:159]
    v_mfma_f32_16x16x32_bf16 a[160:163], v[108:111], v[180:183], a[160:163]
    v_mfma_f32_16x16x32_bf16 a[160:163], v[124:127], v[196:199], a[160:163]
    v_mfma_f32_16x16x32_bf16 a[164:167], v[112:115], v[180:183], a[164:167]
    v_mfma_f32_16x16x32_bf16 a[164:167], v[128:131], v[196:199], a[164:167]
    v_mfma_f32_16x16x32_bf16 a[168:171], v[116:119], v[180:183], a[168:171]
    v_mfma_f32_16x16x32_bf16 a[168:171], v[132:135], v[196:199], a[168:171]
    v_mfma_f32_16x16x32_bf16 a[172:175], v[120:123], v[180:183], a[172:175]
    v_mfma_f32_16x16x32_bf16 a[172:175], v[136:139], v[196:199], a[172:175]
    v_mfma_f32_16x16x32_bf16 a[176:179], v[108:111], v[184:187], a[176:179]
    v_mfma_f32_16x16x32_bf16 a[176:179], v[124:127], v[200:203], a[176:179]
    v_mfma_f32_16x16x32_bf16 a[180:183], v[112:115], v[184:187], a[180:183]
    v_mfma_f32_16x16x32_bf16 a[180:183], v[128:131], v[200:203], a[180:183]
    v_mfma_f32_16x16x32_bf16 a[184:187], v[116:119], v[184:187], a[184:187]
    v_mfma_f32_16x16x32_bf16 a[184:187], v[132:135], v[200:203], a[184:187]
    v_mfma_f32_16x16x32_bf16 a[188:191], v[120:123], v[184:187], a[188:191]
    v_mfma_f32_16x16x32_bf16 a[188:191], v[136:139], v[200:203], a[188:191]
    s_waitcnt vmcnt(8) lgkmcnt(0)
    s_barrier
    v_mfma_f32_16x16x32_bf16 a[128:131], v[76:79], v[140:143], a[128:131]
    ds_read_b64_tr_b16 v[108:109], v13 offset:32768
    ds_read_b64_tr_b16 v[110:111], v13 offset:36864
    v_mfma_f32_16x16x32_bf16 a[128:131], v[92:95], v[156:159], a[128:131]
    ds_read_b64_tr_b16 v[112:113], v14 offset:32768
    ds_read_b64_tr_b16 v[114:115], v14 offset:36864
    v_mfma_f32_16x16x32_bf16 a[132:135], v[80:83], v[140:143], a[132:135]
    ds_read_b64_tr_b16 v[116:117], v15 offset:32768
    ds_read_b64_tr_b16 v[118:119], v15 offset:36864
    v_mfma_f32_16x16x32_bf16 a[132:135], v[96:99], v[156:159], a[132:135]
    ds_read_b64_tr_b16 v[120:121], v16 offset:32768
    ds_read_b64_tr_b16 v[122:123], v16 offset:36864
    v_mfma_f32_16x16x32_bf16 a[136:139], v[84:87], v[140:143], a[136:139]
    ds_read_b128 v[172:175], v21 offset:32768
    ds_read_b128 v[176:179], v21 offset:33792
    v_mfma_f32_16x16x32_bf16 a[136:139], v[100:103], v[156:159], a[136:139]
    ds_read_b128 v[180:183], v21 offset:34816
    ds_read_b128 v[184:187], v21 offset:35840
    v_mfma_f32_16x16x32_bf16 a[140:143], v[88:91], v[140:143], a[140:143]
    ds_read_b64_tr_b16 v[124:125], v13 offset:49152
    ds_read_b64_tr_b16 v[126:127], v13 offset:53248
    v_mfma_f32_16x16x32_bf16 a[140:143], v[104:107], v[156:159], a[140:143]
    ds_read_b64_tr_b16 v[128:129], v14 offset:49152
    ds_read_b64_tr_b16 v[130:131], v14 offset:53248
    v_mfma_f32_16x16x32_bf16 a[144:147], v[76:79], v[144:147], a[144:147]
    ds_read_b64_tr_b16 v[132:133], v15 offset:49152
    ds_read_b64_tr_b16 v[134:135], v15 offset:53248
    v_mfma_f32_16x16x32_bf16 a[144:147], v[92:95], v[160:163], a[144:147]
    ds_read_b64_tr_b16 v[136:137], v16 offset:49152
    ds_read_b64_tr_b16 v[138:139], v16 offset:53248
    v_mfma_f32_16x16x32_bf16 a[148:151], v[80:83], v[144:147], a[148:151]
    ds_read_b128 v[188:191], v21 offset:49152
    ds_read_b128 v[192:195], v21 offset:50176
    v_mfma_f32_16x16x32_bf16 a[148:151], v[96:99], v[160:163], a[148:151]
    ds_read_b128 v[196:199], v21 offset:51200
    ds_read_b128 v[200:203], v21 offset:52224
    v_mfma_f32_16x16x32_bf16 a[152:155], v[84:87], v[144:147], a[152:155]
    v_mfma_f32_16x16x32_bf16 a[152:155], v[100:103], v[160:163], a[152:155]
    v_mfma_f32_16x16x32_bf16 a[156:159], v[88:91], v[144:147], a[156:159]
    v_mfma_f32_16x16x32_bf16 a[156:159], v[104:107], v[160:163], a[156:159]
    v_mfma_f32_16x16x32_bf16 a[160:163], v[76:79], v[148:151], a[160:163]
    v_mfma_f32_16x16x32_bf16 a[160:163], v[92:95], v[164:167], a[160:163]
    v_mfma_f32_16x16x32_bf16 a[164:167], v[80:83], v[148:151], a[164:167]
    v_mfma_f32_16x16x32_bf16 a[164:167], v[96:99], v[164:167], a[164:167]
    v_mfma_f32_16x16x32_bf16 a[168:171], v[84:87], v[148:151], a[168:171]
    v_mfma_f32_16x16x32_bf16 a[168:171], v[100:103], v[164:167], a[168:171]
    v_mfma_f32_16x16x32_bf16 a[172:175], v[88:91], v[148:151], a[172:175]
    v_mfma_f32_16x16x32_bf16 a[172:175], v[104:107], v[164:167], a[172:175]
    v_mfma_f32_16x16x32_bf16 a[176:179], v[76:79], v[152:155], a[176:179]
    v_mfma_f32_16x16x32_bf16 a[176:179], v[92:95], v[168:171], a[176:179]
    v_mfma_f32_16x16x32_bf16 a[180:183], v[80:83], v[152:155], a[180:183]
    v_mfma_f32_16x16x32_bf16 a[180:183], v[96:99], v[168:171], a[180:183]
    v_mfma_f32_16x16x32_bf16 a[184:187], v[84:87], v[152:155], a[184:187]
    v_mfma_f32_16x16x32_bf16 a[184:187], v[100:103], v[168:171], a[184:187]
    v_mfma_f32_16x16x32_bf16 a[188:191], v[88:91], v[152:155], a[188:191]
    v_mfma_f32_16x16x32_bf16 a[188:191], v[104:107], v[168:171], a[188:191]
    s_waitcnt vmcnt(0) lgkmcnt(0)
    s_barrier
    v_mfma_f32_16x16x32_bf16 a[128:131], v[108:111], v[172:175], a[128:131]
    ds_read_b64_tr_b16 v[76:77], v17 offset:0
    ds_read_b64_tr_b16 v[78:79], v17 offset:4096
    v_mfma_f32_16x16x32_bf16 a[128:131], v[124:127], v[188:191], a[128:131]
    ds_read_b64_tr_b16 v[80:81], v18 offset:0
    ds_read_b64_tr_b16 v[82:83], v18 offset:4096
    v_mfma_f32_16x16x32_bf16 a[132:135], v[112:115], v[172:175], a[132:135]
    ds_read_b64_tr_b16 v[84:85], v19 offset:0
    ds_read_b64_tr_b16 v[86:87], v19 offset:4096
    v_mfma_f32_16x16x32_bf16 a[132:135], v[128:131], v[188:191], a[132:135]
    ds_read_b64_tr_b16 v[88:89], v20 offset:0
    ds_read_b64_tr_b16 v[90:91], v20 offset:4096
    v_mfma_f32_16x16x32_bf16 a[136:139], v[116:119], v[172:175], a[136:139]
    ds_read_b128 v[140:143], v22 offset:0
    ds_read_b128 v[144:147], v22 offset:1024
    v_mfma_f32_16x16x32_bf16 a[136:139], v[132:135], v[188:191], a[136:139]
    ds_read_b128 v[148:151], v22 offset:2048
    ds_read_b128 v[152:155], v22 offset:3072
    v_mfma_f32_16x16x32_bf16 a[140:143], v[120:123], v[172:175], a[140:143]
    ds_read_b64_tr_b16 v[92:93], v17 offset:16384
    ds_read_b64_tr_b16 v[94:95], v17 offset:20480
    v_mfma_f32_16x16x32_bf16 a[140:143], v[136:139], v[188:191], a[140:143]
    ds_read_b64_tr_b16 v[96:97], v18 offset:16384
    ds_read_b64_tr_b16 v[98:99], v18 offset:20480
    v_mfma_f32_16x16x32_bf16 a[144:147], v[108:111], v[176:179], a[144:147]
    ds_read_b64_tr_b16 v[100:101], v19 offset:16384
    ds_read_b64_tr_b16 v[102:103], v19 offset:20480
    v_mfma_f32_16x16x32_bf16 a[144:147], v[124:127], v[192:195], a[144:147]
    ds_read_b64_tr_b16 v[104:105], v20 offset:16384
    ds_read_b64_tr_b16 v[106:107], v20 offset:20480
    v_mfma_f32_16x16x32_bf16 a[148:151], v[112:115], v[176:179], a[148:151]
    ds_read_b128 v[156:159], v22 offset:16384
    ds_read_b128 v[160:163], v22 offset:17408
    v_mfma_f32_16x16x32_bf16 a[148:151], v[128:131], v[192:195], a[148:151]
    ds_read_b128 v[164:167], v22 offset:18432
    ds_read_b128 v[168:171], v22 offset:19456
    v_mfma_f32_16x16x32_bf16 a[152:155], v[116:119], v[176:179], a[152:155]
    v_mfma_f32_16x16x32_bf16 a[152:155], v[132:135], v[192:195], a[152:155]
    v_mfma_f32_16x16x32_bf16 a[156:159], v[120:123], v[176:179], a[156:159]
    v_mfma_f32_16x16x32_bf16 a[156:159], v[136:139], v[192:195], a[156:159]
    v_mfma_f32_16x16x32_bf16 a[160:163], v[108:111], v[180:183], a[160:163]
    v_mfma_f32_16x16x32_bf16 a[160:163], v[124:127], v[196:199], a[160:163]
    v_mfma_f32_16x16x32_bf16 a[164:167], v[112:115], v[180:183], a[164:167]
    v_mfma_f32_16x16x32_bf16 a[164:167], v[128:131], v[196:199], a[164:167]
    v_mfma_f32_16x16x32_bf16 a[168:171], v[116:119], v[180:183], a[168:171]
    v_mfma_f32_16x16x32_bf16 a[168:171], v[132:135], v[196:199], a[168:171]
    v_mfma_f32_16x16x32_bf16 a[172:175], v[120:123], v[180:183], a[172:175]
    v_mfma_f32_16x16x32_bf16 a[172:175], v[136:139], v[196:199], a[172:175]
    v_mfma_f32_16x16x32_bf16 a[176:179], v[108:111], v[184:187], a[176:179]
    v_mfma_f32_16x16x32_bf16 a[176:179], v[124:127], v[200:203], a[176:179]
    v_mfma_f32_16x16x32_bf16 a[180:183], v[112:115], v[184:187], a[180:183]
    v_mfma_f32_16x16x32_bf16 a[180:183], v[128:131], v[200:203], a[180:183]
    v_mfma_f32_16x16x32_bf16 a[184:187], v[116:119], v[184:187], a[184:187]
    v_mfma_f32_16x16x32_bf16 a[184:187], v[132:135], v[200:203], a[184:187]
    v_mfma_f32_16x16x32_bf16 a[188:191], v[120:123], v[184:187], a[188:191]
    v_mfma_f32_16x16x32_bf16 a[188:191], v[136:139], v[200:203], a[188:191]
    s_waitcnt lgkmcnt(0)
    v_mfma_f32_16x16x32_bf16 a[128:131], v[76:79], v[140:143], a[128:131]
    v_mfma_f32_16x16x32_bf16 a[128:131], v[92:95], v[156:159], a[128:131]
    v_mfma_f32_16x16x32_bf16 a[132:135], v[80:83], v[140:143], a[132:135]
    v_mfma_f32_16x16x32_bf16 a[132:135], v[96:99], v[156:159], a[132:135]
    v_mfma_f32_16x16x32_bf16 a[136:139], v[84:87], v[140:143], a[136:139]
    v_mfma_f32_16x16x32_bf16 a[136:139], v[100:103], v[156:159], a[136:139]
    v_mfma_f32_16x16x32_bf16 a[140:143], v[88:91], v[140:143], a[140:143]
    v_mfma_f32_16x16x32_bf16 a[140:143], v[104:107], v[156:159], a[140:143]
    v_mfma_f32_16x16x32_bf16 a[144:147], v[76:79], v[144:147], a[144:147]
    v_mfma_f32_16x16x32_bf16 a[144:147], v[92:95], v[160:163], a[144:147]
    v_mfma_f32_16x16x32_bf16 a[148:151], v[80:83], v[144:147], a[148:151]
    v_accvgpr_read_b32 v208, a128
    v_accvgpr_read_b32 v209, a129
    v_accvgpr_read_b32 v210, a130
    v_accvgpr_read_b32 v211, a131
    v_mfma_f32_16x16x32_bf16 a[148:151], v[96:99], v[160:163], a[148:151]
    v_accvgpr_read_b32 v212, a132
    v_accvgpr_read_b32 v213, a133
    v_accvgpr_read_b32 v214, a134
    v_accvgpr_read_b32 v215, a135
    v_mfma_f32_16x16x32_bf16 a[152:155], v[84:87], v[144:147], a[152:155]
    v_cvt_pk_bf16_f32 v216, v208, v209
    v_cvt_pk_bf16_f32 v217, v210, v211
    v_cvt_pk_bf16_f32 v218, v212, v213
    v_cvt_pk_bf16_f32 v219, v214, v215
    v_mfma_f32_16x16x32_bf16 a[152:155], v[100:103], v[160:163], a[152:155]
    s_add_u32 s69, s68, 0
    buffer_store_dwordx4 v[216:219], v10, s[64:67], s69 offen offset:0 sc1
    v_mfma_f32_16x16x32_bf16 a[156:159], v[88:91], v[144:147], a[156:159]
    v_accvgpr_read_b32 v220, a136
    v_accvgpr_read_b32 v221, a137
    v_accvgpr_read_b32 v222, a138
    v_accvgpr_read_b32 v223, a139
    v_mfma_f32_16x16x32_bf16 a[156:159], v[104:107], v[160:163], a[156:159]
    v_accvgpr_read_b32 v224, a140
    v_accvgpr_read_b32 v225, a141
    v_accvgpr_read_b32 v226, a142
    v_accvgpr_read_b32 v227, a143
    v_mfma_f32_16x16x32_bf16 a[160:163], v[76:79], v[148:151], a[160:163]
    v_cvt_pk_bf16_f32 v228, v220, v221
    v_cvt_pk_bf16_f32 v229, v222, v223
    v_cvt_pk_bf16_f32 v230, v224, v225
    v_cvt_pk_bf16_f32 v231, v226, v227
    v_mfma_f32_16x16x32_bf16 a[160:163], v[92:95], v[164:167], a[160:163]
    buffer_store_dwordx4 v[228:231], v10, s[64:67], s69 offen offset:1024 sc1
    v_mfma_f32_16x16x32_bf16 a[164:167], v[80:83], v[148:151], a[164:167]
    v_accvgpr_read_b32 v208, a144
    v_accvgpr_read_b32 v209, a145
    v_accvgpr_read_b32 v210, a146
    v_accvgpr_read_b32 v211, a147
    v_mfma_f32_16x16x32_bf16 a[164:167], v[96:99], v[164:167], a[164:167]
    v_accvgpr_read_b32 v212, a148
    v_accvgpr_read_b32 v213, a149
    v_accvgpr_read_b32 v214, a150
    v_accvgpr_read_b32 v215, a151
    v_mfma_f32_16x16x32_bf16 a[168:171], v[84:87], v[148:151], a[168:171]
    v_cvt_pk_bf16_f32 v216, v208, v209
    v_cvt_pk_bf16_f32 v217, v210, v211
    v_cvt_pk_bf16_f32 v218, v212, v213
    v_cvt_pk_bf16_f32 v219, v214, v215
    v_mfma_f32_16x16x32_bf16 a[168:171], v[100:103], v[164:167], a[168:171]
    buffer_store_dwordx4 v[216:219], v10, s[64:67], s69 offen offset:2048 sc1
    v_mfma_f32_16x16x32_bf16 a[172:175], v[88:91], v[148:151], a[172:175]
    v_accvgpr_read_b32 v220, a152
    v_accvgpr_read_b32 v221, a153
    v_accvgpr_read_b32 v222, a154
    v_accvgpr_read_b32 v223, a155
    v_mfma_f32_16x16x32_bf16 a[172:175], v[104:107], v[164:167], a[172:175]
    v_accvgpr_read_b32 v224, a156
    v_accvgpr_read_b32 v225, a157
    v_accvgpr_read_b32 v226, a158
    v_accvgpr_read_b32 v227, a159
    v_mfma_f32_16x16x32_bf16 a[176:179], v[76:79], v[152:155], a[176:179]
    v_cvt_pk_bf16_f32 v228, v220, v221
    v_cvt_pk_bf16_f32 v229, v222, v223
    v_cvt_pk_bf16_f32 v230, v224, v225
    v_cvt_pk_bf16_f32 v231, v226, v227
    v_mfma_f32_16x16x32_bf16 a[176:179], v[92:95], v[168:171], a[176:179]
    buffer_store_dwordx4 v[228:231], v10, s[64:67], s69 offen offset:3072 sc1
    v_mfma_f32_16x16x32_bf16 a[180:183], v[80:83], v[152:155], a[180:183]
    v_accvgpr_read_b32 v208, a160
    v_accvgpr_read_b32 v209, a161
    v_accvgpr_read_b32 v210, a162
    v_accvgpr_read_b32 v211, a163
    v_mfma_f32_16x16x32_bf16 a[180:183], v[96:99], v[168:171], a[180:183]
    v_accvgpr_read_b32 v212, a164
    v_accvgpr_read_b32 v213, a165
    v_accvgpr_read_b32 v214, a166
    v_accvgpr_read_b32 v215, a167
    v_mfma_f32_16x16x32_bf16 a[184:187], v[84:87], v[152:155], a[184:187]
    v_cvt_pk_bf16_f32 v216, v208, v209
    v_cvt_pk_bf16_f32 v217, v210, v211
    v_cvt_pk_bf16_f32 v218, v212, v213
    v_cvt_pk_bf16_f32 v219, v214, v215
    v_mfma_f32_16x16x32_bf16 a[184:187], v[100:103], v[168:171], a[184:187]
    s_add_u32 s69, s68, 4096
    buffer_store_dwordx4 v[216:219], v10, s[64:67], s69 offen offset:0 sc1
    v_mfma_f32_16x16x32_bf16 a[188:191], v[88:91], v[152:155], a[188:191]
    v_accvgpr_read_b32 v220, a168
    v_accvgpr_read_b32 v221, a169
    v_accvgpr_read_b32 v222, a170
    v_accvgpr_read_b32 v223, a171
    v_mfma_f32_16x16x32_bf16 a[188:191], v[104:107], v[168:171], a[188:191]
    s_nop 7
    v_accvgpr_read_b32 v224, a172
    v_accvgpr_read_b32 v225, a173
    v_accvgpr_read_b32 v226, a174
    v_accvgpr_read_b32 v227, a175
    v_cvt_pk_bf16_f32 v228, v220, v221
    v_cvt_pk_bf16_f32 v229, v222, v223
    v_cvt_pk_bf16_f32 v230, v224, v225
    v_cvt_pk_bf16_f32 v231, v226, v227
    buffer_store_dwordx4 v[228:231], v10, s[64:67], s69 offen offset:1024 sc1
    v_accvgpr_read_b32 v208, a176
    v_accvgpr_read_b32 v209, a177
    v_accvgpr_read_b32 v210, a178
    v_accvgpr_read_b32 v211, a179
    v_accvgpr_read_b32 v212, a180
    v_accvgpr_read_b32 v213, a181
    v_accvgpr_read_b32 v214, a182
    v_accvgpr_read_b32 v215, a183
    v_cvt_pk_bf16_f32 v216, v208, v209
    v_cvt_pk_bf16_f32 v217, v210, v211
    v_cvt_pk_bf16_f32 v218, v212, v213
    v_cvt_pk_bf16_f32 v219, v214, v215
    buffer_store_dwordx4 v[216:219], v10, s[64:67], s69 offen offset:2048 sc1
    v_accvgpr_read_b32 v220, a184
    v_accvgpr_read_b32 v221, a185
    v_accvgpr_read_b32 v222, a186
    v_accvgpr_read_b32 v223, a187
    v_accvgpr_read_b32 v224, a188
    v_accvgpr_read_b32 v225, a189
    v_accvgpr_read_b32 v226, a190
    v_accvgpr_read_b32 v227, a191
    v_cvt_pk_bf16_f32 v228, v220, v221
    v_cvt_pk_bf16_f32 v229, v222, v223
    v_cvt_pk_bf16_f32 v230, v224, v225
    v_cvt_pk_bf16_f32 v231, v226, v227
    buffer_store_dwordx4 v[228:231], v10, s[64:67], s69 offen offset:3072 sc1
    s_lshr_b32 s52, s88, 1
    s_lshl_b32 s52, s52, 1
    s_and_b32 s53, s3, 1
    s_add_u32 s52, s52, s53
    s_and_b32 s53, s88, 1
    s_lshl_b32 s53, s53, 1
    s_lshr_b32 s54, s3, 1
    s_add_u32 s53, s53, s54
    s_lshl_b32 s68, s52, 13
    s_lshl_b32 s54, s53, 11
    s_add_u32 s68, s68, s54
    s_lshl_b32 s52, s71, 7
    s_lshr_b32 s54, s88, 1
    s_lshl_b32 s54, s54, 6
    s_add_u32 s52, s52, s54
    s_lshl_b32 s53, s53, 4
    s_add_u32 s52, s52, s53
    s_lshl_b32 s52, s52, 10
    s_add_u32 s52, s52, s89
    s_and_b32 s53, s3, 1
    s_lshl_b32 s53, s53, 7
    s_add_u32 s69, s52, s53
    v_and_b32 v16, 15, v1
    v_lshrrev_b32 v17, 4, v1
    v_lshlrev_b32 v16, 10, v16
    v_lshl_add_u32 v16, v17, 3, v16
    buffer_load_dwordx2 v[20:21], v16, s[80:83], s69 offen offset:0
    buffer_load_dwordx2 v[22:23], v16, s[80:83], s69 offen offset:32
    buffer_load_dwordx2 v[24:25], v16, s[80:83], s69 offen offset:64
    buffer_load_dwordx2 v[26:27], v16, s[80:83], s69 offen offset:96
    s_waitcnt vmcnt(0)
    s_barrier
    s_cmp_eq_u32 s3, 0
    s_cbranch_scc0 KF_sige
    s_mov_b64 s[96:97], exec
    s_mov_b64 exec, 1
    v_mov_b32 v3, 1
    v_mov_b32 v2, 0
    buffer_store_dword v3, v2, s[76:79], s62 offen offset:0 sc1
    s_mov_b64 exec, s[96:97]
KF_sige:
    s_and_b32 s60, s62, 0xffffff80
    s_cmp_eq_u32 s3, 0
    s_cbranch_scc0 KF_pdA
    v_and_b32 v2, 3, v1
    v_lshlrev_b32 v2, 2, v2
    v_add_u32 v2, 16, v2
    s_mov_b32 s97, 0
KF_pd:
    buffer_load_dword v3, v2, s[76:79], s60 offen sc1
    s_waitcnt vmcnt(0)
    s_add_u32 s97, s97, 1
    v_cmp_ne_u32 vcc, 1, v3
    s_nop 4
    s_cbranch_vccz KF_pd_ok
    s_cmp_ge_u32 s97, 20000
    s_cbranch_scc1 KF_pd_ok
    s_sleep 2
    s_branch KF_pd
KF_pd_ok:
KF_pdA:
    s_barrier
    s_add_u32 s52, s68, 32768
    buffer_load_dwordx4 v[160:163], v10, s[64:67], s52 offen offset:0 sc1
    buffer_load_dwordx4 v[164:167], v10, s[64:67], s52 offen offset:1024 sc1
    s_add_u32 s52, s68, 98304
    buffer_load_dwordx4 v[168:171], v10, s[64:67], s52 offen offset:0 sc1
    buffer_load_dwordx4 v[172:175], v10, s[64:67], s52 offen offset:1024 sc1
    s_add_u32 s52, s68, 163840
    buffer_load_dwordx4 v[176:179], v10, s[64:67], s52 offen offset:0 sc1
    buffer_load_dwordx4 v[180:183], v10, s[64:67], s52 offen offset:1024 sc1
    s_add_u32 s52, s68, 229376
    buffer_load_dwordx4 v[184:187], v10, s[64:67], s52 offen offset:0 sc1
    buffer_load_dwordx4 v[188:191], v10, s[64:67], s52 offen offset:1024 sc1
    s_waitcnt vmcnt(0)
    v_lshlrev_b32 v96, 16, v160
    v_and_b32 v97, 0xffff0000, v160
    v_lshlrev_b32 v98, 16, v161
    v_and_b32 v99, 0xffff0000, v161
    v_lshlrev_b32 v100, 16, v162
    v_and_b32 v101, 0xffff0000, v162
    v_lshlrev_b32 v102, 16, v163
    v_and_b32 v103, 0xffff0000, v163
    v_lshlrev_b32 v104, 16, v164
    v_and_b32 v105, 0xffff0000, v164
    v_lshlrev_b32 v106, 16, v165
    v_and_b32 v107, 0xffff0000, v165
    v_lshlrev_b32 v108, 16, v166
    v_and_b32 v109, 0xffff0000, v166
    v_lshlrev_b32 v110, 16, v167
    v_and_b32 v111, 0xffff0000, v167
    v_lshlrev_b32 v112, 16, v168
    v_and_b32 v113, 0xffff0000, v168
    v_lshlrev_b32 v114, 16, v169
    v_and_b32 v115, 0xffff0000, v169
    v_lshlrev_b32 v116, 16, v170
    v_and_b32 v117, 0xffff0000, v170
    v_lshlrev_b32 v118, 16, v171
    v_and_b32 v119, 0xffff0000, v171
    v_lshlrev_b32 v120, 16, v172
    v_and_b32 v121, 0xffff0000, v172
    v_lshlrev_b32 v122, 16, v173
    v_and_b32 v123, 0xffff0000, v173
    v_lshlrev_b32 v124, 16, v174
    v_and_b32 v125, 0xffff0000, v174
    v_lshlrev_b32 v126, 16, v175
    v_and_b32 v127, 0xffff0000, v175
    v_pk_add_f32 v[96:97], v[96:97], v[112:113]
    v_pk_add_f32 v[98:99], v[98:99], v[114:115]
    v_pk_add_f32 v[100:101], v[100:101], v[116:117]
    v_pk_add_f32 v[102:103], v[102:103], v[118:119]
    v_pk_add_f32 v[104:105], v[104:105], v[120:121]
    v_pk_add_f32 v[106:107], v[106:107], v[122:123]
    v_pk_add_f32 v[108:109], v[108:109], v[124:125]
    v_pk_add_f32 v[110:111], v[110:111], v[126:127]
    v_lshlrev_b32 v112, 16, v176
    v_and_b32 v113, 0xffff0000, v176
    v_lshlrev_b32 v114, 16, v177
    v_and_b32 v115, 0xffff0000, v177
    v_lshlrev_b32 v116, 16, v178
    v_and_b32 v117, 0xffff0000, v178
    v_lshlrev_b32 v118, 16, v179
    v_and_b32 v119, 0xffff0000, v179
    v_lshlrev_b32 v120, 16, v180
    v_and_b32 v121, 0xffff0000, v180
    v_lshlrev_b32 v122, 16, v181
    v_and_b32 v123, 0xffff0000, v181
    v_lshlrev_b32 v124, 16, v182
    v_and_b32 v125, 0xffff0000, v182
    v_lshlrev_b32 v126, 16, v183
    v_and_b32 v127, 0xffff0000, v183
    v_pk_add_f32 v[96:97], v[96:97], v[112:113]
    v_pk_add_f32 v[98:99], v[98:99], v[114:115]
    v_pk_add_f32 v[100:101], v[100:101], v[116:117]
    v_pk_add_f32 v[102:103], v[102:103], v[118:119]
    v_pk_add_f32 v[104:105], v[104:105], v[120:121]
    v_pk_add_f32 v[106:107], v[106:107], v[122:123]
    v_pk_add_f32 v[108:109], v[108:109], v[124:125]
    v_pk_add_f32 v[110:111], v[110:111], v[126:127]
    v_lshlrev_b32 v112, 16, v184
    v_and_b32 v113, 0xffff0000, v184
    v_lshlrev_b32 v114, 16, v185
    v_and_b32 v115, 0xffff0000, v185
    v_lshlrev_b32 v116, 16, v186
    v_and_b32 v117, 0xffff0000, v186
    v_lshlrev_b32 v118, 16, v187
    v_and_b32 v119, 0xffff0000, v187
    v_lshlrev_b32 v120, 16, v188
    v_and_b32 v121, 0xffff0000, v188
    v_lshlrev_b32 v122, 16, v189
    v_and_b32 v123, 0xffff0000, v189
    v_lshlrev_b32 v124, 16, v190
    v_and_b32 v125, 0xffff0000, v190
    v_lshlrev_b32 v126, 16, v191
    v_and_b32 v127, 0xffff0000, v191
    v_pk_add_f32 v[96:97], v[96:97], v[112:113]
    v_pk_add_f32 v[98:99], v[98:99], v[114:115]
    v_pk_add_f32 v[100:101], v[100:101], v[116:117]
    v_pk_add_f32 v[102:103], v[102:103], v[118:119]
    v_pk_add_f32 v[104:105], v[104:105], v[120:121]
    v_pk_add_f32 v[106:107], v[106:107], v[122:123]
    v_pk_add_f32 v[108:109], v[108:109], v[124:125]
    v_pk_add_f32 v[110:111], v[110:111], v[126:127]
    v_cvt_pk_bf16_f32 v56, v96, v97
    v_cvt_pk_bf16_f32 v57, v98, v99
    v_cvt_pk_bf16_f32 v58, v100, v101
    v_cvt_pk_bf16_f32 v59, v102, v103
    v_cvt_pk_bf16_f32 v60, v104, v105
    v_cvt_pk_bf16_f32 v61, v106, v107
    v_cvt_pk_bf16_f32 v62, v108, v109
    v_cvt_pk_bf16_f32 v63, v110, v111
    v_lshlrev_b32 v96, 16, v56
    v_and_b32 v97, 0xffff0000, v56
    v_lshlrev_b32 v98, 16, v57
    v_and_b32 v99, 0xffff0000, v57
    v_lshlrev_b32 v100, 16, v58
    v_and_b32 v101, 0xffff0000, v58
    v_lshlrev_b32 v102, 16, v59
    v_and_b32 v103, 0xffff0000, v59
    v_lshlrev_b32 v104, 16, v60
    v_and_b32 v105, 0xffff0000, v60
    v_lshlrev_b32 v106, 16, v61
    v_and_b32 v107, 0xffff0000, v61
    v_lshlrev_b32 v108, 16, v62
    v_and_b32 v109, 0xffff0000, v62
    v_lshlrev_b32 v110, 16, v63
    v_and_b32 v111, 0xffff0000, v63
    s_mov_b32 s52, 0xbfb8aa3b
    v_mul_f32 v64, s52, v96
    v_mul_f32 v65, s52, v97
    v_mul_f32 v66, s52, v98
    v_mul_f32 v67, s52, v99
    v_mul_f32 v68, s52, v100
    v_mul_f32 v69, s52, v101
    v_mul_f32 v70, s52, v102
    v_mul_f32 v71, s52, v103
    v_mul_f32 v72, s52, v104
    v_mul_f32 v73, s52, v105
    v_mul_f32 v74, s52, v106
    v_mul_f32 v75, s52, v107
    v_mul_f32 v76, s52, v108
    v_mul_f32 v77, s52, v109
    v_mul_f32 v78, s52, v110
    v_mul_f32 v79, s52, v111
    v_exp_f32 v64, v64
    v_exp_f32 v65, v65
    v_exp_f32 v66, v66
    v_exp_f32 v67, v67
    v_exp_f32 v68, v68
    v_exp_f32 v69, v69
    v_exp_f32 v70, v70
    v_exp_f32 v71, v71
    v_exp_f32 v72, v72
    v_exp_f32 v73, v73
    v_exp_f32 v74, v74
    v_exp_f32 v75, v75
    v_exp_f32 v76, v76
    v_exp_f32 v77, v77
    v_exp_f32 v78, v78
    v_exp_f32 v79, v79
    v_add_f32 v64, 1.0, v64
    v_add_f32 v65, 1.0, v65
    v_add_f32 v66, 1.0, v66
    v_add_f32 v67, 1.0, v67
    v_add_f32 v68, 1.0, v68
    v_add_f32 v69, 1.0, v69
    v_add_f32 v70, 1.0, v70
    v_add_f32 v71, 1.0, v71
    v_add_f32 v72, 1.0, v72
    v_add_f32 v73, 1.0, v73
    v_add_f32 v74, 1.0, v74
    v_add_f32 v75, 1.0, v75
    v_add_f32 v76, 1.0, v76
    v_add_f32 v77, 1.0, v77
    v_add_f32 v78, 1.0, v78
    v_add_f32 v79, 1.0, v79
    v_rcp_f32 v64, v64
    v_rcp_f32 v65, v65
    v_rcp_f32 v66, v66
    v_rcp_f32 v67, v67
    v_rcp_f32 v68, v68
    v_rcp_f32 v69, v69
    v_rcp_f32 v70, v70
    v_rcp_f32 v71, v71
    v_rcp_f32 v72, v72
    v_rcp_f32 v73, v73
    v_rcp_f32 v74, v74
    v_rcp_f32 v75, v75
    v_rcp_f32 v76, v76
    v_rcp_f32 v77, v77
    v_rcp_f32 v78, v78
    v_rcp_f32 v79, v79
    s_nop 0
    v_pk_mul_f32 v[64:65], v[64:65], v[96:97]
    v_pk_mul_f32 v[66:67], v[66:67], v[98:99]
    v_pk_mul_f32 v[68:69], v[68:69], v[100:101]
    v_pk_mul_f32 v[70:71], v[70:71], v[102:103]
    v_pk_mul_f32 v[72:73], v[72:73], v[104:105]
    v_pk_mul_f32 v[74:75], v[74:75], v[106:107]
    v_pk_mul_f32 v[76:77], v[76:77], v[108:109]
    v_pk_mul_f32 v[78:79], v[78:79], v[110:111]
    v_cvt_pk_bf16_f32 v56, v64, v65
    v_cvt_pk_bf16_f32 v57, v66, v67
    v_cvt_pk_bf16_f32 v58, v68, v69
    v_cvt_pk_bf16_f32 v59, v70, v71
    v_cvt_pk_bf16_f32 v60, v72, v73
    v_cvt_pk_bf16_f32 v61, v74, v75
    v_cvt_pk_bf16_f32 v62, v76, v77
    v_cvt_pk_bf16_f32 v63, v78, v79
    v_lshlrev_b32 v64, 16, v56
    v_and_b32 v65, 0xffff0000, v56
    v_lshlrev_b32 v66, 16, v57
    v_and_b32 v67, 0xffff0000, v57
    v_lshlrev_b32 v68, 16, v58
    v_and_b32 v69, 0xffff0000, v58
    v_lshlrev_b32 v70, 16, v59
    v_and_b32 v71, 0xffff0000, v59
    v_lshlrev_b32 v72, 16, v60
    v_and_b32 v73, 0xffff0000, v60
    v_lshlrev_b32 v74, 16, v61
    v_and_b32 v75, 0xffff0000, v61
    v_lshlrev_b32 v76, 16, v62
    v_and_b32 v77, 0xffff0000, v62
    v_lshlrev_b32 v78, 16, v63
    v_and_b32 v79, 0xffff0000, v63
    v_lshlrev_b32 v96, 16, v20
    v_and_b32 v97, 0xffff0000, v20
    v_lshlrev_b32 v98, 16, v21
    v_and_b32 v99, 0xffff0000, v21
    v_lshlrev_b32 v100, 16, v22
    v_and_b32 v101, 0xffff0000, v22
    v_lshlrev_b32 v102, 16, v23
    v_and_b32 v103, 0xffff0000, v23
    v_lshlrev_b32 v104, 16, v24
    v_and_b32 v105, 0xffff0000, v24
    v_lshlrev_b32 v106, 16, v25
    v_and_b32 v107, 0xffff0000, v25
    v_lshlrev_b32 v108, 16, v26
    v_and_b32 v109, 0xffff0000, v26
    v_lshlrev_b32 v110, 16, v27
    v_and_b32 v111, 0xffff0000, v27
    s_cmp_eq_u32 s3, 0
    s_cbranch_scc0 KF_peA
    v_and_b32 v2, 3, v1
    v_lshlrev_b32 v2, 2, v2
    s_mov_b32 s97, 0
KF_pe:
    buffer_load_dword v3, v2, s[76:79], s60 offen sc1
    s_waitcnt vmcnt(0)
    s_add_u32 s97, s97, 1
    v_cmp_ne_u32 vcc, 1, v3
    s_nop 4
    s_cbranch_vccz KF_pe_ok
    s_cmp_ge_u32 s97, 20000
    s_cbranch_scc1 KF_pe_ok
    s_sleep 2
    s_branch KF_pe
KF_pe_ok:
KF_peA:
    s_barrier
    s_add_u32 s52, s68, 0
    buffer_load_dwordx4 v[128:131], v10, s[64:67], s52 offen offset:0 sc1
    buffer_load_dwordx4 v[132:135], v10, s[64:67], s52 offen offset:1024 sc1
    s_add_u32 s52, s68, 65536
    buffer_load_dwordx4 v[136:139], v10, s[64:67], s52 offen offset:0 sc1
    buffer_load_dwordx4 v[140:143], v10, s[64:67], s52 offen offset:1024 sc1
    s_add_u32 s52, s68, 131072
    buffer_load_dwordx4 v[144:147], v10, s[64:67], s52 offen offset:0 sc1
    buffer_load_dwordx4 v[148:151], v10, s[64:67], s52 offen offset:1024 sc1
    s_add_u32 s52, s68, 196608
    buffer_load_dwordx4 v[152:155], v10, s[64:67], s52 offen offset:0 sc1
    buffer_load_dwordx4 v[156:159], v10, s[64:67], s52 offen offset:1024 sc1
    s_waitcnt vmcnt(0)
    v_lshlrev_b32 v32, 16, v128
    v_and_b32 v33, 0xffff0000, v128
    v_lshlrev_b32 v34, 16, v129
    v_and_b32 v35, 0xffff0000, v129
    v_lshlrev_b32 v36, 16, v130
    v_and_b32 v37, 0xffff0000, v130
    v_lshlrev_b32 v38, 16, v131
    v_and_b32 v39, 0xffff0000, v131
    v_lshlrev_b32 v40, 16, v132
    v_and_b32 v41, 0xffff0000, v132
    v_lshlrev_b32 v42, 16, v133
    v_and_b32 v43, 0xffff0000, v133
    v_lshlrev_b32 v44, 16, v134
    v_and_b32 v45, 0xffff0000, v134
    v_lshlrev_b32 v46, 16, v135
    v_and_b32 v47, 0xffff0000, v135
    v_lshlrev_b32 v48, 16, v136
    v_and_b32 v49, 0xffff0000, v136
    v_lshlrev_b32 v50, 16, v137
    v_and_b32 v51, 0xffff0000, v137
    v_lshlrev_b32 v52, 16, v138
    v_and_b32 v53, 0xffff0000, v138
    v_lshlrev_b32 v54, 16, v139
    v_and_b32 v55, 0xffff0000, v139
    v_lshlrev_b32 v56, 16, v140
    v_and_b32 v57, 0xffff0000, v140
    v_lshlrev_b32 v58, 16, v141
    v_and_b32 v59, 0xffff0000, v141
    v_lshlrev_b32 v60, 16, v142
    v_and_b32 v61, 0xffff0000, v142
    v_lshlrev_b32 v62, 16, v143
    v_and_b32 v63, 0xffff0000, v143
    v_pk_add_f32 v[32:33], v[32:33], v[48:49]
    v_pk_add_f32 v[34:35], v[34:35], v[50:51]
    v_pk_add_f32 v[36:37], v[36:37], v[52:53]
    v_pk_add_f32 v[38:39], v[38:39], v[54:55]
    v_pk_add_f32 v[40:41], v[40:41], v[56:57]
    v_pk_add_f32 v[42:43], v[42:43], v[58:59]
    v_pk_add_f32 v[44:45], v[44:45], v[60:61]
    v_pk_add_f32 v[46:47], v[46:47], v[62:63]
    v_lshlrev_b32 v48, 16, v144
    v_and_b32 v49, 0xffff0000, v144
    v_lshlrev_b32 v50, 16, v145
    v_and_b32 v51, 0xffff0000, v145
    v_lshlrev_b32 v52, 16, v146
    v_and_b32 v53, 0xffff0000, v146
    v_lshlrev_b32 v54, 16, v147
    v_and_b32 v55, 0xffff0000, v147
    v_lshlrev_b32 v56, 16, v148
    v_and_b32 v57, 0xffff0000, v148
    v_lshlrev_b32 v58, 16, v149
    v_and_b32 v59, 0xffff0000, v149
    v_lshlrev_b32 v60, 16, v150
    v_and_b32 v61, 0xffff0000, v150
    v_lshlrev_b32 v62, 16, v151
    v_and_b32 v63, 0xffff0000, v151
    v_pk_add_f32 v[32:33], v[32:33], v[48:49]
    v_pk_add_f32 v[34:35], v[34:35], v[50:51]
    v_pk_add_f32 v[36:37], v[36:37], v[52:53]
    v_pk_add_f32 v[38:39], v[38:39], v[54:55]
    v_pk_add_f32 v[40:41], v[40:41], v[56:57]
    v_pk_add_f32 v[42:43], v[42:43], v[58:59]
    v_pk_add_f32 v[44:45], v[44:45], v[60:61]
    v_pk_add_f32 v[46:47], v[46:47], v[62:63]
    v_lshlrev_b32 v48, 16, v152
    v_and_b32 v49, 0xffff0000, v152
    v_lshlrev_b32 v50, 16, v153
    v_and_b32 v51, 0xffff0000, v153
    v_lshlrev_b32 v52, 16, v154
    v_and_b32 v53, 0xffff0000, v154
    v_lshlrev_b32 v54, 16, v155
    v_and_b32 v55, 0xffff0000, v155
    v_lshlrev_b32 v56, 16, v156
    v_and_b32 v57, 0xffff0000, v156
    v_lshlrev_b32 v58, 16, v157
    v_and_b32 v59, 0xffff0000, v157
    v_lshlrev_b32 v60, 16, v158
    v_and_b32 v61, 0xffff0000, v158
    v_lshlrev_b32 v62, 16, v159
    v_and_b32 v63, 0xffff0000, v159
    v_pk_add_f32 v[32:33], v[32:33], v[48:49]
    v_pk_add_f32 v[34:35], v[34:35], v[50:51]
    v_pk_add_f32 v[36:37], v[36:37], v[52:53]
    v_pk_add_f32 v[38:39], v[38:39], v[54:55]
    v_pk_add_f32 v[40:41], v[40:41], v[56:57]
    v_pk_add_f32 v[42:43], v[42:43], v[58:59]
    v_pk_add_f32 v[44:45], v[44:45], v[60:61]
    v_pk_add_f32 v[46:47], v[46:47], v[62:63]
    v_cvt_pk_bf16_f32 v48, v32, v33
    v_cvt_pk_bf16_f32 v49, v34, v35
    v_cvt_pk_bf16_f32 v50, v36, v37
    v_cvt_pk_bf16_f32 v51, v38, v39
    v_cvt_pk_bf16_f32 v52, v40, v41
    v_cvt_pk_bf16_f32 v53, v42, v43
    v_cvt_pk_bf16_f32 v54, v44, v45
    v_cvt_pk_bf16_f32 v55, v46, v47
    v_lshlrev_b32 v32, 16, v48
    v_and_b32 v33, 0xffff0000, v48
    v_lshlrev_b32 v34, 16, v49
    v_and_b32 v35, 0xffff0000, v49
    v_lshlrev_b32 v36, 16, v50
    v_and_b32 v37, 0xffff0000, v50
    v_lshlrev_b32 v38, 16, v51
    v_and_b32 v39, 0xffff0000, v51
    v_lshlrev_b32 v40, 16, v52
    v_and_b32 v41, 0xffff0000, v52
    v_lshlrev_b32 v42, 16, v53
    v_and_b32 v43, 0xffff0000, v53
    v_lshlrev_b32 v44, 16, v54
    v_and_b32 v45, 0xffff0000, v54
    v_lshlrev_b32 v46, 16, v55
    v_and_b32 v47, 0xffff0000, v55
    v_pk_mul_f32 v[64:65], v[64:65], v[32:33]
    v_pk_mul_f32 v[66:67], v[66:67], v[34:35]
    v_pk_mul_f32 v[68:69], v[68:69], v[36:37]
    v_pk_mul_f32 v[70:71], v[70:71], v[38:39]
    v_pk_mul_f32 v[72:73], v[72:73], v[40:41]
    v_pk_mul_f32 v[74:75], v[74:75], v[42:43]
    v_pk_mul_f32 v[76:77], v[76:77], v[44:45]
    v_pk_mul_f32 v[78:79], v[78:79], v[46:47]
    v_cvt_pk_bf16_f32 v56, v64, v65
    v_cvt_pk_bf16_f32 v57, v66, v67
    v_cvt_pk_bf16_f32 v58, v68, v69
    v_cvt_pk_bf16_f32 v59, v70, v71
    v_cvt_pk_bf16_f32 v60, v72, v73
    v_cvt_pk_bf16_f32 v61, v74, v75
    v_cvt_pk_bf16_f32 v62, v76, v77
    v_cvt_pk_bf16_f32 v63, v78, v79
    v_lshlrev_b32 v64, 16, v56
    v_and_b32 v65, 0xffff0000, v56
    v_lshlrev_b32 v66, 16, v57
    v_and_b32 v67, 0xffff0000, v57
    v_lshlrev_b32 v68, 16, v58
    v_and_b32 v69, 0xffff0000, v58
    v_lshlrev_b32 v70, 16, v59
    v_and_b32 v71, 0xffff0000, v59
    v_lshlrev_b32 v72, 16, v60
    v_and_b32 v73, 0xffff0000, v60
    v_lshlrev_b32 v74, 16, v61
    v_and_b32 v75, 0xffff0000, v61
    v_lshlrev_b32 v76, 16, v62
    v_and_b32 v77, 0xffff0000, v62
    v_lshlrev_b32 v78, 16, v63
    v_and_b32 v79, 0xffff0000, v63
    v_pk_add_f32 v[64:65], v[64:65], v[96:97]
    v_pk_add_f32 v[66:67], v[66:67], v[98:99]
    v_pk_add_f32 v[68:69], v[68:69], v[100:101]
    v_pk_add_f32 v[70:71], v[70:71], v[102:103]
    v_pk_add_f32 v[72:73], v[72:73], v[104:105]
    v_pk_add_f32 v[74:75], v[74:75], v[106:107]
    v_pk_add_f32 v[76:77], v[76:77], v[108:109]
    v_pk_add_f32 v[78:79], v[78:79], v[110:111]
    v_cvt_pk_bf16_f32 v56, v64, v65
    v_cvt_pk_bf16_f32 v57, v66, v67
    v_cvt_pk_bf16_f32 v58, v68, v69
    v_cvt_pk_bf16_f32 v59, v70, v71
    v_cvt_pk_bf16_f32 v60, v72, v73
    v_cvt_pk_bf16_f32 v61, v74, v75
    v_cvt_pk_bf16_f32 v62, v76, v77
    v_cvt_pk_bf16_f32 v63, v78, v79
    buffer_store_dwordx2 v[56:57], v16, s[84:87], s69 offen offset:0 nt
    buffer_store_dwordx2 v[58:59], v16, s[84:87], s69 offen offset:32 nt
    buffer_store_dwordx2 v[60:61], v16, s[84:87], s69 offen offset:64 nt
    buffer_store_dwordx2 v[62:63], v16, s[84:87], s69 offen offset:96 nt
KF_end:
    s_endpgm
KF_codeend:
.section .rodata,"a"
.p2align 6
.amdhsa_kernel recurrent_scan__mha_block_cached__glu_gated_reglu__prompt_kernel
  .amdhsa_next_free_vgpr 512
  .amdhsa_next_free_sgpr 102
  .amdhsa_accum_offset 256
  .amdhsa_group_segment_fixed_size 0
  .amdhsa_kernarg_size 96
  .amdhsa_user_sgpr_count 2
  .amdhsa_user_sgpr_kernarg_segment_ptr 1
  .amdhsa_system_sgpr_workgroup_id_x 1
.end_amdhsa_kernel
```
